```python
import torch

def _softmax(x, axis=-1):
    return torch.softmax(x, dim=axis)

def _gelu(x):
    return torch.nn.functional.gelu(x, approximate='tanh')

def _silu(x):
    return torch.nn.functional.silu(x)

def _sigmoid(x):
    return torch.sigmoid(x)

def _layernorm(x, axis=-1, eps=1e-05):
    m = x.mean(dim=axis, keepdim=True)
    v = x.var(dim=axis, keepdim=True, unbiased=False)
    return (x - m) / torch.sqrt(v + eps)

def _scatter_add(tgt, idx, src, axis=0):
    return tgt.clone().index_add_(axis, idx, src)

def _segment_sum(src, seg, n):
    out = torch.zeros((n,) + src.shape[1:], dtype=src.dtype)
    return out.index_add_(0, seg, src)

def _pad(x, pw):
    flat = tuple((v for pair in reversed(pw) for v in pair))
    return torch.nn.functional.pad(x, flat)
kernel_name = 'interleave_layers__memory_aug_recurrent_mem_tr__dense_activation_silu__prompt'

def setup_inputs():

    _w = lambda a: (lambda t: t.to(torch.bfloat16) if t.is_floating_point() else t)(torch.as_tensor(a))

    def _A_setup():
        B, S, Dm = (1, 2048, 512)
        H, Dh = (32, 128)
        M, seg = (8, 32)
        seg = min(seg, S)
        S = S // seg * seg
        return {'x': _w((lambda *s: torch.randn(*s, dtype=torch.bfloat16) * 0.05)(B, S, Dm)), 'mem0': _w((lambda *s: torch.randn(*s, dtype=torch.bfloat16) * 0.2)(B, M, Dm)), 'Wq': _w((lambda *s: torch.randn(*s, dtype=torch.bfloat16) * 1.6)(Dm, H, Dh) * Dm ** (-0.5)), 'Wk': _w((lambda *s: torch.randn(*s, dtype=torch.bfloat16) * 1.6)(Dm, H, Dh) * Dm ** (-0.5)), 'Wv': _w((lambda *s: torch.randn(*s, dtype=torch.bfloat16) * 0.2)(Dm, H, Dh) * Dm ** (-0.5)), 'Wo': _w((lambda *s: torch.randn(*s, dtype=torch.bfloat16) * 0.2)(H, Dh, Dm) * (H * Dh) ** (-0.5)), 'seg_len': seg}
    _A_in = _A_setup()

    def _B_setup():
        B, S, D, F = (1, 2048, 512, 1376)
        return {'x': _w((lambda *s: torch.randn(*s, dtype=torch.bfloat16) * 0.05)(B, S, D)), 'w1': _w((lambda *s: torch.randn(*s, dtype=torch.bfloat16) * 0.4)(D, F) * D ** (-0.5)), 'w2': _w((lambda *s: torch.randn(*s, dtype=torch.bfloat16) * 0.1)(F, D) * F ** (-0.5))}
    _B_in = _B_setup()
    return {'A_x': _A_in['x'], 'A_mem0': _A_in['mem0'], 'A_Wq': _A_in['Wq'], 'A_Wk': _A_in['Wk'], 'A_Wv': _A_in['Wv'], 'A_Wo': _A_in['Wo'], 'A_seg_len': _A_in['seg_len'], 'B_x': _B_in['x'], 'B_w1': _B_in['w1'], 'B_w2': _B_in['w2']}

def reference(A_x, A_mem0, A_Wq, A_Wk, A_Wv, A_Wo, A_seg_len, B_x, B_w1, B_w2):

    def _A_ref(x, mem0, Wq, Wk, Wv, Wo, seg_len):
        B, S, Dm = x.shape
        H, Dh = (Wq.shape[1], Wq.shape[2])
        M = mem0.shape[1]
        scale = Dh ** (-0.5)
        n_seg = S // seg_len
        L = M + seg_len
        idx = torch.arange(L)
        mask = (idx[:, None] < M) | (idx[:, None] >= idx[None, :])
        mem = mem0
        outs = []
        for s in range(n_seg):
            xs = x[:, s * seg_len:(s + 1) * seg_len, :].clone()
            h = torch.concatenate([mem, xs], axis=1)
            q = torch.einsum('btd,dhe->bhte', h, Wq)
            k = torch.einsum('btd,dhe->bhte', h, Wk)
            v = torch.einsum('btd,dhe->bhte', h, Wv)
            scores = torch.einsum('bhqe,bhke->bhqk', q, k) * scale
            scores = torch.where(mask[None, None], scores, -1000000000.0)
            p = _softmax(scores, axis=-1)
            o = torch.einsum('bhqk,bhke->bhqe', p, v)
            o = torch.einsum('bhte,hed->btd', o, Wo)
            mem = o[:, :M, :].clone()
            outs.append(o[:, M:, :])
        return torch.concatenate(outs, axis=1)

    def _B_ref(x, w1, w2):
        h = torch.einsum('bsd,df->bsf', x, w1)
        h = _silu(h)
        out = torch.einsum('bsf,fd->bsd', h, w2)
        return out
    x = A_x
    x = x + _A_ref(_layernorm(x, axis=-1), A_mem0, A_Wq, A_Wk, A_Wv, A_Wo, A_seg_len)
    x = x + _B_ref(_layernorm(x, axis=-1), B_w1, B_w2)
    x = x + _A_ref(_layernorm(x, axis=-1), A_mem0, A_Wq, A_Wk, A_Wv, A_Wo, A_seg_len)
    x = x + _B_ref(_layernorm(x, axis=-1), B_w1, B_w2)
    return x
```

```asm
; @launch kernel=interleave_layers__memory_aug_recurrent_mem_tr__dense_activation_silu__prompt_kernel grid=(256,1,1) block=(256,1,1) lds=163840
.amdgcn_target "amdgcn-amd-amdhsa--gfx950"
.text
.globl interleave_layers__memory_aug_recurrent_mem_tr__dense_activation_silu__prompt_kernel
.p2align 8
.type interleave_layers__memory_aug_recurrent_mem_tr__dense_activation_silu__prompt_kernel,@function
interleave_layers__memory_aug_recurrent_mem_tr__dense_activation_silu__prompt_kernel:
    s_cmp_ge_u32 s2, 256
    s_cbranch_scc1 M_exit
    s_load_dwordx2 s[20:21], s[0:1], 0
    s_load_dwordx2 s[22:23], s[0:1], 80
    s_load_dwordx2 s[24:25], s[0:1], 96
    s_load_dwordx8 s[80:87], s[0:1], 16
    s_load_dwordx4 s[88:91], s[0:1], 64
    s_load_dwordx2 s[92:93], s[0:1], 8
    s_load_dwordx2 s[94:95], s[0:1], 88
    v_and_b32 v1, 63, v0
    v_min_u32 v2, 1, v1
    v_lshlrev_b32 v2, 30, v2
    v_lshlrev_b32 v1, 4, v1
    v_mov_b32 v3, 1
    v_and_b32 v5, 15, v0
    v_bfe_u32 v6, v0, 4, 2
    v_lshrrev_b32 v4, 6, v0
    s_waitcnt lgkmcnt(0)
    s_mov_b32 s8, s24
    s_and_b32 s9, s25, 0xffff
    s_mov_b32 s10, 0x10000000
    s_mov_b32 s11, 0x20000
    s_mov_b32 s12, s20
    s_and_b32 s13, s21, 0xffff
    s_mov_b32 s14, 0x200000
    s_mov_b32 s15, 0x20000
    s_mov_b32 s16, s22
    s_and_b32 s17, s23, 0xffff
    s_mov_b32 s18, 0x200000
    s_mov_b32 s19, 0x20000
    s_mov_b32 s4, s94
    s_and_b32 s5, s95, 0xffff
    s_mov_b32 s6, 0x100
    s_mov_b32 s7, 0x20000
    v_readfirstlane_b32 s20, v4
    s_lshr_b32 s21, s2, 3
    s_and_b32 s22, s2, 7
    s_mov_b32 s30, 2097152
    s_mov_b32 s31, 0x3e0293ee
    s_cmp_lt_u32 s22, 2
    s_cbranch_scc1 R_C
    s_cmp_lt_u32 s22, 5
    s_cbranch_scc1 R_A
    s_cmp_lt_u32 s22, 7
    s_cbranch_scc1 R_B
    s_branch R_F
R_C:
    s_mov_b32 s23, s22
    s_mov_b32 s24, 0
    s_mov_b32 s48, 0
    s_mov_b32 s49, 0
    s_getreg_b32 s25, hwreg(HW_REG_XCC_ID, 0, 4)
    s_and_b32 s75, s25, 3
    s_lshl_b32 s75, s75, 3
    s_and_b32 s25, s25, 4
    s_lshl_b32 s76, s23, 3
    s_add_u32 s76, s76, s25
    s_add_u32 s76, s76, 64
    s_lshl_b32 s25, 1, s75
    v_mov_b32 v4, s25
    s_cmp_lg_u32 s20, 0
    s_cbranch_scc1 L_ga_1
    buffer_atomic_add v4, v2, s[4:7], s76 offen sc1
L_ga_1:
    s_cmp_eq_u32 s23, 0
    s_cbranch_scc1 C_ld
    s_waitcnt vmcnt(0)
    s_cmp_lg_u32 s20, 0
    s_cbranch_scc1 L_ia_2
    v_mov_b32 v4, 1
    buffer_atomic_add v4, v2, s[4:7], 0 offen offset:0 sc1
L_ia_2:
    s_cmp_lg_u32 s20, 0
    s_cbranch_scc1 L_wd_4
L_w_3:
    buffer_load_dword v4, v2, s[4:7], 0 offen offset:224 sc1
    s_waitcnt vmcnt(0)
    v_readfirstlane_b32 s34, v4
    s_nop 0
    s_cmp_ge_u32 s34, 32
    s_cbranch_scc1 L_wd_4
    s_sleep 2
    s_sub_u32 s30, s30, 1
    s_cbranch_scc0 L_w_3
    s_branch M_done
L_wd_4:
    s_barrier
C_ld:
    s_lshl_b32 s28, s20, 15
    s_lshl_b32 s29, s20, 13
    s_add_u32 s29, s29, 131072
    v_and_b32 v29, 3, v0
    v_bfe_u32 v30, v0, 2, 2
    v_bfe_u32 v31, v0, 2, 4
    v_lshl_add_u32 v32, v6, 3, v30
    v_lshlrev_b32 v33, 8, v32
    v_lshl_add_u32 v33, v29, 3, v33
    v_xor_b32 v34, s20, v30
    v_lshl_add_u32 v33, v34, 6, v33
    s_xor_b32 s27, s20, 0
    s_lshl_b32 s26, s27, 15
    v_add_u32 v40, s26, v33
    s_lshl_b32 s26, s27, 13
    s_add_u32 s26, s26, 131072
    v_add_u32 v44, s26, v33
    s_xor_b32 s27, s20, 1
    s_lshl_b32 s26, s27, 15
    v_add_u32 v41, s26, v33
    s_lshl_b32 s26, s27, 13
    s_add_u32 s26, s26, 131072
    v_add_u32 v45, s26, v33
    s_xor_b32 s27, s20, 2
    s_lshl_b32 s26, s27, 15
    v_add_u32 v42, s26, v33
    s_lshl_b32 s26, s27, 13
    s_add_u32 s26, s26, 131072
    v_add_u32 v46, s26, v33
    s_xor_b32 s27, s20, 3
    s_lshl_b32 s26, s27, 15
    v_add_u32 v43, s26, v33
    s_lshl_b32 s26, s27, 13
    s_add_u32 s26, s26, 131072
    v_add_u32 v47, s26, v33
    v_lshlrev_b32 v33, 7, v32
    v_lshl_add_u32 v33, v29, 3, v33
    v_add_u32 v35, s28, v33
    v_add_u32 v36, s29, v33
    v_bfe_u32 v33, v0, 3, 3
    v_mul_u32_u24 v34, 2752, v33
    v_and_b32 v33, 7, v0
    v_lshl_add_u32 v34, v33, 4, v34
    v_cmp_gt_u32 vcc, 6, v33
    v_mov_b32 v33, 0x40000000
    s_nop 0
    v_cndmask_b32 v34, v33, v34, vcc
    v_lshlrev_b32 v19, 2, v6
    v_xor_b32 v19, v19, v5
    v_lshlrev_b32 v19, 4, v19
    v_lshl_add_u32 v16, v6, 13, v19
    v_lshl_add_u32 v19, v6, 10, v19
    v_lshlrev_b32 v32, 8, v31
    v_lshl_add_u32 v32, v29, 4, v32
    v_xor_b32 v33, 0, v30
    v_lshl_add_u32 v33, v33, 6, v32
    v_add_u32 v20, s28, v33
    v_add_u32 v24, s29, v33
    v_xor_b32 v33, 1, v30
    v_lshl_add_u32 v33, v33, 6, v32
    v_add_u32 v21, s28, v33
    v_add_u32 v25, s29, v33
    v_xor_b32 v33, 2, v30
    v_lshl_add_u32 v33, v33, 6, v32
    v_add_u32 v22, s28, v33
    v_add_u32 v26, s29, v33
    v_xor_b32 v33, 3, v30
    v_lshl_add_u32 v33, v33, 6, v32
    v_add_u32 v23, s28, v33
    v_add_u32 v27, s29, v33
    v_add_u32 v13, s28, v1
    s_mov_b32 s96, s80
    s_and_b32 s97, s81, 0xffff
    s_mov_b32 s98, 0x400000
    s_mov_b32 s99, 0x20000
    s_mov_b32 s26, 4294934528
    s_mul_i32 s35, s21, 256
    s_add_u32 s26, s26, s35
    s_mul_i32 s35, s20, 1048576
    s_add_u32 s26, s26, s35
    s_add_u32 m0, s28, 24576
    s_add_u32 s26, s26, 32768
    buffer_load_dwordx4 v16, s[96:99], s26 offen lds
    s_add_u32 m0, s28, 25600
    s_add_u32 s26, s26, 32768
    buffer_load_dwordx4 v16, s[96:99], s26 offen lds
    s_add_u32 m0, s28, 26624
    s_add_u32 s26, s26, 32768
    buffer_load_dwordx4 v16, s[96:99], s26 offen lds
    s_add_u32 m0, s28, 27648
    s_add_u32 s26, s26, 32768
    buffer_load_dwordx4 v16, s[96:99], s26 offen lds
    s_add_u32 m0, s28, 28672
    s_add_u32 s26, s26, 32768
    buffer_load_dwordx4 v16, s[96:99], s26 offen lds
    s_add_u32 m0, s28, 29696
    s_add_u32 s26, s26, 32768
    buffer_load_dwordx4 v16, s[96:99], s26 offen lds
    s_add_u32 m0, s28, 30720
    s_add_u32 s26, s26, 32768
    buffer_load_dwordx4 v16, s[96:99], s26 offen lds
    s_add_u32 m0, s28, 31744
    s_add_u32 s26, s26, 32768
    buffer_load_dwordx4 v16, s[96:99], s26 offen lds
    s_add_u32 m0, s29, 0
    s_add_u32 s26, s26, 32768
    buffer_load_dwordx4 v16, s[96:99], s26 offen lds
    s_add_u32 m0, s29, 1024
    s_add_u32 s26, s26, 32768
    buffer_load_dwordx4 v16, s[96:99], s26 offen lds
    s_add_u32 m0, s29, 2048
    s_add_u32 s26, s26, 32768
    buffer_load_dwordx4 v16, s[96:99], s26 offen lds
    s_add_u32 m0, s29, 3072
    s_add_u32 s26, s26, 32768
    buffer_load_dwordx4 v16, s[96:99], s26 offen lds
    s_add_u32 m0, s29, 4096
    s_add_u32 s26, s26, 32768
    buffer_load_dwordx4 v16, s[96:99], s26 offen lds
    s_add_u32 m0, s29, 5120
    s_add_u32 s26, s26, 32768
    buffer_load_dwordx4 v16, s[96:99], s26 offen lds
    s_add_u32 m0, s29, 6144
    s_add_u32 s26, s26, 32768
    buffer_load_dwordx4 v16, s[96:99], s26 offen lds
    s_add_u32 m0, s29, 7168
    s_add_u32 s26, s26, 32768
    buffer_load_dwordx4 v16, s[96:99], s26 offen lds
    s_add_u32 m0, s28, 0
    s_add_u32 s26, s26, 32768
    buffer_load_dwordx4 v16, s[96:99], s26 offen lds
    s_add_u32 m0, s28, 1024
    s_add_u32 s26, s26, 32768
    buffer_load_dwordx4 v16, s[96:99], s26 offen lds
    s_add_u32 m0, s28, 2048
    s_add_u32 s26, s26, 32768
    buffer_load_dwordx4 v16, s[96:99], s26 offen lds
    s_add_u32 m0, s28, 3072
    s_add_u32 s26, s26, 32768
    buffer_load_dwordx4 v16, s[96:99], s26 offen lds
    s_add_u32 m0, s28, 4096
    s_add_u32 s26, s26, 32768
    buffer_load_dwordx4 v16, s[96:99], s26 offen lds
    s_add_u32 m0, s28, 5120
    s_add_u32 s26, s26, 32768
    buffer_load_dwordx4 v16, s[96:99], s26 offen lds
    s_add_u32 m0, s28, 6144
    s_add_u32 s26, s26, 32768
    buffer_load_dwordx4 v16, s[96:99], s26 offen lds
    s_add_u32 m0, s28, 7168
    s_add_u32 s26, s26, 32768
    buffer_load_dwordx4 v16, s[96:99], s26 offen lds
    s_add_u32 m0, s28, 8192
    s_add_u32 s26, s26, 32768
    buffer_load_dwordx4 v16, s[96:99], s26 offen lds
    s_add_u32 m0, s28, 9216
    s_add_u32 s26, s26, 32768
    buffer_load_dwordx4 v16, s[96:99], s26 offen lds
    s_add_u32 m0, s28, 10240
    s_add_u32 s26, s26, 32768
    buffer_load_dwordx4 v16, s[96:99], s26 offen lds
    s_add_u32 m0, s28, 11264
    s_add_u32 s26, s26, 32768
    buffer_load_dwordx4 v16, s[96:99], s26 offen lds
    s_add_u32 m0, s28, 12288
    s_add_u32 s26, s26, 32768
    buffer_load_dwordx4 v16, s[96:99], s26 offen lds
    s_add_u32 m0, s28, 13312
    s_add_u32 s26, s26, 32768
    buffer_load_dwordx4 v16, s[96:99], s26 offen lds
    s_add_u32 m0, s28, 14336
    s_add_u32 s26, s26, 32768
    buffer_load_dwordx4 v16, s[96:99], s26 offen lds
    s_add_u32 m0, s28, 15360
    s_add_u32 s26, s26, 32768
    buffer_load_dwordx4 v16, s[96:99], s26 offen lds
    s_waitcnt vmcnt(24)
    s_barrier
    s_cmp_lg_u32 s23, 0
    s_cbranch_scc1 C_ld2
    s_cmp_lg_u32 s20, 0
    s_cbranch_scc1 L_ia_5
    v_mov_b32 v4, 1
    buffer_atomic_add v4, v2, s[4:7], 0 offen offset:0 sc1
L_ia_5:
C_ld2:
    s_mov_b32 s96, s82
    s_and_b32 s97, s83, 0xffff
    s_mov_b32 s98, 0x400000
    s_mov_b32 s99, 0x20000
    s_mov_b32 s26, 4294934528
    s_mul_i32 s35, s21, 256
    s_add_u32 s26, s26, s35
    s_mul_i32 s35, s20, 1048576
    s_add_u32 s26, s26, s35
    s_add_u32 m0, s28, 16384
    s_add_u32 s26, s26, 32768
    buffer_load_dwordx4 v16, s[96:99], s26 offen lds
    s_add_u32 m0, s28, 17408
    s_add_u32 s26, s26, 32768
    buffer_load_dwordx4 v16, s[96:99], s26 offen lds
    s_add_u32 m0, s28, 18432
    s_add_u32 s26, s26, 32768
    buffer_load_dwordx4 v16, s[96:99], s26 offen lds
    s_add_u32 m0, s28, 19456
    s_add_u32 s26, s26, 32768
    buffer_load_dwordx4 v16, s[96:99], s26 offen lds
    s_add_u32 m0, s28, 20480
    s_add_u32 s26, s26, 32768
    buffer_load_dwordx4 v16, s[96:99], s26 offen lds
    s_add_u32 m0, s28, 21504
    s_add_u32 s26, s26, 32768
    buffer_load_dwordx4 v16, s[96:99], s26 offen lds
    s_add_u32 m0, s28, 22528
    s_add_u32 s26, s26, 32768
    buffer_load_dwordx4 v16, s[96:99], s26 offen lds
    s_add_u32 m0, s28, 23552
    s_add_u32 s26, s26, 32768
    buffer_load_dwordx4 v16, s[96:99], s26 offen lds
    ds_read_b64_tr_b16 a[0:1], v40 offset:24576
    ds_read_b64_tr_b16 a[2:3], v40 offset:25600
    ds_read_b64_tr_b16 a[64:65], v40 offset:24608
    ds_read_b64_tr_b16 a[66:67], v40 offset:25632
    ds_read_b64_tr_b16 a[16:17], v41 offset:24576
    ds_read_b64_tr_b16 a[18:19], v41 offset:25600
    ds_read_b64_tr_b16 a[80:81], v41 offset:24608
    ds_read_b64_tr_b16 a[82:83], v41 offset:25632
    ds_read_b64_tr_b16 a[32:33], v42 offset:24576
    ds_read_b64_tr_b16 a[34:35], v42 offset:25600
    ds_read_b64_tr_b16 a[96:97], v42 offset:24608
    ds_read_b64_tr_b16 a[98:99], v42 offset:25632
    ds_read_b64_tr_b16 a[48:49], v43 offset:24576
    ds_read_b64_tr_b16 a[50:51], v43 offset:25600
    ds_read_b64_tr_b16 a[112:113], v43 offset:24608
    ds_read_b64_tr_b16 a[114:115], v43 offset:25632
    s_waitcnt lgkmcnt(0)
    s_waitcnt vmcnt(24)
    s_barrier
    s_add_u32 m0, s28, 24576
    s_add_u32 s26, s26, 32768
    buffer_load_dwordx4 v16, s[96:99], s26 offen lds
    s_add_u32 m0, s28, 25600
    s_add_u32 s26, s26, 32768
    buffer_load_dwordx4 v16, s[96:99], s26 offen lds
    s_add_u32 m0, s28, 26624
    s_add_u32 s26, s26, 32768
    buffer_load_dwordx4 v16, s[96:99], s26 offen lds
    s_add_u32 m0, s28, 27648
    s_add_u32 s26, s26, 32768
    buffer_load_dwordx4 v16, s[96:99], s26 offen lds
    s_add_u32 m0, s28, 28672
    s_add_u32 s26, s26, 32768
    buffer_load_dwordx4 v16, s[96:99], s26 offen lds
    s_add_u32 m0, s28, 29696
    s_add_u32 s26, s26, 32768
    buffer_load_dwordx4 v16, s[96:99], s26 offen lds
    s_add_u32 m0, s28, 30720
    s_add_u32 s26, s26, 32768
    buffer_load_dwordx4 v16, s[96:99], s26 offen lds
    s_add_u32 m0, s28, 31744
    s_add_u32 s26, s26, 32768
    buffer_load_dwordx4 v16, s[96:99], s26 offen lds
    ds_read_b64_tr_b16 a[4:5], v44 offset:0
    ds_read_b64_tr_b16 a[6:7], v44 offset:1024
    ds_read_b64_tr_b16 a[68:69], v44 offset:32
    ds_read_b64_tr_b16 a[70:71], v44 offset:1056
    ds_read_b64_tr_b16 a[20:21], v45 offset:0
    ds_read_b64_tr_b16 a[22:23], v45 offset:1024
    ds_read_b64_tr_b16 a[84:85], v45 offset:32
    ds_read_b64_tr_b16 a[86:87], v45 offset:1056
    ds_read_b64_tr_b16 a[36:37], v46 offset:0
    ds_read_b64_tr_b16 a[38:39], v46 offset:1024
    ds_read_b64_tr_b16 a[100:101], v46 offset:32
    ds_read_b64_tr_b16 a[102:103], v46 offset:1056
    ds_read_b64_tr_b16 a[52:53], v47 offset:0
    ds_read_b64_tr_b16 a[54:55], v47 offset:1024
    ds_read_b64_tr_b16 a[116:117], v47 offset:32
    ds_read_b64_tr_b16 a[118:119], v47 offset:1056
    s_waitcnt lgkmcnt(0)
    s_waitcnt vmcnt(24)
    s_barrier
    s_add_u32 m0, s29, 0
    s_add_u32 s26, s26, 32768
    buffer_load_dwordx4 v16, s[96:99], s26 offen lds
    s_add_u32 m0, s29, 1024
    s_add_u32 s26, s26, 32768
    buffer_load_dwordx4 v16, s[96:99], s26 offen lds
    s_add_u32 m0, s29, 2048
    s_add_u32 s26, s26, 32768
    buffer_load_dwordx4 v16, s[96:99], s26 offen lds
    s_add_u32 m0, s29, 3072
    s_add_u32 s26, s26, 32768
    buffer_load_dwordx4 v16, s[96:99], s26 offen lds
    s_add_u32 m0, s29, 4096
    s_add_u32 s26, s26, 32768
    buffer_load_dwordx4 v16, s[96:99], s26 offen lds
    s_add_u32 m0, s29, 5120
    s_add_u32 s26, s26, 32768
    buffer_load_dwordx4 v16, s[96:99], s26 offen lds
    s_add_u32 m0, s29, 6144
    s_add_u32 s26, s26, 32768
    buffer_load_dwordx4 v16, s[96:99], s26 offen lds
    s_add_u32 m0, s29, 7168
    s_add_u32 s26, s26, 32768
    buffer_load_dwordx4 v16, s[96:99], s26 offen lds
    ds_read_b64_tr_b16 a[8:9], v40 offset:0
    ds_read_b64_tr_b16 a[10:11], v40 offset:1024
    ds_read_b64_tr_b16 a[72:73], v40 offset:32
    ds_read_b64_tr_b16 a[74:75], v40 offset:1056
    ds_read_b64_tr_b16 a[24:25], v41 offset:0
    ds_read_b64_tr_b16 a[26:27], v41 offset:1024
    ds_read_b64_tr_b16 a[88:89], v41 offset:32
    ds_read_b64_tr_b16 a[90:91], v41 offset:1056
    ds_read_b64_tr_b16 a[40:41], v42 offset:0
    ds_read_b64_tr_b16 a[42:43], v42 offset:1024
    ds_read_b64_tr_b16 a[104:105], v42 offset:32
    ds_read_b64_tr_b16 a[106:107], v42 offset:1056
    ds_read_b64_tr_b16 a[56:57], v43 offset:0
    ds_read_b64_tr_b16 a[58:59], v43 offset:1024
    ds_read_b64_tr_b16 a[120:121], v43 offset:32
    ds_read_b64_tr_b16 a[122:123], v43 offset:1056
    s_waitcnt lgkmcnt(0)
    s_waitcnt vmcnt(24)
    s_barrier
    s_add_u32 m0, s28, 0
    s_add_u32 s26, s26, 32768
    buffer_load_dwordx4 v16, s[96:99], s26 offen lds
    s_add_u32 m0, s28, 1024
    s_add_u32 s26, s26, 32768
    buffer_load_dwordx4 v16, s[96:99], s26 offen lds
    s_add_u32 m0, s28, 2048
    s_add_u32 s26, s26, 32768
    buffer_load_dwordx4 v16, s[96:99], s26 offen lds
    s_add_u32 m0, s28, 3072
    s_add_u32 s26, s26, 32768
    buffer_load_dwordx4 v16, s[96:99], s26 offen lds
    s_add_u32 m0, s28, 4096
    s_add_u32 s26, s26, 32768
    buffer_load_dwordx4 v16, s[96:99], s26 offen lds
    s_add_u32 m0, s28, 5120
    s_add_u32 s26, s26, 32768
    buffer_load_dwordx4 v16, s[96:99], s26 offen lds
    s_add_u32 m0, s28, 6144
    s_add_u32 s26, s26, 32768
    buffer_load_dwordx4 v16, s[96:99], s26 offen lds
    s_add_u32 m0, s28, 7168
    s_add_u32 s26, s26, 32768
    buffer_load_dwordx4 v16, s[96:99], s26 offen lds
    ds_read_b64_tr_b16 a[12:13], v40 offset:8192
    ds_read_b64_tr_b16 a[14:15], v40 offset:9216
    ds_read_b64_tr_b16 a[76:77], v40 offset:8224
    ds_read_b64_tr_b16 a[78:79], v40 offset:9248
    ds_read_b64_tr_b16 a[28:29], v41 offset:8192
    ds_read_b64_tr_b16 a[30:31], v41 offset:9216
    ds_read_b64_tr_b16 a[92:93], v41 offset:8224
    ds_read_b64_tr_b16 a[94:95], v41 offset:9248
    ds_read_b64_tr_b16 a[44:45], v42 offset:8192
    ds_read_b64_tr_b16 a[46:47], v42 offset:9216
    ds_read_b64_tr_b16 a[108:109], v42 offset:8224
    ds_read_b64_tr_b16 a[110:111], v42 offset:9248
    ds_read_b64_tr_b16 a[60:61], v43 offset:8192
    ds_read_b64_tr_b16 a[62:63], v43 offset:9216
    ds_read_b64_tr_b16 a[124:125], v43 offset:8224
    ds_read_b64_tr_b16 a[126:127], v43 offset:9248
    s_waitcnt lgkmcnt(0)
    s_waitcnt vmcnt(24)
    s_barrier
    s_mov_b32 s96, s84
    s_and_b32 s97, s85, 0xffff
    s_mov_b32 s98, 0x400000
    s_mov_b32 s99, 0x20000
    s_mov_b32 s26, 4294934528
    s_mul_i32 s35, s21, 256
    s_add_u32 s26, s26, s35
    s_mul_i32 s35, s20, 1048576
    s_add_u32 s26, s26, s35
    s_add_u32 m0, s28, 8192
    s_add_u32 s26, s26, 32768
    buffer_load_dwordx4 v16, s[96:99], s26 offen lds
    s_add_u32 m0, s28, 9216
    s_add_u32 s26, s26, 32768
    buffer_load_dwordx4 v16, s[96:99], s26 offen lds
    s_add_u32 m0, s28, 10240
    s_add_u32 s26, s26, 32768
    buffer_load_dwordx4 v16, s[96:99], s26 offen lds
    s_add_u32 m0, s28, 11264
    s_add_u32 s26, s26, 32768
    buffer_load_dwordx4 v16, s[96:99], s26 offen lds
    s_add_u32 m0, s28, 12288
    s_add_u32 s26, s26, 32768
    buffer_load_dwordx4 v16, s[96:99], s26 offen lds
    s_add_u32 m0, s28, 13312
    s_add_u32 s26, s26, 32768
    buffer_load_dwordx4 v16, s[96:99], s26 offen lds
    s_add_u32 m0, s28, 14336
    s_add_u32 s26, s26, 32768
    buffer_load_dwordx4 v16, s[96:99], s26 offen lds
    s_add_u32 m0, s28, 15360
    s_add_u32 s26, s26, 32768
    buffer_load_dwordx4 v16, s[96:99], s26 offen lds
    ds_read_b64_tr_b16 a[128:129], v40 offset:16384
    ds_read_b64_tr_b16 a[130:131], v40 offset:17408
    ds_read_b64_tr_b16 a[192:193], v40 offset:16416
    ds_read_b64_tr_b16 a[194:195], v40 offset:17440
    ds_read_b64_tr_b16 a[144:145], v41 offset:16384
    ds_read_b64_tr_b16 a[146:147], v41 offset:17408
    ds_read_b64_tr_b16 a[208:209], v41 offset:16416
    ds_read_b64_tr_b16 a[210:211], v41 offset:17440
    ds_read_b64_tr_b16 a[160:161], v42 offset:16384
    ds_read_b64_tr_b16 a[162:163], v42 offset:17408
    ds_read_b64_tr_b16 a[224:225], v42 offset:16416
    ds_read_b64_tr_b16 a[226:227], v42 offset:17440
    ds_read_b64_tr_b16 a[176:177], v43 offset:16384
    ds_read_b64_tr_b16 a[178:179], v43 offset:17408
    ds_read_b64_tr_b16 a[240:241], v43 offset:16416
    ds_read_b64_tr_b16 a[242:243], v43 offset:17440
    s_waitcnt lgkmcnt(0)
    s_waitcnt vmcnt(24)
    s_barrier
    s_add_u32 m0, s28, 16384
    s_add_u32 s26, s26, 32768
    buffer_load_dwordx4 v16, s[96:99], s26 offen lds
    s_add_u32 m0, s28, 17408
    s_add_u32 s26, s26, 32768
    buffer_load_dwordx4 v16, s[96:99], s26 offen lds
    s_add_u32 m0, s28, 18432
    s_add_u32 s26, s26, 32768
    buffer_load_dwordx4 v16, s[96:99], s26 offen lds
    s_add_u32 m0, s28, 19456
    s_add_u32 s26, s26, 32768
    buffer_load_dwordx4 v16, s[96:99], s26 offen lds
    s_add_u32 m0, s28, 20480
    s_add_u32 s26, s26, 32768
    buffer_load_dwordx4 v16, s[96:99], s26 offen lds
    s_add_u32 m0, s28, 21504
    s_add_u32 s26, s26, 32768
    buffer_load_dwordx4 v16, s[96:99], s26 offen lds
    s_add_u32 m0, s28, 22528
    s_add_u32 s26, s26, 32768
    buffer_load_dwordx4 v16, s[96:99], s26 offen lds
    s_add_u32 m0, s28, 23552
    s_add_u32 s26, s26, 32768
    buffer_load_dwordx4 v16, s[96:99], s26 offen lds
    ds_read_b64_tr_b16 a[132:133], v40 offset:24576
    ds_read_b64_tr_b16 a[134:135], v40 offset:25600
    ds_read_b64_tr_b16 a[196:197], v40 offset:24608
    ds_read_b64_tr_b16 a[198:199], v40 offset:25632
    ds_read_b64_tr_b16 a[148:149], v41 offset:24576
    ds_read_b64_tr_b16 a[150:151], v41 offset:25600
    ds_read_b64_tr_b16 a[212:213], v41 offset:24608
    ds_read_b64_tr_b16 a[214:215], v41 offset:25632
    ds_read_b64_tr_b16 a[164:165], v42 offset:24576
    ds_read_b64_tr_b16 a[166:167], v42 offset:25600
    ds_read_b64_tr_b16 a[228:229], v42 offset:24608
    ds_read_b64_tr_b16 a[230:231], v42 offset:25632
    ds_read_b64_tr_b16 a[180:181], v43 offset:24576
    ds_read_b64_tr_b16 a[182:183], v43 offset:25600
    ds_read_b64_tr_b16 a[244:245], v43 offset:24608
    ds_read_b64_tr_b16 a[246:247], v43 offset:25632
    s_waitcnt lgkmcnt(0)
    s_waitcnt vmcnt(24)
    s_barrier
    s_add_u32 m0, s28, 24576
    s_add_u32 s26, s26, 32768
    buffer_load_dwordx4 v16, s[96:99], s26 offen lds
    s_add_u32 m0, s28, 25600
    s_add_u32 s26, s26, 32768
    buffer_load_dwordx4 v16, s[96:99], s26 offen lds
    s_add_u32 m0, s28, 26624
    s_add_u32 s26, s26, 32768
    buffer_load_dwordx4 v16, s[96:99], s26 offen lds
    s_add_u32 m0, s28, 27648
    s_add_u32 s26, s26, 32768
    buffer_load_dwordx4 v16, s[96:99], s26 offen lds
    s_add_u32 m0, s28, 28672
    s_add_u32 s26, s26, 32768
    buffer_load_dwordx4 v16, s[96:99], s26 offen lds
    s_add_u32 m0, s28, 29696
    s_add_u32 s26, s26, 32768
    buffer_load_dwordx4 v16, s[96:99], s26 offen lds
    s_add_u32 m0, s28, 30720
    s_add_u32 s26, s26, 32768
    buffer_load_dwordx4 v16, s[96:99], s26 offen lds
    s_add_u32 m0, s28, 31744
    s_add_u32 s26, s26, 32768
    buffer_load_dwordx4 v16, s[96:99], s26 offen lds
    ds_read_b64_tr_b16 a[136:137], v44 offset:0
    ds_read_b64_tr_b16 a[138:139], v44 offset:1024
    ds_read_b64_tr_b16 a[200:201], v44 offset:32
    ds_read_b64_tr_b16 a[202:203], v44 offset:1056
    ds_read_b64_tr_b16 a[152:153], v45 offset:0
    ds_read_b64_tr_b16 a[154:155], v45 offset:1024
    ds_read_b64_tr_b16 a[216:217], v45 offset:32
    ds_read_b64_tr_b16 a[218:219], v45 offset:1056
    ds_read_b64_tr_b16 a[168:169], v46 offset:0
    ds_read_b64_tr_b16 a[170:171], v46 offset:1024
    ds_read_b64_tr_b16 a[232:233], v46 offset:32
    ds_read_b64_tr_b16 a[234:235], v46 offset:1056
    ds_read_b64_tr_b16 a[184:185], v47 offset:0
    ds_read_b64_tr_b16 a[186:187], v47 offset:1024
    ds_read_b64_tr_b16 a[248:249], v47 offset:32
    ds_read_b64_tr_b16 a[250:251], v47 offset:1056
    s_waitcnt lgkmcnt(0)
    s_waitcnt vmcnt(24)
    s_barrier
    s_add_u32 m0, s29, 0
    s_add_u32 s26, s26, 32768
    buffer_load_dwordx4 v16, s[96:99], s26 offen lds
    s_add_u32 m0, s29, 1024
    s_add_u32 s26, s26, 32768
    buffer_load_dwordx4 v16, s[96:99], s26 offen lds
    s_add_u32 m0, s29, 2048
    s_add_u32 s26, s26, 32768
    buffer_load_dwordx4 v16, s[96:99], s26 offen lds
    s_add_u32 m0, s29, 3072
    s_add_u32 s26, s26, 32768
    buffer_load_dwordx4 v16, s[96:99], s26 offen lds
    s_add_u32 m0, s29, 4096
    s_add_u32 s26, s26, 32768
    buffer_load_dwordx4 v16, s[96:99], s26 offen lds
    s_add_u32 m0, s29, 5120
    s_add_u32 s26, s26, 32768
    buffer_load_dwordx4 v16, s[96:99], s26 offen lds
    s_add_u32 m0, s29, 6144
    s_add_u32 s26, s26, 32768
    buffer_load_dwordx4 v16, s[96:99], s26 offen lds
    s_add_u32 m0, s29, 7168
    s_add_u32 s26, s26, 32768
    buffer_load_dwordx4 v16, s[96:99], s26 offen lds
    ds_read_b64_tr_b16 a[140:141], v40 offset:0
    ds_read_b64_tr_b16 a[142:143], v40 offset:1024
    ds_read_b64_tr_b16 a[204:205], v40 offset:32
    ds_read_b64_tr_b16 a[206:207], v40 offset:1056
    ds_read_b64_tr_b16 a[156:157], v41 offset:0
    ds_read_b64_tr_b16 a[158:159], v41 offset:1024
    ds_read_b64_tr_b16 a[220:221], v41 offset:32
    ds_read_b64_tr_b16 a[222:223], v41 offset:1056
    ds_read_b64_tr_b16 a[172:173], v42 offset:0
    ds_read_b64_tr_b16 a[174:175], v42 offset:1024
    ds_read_b64_tr_b16 a[236:237], v42 offset:32
    ds_read_b64_tr_b16 a[238:239], v42 offset:1056
    ds_read_b64_tr_b16 a[188:189], v43 offset:0
    ds_read_b64_tr_b16 a[190:191], v43 offset:1024
    ds_read_b64_tr_b16 a[252:253], v43 offset:32
    ds_read_b64_tr_b16 a[254:255], v43 offset:1056
    s_waitcnt lgkmcnt(0)
    s_waitcnt vmcnt(24)
    s_barrier
    s_mov_b32 s96, s86
    s_and_b32 s97, s87, 0xffff
    s_mov_b32 s98, 0x400000
    s_mov_b32 s99, 0x20000
    s_mov_b32 s26, 4294963200
    s_mul_i32 s35, s21, 131072
    s_add_u32 s26, s26, s35
    s_mul_i32 s35, s20, 256
    s_add_u32 s26, s26, s35
    s_add_u32 m0, s28, 0
    s_add_u32 s26, s26, 4096
    buffer_load_dwordx4 v19, s[96:99], s26 offen lds
    s_add_u32 m0, s28, 1024
    s_add_u32 s26, s26, 4096
    buffer_load_dwordx4 v19, s[96:99], s26 offen lds
    s_add_u32 m0, s28, 2048
    s_add_u32 s26, s26, 4096
    buffer_load_dwordx4 v19, s[96:99], s26 offen lds
    s_add_u32 m0, s28, 3072
    s_add_u32 s26, s26, 4096
    buffer_load_dwordx4 v19, s[96:99], s26 offen lds
    s_add_u32 m0, s28, 4096
    s_add_u32 s26, s26, 4096
    buffer_load_dwordx4 v19, s[96:99], s26 offen lds
    s_add_u32 m0, s28, 5120
    s_add_u32 s26, s26, 4096
    buffer_load_dwordx4 v19, s[96:99], s26 offen lds
    s_add_u32 m0, s28, 6144
    s_add_u32 s26, s26, 4096
    buffer_load_dwordx4 v19, s[96:99], s26 offen lds
    s_add_u32 m0, s28, 7168
    s_add_u32 s26, s26, 4096
    buffer_load_dwordx4 v19, s[96:99], s26 offen lds
    ds_read_b64_tr_b16 v[128:129], v40 offset:8192
    ds_read_b64_tr_b16 v[130:131], v40 offset:9216
    ds_read_b64_tr_b16 v[192:193], v40 offset:8224
    ds_read_b64_tr_b16 v[194:195], v40 offset:9248
    ds_read_b64_tr_b16 v[144:145], v41 offset:8192
    ds_read_b64_tr_b16 v[146:147], v41 offset:9216
    ds_read_b64_tr_b16 v[208:209], v41 offset:8224
    ds_read_b64_tr_b16 v[210:211], v41 offset:9248
    ds_read_b64_tr_b16 v[160:161], v42 offset:8192
    ds_read_b64_tr_b16 v[162:163], v42 offset:9216
    ds_read_b64_tr_b16 v[224:225], v42 offset:8224
    ds_read_b64_tr_b16 v[226:227], v42 offset:9248
    ds_read_b64_tr_b16 v[176:177], v43 offset:8192
    ds_read_b64_tr_b16 v[178:179], v43 offset:9216
    ds_read_b64_tr_b16 v[240:241], v43 offset:8224
    ds_read_b64_tr_b16 v[242:243], v43 offset:9248
    s_waitcnt lgkmcnt(0)
    s_waitcnt vmcnt(24)
    s_barrier
    s_add_u32 m0, s28, 8192
    s_add_u32 s26, s26, 4096
    buffer_load_dwordx4 v19, s[96:99], s26 offen lds
    s_add_u32 m0, s28, 9216
    s_add_u32 s26, s26, 4096
    buffer_load_dwordx4 v19, s[96:99], s26 offen lds
    s_add_u32 m0, s28, 10240
    s_add_u32 s26, s26, 4096
    buffer_load_dwordx4 v19, s[96:99], s26 offen lds
    s_add_u32 m0, s28, 11264
    s_add_u32 s26, s26, 4096
    buffer_load_dwordx4 v19, s[96:99], s26 offen lds
    s_add_u32 m0, s28, 12288
    s_add_u32 s26, s26, 4096
    buffer_load_dwordx4 v19, s[96:99], s26 offen lds
    s_add_u32 m0, s28, 13312
    s_add_u32 s26, s26, 4096
    buffer_load_dwordx4 v19, s[96:99], s26 offen lds
    s_add_u32 m0, s28, 14336
    s_add_u32 s26, s26, 4096
    buffer_load_dwordx4 v19, s[96:99], s26 offen lds
    s_add_u32 m0, s28, 15360
    s_add_u32 s26, s26, 4096
    buffer_load_dwordx4 v19, s[96:99], s26 offen lds
    ds_read_b64_tr_b16 v[132:133], v40 offset:16384
    ds_read_b64_tr_b16 v[134:135], v40 offset:17408
    ds_read_b64_tr_b16 v[196:197], v40 offset:16416
    ds_read_b64_tr_b16 v[198:199], v40 offset:17440
    ds_read_b64_tr_b16 v[148:149], v41 offset:16384
    ds_read_b64_tr_b16 v[150:151], v41 offset:17408
    ds_read_b64_tr_b16 v[212:213], v41 offset:16416
    ds_read_b64_tr_b16 v[214:215], v41 offset:17440
    ds_read_b64_tr_b16 v[164:165], v42 offset:16384
    ds_read_b64_tr_b16 v[166:167], v42 offset:17408
    ds_read_b64_tr_b16 v[228:229], v42 offset:16416
    ds_read_b64_tr_b16 v[230:231], v42 offset:17440
    ds_read_b64_tr_b16 v[180:181], v43 offset:16384
    ds_read_b64_tr_b16 v[182:183], v43 offset:17408
    ds_read_b64_tr_b16 v[244:245], v43 offset:16416
    ds_read_b64_tr_b16 v[246:247], v43 offset:17440
    s_waitcnt lgkmcnt(0)
    s_waitcnt vmcnt(24)
    s_barrier
    buffer_load_dword v37, v2, s[4:7], 0 offen sc1
    s_add_u32 m0, s28, 16384
    s_add_u32 s26, s26, 4096
    buffer_load_dwordx4 v19, s[96:99], s26 offen lds
    s_add_u32 m0, s28, 17408
    s_add_u32 s26, s26, 4096
    buffer_load_dwordx4 v19, s[96:99], s26 offen lds
    s_add_u32 m0, s28, 18432
    s_add_u32 s26, s26, 4096
    buffer_load_dwordx4 v19, s[96:99], s26 offen lds
    s_add_u32 m0, s28, 19456
    s_add_u32 s26, s26, 4096
    buffer_load_dwordx4 v19, s[96:99], s26 offen lds
    s_add_u32 m0, s28, 20480
    s_add_u32 s26, s26, 4096
    buffer_load_dwordx4 v19, s[96:99], s26 offen lds
    s_add_u32 m0, s28, 21504
    s_add_u32 s26, s26, 4096
    buffer_load_dwordx4 v19, s[96:99], s26 offen lds
    s_add_u32 m0, s28, 22528
    s_add_u32 s26, s26, 4096
    buffer_load_dwordx4 v19, s[96:99], s26 offen lds
    s_add_u32 m0, s28, 23552
    s_add_u32 s26, s26, 4096
    buffer_load_dwordx4 v19, s[96:99], s26 offen lds
    ds_read_b64_tr_b16 v[136:137], v40 offset:24576
    ds_read_b64_tr_b16 v[138:139], v40 offset:25600
    ds_read_b64_tr_b16 v[200:201], v40 offset:24608
    ds_read_b64_tr_b16 v[202:203], v40 offset:25632
    ds_read_b64_tr_b16 v[152:153], v41 offset:24576
    ds_read_b64_tr_b16 v[154:155], v41 offset:25600
    ds_read_b64_tr_b16 v[216:217], v41 offset:24608
    ds_read_b64_tr_b16 v[218:219], v41 offset:25632
    ds_read_b64_tr_b16 v[168:169], v42 offset:24576
    ds_read_b64_tr_b16 v[170:171], v42 offset:25600
    ds_read_b64_tr_b16 v[232:233], v42 offset:24608
    ds_read_b64_tr_b16 v[234:235], v42 offset:25632
    ds_read_b64_tr_b16 v[184:185], v43 offset:24576
    ds_read_b64_tr_b16 v[186:187], v43 offset:25600
    ds_read_b64_tr_b16 v[248:249], v43 offset:24608
    ds_read_b64_tr_b16 v[250:251], v43 offset:25632
    s_waitcnt lgkmcnt(0)
    s_waitcnt vmcnt(24)
    s_barrier
    s_add_u32 m0, s28, 24576
    s_add_u32 s26, s26, 4096
    buffer_load_dwordx4 v19, s[96:99], s26 offen lds
    s_add_u32 m0, s28, 25600
    s_add_u32 s26, s26, 4096
    buffer_load_dwordx4 v19, s[96:99], s26 offen lds
    s_add_u32 m0, s28, 26624
    s_add_u32 s26, s26, 4096
    buffer_load_dwordx4 v19, s[96:99], s26 offen lds
    s_add_u32 m0, s28, 27648
    s_add_u32 s26, s26, 4096
    buffer_load_dwordx4 v19, s[96:99], s26 offen lds
    s_add_u32 m0, s28, 28672
    s_add_u32 s26, s26, 4096
    buffer_load_dwordx4 v19, s[96:99], s26 offen lds
    s_add_u32 m0, s28, 29696
    s_add_u32 s26, s26, 4096
    buffer_load_dwordx4 v19, s[96:99], s26 offen lds
    s_add_u32 m0, s28, 30720
    s_add_u32 s26, s26, 4096
    buffer_load_dwordx4 v19, s[96:99], s26 offen lds
    s_add_u32 m0, s28, 31744
    s_add_u32 s26, s26, 4096
    buffer_load_dwordx4 v19, s[96:99], s26 offen lds
    ds_read_b64_tr_b16 v[140:141], v44 offset:0
    ds_read_b64_tr_b16 v[142:143], v44 offset:1024
    ds_read_b64_tr_b16 v[204:205], v44 offset:32
    ds_read_b64_tr_b16 v[206:207], v44 offset:1056
    ds_read_b64_tr_b16 v[156:157], v45 offset:0
    ds_read_b64_tr_b16 v[158:159], v45 offset:1024
    ds_read_b64_tr_b16 v[220:221], v45 offset:32
    ds_read_b64_tr_b16 v[222:223], v45 offset:1056
    ds_read_b64_tr_b16 v[172:173], v46 offset:0
    ds_read_b64_tr_b16 v[174:175], v46 offset:1024
    ds_read_b64_tr_b16 v[236:237], v46 offset:32
    ds_read_b64_tr_b16 v[238:239], v46 offset:1056
    ds_read_b64_tr_b16 v[188:189], v47 offset:0
    ds_read_b64_tr_b16 v[190:191], v47 offset:1024
    ds_read_b64_tr_b16 v[252:253], v47 offset:32
    ds_read_b64_tr_b16 v[254:255], v47 offset:1056
    s_waitcnt lgkmcnt(0)
    s_waitcnt vmcnt(24)
    s_barrier
    ds_read_b64_tr_b16 v[64:65], v20 offset:0
    ds_read_b64_tr_b16 v[66:67], v20 offset:4096
    ds_read_b64_tr_b16 v[68:69], v20 offset:8
    ds_read_b64_tr_b16 v[70:71], v20 offset:4104
    ds_read_b64_tr_b16 v[72:73], v21 offset:0
    ds_read_b64_tr_b16 v[74:75], v21 offset:4096
    ds_read_b64_tr_b16 v[76:77], v21 offset:8
    ds_read_b64_tr_b16 v[78:79], v21 offset:4104
    ds_read_b64_tr_b16 v[80:81], v22 offset:0
    ds_read_b64_tr_b16 v[82:83], v22 offset:4096
    ds_read_b64_tr_b16 v[84:85], v22 offset:8
    ds_read_b64_tr_b16 v[86:87], v22 offset:4104
    ds_read_b64_tr_b16 v[88:89], v23 offset:0
    ds_read_b64_tr_b16 v[90:91], v23 offset:4096
    ds_read_b64_tr_b16 v[92:93], v23 offset:8
    ds_read_b64_tr_b16 v[94:95], v23 offset:4104
    s_waitcnt lgkmcnt(0)
    ds_write_b128 v13, v[64:67] offset:0
    ds_write_b128 v13, v[68:71] offset:1024
    ds_write_b128 v13, v[72:75] offset:2048
    ds_write_b128 v13, v[76:79] offset:3072
    ds_write_b128 v13, v[80:83] offset:4096
    ds_write_b128 v13, v[84:87] offset:5120
    ds_write_b128 v13, v[88:91] offset:6144
    ds_write_b128 v13, v[92:95] offset:7168
    s_waitcnt vmcnt(16)
    ds_read_b64_tr_b16 v[64:65], v20 offset:8192
    ds_read_b64_tr_b16 v[66:67], v20 offset:12288
    ds_read_b64_tr_b16 v[68:69], v20 offset:8200
    ds_read_b64_tr_b16 v[70:71], v20 offset:12296
    ds_read_b64_tr_b16 v[72:73], v21 offset:8192
    ds_read_b64_tr_b16 v[74:75], v21 offset:12288
    ds_read_b64_tr_b16 v[76:77], v21 offset:8200
    ds_read_b64_tr_b16 v[78:79], v21 offset:12296
    ds_read_b64_tr_b16 v[80:81], v22 offset:8192
    ds_read_b64_tr_b16 v[82:83], v22 offset:12288
    ds_read_b64_tr_b16 v[84:85], v22 offset:8200
    ds_read_b64_tr_b16 v[86:87], v22 offset:12296
    ds_read_b64_tr_b16 v[88:89], v23 offset:8192
    ds_read_b64_tr_b16 v[90:91], v23 offset:12288
    ds_read_b64_tr_b16 v[92:93], v23 offset:8200
    ds_read_b64_tr_b16 v[94:95], v23 offset:12296
    s_waitcnt lgkmcnt(0)
    ds_write_b128 v13, v[64:67] offset:8192
    ds_write_b128 v13, v[68:71] offset:9216
    ds_write_b128 v13, v[72:75] offset:10240
    ds_write_b128 v13, v[76:79] offset:11264
    ds_write_b128 v13, v[80:83] offset:12288
    ds_write_b128 v13, v[84:87] offset:13312
    ds_write_b128 v13, v[88:91] offset:14336
    ds_write_b128 v13, v[92:95] offset:15360
    s_waitcnt vmcnt(8)
    v_readfirstlane_b32 s33, v37
    buffer_load_dword v38, v2, s[4:7], s76 offen sc1
    ds_read_b64_tr_b16 v[64:65], v20 offset:16384
    ds_read_b64_tr_b16 v[66:67], v20 offset:20480
    ds_read_b64_tr_b16 v[68:69], v20 offset:16392
    ds_read_b64_tr_b16 v[70:71], v20 offset:20488
    ds_read_b64_tr_b16 v[72:73], v21 offset:16384
    ds_read_b64_tr_b16 v[74:75], v21 offset:20480
    ds_read_b64_tr_b16 v[76:77], v21 offset:16392
    ds_read_b64_tr_b16 v[78:79], v21 offset:20488
    ds_read_b64_tr_b16 v[80:81], v22 offset:16384
    ds_read_b64_tr_b16 v[82:83], v22 offset:20480
    ds_read_b64_tr_b16 v[84:85], v22 offset:16392
    ds_read_b64_tr_b16 v[86:87], v22 offset:20488
    ds_read_b64_tr_b16 v[88:89], v23 offset:16384
    ds_read_b64_tr_b16 v[90:91], v23 offset:20480
    ds_read_b64_tr_b16 v[92:93], v23 offset:16392
    ds_read_b64_tr_b16 v[94:95], v23 offset:20488
    s_waitcnt lgkmcnt(0)
    ds_write_b128 v13, v[64:67] offset:16384
    ds_write_b128 v13, v[68:71] offset:17408
    ds_write_b128 v13, v[72:75] offset:18432
    ds_write_b128 v13, v[76:79] offset:19456
    ds_write_b128 v13, v[80:83] offset:20480
    ds_write_b128 v13, v[84:87] offset:21504
    ds_write_b128 v13, v[88:91] offset:22528
    ds_write_b128 v13, v[92:95] offset:23552
    s_waitcnt vmcnt(0)
    ds_read_b64_tr_b16 v[64:65], v20 offset:24576
    ds_read_b64_tr_b16 v[66:67], v20 offset:28672
    ds_read_b64_tr_b16 v[68:69], v20 offset:24584
    ds_read_b64_tr_b16 v[70:71], v20 offset:28680
    ds_read_b64_tr_b16 v[72:73], v21 offset:24576
    ds_read_b64_tr_b16 v[74:75], v21 offset:28672
    ds_read_b64_tr_b16 v[76:77], v21 offset:24584
    ds_read_b64_tr_b16 v[78:79], v21 offset:28680
    ds_read_b64_tr_b16 v[80:81], v22 offset:24576
    ds_read_b64_tr_b16 v[82:83], v22 offset:28672
    ds_read_b64_tr_b16 v[84:85], v22 offset:24584
    ds_read_b64_tr_b16 v[86:87], v22 offset:28680
    ds_read_b64_tr_b16 v[88:89], v23 offset:24576
    ds_read_b64_tr_b16 v[90:91], v23 offset:28672
    ds_read_b64_tr_b16 v[92:93], v23 offset:24584
    ds_read_b64_tr_b16 v[94:95], v23 offset:28680
    s_waitcnt lgkmcnt(0)
    ds_write_b128 v13, v[64:67] offset:24576
    ds_write_b128 v13, v[68:71] offset:25600
    ds_write_b128 v13, v[72:75] offset:26624
    ds_write_b128 v13, v[76:79] offset:27648
    ds_write_b128 v13, v[80:83] offset:28672
    ds_write_b128 v13, v[84:87] offset:29696
    ds_write_b128 v13, v[88:91] offset:30720
    ds_write_b128 v13, v[92:95] offset:31744
    s_cmp_lg_u32 s23, 0
    s_cbranch_scc1 C_ld3
    s_cmp_lg_u32 s20, 0
    s_cbranch_scc1 L_ia_6
    v_mov_b32 v4, 1
    buffer_atomic_add v4, v2, s[4:7], 0 offen offset:224 sc1
L_ia_6:
C_ld3:
    s_waitcnt lgkmcnt(0)
    s_cmp_ge_u32 s33, 160
    s_cbranch_scc1 C_in
L_ci_7:
    s_sleep 2
    buffer_load_dword v4, v2, s[4:7], 0 offen sc1
    s_sub_u32 s30, s30, 1
    s_cbranch_scc1 M_done
    s_waitcnt vmcnt(0)
    v_readfirstlane_b32 s33, v4
    s_nop 0
    s_cmp_lt_u32 s33, 160
    s_cbranch_scc1 L_ci_7
    buffer_load_dword v38, v2, s[4:7], s76 offen sc1
    s_waitcnt vmcnt(0)
C_in:
    v_readfirstlane_b32 s76, v38
    s_nop 0
    s_lshr_b32 s76, s76, s75
    s_and_b32 s76, s76, 255
    v_and_b32 v16, 7, v5
    v_lshrrev_b32 v17, 3, v5
    v_lshrrev_b32 v18, 1, v16
    v_and_b32 v21, 1, v5
    v_add_u32 v8, 131072, v1
    s_lshl_b32 s67, s20, 11
    s_lshl_b32 s79, s20, 12
    s_add_u32 s79, s79, 147456
    v_add_u32 v73, s67, v8
    v_lshlrev_b32 v7, 4, v21
    v_mov_b32 v20, 0x3f80
    v_lshlrev_b32 v7, v7, v20
    v_cmp_eq_u32 s[40:41], 0, v18
    v_cmp_eq_u32 s[42:43], 1, v18
    v_cmp_eq_u32 s[44:45], 2, v18
    v_cmp_eq_u32 s[46:47], 3, v18
    v_cmp_eq_u32 s[58:59], 1, v17
    v_cmp_eq_u32 vcc, v18, v6
    s_nop 1
    v_cndmask_b32 v20, 0, v7, vcc
    v_cndmask_b32 v10, v20, 0, s[58:59]
    v_cndmask_b32 v11, 0, v20, s[58:59]
    v_and_b32 v20, 2, v5
    v_cmp_eq_u32 vcc, 0, v20
    v_mov_b32 v9, 0xeeeeeeee
    v_mov_b32 v20, 0x44444444
    v_cndmask_b32 v9, v9, v20, vcc
    v_lshl_add_u32 v19, v6, 3, v16
    v_lshlrev_b32 v19, 4, v19
    s_mul_i32 s25, s20, 1536
    s_add_u32 s25, s25, 139264
    v_add_u32 v14, s25, v19
    v_lshl_add_u32 v15, v17, 9, v19
    v_add_u32 v15, 139776, v15
    v_lshrrev_b32 v12, 1, v6
    v_lshl_add_u32 v12, v12, 3, v16
    v_lshlrev_b32 v12, 4, v12
    v_and_b32 v20, 1, v6
    v_lshl_add_u32 v20, v20, 1, v17
    v_lshl_add_u32 v12, v20, 2, v12
    v_add_u32 v12, 139520, v12
    v_lshrrev_b32 v3, 1, v6
    v_lshlrev_b32 v3, 8, v3
    v_lshl_add_u32 v3, v18, 6, v3
    v_lshl_add_u32 v3, v21, 4, v3
    v_and_b32 v20, 1, v6
    v_lshl_add_u32 v3, v20, 3, v3
    s_lshl_b32 s25, s20, 9
    s_add_u32 s25, s25, 145408
    v_add_u32 v3, s25, v3
    v_bfe_u32 v6, v0, 2, 4
    v_mul_u32_u24 v6, 2304, v6
    v_and_b32 v20, 3, v0
    v_lshl_add_u32 v6, v20, 4, v6
    v_lshlrev_b32 v5, 4, v21
    v_bfe_u32 v20, v0, 2, 1
    v_lshl_add_u32 v5, v20, 9, v5
    v_bfe_u32 v20, v0, 5, 1
    v_lshl_add_u32 v5, v20, 5, v5
    v_bfe_u32 v20, v0, 1, 1
    v_lshl_add_u32 v5, v20, 2, v5
    v_mov_b64 v[16:17], 0
    v_mov_b64 v[18:19], 0
    v_mov_b64 v[20:21], 0
    v_mov_b64 v[22:23], 0
    v_mov_b64 v[24:25], 0
    v_mov_b64 v[26:27], 0
    v_mov_b64 v[28:29], 0
    v_mov_b64 v[30:31], 0
    v_mov_b64 v[36:37], 0
    v_mov_b64 v[38:39], 0
    v_mov_b64 v[40:41], 0
    v_mov_b64 v[42:43], 0
    v_mov_b64 v[44:45], 0
    v_mov_b64 v[46:47], 0
    v_mov_b64 v[32:33], -1
    v_mov_b64 v[34:35], -1
    ds_read_b128 v[96:99], v13 offset:0
    ds_read_b128 v[100:103], v13 offset:8192
    ds_read_b128 v[104:107], v13 offset:16384
    ds_read_b128 v[108:111], v13 offset:24576
    ds_read_b128 v[112:115], v13 offset:1024
    ds_read_b128 v[116:119], v13 offset:9216
    ds_read_b128 v[120:123], v13 offset:17408
    ds_read_b128 v[124:127], v13 offset:25600
    s_lshl_b32 s25, s23, 19
    s_add_u32 s25, s25, 36700160
    s_lshl_b32 s26, s20, 11
    s_add_u32 s60, s25, s26
    s_lshr_b32 s26, s21, 2
    s_lshl_b32 s26, s26, 10
    s_add_u32 s71, s25, s26
    s_and_b32 s26, s21, 3
    s_lshl_b32 s26, s26, 6
    s_add_u32 s71, s71, s26
    s_lshr_b32 s26, s20, 1
    s_lshl_b32 s26, s26, 8
    s_add_u32 s71, s71, s26
    s_and_b32 s26, s20, 1
    s_lshl_b32 s26, s26, 3
    s_add_u32 s71, s71, s26
    s_add_u32 s71, s71, 8192
    s_mul_i32 s25, s23, 1179648
    s_add_u32 s25, s25, 37748736
    s_mul_i32 s26, s21, 9216
    s_add_u32 s70, s25, s26
    s_mul_i32 s26, s20, 2304
    s_add_u32 s70, s70, s26
    s_mul_i32 s26, s20, 73728
    s_add_u32 s73, s25, s26
    s_lshl_b32 s26, s21, 6
    s_add_u32 s73, s73, s26
    s_mov_b32 s68, s73
    s_add_u32 s63, s70, 884736
    s_lshl_b32 s25, s21, 12
    s_lshl_b32 s26, s20, 10
    s_add_u32 s25, s25, s26
    s_lshl_b32 s26, s23, 23
    s_add_u32 s26, s26, s25
    s_add_u32 s51, s26, 142606336
    s_add_u32 s65, s26, 201326592
    s_lshl_b32 s26, s23, 24
    s_add_u32 s61, s26, s25
    s_add_u32 s61, s61, 75497472
    s_lshl_b32 s25, s25, 1
    s_add_u32 s69, s26, s25
    s_add_u32 s69, s69, 109049856
    s_add_u32 s66, s61, 130048
    s_mov_b32 m0, s79
    s_lshr_b32 s25, s21, 1
    s_mov_b32 s72, 35782656
    s_mul_i32 s35, s23, 32768
    s_add_u32 s72, s72, s35
    s_mul_i32 s35, s25, 64
    s_add_u32 s72, s72, s35
    s_mov_b32 s74, 35651584
    s_mul_i32 s35, s23, 65536
    s_add_u32 s74, s74, s35
    s_mul_i32 s35, s21, 64
    s_add_u32 s74, s74, s35
    s_lshl_b32 s78, s20, 2
    s_add_u32 s78, s78, 16
    s_add_u32 s64, s74, s78
    s_mov_b32 s62, s72
    s_mov_b32 s33, 0
L_w_8:
    buffer_load_dword v4, v2, s[8:11], s64 offen sc1
    s_waitcnt vmcnt(0)
    v_readfirstlane_b32 s34, v4
    s_nop 0
    s_cmp_ge_u32 s34, 1
    s_cbranch_scc1 L_wd_9
    s_sleep 1
    s_sub_u32 s30, s30, 1
    s_cbranch_scc0 L_w_8
    s_branch M_done
L_wd_9:
    s_mov_b32 s64, s74
    buffer_load_dwordx4 v1, s[8:11], s61 offen offset:0 sc1 lds
    buffer_load_dwordx4 v1, s[8:11], s66 offen offset:1024 sc1 lds
    buffer_load_dwordx4 v1, s[8:11], s69 offen offset:2048 sc1 lds
    buffer_load_dwordx4 v1, s[8:11], s69 offen offset:3072 sc1 lds
    buffer_load_dwordx4 v[64:67], v1, s[8:11], s60 offen sc1
    buffer_load_dwordx4 v[68:71], v1, s[8:11], s60 offen offset:1024 sc1
    buffer_load_dword v0, v2, s[8:11], s74 offen sc1
    s_waitcnt vmcnt(0)
    v_add_u32 v72, s79, v1
    s_add_u32 s61, s61, 262144
    s_add_u32 s66, s66, 262144
    s_add_u32 s69, s69, 262144
    ds_read_b128 v[48:51], v72 offset:0
    ds_read_b128 v[52:55], v72 offset:1024
    ds_read_b128 v[56:59], v72 offset:2048
    ds_read_b128 v[60:63], v72 offset:3072
    s_mov_b32 s77, s64
    s_add_u32 s25, s24, 2
    s_min_u32 s25, s25, 63
    s_lshr_b32 s64, s25, 1
    s_lshl_b32 s64, s64, 11
    s_add_u32 s64, s64, s74
    s_bitcmp1_b32 s25, 0
    s_cselect_b32 s35, 0, s78
    s_add_u32 s64, s64, s35
    s_sub_u32 s25, s24, 1
    s_lshr_b32 s25, s25, 1
    s_lshl_b32 s25, s25, 10
    s_cmp_lt_u32 s24, 1
    s_cselect_b32 s25, 165675008, s25
    s_add_u32 s62, s72, s25
    s_cmp_eq_u32 s24, 63
    s_cselect_b32 s33, 3, s33
    v_readfirstlane_b32 s34, v0
    s_mov_b32 s65, s33
    v_xor_b32 v76, 2048, v73
    v_xor_b32 v84, 4096, v73
    v_xor_b32 v92, 6144, v73
    s_cmp_lt_u32 s34, 1
    s_cselect_b32 s33, 1, 0
    s_cmp_eq_u32 s76, 32
    s_cbranch_scc1 C_goL
    s_branch C_goG
C_loopG:
L_cg_10:
    buffer_load_dwordx4 v[64:67], v1, s[8:11], s60 offen sc1
    buffer_load_dwordx4 v[68:71], v1, s[8:11], s60 offen offset:1024 sc1
L_cg1_11:
    s_sub_u32 s30, s30, 1
    s_cbranch_scc1 M_done
    s_waitcnt vmcnt(0)
    v_max3_u32 v4, v64, v65, v66
    v_max3_u32 v72, v67, v68, v69
    v_max3_u32 v4, v4, v70, v71
    v_max_u32 v4, v4, v72
    v_cmp_eq_u32 vcc, -1, v4
    s_nop 0
    s_cbranch_vccnz L_cg_10
C_goG:
    ds_write_b128 v73, v[64:67]
    ds_write_b128 v73, v[68:71] offset:1024
    v_smfmac_f32_16x16x64_bf16 v[16:19], v[64:67], a[0:7], v9
    v_smfmac_f32_16x16x64_bf16 v[16:19], v[68:71], a[8:15], v9
    v_smfmac_f32_16x16x64_bf16 v[20:23], v[64:67], a[128:135], v9
    v_smfmac_f32_16x16x64_bf16 v[20:23], v[68:71], a[136:143], v9
    s_waitcnt lgkmcnt(0)
    s_barrier
    ds_read_b128 v[72:75], v76 offset:0
    ds_read_b128 v[76:79], v76 offset:1024
    ds_read_b128 v[80:83], v84 offset:0
    ds_read_b128 v[84:87], v84 offset:1024
    ds_read_b128 v[88:91], v92 offset:0
    ds_read_b128 v[92:95], v92 offset:1024
    v_smfmac_f32_16x16x64_bf16 v[24:27], v[64:67], a[64:71], v9
    v_smfmac_f32_16x16x64_bf16 v[24:27], v[68:71], a[72:79], v9
    v_mov_b32 v4, 1
    buffer_atomic_add v4, v2, s[8:11], s62 offen sc1
    v_smfmac_f32_16x16x64_bf16 v[28:31], v[64:67], a[192:199], v9
    v_smfmac_f32_16x16x64_bf16 v[28:31], v[68:71], a[200:207], v9
    buffer_load_dwordx4 v1, s[8:11], s61 offen offset:0 sc1 lds
    v_smfmac_f32_16x16x64_bf16 v[40:43], v[64:67], v[128:135], v9
    v_smfmac_f32_16x16x64_bf16 v[40:43], v[68:71], v[136:143], v9
    buffer_load_dwordx4 v1, s[8:11], s66 offen offset:1024 sc1 lds
    v_smfmac_f32_16x16x64_bf16 v[44:47], v[64:67], v[192:199], v9
    v_smfmac_f32_16x16x64_bf16 v[44:47], v[68:71], v[200:207], v9
    buffer_load_dwordx4 v1, s[8:11], s69 offen offset:2048 sc1 lds
    ds_read_b128 v[64:67], v13 offset:2048
    ds_read_b128 v[68:71], v13 offset:10240
    s_waitcnt lgkmcnt(7)
    v_smfmac_f32_16x16x64_bf16 v[16:19], v[72:75], a[16:23], v9
    v_smfmac_f32_16x16x64_bf16 v[20:23], v[72:75], a[144:151], v9
    buffer_load_dwordx4 v1, s[8:11], s69 offen offset:3072 sc1 lds
    s_waitcnt lgkmcnt(6)
    v_smfmac_f32_16x16x64_bf16 v[16:19], v[76:79], a[24:31], v9
    v_smfmac_f32_16x16x64_bf16 v[20:23], v[76:79], a[152:159], v9
    buffer_store_dwordx4 v[32:35], v1, s[8:11], s63 offen offset:0 sc1
    s_waitcnt lgkmcnt(5)
    v_smfmac_f32_16x16x64_bf16 v[16:19], v[80:83], a[32:39], v9
    v_smfmac_f32_16x16x64_bf16 v[20:23], v[80:83], a[160:167], v9
    buffer_store_dwordx4 v[32:35], v1, s[8:11], s63 offen offset:1024 sc1
    s_waitcnt lgkmcnt(4)
    v_smfmac_f32_16x16x64_bf16 v[16:19], v[84:87], a[40:47], v9
    v_smfmac_f32_16x16x64_bf16 v[20:23], v[84:87], a[168:175], v9
    s_waitcnt lgkmcnt(3)
    v_smfmac_f32_16x16x64_bf16 v[16:19], v[88:91], a[48:55], v9
    v_smfmac_f32_16x16x64_bf16 v[20:23], v[88:91], a[176:183], v9
    s_waitcnt lgkmcnt(2)
    v_smfmac_f32_16x16x64_bf16 v[16:19], v[92:95], a[56:63], v9
    v_smfmac_f32_16x16x64_bf16 v[20:23], v[92:95], a[184:191], v9
    v_smfmac_f32_16x16x64_bf16 v[24:27], v[72:75], a[80:87], v9
    v_add_f32 v16, v16, v18
    v_add_f32 v17, v17, v19
    v_smfmac_f32_16x16x64_bf16 v[28:31], v[72:75], a[208:215], v9
    v_add_f32 v20, v20, v22
    v_add_f32 v21, v21, v23
    v_smfmac_f32_16x16x64_bf16 v[24:27], v[76:79], a[88:95], v9
    v_cvt_pk_bf16_f32 v16, v16, v17
    v_smfmac_f32_16x16x64_bf16 v[28:31], v[76:79], a[216:223], v9
    v_cvt_pk_bf16_f32 v17, v20, v21
    v_smfmac_f32_16x16x64_bf16 v[24:27], v[80:83], a[96:103], v9
    v_smfmac_f32_16x16x64_bf16 v[28:31], v[80:83], a[224:231], v9
    v_mfma_f32_16x16x16_bf16 v[20:23], v[16:17], v[10:11], 0
    v_smfmac_f32_16x16x64_bf16 v[24:27], v[84:87], a[104:111], v9
    v_smfmac_f32_16x16x64_bf16 v[28:31], v[84:87], a[232:239], v9
    v_smfmac_f32_16x16x64_bf16 v[24:27], v[88:91], a[112:119], v9
    v_cvt_pk_bf16_f32 v36, v20, v21
    v_smfmac_f32_16x16x64_bf16 v[28:31], v[88:91], a[240:247], v9
    v_cvt_pk_bf16_f32 v37, v22, v23
    v_smfmac_f32_16x16x64_bf16 v[24:27], v[92:95], a[120:127], v9
    v_smfmac_f32_16x16x64_bf16 v[28:31], v[92:95], a[248:255], v9
    v_smfmac_f32_16x16x64_bf16 v[40:43], v[72:75], v[144:151], v9
    v_add_f32 v24, v24, v26
    v_add_f32 v25, v25, v27
    s_nop 1
    v_add_f32 v28, v28, v30
    v_add_f32 v29, v29, v31
    v_cvt_pk_bf16_f32 v24, v24, v25
    v_cvt_pk_bf16_f32 v25, v28, v29
    s_nop 1
    v_mfma_f32_16x16x16_bf16 v[28:31], v[24:25], v[10:11], 0
    v_smfmac_f32_16x16x64_bf16 v[44:47], v[72:75], v[208:215], v9
    s_nop 3
    v_cvt_pk_bf16_f32 v38, v28, v29
    v_cvt_pk_bf16_f32 v39, v30, v31
    s_cmp_lg_u32 s65, 0
    s_cbranch_scc1 L_ck_12
L_ck_12r:
    v_mfma_f32_16x16x32_bf16 v[20:23], v[48:51], v[36:39], 0
    v_mfma_f32_16x16x32_bf16 v[24:27], v[52:55], v[36:39], 0
    v_mfma_f32_16x16x32_bf16 v[16:19], v[36:39], v[36:39], 0
    s_andn2_b64 exec, exec, s[58:59]
    ds_write_b128 v14, v[20:23] offset:512
    s_nop 1
    ds_write_b128 v14, v[24:27] offset:1024
    s_nop 2
    ds_write_b128 v14, v[16:19] offset:0
    s_mov_b64 exec, -1
    v_smfmac_f32_16x16x64_bf16 v[40:43], v[76:79], v[152:159], v9
    v_smfmac_f32_16x16x64_bf16 v[44:47], v[76:79], v[216:223], v9
    v_smfmac_f32_16x16x64_bf16 v[40:43], v[80:83], v[160:167], v9
    s_waitcnt lgkmcnt(0)
    s_barrier
    ds_read_b128 v[16:19], v15 offset:0
    ds_read_b32 v48, v12 offset:0
    ds_read_b128 v[20:23], v15 offset:1536
    ds_read_b32 v49, v12 offset:1536
    ds_read_b128 v[24:27], v15 offset:3072
    ds_read_b32 v50, v12 offset:3072
    ds_read_b128 v[28:31], v15 offset:4608
    ds_read_b32 v51, v12 offset:4608
    v_smfmac_f32_16x16x64_bf16 v[44:47], v[80:83], v[224:231], v9
    ds_read_b128 v[72:75], v13 offset:18432
    v_smfmac_f32_16x16x64_bf16 v[40:43], v[84:87], v[168:175], v9
    ds_read_b128 v[76:79], v13 offset:26624
    v_smfmac_f32_16x16x64_bf16 v[44:47], v[84:87], v[232:239], v9
    ds_read_b128 v[80:83], v13 offset:3072
    v_smfmac_f32_16x16x64_bf16 v[40:43], v[88:91], v[176:183], v9
    ds_read_b128 v[84:87], v13 offset:11264
    s_waitcnt lgkmcnt(8)
    v_add_f32 v16, v16, v20
    v_add_f32 v17, v17, v21
    v_add_f32 v18, v18, v22
    v_add_f32 v19, v19, v23
    s_waitcnt lgkmcnt(4)
    v_add_f32 v24, v24, v28
    v_add_f32 v25, v25, v29
    v_add_f32 v26, v26, v30
    v_add_f32 v27, v27, v31
    v_add_f32 v48, v48, v50
    v_add_f32 v49, v49, v51
    v_add_f32 v16, v16, v24
    v_add_f32 v17, v17, v25
    v_add_f32 v18, v18, v26
    v_add_f32 v19, v19, v27
    v_add_f32 v48, v48, v49
    v_max3_f32 v4, v16, v17, v18
    v_max3_f32 v4, v4, v19, v48
    v_smfmac_f32_16x16x64_bf16 v[44:47], v[88:91], v[240:247], v9
    s_nop 0
    v_max_f32_dpp v4, v4, v4 row_ror:8 row_mask:0xf bank_mask:0xf
    v_mov_b32 v49, v4
    v_smfmac_f32_16x16x64_bf16 v[40:43], v[92:95], v[184:191], v9
    ds_read_b128 v[88:91], v13 offset:19456
    v_permlane16_swap_b32 v4, v49
    v_max_f32 v4, v4, v49
    v_mov_b32 v49, v4
    v_smfmac_f32_16x16x64_bf16 v[44:47], v[92:95], v[248:255], v9
    s_nop 0
    v_permlane32_swap_b32 v4, v49
    v_max_f32 v4, v4, v49
    v_mul_f32 v4, 0xbe0293ee, v4
    v_fma_f32 v16, v16, s31, v4
    v_fma_f32 v17, v17, s31, v4
    v_fma_f32 v18, v18, s31, v4
    v_fma_f32 v19, v19, s31, v4
    v_fma_f32 v48, v48, s31, v4
    v_exp_f32 v16, v16
    v_exp_f32 v17, v17
    v_exp_f32 v18, v18
    v_exp_f32 v19, v19
    v_exp_f32 v48, v48
    v_cvt_pk_bf16_f32 v32, v16, v17
    v_cvt_pk_bf16_f32 v33, v18, v19
    v_mov_b32_dpp v49, v48 row_ror:8 row_mask:0xf bank_mask:0xf
    v_mov_b32 v51, 0
    v_mov_b32_dpp v34, v32 row_ror:8 row_mask:0xf bank_mask:0xf
    v_mov_b32_dpp v35, v33 row_ror:8 row_mask:0xf bank_mask:0xf
    v_cvt_pk_bf16_f32 v50, v48, v49
    v_add_f32 v40, v40, v42
    v_add_f32 v41, v41, v43
    v_add_f32 v44, v44, v46
    v_add_f32 v45, v45, v47
    v_mfma_f32_16x16x32_bf16 v[28:31], v[56:59], v[32:35], 0
    v_mfma_f32_16x16x32_bf16 v[52:55], v[60:63], v[32:35], 0
    v_cvt_pk_bf16_f32 v40, v40, v41
    v_cvt_pk_bf16_f32 v41, v44, v45
    v_cvt_pk_bf16_f32 v42, v44, v45
    v_mov_b32 v43, 0
    v_add_f32 v20, v16, v18
    v_add_f32 v21, v17, v19
    v_add_f32 v4, v20, v48
    v_add_f32 v4, v4, v21
    v_mfma_f32_16x16x16_bf16 v[28:31], v[40:41], v[50:51], v[28:31]
    v_mfma_f32_16x16x16_bf16 v[52:55], v[42:43], v[50:51], v[52:55]
    ds_read_b128 v[92:95], v13 offset:27648
    v_add_f32_dpp v4, v4, v4 row_ror:8 row_mask:0xf bank_mask:0xf
    v_mov_b32_dpp v36, v40 quad_perm:[0,1,2,3] row_mask:0xf bank_mask:0x3
    v_mov_b32 v20, v4
    v_mov_b32_dpp v37, v41 quad_perm:[0,1,2,3] row_mask:0xf bank_mask:0x3
    s_nop 0
    v_permlane16_swap_b32 v4, v20
    v_add_f32 v4, v4, v20
    v_mov_b32 v20, v4
    v_mov_b32_dpp v38, v40 row_ror:8 row_mask:0xf bank_mask:0x3
    s_nop 0
    v_permlane32_swap_b32 v4, v20
    v_add_f32 v4, v4, v20
    v_rcp_f32 v4, v4
    v_mov_b32_dpp v39, v41 row_ror:8 row_mask:0xf bank_mask:0x3
    buffer_load_dword v0, v2, s[8:11], s64 offen sc1
    buffer_store_dwordx4 v[36:39], v1, s[8:11], s51 offen sc1
    v_pk_mul_f32 v[28:29], v[28:29], v[4:5] op_sel_hi:[1,0]
    v_pk_mul_f32 v[30:31], v[30:31], v[4:5] op_sel_hi:[1,0]
    v_pk_mul_f32 v[52:53], v[52:53], v[4:5] op_sel_hi:[1,0]
    v_pk_mul_f32 v[54:55], v[54:55], v[4:5] op_sel_hi:[1,0]
    v_cvt_pk_bf16_f32 v24, v28, v29
    v_cvt_pk_bf16_f32 v26, v30, v31
    v_cvt_pk_bf16_f32 v25, v52, v53
    v_cvt_pk_bf16_f32 v27, v54, v55
    s_andn2_b64 exec, exec, s[58:59]
    ds_write2_b64 v3, v[24:25], v[26:27] offset1:4
    s_mov_b64 exec, -1
    v_mov_b64 v[16:17], 0
    v_mov_b64 v[18:19], 0
    v_mov_b64 v[20:21], 0
    v_mov_b64 v[22:23], 0
    v_mov_b64 v[28:29], 0
    v_mov_b64 v[30:31], 0
    v_mov_b64 v[32:33], 0
    v_mov_b64 v[34:35], 0
    s_waitcnt lgkmcnt(0)
    s_barrier
    ds_read_b128 v[56:59], v8 offset:14336
    ds_read_b128 v[60:63], v8 offset:15360
    s_add_u32 s25, s68, 36864
    v_mov_b64 v[40:41], 0
    v_mov_b64 v[42:43], 0
    v_mov_b64 v[44:45], 0
    v_mov_b64 v[46:47], 0
    v_mov_b64 v[48:49], 0
    v_mov_b64 v[50:51], 0
    v_mov_b64 v[52:53], 0
    v_mov_b64 v[54:55], 0
    s_cmp_eq_u32 s33, 0
    s_cbranch_scc1 C_s2G
    buffer_load_dword v36, v2, s[8:11], s77 offen sc1
C_s2G:
    s_waitcnt lgkmcnt(1)
    v_smfmac_f32_16x16x64_bf16 v[16:19], v[56:59], v[96:103], v9
    s_waitcnt lgkmcnt(0)
    v_smfmac_f32_16x16x64_bf16 v[16:19], v[60:63], v[104:111], v9
    ds_read_b128 v[96:99], v13 offset:4096
    ds_read_b128 v[100:103], v13 offset:12288
    v_smfmac_f32_16x16x64_bf16 v[20:23], v[56:59], v[112:119], v9
    ds_read_b128 v[104:107], v13 offset:20480
    ds_read_b128 v[108:111], v13 offset:28672
    v_smfmac_f32_16x16x64_bf16 v[20:23], v[60:63], v[120:127], v9
    ds_read_b128 v[112:115], v13 offset:5120
    ds_read_b128 v[116:119], v13 offset:13312
    v_add_f32 v16, v16, v18
    v_add_f32 v17, v17, v19
    v_smfmac_f32_16x16x64_bf16 v[28:31], v[56:59], v[64:71], v9
    ds_read_b128 v[120:123], v13 offset:21504
    ds_read_b128 v[124:127], v13 offset:29696
    v_cvt_pk_bf16_f32 v24, v16, v17
    v_smfmac_f32_16x16x64_bf16 v[28:31], v[60:63], v[72:79], v9
    ds_read_b128 v[64:67], v13 offset:6144
    ds_read_b128 v[68:71], v13 offset:14336
    v_add_f32 v20, v20, v22
    v_add_f32 v21, v21, v23
    v_smfmac_f32_16x16x64_bf16 v[32:35], v[56:59], v[80:87], v9
    ds_read_b128 v[72:75], v13 offset:22528
    ds_read_b128 v[76:79], v13 offset:30720
    v_cvt_pk_bf16_f32 v25, v20, v21
    v_smfmac_f32_16x16x64_bf16 v[32:35], v[60:63], v[88:95], v9
    ds_read_b128 v[80:83], v13 offset:7168
    ds_read_b128 v[84:87], v13 offset:15360
    v_add_f32 v28, v28, v30
    v_add_f32 v29, v29, v31
    s_waitcnt lgkmcnt(12)
    v_smfmac_f32_16x16x64_bf16 v[40:43], v[56:59], v[96:103], v9
    ds_read_b128 v[88:91], v13 offset:23552
    ds_read_b128 v[92:95], v13 offset:31744
    v_cvt_pk_bf16_f32 v26, v28, v29
    s_waitcnt lgkmcnt(12)
    v_smfmac_f32_16x16x64_bf16 v[40:43], v[60:63], v[104:111], v9
    v_add_f32 v32, v32, v34
    v_add_f32 v33, v33, v35
    s_waitcnt lgkmcnt(10)
    v_smfmac_f32_16x16x64_bf16 v[44:47], v[56:59], v[112:119], v9
    v_cvt_pk_bf16_f32 v27, v32, v33
    buffer_store_dwordx4 v[24:27], v6, s[8:11], s68 offen sc1
    s_waitcnt lgkmcnt(8)
    v_smfmac_f32_16x16x64_bf16 v[44:47], v[60:63], v[120:127], v9
    v_add_f32 v40, v40, v42
    v_add_f32 v41, v41, v43
    s_waitcnt lgkmcnt(6)
    v_smfmac_f32_16x16x64_bf16 v[48:51], v[56:59], v[64:71], v9
    v_cvt_pk_bf16_f32 v16, v40, v41
    s_waitcnt lgkmcnt(4)
    v_smfmac_f32_16x16x64_bf16 v[48:51], v[60:63], v[72:79], v9
    v_add_f32 v44, v44, v46
    v_add_f32 v45, v45, v47
    s_waitcnt lgkmcnt(2)
    v_smfmac_f32_16x16x64_bf16 v[52:55], v[56:59], v[80:87], v9
    v_cvt_pk_bf16_f32 v17, v44, v45
    s_waitcnt lgkmcnt(0)
    v_smfmac_f32_16x16x64_bf16 v[52:55], v[60:63], v[88:95], v9
    v_add_f32 v48, v48, v50
    v_add_f32 v49, v49, v51
    v_cvt_pk_bf16_f32 v18, v48, v49
    s_nop 4
    v_add_f32 v52, v52, v54
    v_add_f32 v53, v53, v55
    v_cvt_pk_bf16_f32 v19, v52, v53
    buffer_store_dwordx4 v[16:19], v6, s[8:11], s25 offen sc1
    s_and_b32 s25, s24, 3
    s_mul_i32 s25, s25, 294912
    s_add_u32 s63, s70, s25
    ds_read_b128 v[96:99], v13 offset:0
    ds_read_b128 v[100:103], v13 offset:8192
    ds_read_b128 v[104:107], v13 offset:16384
    ds_read_b128 v[108:111], v13 offset:24576
    ds_read_b128 v[112:115], v13 offset:1024
    ds_read_b128 v[116:119], v13 offset:9216
    ds_read_b128 v[120:123], v13 offset:17408
    ds_read_b128 v[124:127], v13 offset:25600
    v_cndmask_b32 v92, 0, v7, s[40:41]
    v_cndmask_b32 v93, 0, v7, s[42:43]
    v_cndmask_b32 v94, 0, v7, s[44:45]
    v_cndmask_b32 v95, 0, v7, s[46:47]
    v_mov_b64 v[20:21], 0
    v_mov_b64 v[22:23], 0
    v_mov_b64 v[24:25], 0
    v_mov_b64 v[26:27], 0
    v_mov_b64 v[28:29], 0
    v_mov_b64 v[30:31], 0
    v_mov_b64 v[40:41], 0
    v_mov_b64 v[42:43], 0
    v_mov_b64 v[44:45], 0
    v_mov_b64 v[46:47], 0
    v_mov_b64 v[32:33], -1
    v_mov_b64 v[34:35], -1
    v_add_u32 v73, s67, v8
    s_add_u32 s24, s24, 1
    s_add_u32 s60, s60, 8192
    s_and_b32 s25, s24, 3
    s_mul_i32 s25, s25, 294912
    s_add_u32 s68, s73, s25
    s_add_u32 s51, s51, 131072
    s_mov_b32 s77, s64
    s_add_u32 s25, s24, 2
    s_min_u32 s25, s25, 63
    s_lshr_b32 s64, s25, 1
    s_lshl_b32 s64, s64, 11
    s_add_u32 s64, s64, s74
    s_bitcmp1_b32 s25, 0
    s_cselect_b32 s35, 0, s78
    s_add_u32 s64, s64, s35
    s_sub_u32 s25, s24, 1
    s_lshr_b32 s25, s25, 1
    s_lshl_b32 s25, s25, 10
    s_cmp_lt_u32 s24, 1
    s_cselect_b32 s25, 165675008, s25
    s_add_u32 s62, s72, s25
    s_cmp_eq_u32 s24, 63
    s_cselect_b32 s33, 3, s33
L_cr_13:
    buffer_load_dwordx4 v[80:83], v1, s[8:11], s63 offen sc1
    buffer_load_dwordx4 v[84:87], v1, s[8:11], s63 offen offset:1024 sc1
L_cr1_14:
    s_sub_u32 s30, s30, 1
    s_cbranch_scc1 M_done
    s_waitcnt vmcnt(0)
    v_mfma_f32_16x16x32_bf16 v[88:91], v[80:83], v[92:95], 0
    v_max3_u32 v4, v80, v81, v82
    v_max3_u32 v72, v83, v84, v85
    v_mfma_f32_16x16x32_bf16 v[88:91], v[84:87], v[92:95], v[88:91]
    v_max3_u32 v4, v4, v86, v87
    v_max_u32 v4, v4, v72
    v_cmp_eq_u32 vcc, -1, v4
    s_nop 0
    s_cbranch_vccnz L_cr_13
    s_nop 2
    v_permlane32_swap_b32 v88, v90
    v_permlane32_swap_b32 v89, v91
    v_pk_add_f32 v[88:89], v[88:89], v[90:91]
    v_mov_b64 v[90:91], v[88:89]
    s_nop 1
    v_permlane16_swap_b32 v88, v90
    v_permlane16_swap_b32 v89, v91
    v_pk_add_f32 v[88:89], v[88:89], v[90:91]
    v_cvt_pk_bf16_f32 v88, v88, v89
    v_min_u32 v88, -2, v88
    buffer_store_dword v88, v5, s[8:11], s71 offen sc1
    v_add_u32 v72, s79, v1
    s_add_u32 s61, s61, 262144
    s_add_u32 s66, s66, 262144
    s_add_u32 s69, s69, 262144
    ds_read_b128 v[48:51], v72 offset:0
    ds_read_b128 v[52:55], v72 offset:1024
    ds_read_b128 v[56:59], v72 offset:2048
    ds_read_b128 v[60:63], v72 offset:3072
    v_mov_b64 v[16:17], 0
    v_mov_b64 v[18:19], 0
    s_add_u32 s71, s71, 8192
    v_readfirstlane_b32 s34, v0
    s_mov_b32 s65, s33
    v_xor_b32 v76, 2048, v73
    v_xor_b32 v84, 4096, v73
    v_xor_b32 v92, 6144, v73
    s_cmp_lt_u32 s34, 1
    s_cselect_b32 s33, 1, 0
    s_cmp_lg_u32 s65, 1
    s_cbranch_scc1 C_loopG
    v_readfirstlane_b32 s34, v36
    s_nop 0
    s_cmp_lt_u32 s34, 1
    s_cbranch_scc1 C_loopG
    s_mov_b32 s65, 0
    s_waitcnt lgkmcnt(0)
    s_sub_u32 s25, s61, 262144
    buffer_load_dwordx4 v[48:51], v1, s[8:11], s25 offen offset:0 sc1
    s_sub_u32 s25, s66, 262144
    buffer_load_dwordx4 v[52:55], v1, s[8:11], s25 offen offset:1024 sc1
    s_sub_u32 s25, s69, 262144
    buffer_load_dwordx4 v[56:59], v1, s[8:11], s25 offen offset:2048 sc1
    s_sub_u32 s25, s69, 262144
    buffer_load_dwordx4 v[60:63], v1, s[8:11], s25 offen offset:3072 sc1
    s_branch C_loopG
L_ck_12:
    s_cmp_eq_u32 s65, 3
    s_cbranch_scc1 L_ck_12f
    s_lshr_b32 s25, s24, 1
    s_lshl_b32 s25, s25, 11
    s_add_u32 s25, s25, s74
    s_bitcmp1_b32 s24, 0
    s_cselect_b32 s35, 0, s78
    s_add_u32 s25, s25, s35
L_w_15:
    buffer_load_dword v4, v2, s[8:11], s25 offen sc1
    s_waitcnt vmcnt(0)
    v_readfirstlane_b32 s34, v4
    s_nop 0
    s_cmp_ge_u32 s34, 1
    s_cbranch_scc1 L_wd_16
    s_sleep 1
    s_sub_u32 s30, s30, 1
    s_cbranch_scc0 L_w_15
    s_branch M_done
L_wd_16:
    s_sub_u32 s25, s61, 262144
    buffer_load_dwordx4 v[48:51], v1, s[8:11], s25 offen offset:0 sc1
    s_sub_u32 s25, s66, 262144
    buffer_load_dwordx4 v[52:55], v1, s[8:11], s25 offen offset:1024 sc1
    s_sub_u32 s25, s69, 262144
    buffer_load_dwordx4 v[56:59], v1, s[8:11], s25 offen offset:2048 sc1
    s_sub_u32 s25, s69, 262144
    buffer_load_dwordx4 v[60:63], v1, s[8:11], s25 offen offset:3072 sc1
    s_waitcnt vmcnt(0)
    s_branch L_ck_12r
L_ck_12f:
    s_nop 7
    v_smfmac_f32_16x16x64_bf16 v[40:43], v[76:79], v[152:159], v9
    v_smfmac_f32_16x16x64_bf16 v[44:47], v[76:79], v[216:223], v9
    v_smfmac_f32_16x16x64_bf16 v[40:43], v[80:83], v[160:167], v9
    v_smfmac_f32_16x16x64_bf16 v[44:47], v[80:83], v[224:231], v9
    v_smfmac_f32_16x16x64_bf16 v[40:43], v[84:87], v[168:175], v9
    v_smfmac_f32_16x16x64_bf16 v[44:47], v[84:87], v[232:239], v9
    v_smfmac_f32_16x16x64_bf16 v[40:43], v[88:91], v[176:183], v9
    v_smfmac_f32_16x16x64_bf16 v[44:47], v[88:91], v[240:247], v9
    v_smfmac_f32_16x16x64_bf16 v[40:43], v[92:95], v[184:191], v9
    v_smfmac_f32_16x16x64_bf16 v[44:47], v[92:95], v[248:255], v9
    s_nop 7
    v_add_f32 v40, v40, v42
    v_add_f32 v41, v41, v43
    v_add_f32 v44, v44, v46
    v_add_f32 v45, v45, v47
    v_cvt_pk_bf16_f32 v40, v40, v41
    v_cvt_pk_bf16_f32 v41, v44, v45
    s_nop 0
    v_mov_b32_dpp v36, v40 quad_perm:[0,1,2,3] row_mask:0xf bank_mask:0x3
    v_mov_b32_dpp v37, v41 quad_perm:[0,1,2,3] row_mask:0xf bank_mask:0x3
    v_mov_b32_dpp v38, v40 row_ror:8 row_mask:0xf bank_mask:0x3
    v_mov_b32_dpp v39, v41 row_ror:8 row_mask:0xf bank_mask:0x3
    s_nop 1
    s_branch C_last
C_loopL:
L_cg_17:
    buffer_load_dwordx4 v[64:67], v1, s[8:11], s60 offen sc1
    buffer_load_dwordx4 v[68:71], v1, s[8:11], s60 offen offset:1024 sc1
L_cg1_18:
    s_sub_u32 s30, s30, 1
    s_cbranch_scc1 M_done
    s_waitcnt vmcnt(0)
    v_max3_u32 v4, v64, v65, v66
    v_max3_u32 v72, v67, v68, v69
    v_max3_u32 v4, v4, v70, v71
    v_max_u32 v4, v4, v72
    v_cmp_eq_u32 vcc, -1, v4
    s_nop 0
    s_cbranch_vccnz L_cg_17
C_goL:
    ds_write_b128 v73, v[64:67]
    ds_write_b128 v73, v[68:71] offset:1024
    v_smfmac_f32_16x16x64_bf16 v[16:19], v[64:67], a[0:7], v9
    v_smfmac_f32_16x16x64_bf16 v[16:19], v[68:71], a[8:15], v9
    v_smfmac_f32_16x16x64_bf16 v[20:23], v[64:67], a[128:135], v9
    v_smfmac_f32_16x16x64_bf16 v[20:23], v[68:71], a[136:143], v9
    s_waitcnt lgkmcnt(0)
    s_barrier
    ds_read_b128 v[72:75], v76 offset:0
    ds_read_b128 v[76:79], v76 offset:1024
    ds_read_b128 v[80:83], v84 offset:0
    ds_read_b128 v[84:87], v84 offset:1024
    ds_read_b128 v[88:91], v92 offset:0
    ds_read_b128 v[92:95], v92 offset:1024
    v_smfmac_f32_16x16x64_bf16 v[24:27], v[64:67], a[64:71], v9
    v_smfmac_f32_16x16x64_bf16 v[24:27], v[68:71], a[72:79], v9
    v_mov_b32 v4, 1
    buffer_atomic_add v4, v2, s[8:11], s62 offen sc1
    v_smfmac_f32_16x16x64_bf16 v[28:31], v[64:67], a[192:199], v9
    v_smfmac_f32_16x16x64_bf16 v[28:31], v[68:71], a[200:207], v9
    buffer_load_dwordx4 v1, s[8:11], s61 offen offset:0 sc1 lds
    v_smfmac_f32_16x16x64_bf16 v[40:43], v[64:67], v[128:135], v9
    v_smfmac_f32_16x16x64_bf16 v[40:43], v[68:71], v[136:143], v9
    buffer_load_dwordx4 v1, s[8:11], s66 offen offset:1024 sc1 lds
    v_smfmac_f32_16x16x64_bf16 v[44:47], v[64:67], v[192:199], v9
    v_smfmac_f32_16x16x64_bf16 v[44:47], v[68:71], v[200:207], v9
    buffer_load_dwordx4 v1, s[8:11], s69 offen offset:2048 sc1 lds
    ds_read_b128 v[64:67], v13 offset:2048
    ds_read_b128 v[68:71], v13 offset:10240
    s_waitcnt lgkmcnt(7)
    v_smfmac_f32_16x16x64_bf16 v[16:19], v[72:75], a[16:23], v9
    v_smfmac_f32_16x16x64_bf16 v[20:23], v[72:75], a[144:151], v9
    buffer_load_dwordx4 v1, s[8:11], s69 offen offset:3072 sc1 lds
    s_waitcnt lgkmcnt(6)
    v_smfmac_f32_16x16x64_bf16 v[16:19], v[76:79], a[24:31], v9
    v_smfmac_f32_16x16x64_bf16 v[20:23], v[76:79], a[152:159], v9
    buffer_store_dwordx4 v[32:35], v1, s[8:11], s63 offen offset:0
    s_waitcnt lgkmcnt(5)
    v_smfmac_f32_16x16x64_bf16 v[16:19], v[80:83], a[32:39], v9
    v_smfmac_f32_16x16x64_bf16 v[20:23], v[80:83], a[160:167], v9
    buffer_store_dwordx4 v[32:35], v1, s[8:11], s63 offen offset:1024
    s_waitcnt lgkmcnt(4)
    v_smfmac_f32_16x16x64_bf16 v[16:19], v[84:87], a[40:47], v9
    v_smfmac_f32_16x16x64_bf16 v[20:23], v[84:87], a[168:175], v9
    s_waitcnt lgkmcnt(3)
    v_smfmac_f32_16x16x64_bf16 v[16:19], v[88:91], a[48:55], v9
    v_smfmac_f32_16x16x64_bf16 v[20:23], v[88:91], a[176:183], v9
    s_waitcnt lgkmcnt(2)
    v_smfmac_f32_16x16x64_bf16 v[16:19], v[92:95], a[56:63], v9
    v_smfmac_f32_16x16x64_bf16 v[20:23], v[92:95], a[184:191], v9
    v_smfmac_f32_16x16x64_bf16 v[24:27], v[72:75], a[80:87], v9
    v_add_f32 v16, v16, v18
    v_add_f32 v17, v17, v19
    v_smfmac_f32_16x16x64_bf16 v[28:31], v[72:75], a[208:215], v9
    v_add_f32 v20, v20, v22
    v_add_f32 v21, v21, v23
    v_smfmac_f32_16x16x64_bf16 v[24:27], v[76:79], a[88:95], v9
    v_cvt_pk_bf16_f32 v16, v16, v17
    v_smfmac_f32_16x16x64_bf16 v[28:31], v[76:79], a[216:223], v9
    v_cvt_pk_bf16_f32 v17, v20, v21
    v_smfmac_f32_16x16x64_bf16 v[24:27], v[80:83], a[96:103], v9
    v_smfmac_f32_16x16x64_bf16 v[28:31], v[80:83], a[224:231], v9
    v_mfma_f32_16x16x16_bf16 v[20:23], v[16:17], v[10:11], 0
    v_smfmac_f32_16x16x64_bf16 v[24:27], v[84:87], a[104:111], v9
    v_smfmac_f32_16x16x64_bf16 v[28:31], v[84:87], a[232:239], v9
    v_smfmac_f32_16x16x64_bf16 v[24:27], v[88:91], a[112:119], v9
    v_cvt_pk_bf16_f32 v36, v20, v21
    v_smfmac_f32_16x16x64_bf16 v[28:31], v[88:91], a[240:247], v9
    v_cvt_pk_bf16_f32 v37, v22, v23
    v_smfmac_f32_16x16x64_bf16 v[24:27], v[92:95], a[120:127], v9
    v_smfmac_f32_16x16x64_bf16 v[28:31], v[92:95], a[248:255], v9
    v_smfmac_f32_16x16x64_bf16 v[40:43], v[72:75], v[144:151], v9
    v_add_f32 v24, v24, v26
    v_add_f32 v25, v25, v27
    s_nop 1
    v_add_f32 v28, v28, v30
    v_add_f32 v29, v29, v31
    v_cvt_pk_bf16_f32 v24, v24, v25
    v_cvt_pk_bf16_f32 v25, v28, v29
    s_nop 1
    v_mfma_f32_16x16x16_bf16 v[28:31], v[24:25], v[10:11], 0
    v_smfmac_f32_16x16x64_bf16 v[44:47], v[72:75], v[208:215], v9
    s_nop 3
    v_cvt_pk_bf16_f32 v38, v28, v29
    v_cvt_pk_bf16_f32 v39, v30, v31
    s_cmp_lg_u32 s65, 0
    s_cbranch_scc1 L_ck_19
L_ck_19r:
    v_mfma_f32_16x16x32_bf16 v[20:23], v[48:51], v[36:39], 0
    v_mfma_f32_16x16x32_bf16 v[24:27], v[52:55], v[36:39], 0
    v_mfma_f32_16x16x32_bf16 v[16:19], v[36:39], v[36:39], 0
    s_andn2_b64 exec, exec, s[58:59]
    ds_write_b128 v14, v[20:23] offset:512
    s_nop 1
    ds_write_b128 v14, v[24:27] offset:1024
    s_nop 2
    ds_write_b128 v14, v[16:19] offset:0
    s_mov_b64 exec, -1
    v_smfmac_f32_16x16x64_bf16 v[40:43], v[76:79], v[152:159], v9
    v_smfmac_f32_16x16x64_bf16 v[44:47], v[76:79], v[216:223], v9
    v_smfmac_f32_16x16x64_bf16 v[40:43], v[80:83], v[160:167], v9
    s_waitcnt lgkmcnt(0)
    s_barrier
    ds_read_b128 v[16:19], v15 offset:0
    ds_read_b32 v48, v12 offset:0
    ds_read_b128 v[20:23], v15 offset:1536
    ds_read_b32 v49, v12 offset:1536
    ds_read_b128 v[24:27], v15 offset:3072
    ds_read_b32 v50, v12 offset:3072
    ds_read_b128 v[28:31], v15 offset:4608
    ds_read_b32 v51, v12 offset:4608
    v_smfmac_f32_16x16x64_bf16 v[44:47], v[80:83], v[224:231], v9
    ds_read_b128 v[72:75], v13 offset:18432
    v_smfmac_f32_16x16x64_bf16 v[40:43], v[84:87], v[168:175], v9
    ds_read_b128 v[76:79], v13 offset:26624
    v_smfmac_f32_16x16x64_bf16 v[44:47], v[84:87], v[232:239], v9
    ds_read_b128 v[80:83], v13 offset:3072
    v_smfmac_f32_16x16x64_bf16 v[40:43], v[88:91], v[176:183], v9
    ds_read_b128 v[84:87], v13 offset:11264
    s_waitcnt lgkmcnt(8)
    v_add_f32 v16, v16, v20
    v_add_f32 v17, v17, v21
    v_add_f32 v18, v18, v22
    v_add_f32 v19, v19, v23
    s_waitcnt lgkmcnt(4)
    v_add_f32 v24, v24, v28
    v_add_f32 v25, v25, v29
    v_add_f32 v26, v26, v30
    v_add_f32 v27, v27, v31
    v_add_f32 v48, v48, v50
    v_add_f32 v49, v49, v51
    v_add_f32 v16, v16, v24
    v_add_f32 v17, v17, v25
    v_add_f32 v18, v18, v26
    v_add_f32 v19, v19, v27
    v_add_f32 v48, v48, v49
    v_max3_f32 v4, v16, v17, v18
    v_max3_f32 v4, v4, v19, v48
    v_smfmac_f32_16x16x64_bf16 v[44:47], v[88:91], v[240:247], v9
    s_nop 0
    v_max_f32_dpp v4, v4, v4 row_ror:8 row_mask:0xf bank_mask:0xf
    v_mov_b32 v49, v4
    v_smfmac_f32_16x16x64_bf16 v[40:43], v[92:95], v[184:191], v9
    ds_read_b128 v[88:91], v13 offset:19456
    v_permlane16_swap_b32 v4, v49
    v_max_f32 v4, v4, v49
    v_mov_b32 v49, v4
    v_smfmac_f32_16x16x64_bf16 v[44:47], v[92:95], v[248:255], v9
    s_nop 0
    v_permlane32_swap_b32 v4, v49
    v_max_f32 v4, v4, v49
    v_mul_f32 v4, 0xbe0293ee, v4
    v_fma_f32 v16, v16, s31, v4
    v_fma_f32 v17, v17, s31, v4
    v_fma_f32 v18, v18, s31, v4
    v_fma_f32 v19, v19, s31, v4
    v_fma_f32 v48, v48, s31, v4
    v_exp_f32 v16, v16
    v_exp_f32 v17, v17
    v_exp_f32 v18, v18
    v_exp_f32 v19, v19
    v_exp_f32 v48, v48
    v_cvt_pk_bf16_f32 v32, v16, v17
    v_cvt_pk_bf16_f32 v33, v18, v19
    v_mov_b32_dpp v49, v48 row_ror:8 row_mask:0xf bank_mask:0xf
    v_mov_b32 v51, 0
    v_mov_b32_dpp v34, v32 row_ror:8 row_mask:0xf bank_mask:0xf
    v_mov_b32_dpp v35, v33 row_ror:8 row_mask:0xf bank_mask:0xf
    v_cvt_pk_bf16_f32 v50, v48, v49
    v_add_f32 v40, v40, v42
    v_add_f32 v41, v41, v43
    v_add_f32 v44, v44, v46
    v_add_f32 v45, v45, v47
    v_mfma_f32_16x16x32_bf16 v[28:31], v[56:59], v[32:35], 0
    v_mfma_f32_16x16x32_bf16 v[52:55], v[60:63], v[32:35], 0
    v_cvt_pk_bf16_f32 v40, v40, v41
    v_cvt_pk_bf16_f32 v41, v44, v45
    v_cvt_pk_bf16_f32 v42, v44, v45
    v_mov_b32 v43, 0
    v_add_f32 v20, v16, v18
    v_add_f32 v21, v17, v19
    v_add_f32 v4, v20, v48
    v_add_f32 v4, v4, v21
    v_mfma_f32_16x16x16_bf16 v[28:31], v[40:41], v[50:51], v[28:31]
    v_mfma_f32_16x16x16_bf16 v[52:55], v[42:43], v[50:51], v[52:55]
    ds_read_b128 v[92:95], v13 offset:27648
    v_add_f32_dpp v4, v4, v4 row_ror:8 row_mask:0xf bank_mask:0xf
    v_mov_b32_dpp v36, v40 quad_perm:[0,1,2,3] row_mask:0xf bank_mask:0x3
    v_mov_b32 v20, v4
    v_mov_b32_dpp v37, v41 quad_perm:[0,1,2,3] row_mask:0xf bank_mask:0x3
    s_nop 0
    v_permlane16_swap_b32 v4, v20
    v_add_f32 v4, v4, v20
    v_mov_b32 v20, v4
    v_mov_b32_dpp v38, v40 row_ror:8 row_mask:0xf bank_mask:0x3
    s_nop 0
    v_permlane32_swap_b32 v4, v20
    v_add_f32 v4, v4, v20
    v_rcp_f32 v4, v4
    v_mov_b32_dpp v39, v41 row_ror:8 row_mask:0xf bank_mask:0x3
    buffer_load_dword v0, v2, s[8:11], s64 offen sc1
    buffer_store_dwordx4 v[36:39], v1, s[8:11], s51 offen sc1
    v_pk_mul_f32 v[28:29], v[28:29], v[4:5] op_sel_hi:[1,0]
    v_pk_mul_f32 v[30:31], v[30:31], v[4:5] op_sel_hi:[1,0]
    v_pk_mul_f32 v[52:53], v[52:53], v[4:5] op_sel_hi:[1,0]
    v_pk_mul_f32 v[54:55], v[54:55], v[4:5] op_sel_hi:[1,0]
    v_cvt_pk_bf16_f32 v24, v28, v29
    v_cvt_pk_bf16_f32 v26, v30, v31
    v_cvt_pk_bf16_f32 v25, v52, v53
    v_cvt_pk_bf16_f32 v27, v54, v55
    s_andn2_b64 exec, exec, s[58:59]
    ds_write2_b64 v3, v[24:25], v[26:27] offset1:4
    s_mov_b64 exec, -1
    v_mov_b64 v[16:17], 0
    v_mov_b64 v[18:19], 0
    v_mov_b64 v[20:21], 0
    v_mov_b64 v[22:23], 0
    v_mov_b64 v[28:29], 0
    v_mov_b64 v[30:31], 0
    v_mov_b64 v[32:33], 0
    v_mov_b64 v[34:35], 0
    s_waitcnt lgkmcnt(0)
    s_barrier
    ds_read_b128 v[56:59], v8 offset:14336
    ds_read_b128 v[60:63], v8 offset:15360
    s_add_u32 s25, s68, 36864
    v_mov_b64 v[40:41], 0
    v_mov_b64 v[42:43], 0
    v_mov_b64 v[44:45], 0
    v_mov_b64 v[46:47], 0
    v_mov_b64 v[48:49], 0
    v_mov_b64 v[50:51], 0
    v_mov_b64 v[52:53], 0
    v_mov_b64 v[54:55], 0
    s_cmp_eq_u32 s33, 0
    s_cbranch_scc1 C_s2L
    buffer_load_dword v36, v2, s[8:11], s77 offen sc1
C_s2L:
    s_waitcnt lgkmcnt(1)
    v_smfmac_f32_16x16x64_bf16 v[16:19], v[56:59], v[96:103], v9
    s_waitcnt lgkmcnt(0)
    v_smfmac_f32_16x16x64_bf16 v[16:19], v[60:63], v[104:111], v9
    ds_read_b128 v[96:99], v13 offset:4096
    ds_read_b128 v[100:103], v13 offset:12288
    v_smfmac_f32_16x16x64_bf16 v[20:23], v[56:59], v[112:119], v9
    ds_read_b128 v[104:107], v13 offset:20480
    ds_read_b128 v[108:111], v13 offset:28672
    v_smfmac_f32_16x16x64_bf16 v[20:23], v[60:63], v[120:127], v9
    ds_read_b128 v[112:115], v13 offset:5120
    ds_read_b128 v[116:119], v13 offset:13312
    v_add_f32 v16, v16, v18
    v_add_f32 v17, v17, v19
    v_smfmac_f32_16x16x64_bf16 v[28:31], v[56:59], v[64:71], v9
    ds_read_b128 v[120:123], v13 offset:21504
    ds_read_b128 v[124:127], v13 offset:29696
    v_cvt_pk_bf16_f32 v24, v16, v17
    v_smfmac_f32_16x16x64_bf16 v[28:31], v[60:63], v[72:79], v9
    ds_read_b128 v[64:67], v13 offset:6144
    ds_read_b128 v[68:71], v13 offset:14336
    v_add_f32 v20, v20, v22
    v_add_f32 v21, v21, v23
    v_smfmac_f32_16x16x64_bf16 v[32:35], v[56:59], v[80:87], v9
    ds_read_b128 v[72:75], v13 offset:22528
    ds_read_b128 v[76:79], v13 offset:30720
    v_cvt_pk_bf16_f32 v25, v20, v21
    v_smfmac_f32_16x16x64_bf16 v[32:35], v[60:63], v[88:95], v9
    ds_read_b128 v[80:83], v13 offset:7168
    ds_read_b128 v[84:87], v13 offset:15360
    v_add_f32 v28, v28, v30
    v_add_f32 v29, v29, v31
    s_waitcnt lgkmcnt(12)
    v_smfmac_f32_16x16x64_bf16 v[40:43], v[56:59], v[96:103], v9
    ds_read_b128 v[88:91], v13 offset:23552
    ds_read_b128 v[92:95], v13 offset:31744
    v_cvt_pk_bf16_f32 v26, v28, v29
    s_waitcnt lgkmcnt(12)
    v_smfmac_f32_16x16x64_bf16 v[40:43], v[60:63], v[104:111], v9
    v_add_f32 v32, v32, v34
    v_add_f32 v33, v33, v35
    s_waitcnt lgkmcnt(10)
    v_smfmac_f32_16x16x64_bf16 v[44:47], v[56:59], v[112:119], v9
    v_cvt_pk_bf16_f32 v27, v32, v33
    buffer_store_dwordx4 v[24:27], v6, s[8:11], s68 offen
    s_waitcnt lgkmcnt(8)
    v_smfmac_f32_16x16x64_bf16 v[44:47], v[60:63], v[120:127], v9
    v_add_f32 v40, v40, v42
    v_add_f32 v41, v41, v43
    s_waitcnt lgkmcnt(6)
    v_smfmac_f32_16x16x64_bf16 v[48:51], v[56:59], v[64:71], v9
    v_cvt_pk_bf16_f32 v16, v40, v41
    s_waitcnt lgkmcnt(4)
    v_smfmac_f32_16x16x64_bf16 v[48:51], v[60:63], v[72:79], v9
    v_add_f32 v44, v44, v46
    v_add_f32 v45, v45, v47
    s_waitcnt lgkmcnt(2)
    v_smfmac_f32_16x16x64_bf16 v[52:55], v[56:59], v[80:87], v9
    v_cvt_pk_bf16_f32 v17, v44, v45
    s_waitcnt lgkmcnt(0)
    v_smfmac_f32_16x16x64_bf16 v[52:55], v[60:63], v[88:95], v9
    v_add_f32 v48, v48, v50
    v_add_f32 v49, v49, v51
    v_cvt_pk_bf16_f32 v18, v48, v49
    s_nop 4
    v_add_f32 v52, v52, v54
    v_add_f32 v53, v53, v55
    v_cvt_pk_bf16_f32 v19, v52, v53
    buffer_store_dwordx4 v[16:19], v6, s[8:11], s25 offen
    s_and_b32 s25, s24, 3
    s_mul_i32 s25, s25, 294912
    s_add_u32 s63, s70, s25
    ds_read_b128 v[96:99], v13 offset:0
    ds_read_b128 v[100:103], v13 offset:8192
    ds_read_b128 v[104:107], v13 offset:16384
    ds_read_b128 v[108:111], v13 offset:24576
    ds_read_b128 v[112:115], v13 offset:1024
    ds_read_b128 v[116:119], v13 offset:9216
    ds_read_b128 v[120:123], v13 offset:17408
    ds_read_b128 v[124:127], v13 offset:25600
    v_cndmask_b32 v92, 0, v7, s[40:41]
    v_cndmask_b32 v93, 0, v7, s[42:43]
    v_cndmask_b32 v94, 0, v7, s[44:45]
    v_cndmask_b32 v95, 0, v7, s[46:47]
    v_mov_b64 v[20:21], 0
    v_mov_b64 v[22:23], 0
    v_mov_b64 v[24:25], 0
    v_mov_b64 v[26:27], 0
    v_mov_b64 v[28:29], 0
    v_mov_b64 v[30:31], 0
    v_mov_b64 v[40:41], 0
    v_mov_b64 v[42:43], 0
    v_mov_b64 v[44:45], 0
    v_mov_b64 v[46:47], 0
    v_mov_b64 v[32:33], -1
    v_mov_b64 v[34:35], -1
    v_add_u32 v73, s67, v8
    s_add_u32 s24, s24, 1
    s_add_u32 s60, s60, 8192
    s_and_b32 s25, s24, 3
    s_mul_i32 s25, s25, 294912
    s_add_u32 s68, s73, s25
    s_add_u32 s51, s51, 131072
    s_mov_b32 s77, s64
    s_add_u32 s25, s24, 2
    s_min_u32 s25, s25, 63
    s_lshr_b32 s64, s25, 1
    s_lshl_b32 s64, s64, 11
    s_add_u32 s64, s64, s74
    s_bitcmp1_b32 s25, 0
    s_cselect_b32 s35, 0, s78
    s_add_u32 s64, s64, s35
    s_sub_u32 s25, s24, 1
    s_lshr_b32 s25, s25, 1
    s_lshl_b32 s25, s25, 10
    s_cmp_lt_u32 s24, 1
    s_cselect_b32 s25, 165675008, s25
    s_add_u32 s62, s72, s25
    s_cmp_eq_u32 s24, 63
    s_cselect_b32 s33, 3, s33
L_cr_20:
    buffer_load_dwordx4 v[80:83], v1, s[8:11], s63 offen sc1
    buffer_load_dwordx4 v[84:87], v1, s[8:11], s63 offen offset:1024 sc1
L_cr1_21:
    s_sub_u32 s30, s30, 1
    s_cbranch_scc1 M_done
    s_waitcnt vmcnt(0)
    v_mfma_f32_16x16x32_bf16 v[88:91], v[80:83], v[92:95], 0
    v_max3_u32 v4, v80, v81, v82
    v_max3_u32 v72, v83, v84, v85
    v_mfma_f32_16x16x32_bf16 v[88:91], v[84:87], v[92:95], v[88:91]
    v_max3_u32 v4, v4, v86, v87
    v_max_u32 v4, v4, v72
    v_cmp_eq_u32 vcc, -1, v4
    s_nop 0
    s_cbranch_vccnz L_cr_20
    s_nop 2
    v_permlane32_swap_b32 v88, v90
    v_permlane32_swap_b32 v89, v91
    v_pk_add_f32 v[88:89], v[88:89], v[90:91]
    v_mov_b64 v[90:91], v[88:89]
    s_nop 1
    v_permlane16_swap_b32 v88, v90
    v_permlane16_swap_b32 v89, v91
    v_pk_add_f32 v[88:89], v[88:89], v[90:91]
    v_cvt_pk_bf16_f32 v88, v88, v89
    v_min_u32 v88, -2, v88
    buffer_store_dword v88, v5, s[8:11], s71 offen
    v_add_u32 v72, s79, v1
    s_add_u32 s61, s61, 262144
    s_add_u32 s66, s66, 262144
    s_add_u32 s69, s69, 262144
    ds_read_b128 v[48:51], v72 offset:0
    ds_read_b128 v[52:55], v72 offset:1024
    ds_read_b128 v[56:59], v72 offset:2048
    ds_read_b128 v[60:63], v72 offset:3072
    v_mov_b64 v[16:17], 0
    v_mov_b64 v[18:19], 0
    s_add_u32 s71, s71, 8192
    v_readfirstlane_b32 s34, v0
    s_mov_b32 s65, s33
    v_xor_b32 v76, 2048, v73
    v_xor_b32 v84, 4096, v73
    v_xor_b32 v92, 6144, v73
    s_cmp_lt_u32 s34, 1
    s_cselect_b32 s33, 1, 0
    s_cmp_lg_u32 s65, 1
    s_cbranch_scc1 C_loopL
    v_readfirstlane_b32 s34, v36
    s_nop 0
    s_cmp_lt_u32 s34, 1
    s_cbranch_scc1 C_loopL
    s_mov_b32 s65, 0
    s_waitcnt lgkmcnt(0)
    s_sub_u32 s25, s61, 262144
    buffer_load_dwordx4 v[48:51], v1, s[8:11], s25 offen offset:0 sc1
    s_sub_u32 s25, s66, 262144
    buffer_load_dwordx4 v[52:55], v1, s[8:11], s25 offen offset:1024 sc1
    s_sub_u32 s25, s69, 262144
    buffer_load_dwordx4 v[56:59], v1, s[8:11], s25 offen offset:2048 sc1
    s_sub_u32 s25, s69, 262144
    buffer_load_dwordx4 v[60:63], v1, s[8:11], s25 offen offset:3072 sc1
    s_branch C_loopL
L_ck_19:
    s_cmp_eq_u32 s65, 3
    s_cbranch_scc1 L_ck_19f
    s_lshr_b32 s25, s24, 1
    s_lshl_b32 s25, s25, 11
    s_add_u32 s25, s25, s74
    s_bitcmp1_b32 s24, 0
    s_cselect_b32 s35, 0, s78
    s_add_u32 s25, s25, s35
L_w_22:
    buffer_load_dword v4, v2, s[8:11], s25 offen sc1
    s_waitcnt vmcnt(0)
    v_readfirstlane_b32 s34, v4
    s_nop 0
    s_cmp_ge_u32 s34, 1
    s_cbranch_scc1 L_wd_23
    s_sleep 1
    s_sub_u32 s30, s30, 1
    s_cbranch_scc0 L_w_22
    s_branch M_done
L_wd_23:
    s_sub_u32 s25, s61, 262144
    buffer_load_dwordx4 v[48:51], v1, s[8:11], s25 offen offset:0 sc1
    s_sub_u32 s25, s66, 262144
    buffer_load_dwordx4 v[52:55], v1, s[8:11], s25 offen offset:1024 sc1
    s_sub_u32 s25, s69, 262144
    buffer_load_dwordx4 v[56:59], v1, s[8:11], s25 offen offset:2048 sc1
    s_sub_u32 s25, s69, 262144
    buffer_load_dwordx4 v[60:63], v1, s[8:11], s25 offen offset:3072 sc1
    s_waitcnt vmcnt(0)
    s_branch L_ck_19r
L_ck_19f:
    s_nop 7
    v_smfmac_f32_16x16x64_bf16 v[40:43], v[76:79], v[152:159], v9
    v_smfmac_f32_16x16x64_bf16 v[44:47], v[76:79], v[216:223], v9
    v_smfmac_f32_16x16x64_bf16 v[40:43], v[80:83], v[160:167], v9
    v_smfmac_f32_16x16x64_bf16 v[44:47], v[80:83], v[224:231], v9
    v_smfmac_f32_16x16x64_bf16 v[40:43], v[84:87], v[168:175], v9
    v_smfmac_f32_16x16x64_bf16 v[44:47], v[84:87], v[232:239], v9
    v_smfmac_f32_16x16x64_bf16 v[40:43], v[88:91], v[176:183], v9
    v_smfmac_f32_16x16x64_bf16 v[44:47], v[88:91], v[240:247], v9
    v_smfmac_f32_16x16x64_bf16 v[40:43], v[92:95], v[184:191], v9
    v_smfmac_f32_16x16x64_bf16 v[44:47], v[92:95], v[248:255], v9
    s_nop 7
    v_add_f32 v40, v40, v42
    v_add_f32 v41, v41, v43
    v_add_f32 v44, v44, v46
    v_add_f32 v45, v45, v47
    v_cvt_pk_bf16_f32 v40, v40, v41
    v_cvt_pk_bf16_f32 v41, v44, v45
    s_nop 0
    v_mov_b32_dpp v36, v40 quad_perm:[0,1,2,3] row_mask:0xf bank_mask:0x3
    v_mov_b32_dpp v37, v41 quad_perm:[0,1,2,3] row_mask:0xf bank_mask:0x3
    v_mov_b32_dpp v38, v40 row_ror:8 row_mask:0xf bank_mask:0x3
    v_mov_b32_dpp v39, v41 row_ror:8 row_mask:0xf bank_mask:0x3
    s_nop 1
    s_branch C_last
C_last:
    buffer_store_dwordx4 v[36:39], v1, s[8:11], s51 offen sc1
    s_add_u32 s62, s72, 31744
    v_mov_b32 v3, 1
    s_waitcnt vmcnt(0)
    buffer_atomic_add v3, v2, s[8:11], s62 offen sc1
    s_branch M_done
R_A:
    s_sub_u32 s25, s22, 2
    s_lshl_b32 s25, s25, 5
    s_add_u32 s25, s25, s21
    s_mul_i32 s21, s25, 171
    s_lshr_b32 s21, s21, 9
    s_mul_i32 s26, s21, 3
    s_sub_u32 s22, s25, s26
    s_add_u32 s22, s22, 2
    s_lshl_b32 s28, s20, 15
    s_lshl_b32 s29, s20, 13
    s_add_u32 s29, s29, 131072
    v_and_b32 v29, 3, v0
    v_bfe_u32 v30, v0, 2, 2
    v_bfe_u32 v31, v0, 2, 4
    v_lshl_add_u32 v32, v6, 3, v30
    v_lshlrev_b32 v33, 8, v32
    v_lshl_add_u32 v33, v29, 3, v33
    v_xor_b32 v34, s20, v30
    v_lshl_add_u32 v33, v34, 6, v33
    s_mov_b32 s27, 0
    s_lshl_b32 s26, s27, 15
    v_add_u32 v40, s26, v33
    s_lshl_b32 s26, s27, 13
    s_add_u32 s26, s26, 131072
    v_add_u32 v44, s26, v33
    s_mov_b32 s27, 1
    s_lshl_b32 s26, s27, 15
    v_add_u32 v41, s26, v33
    s_lshl_b32 s26, s27, 13
    s_add_u32 s26, s26, 131072
    v_add_u32 v45, s26, v33
    s_mov_b32 s27, 2
    s_lshl_b32 s26, s27, 15
    v_add_u32 v42, s26, v33
    s_lshl_b32 s26, s27, 13
    s_add_u32 s26, s26, 131072
    v_add_u32 v46, s26, v33
    s_mov_b32 s27, 3
    s_lshl_b32 s26, s27, 15
    v_add_u32 v43, s26, v33
    s_lshl_b32 s26, s27, 13
    s_add_u32 s26, s26, 131072
    v_add_u32 v47, s26, v33
    v_lshlrev_b32 v33, 7, v32
    v_lshl_add_u32 v33, v29, 3, v33
    v_add_u32 v35, s28, v33
    v_add_u32 v36, s29, v33
    v_bfe_u32 v33, v0, 3, 3
    v_mul_u32_u24 v34, 2752, v33
    v_and_b32 v33, 7, v0
    v_lshl_add_u32 v34, v33, 4, v34
    v_cmp_gt_u32 vcc, 6, v33
    v_mov_b32 v33, 0x40000000
    s_nop 0
    v_cndmask_b32 v34, v33, v34, vcc
    v_lshlrev_b32 v19, 2, v6
    v_xor_b32 v19, v19, v5
    v_lshlrev_b32 v19, 4, v19
    v_lshl_add_u32 v16, v6, 13, v19
    v_lshl_add_u32 v19, v6, 10, v19
    v_lshlrev_b32 v32, 8, v31
    v_lshl_add_u32 v32, v29, 4, v32
    v_xor_b32 v33, 0, v30
    v_lshl_add_u32 v33, v33, 6, v32
    v_add_u32 v20, s28, v33
    v_add_u32 v24, s29, v33
    v_xor_b32 v33, 1, v30
    v_lshl_add_u32 v33, v33, 6, v32
    v_add_u32 v21, s28, v33
    v_add_u32 v25, s29, v33
    v_xor_b32 v33, 2, v30
    v_lshl_add_u32 v33, v33, 6, v32
    v_add_u32 v22, s28, v33
    v_add_u32 v26, s29, v33
    v_xor_b32 v33, 3, v30
    v_lshl_add_u32 v33, v33, 6, v32
    v_add_u32 v23, s28, v33
    v_add_u32 v27, s29, v33
    s_mov_b32 s96, s80
    s_and_b32 s97, s81, 0xffff
    s_mov_b32 s98, 0x400000
    s_mov_b32 s99, 0x20000
    s_mov_b32 s26, 4294934528
    s_mul_i32 s35, s21, 256
    s_add_u32 s26, s26, s35
    s_mul_i32 s35, s20, 1048576
    s_add_u32 s26, s26, s35
    s_add_u32 m0, s28, 0
    s_add_u32 s26, s26, 32768
    buffer_load_dwordx4 v16, s[96:99], s26 offen lds
    s_add_u32 m0, s28, 1024
    s_add_u32 s26, s26, 32768
    buffer_load_dwordx4 v16, s[96:99], s26 offen lds
    s_add_u32 m0, s28, 2048
    s_add_u32 s26, s26, 32768
    buffer_load_dwordx4 v16, s[96:99], s26 offen lds
    s_add_u32 m0, s28, 3072
    s_add_u32 s26, s26, 32768
    buffer_load_dwordx4 v16, s[96:99], s26 offen lds
    s_add_u32 m0, s28, 4096
    s_add_u32 s26, s26, 32768
    buffer_load_dwordx4 v16, s[96:99], s26 offen lds
    s_add_u32 m0, s28, 5120
    s_add_u32 s26, s26, 32768
    buffer_load_dwordx4 v16, s[96:99], s26 offen lds
    s_add_u32 m0, s28, 6144
    s_add_u32 s26, s26, 32768
    buffer_load_dwordx4 v16, s[96:99], s26 offen lds
    s_add_u32 m0, s28, 7168
    s_add_u32 s26, s26, 32768
    buffer_load_dwordx4 v16, s[96:99], s26 offen lds
    s_add_u32 m0, s28, 8192
    s_add_u32 s26, s26, 32768
    buffer_load_dwordx4 v16, s[96:99], s26 offen lds
    s_add_u32 m0, s28, 9216
    s_add_u32 s26, s26, 32768
    buffer_load_dwordx4 v16, s[96:99], s26 offen lds
    s_add_u32 m0, s28, 10240
    s_add_u32 s26, s26, 32768
    buffer_load_dwordx4 v16, s[96:99], s26 offen lds
    s_add_u32 m0, s28, 11264
    s_add_u32 s26, s26, 32768
    buffer_load_dwordx4 v16, s[96:99], s26 offen lds
    s_add_u32 m0, s28, 12288
    s_add_u32 s26, s26, 32768
    buffer_load_dwordx4 v16, s[96:99], s26 offen lds
    s_add_u32 m0, s28, 13312
    s_add_u32 s26, s26, 32768
    buffer_load_dwordx4 v16, s[96:99], s26 offen lds
    s_add_u32 m0, s28, 14336
    s_add_u32 s26, s26, 32768
    buffer_load_dwordx4 v16, s[96:99], s26 offen lds
    s_add_u32 m0, s28, 15360
    s_add_u32 s26, s26, 32768
    buffer_load_dwordx4 v16, s[96:99], s26 offen lds
    s_add_u32 m0, s28, 16384
    s_add_u32 s26, s26, 32768
    buffer_load_dwordx4 v16, s[96:99], s26 offen lds
    s_add_u32 m0, s28, 17408
    s_add_u32 s26, s26, 32768
    buffer_load_dwordx4 v16, s[96:99], s26 offen lds
    s_add_u32 m0, s28, 18432
    s_add_u32 s26, s26, 32768
    buffer_load_dwordx4 v16, s[96:99], s26 offen lds
    s_add_u32 m0, s28, 19456
    s_add_u32 s26, s26, 32768
    buffer_load_dwordx4 v16, s[96:99], s26 offen lds
    s_add_u32 m0, s28, 20480
    s_add_u32 s26, s26, 32768
    buffer_load_dwordx4 v16, s[96:99], s26 offen lds
    s_add_u32 m0, s28, 21504
    s_add_u32 s26, s26, 32768
    buffer_load_dwordx4 v16, s[96:99], s26 offen lds
    s_add_u32 m0, s28, 22528
    s_add_u32 s26, s26, 32768
    buffer_load_dwordx4 v16, s[96:99], s26 offen lds
    s_add_u32 m0, s28, 23552
    s_add_u32 s26, s26, 32768
    buffer_load_dwordx4 v16, s[96:99], s26 offen lds
    s_add_u32 m0, s28, 24576
    s_add_u32 s26, s26, 32768
    buffer_load_dwordx4 v16, s[96:99], s26 offen lds
    s_add_u32 m0, s28, 25600
    s_add_u32 s26, s26, 32768
    buffer_load_dwordx4 v16, s[96:99], s26 offen lds
    s_add_u32 m0, s28, 26624
    s_add_u32 s26, s26, 32768
    buffer_load_dwordx4 v16, s[96:99], s26 offen lds
    s_add_u32 m0, s28, 27648
    s_add_u32 s26, s26, 32768
    buffer_load_dwordx4 v16, s[96:99], s26 offen lds
    s_add_u32 m0, s28, 28672
    s_add_u32 s26, s26, 32768
    buffer_load_dwordx4 v16, s[96:99], s26 offen lds
    s_add_u32 m0, s28, 29696
    s_add_u32 s26, s26, 32768
    buffer_load_dwordx4 v16, s[96:99], s26 offen lds
    s_add_u32 m0, s28, 30720
    s_add_u32 s26, s26, 32768
    buffer_load_dwordx4 v16, s[96:99], s26 offen lds
    s_add_u32 m0, s28, 31744
    s_add_u32 s26, s26, 32768
    buffer_load_dwordx4 v16, s[96:99], s26 offen lds
    s_waitcnt vmcnt(24)
    s_barrier
    s_mov_b32 s96, s82
    s_and_b32 s97, s83, 0xffff
    s_mov_b32 s98, 0x400000
    s_mov_b32 s99, 0x20000
    s_mov_b32 s26, 4294934528
    s_mul_i32 s35, s21, 256
    s_add_u32 s26, s26, s35
    s_mul_i32 s35, s20, 1048576
    s_add_u32 s26, s26, s35
    s_add_u32 m0, s29, 0
    s_add_u32 s26, s26, 32768
    buffer_load_dwordx4 v16, s[96:99], s26 offen lds
    s_add_u32 m0, s29, 1024
    s_add_u32 s26, s26, 32768
    buffer_load_dwordx4 v16, s[96:99], s26 offen lds
    s_add_u32 m0, s29, 2048
    s_add_u32 s26, s26, 32768
    buffer_load_dwordx4 v16, s[96:99], s26 offen lds
    s_add_u32 m0, s29, 3072
    s_add_u32 s26, s26, 32768
    buffer_load_dwordx4 v16, s[96:99], s26 offen lds
    s_add_u32 m0, s29, 4096
    s_add_u32 s26, s26, 32768
    buffer_load_dwordx4 v16, s[96:99], s26 offen lds
    s_add_u32 m0, s29, 5120
    s_add_u32 s26, s26, 32768
    buffer_load_dwordx4 v16, s[96:99], s26 offen lds
    s_add_u32 m0, s29, 6144
    s_add_u32 s26, s26, 32768
    buffer_load_dwordx4 v16, s[96:99], s26 offen lds
    s_add_u32 m0, s29, 7168
    s_add_u32 s26, s26, 32768
    buffer_load_dwordx4 v16, s[96:99], s26 offen lds
    ds_read_b64_tr_b16 a[0:1], v40 offset:0
    ds_read_b64_tr_b16 a[2:3], v40 offset:1024
    ds_read_b64_tr_b16 a[64:65], v40 offset:32
    ds_read_b64_tr_b16 a[66:67], v40 offset:1056
    ds_read_b64_tr_b16 a[16:17], v41 offset:0
    ds_read_b64_tr_b16 a[18:19], v41 offset:1024
    ds_read_b64_tr_b16 a[80:81], v41 offset:32
    ds_read_b64_tr_b16 a[82:83], v41 offset:1056
    ds_read_b64_tr_b16 a[32:33], v42 offset:0
    ds_read_b64_tr_b16 a[34:35], v42 offset:1024
    ds_read_b64_tr_b16 a[96:97], v42 offset:32
    ds_read_b64_tr_b16 a[98:99], v42 offset:1056
    ds_read_b64_tr_b16 a[48:49], v43 offset:0
    ds_read_b64_tr_b16 a[50:51], v43 offset:1024
    ds_read_b64_tr_b16 a[112:113], v43 offset:32
    ds_read_b64_tr_b16 a[114:115], v43 offset:1056
    s_waitcnt lgkmcnt(0)
    s_waitcnt vmcnt(24)
    s_barrier
    s_add_u32 m0, s28, 0
    s_add_u32 s26, s26, 32768
    buffer_load_dwordx4 v16, s[96:99], s26 offen lds
    s_add_u32 m0, s28, 1024
    s_add_u32 s26, s26, 32768
    buffer_load_dwordx4 v16, s[96:99], s26 offen lds
    s_add_u32 m0, s28, 2048
    s_add_u32 s26, s26, 32768
    buffer_load_dwordx4 v16, s[96:99], s26 offen lds
    s_add_u32 m0, s28, 3072
    s_add_u32 s26, s26, 32768
    buffer_load_dwordx4 v16, s[96:99], s26 offen lds
    s_add_u32 m0, s28, 4096
    s_add_u32 s26, s26, 32768
    buffer_load_dwordx4 v16, s[96:99], s26 offen lds
    s_add_u32 m0, s28, 5120
    s_add_u32 s26, s26, 32768
    buffer_load_dwordx4 v16, s[96:99], s26 offen lds
    s_add_u32 m0, s28, 6144
    s_add_u32 s26, s26, 32768
    buffer_load_dwordx4 v16, s[96:99], s26 offen lds
    s_add_u32 m0, s28, 7168
    s_add_u32 s26, s26, 32768
    buffer_load_dwordx4 v16, s[96:99], s26 offen lds
    ds_read_b64_tr_b16 a[4:5], v40 offset:8192
    ds_read_b64_tr_b16 a[6:7], v40 offset:9216
    ds_read_b64_tr_b16 a[68:69], v40 offset:8224
    ds_read_b64_tr_b16 a[70:71], v40 offset:9248
    ds_read_b64_tr_b16 a[20:21], v41 offset:8192
    ds_read_b64_tr_b16 a[22:23], v41 offset:9216
    ds_read_b64_tr_b16 a[84:85], v41 offset:8224
    ds_read_b64_tr_b16 a[86:87], v41 offset:9248
    ds_read_b64_tr_b16 a[36:37], v42 offset:8192
    ds_read_b64_tr_b16 a[38:39], v42 offset:9216
    ds_read_b64_tr_b16 a[100:101], v42 offset:8224
    ds_read_b64_tr_b16 a[102:103], v42 offset:9248
    ds_read_b64_tr_b16 a[52:53], v43 offset:8192
    ds_read_b64_tr_b16 a[54:55], v43 offset:9216
    ds_read_b64_tr_b16 a[116:117], v43 offset:8224
    ds_read_b64_tr_b16 a[118:119], v43 offset:9248
    s_waitcnt lgkmcnt(0)
    s_waitcnt vmcnt(24)
    s_barrier
    s_add_u32 m0, s28, 8192
    s_add_u32 s26, s26, 32768
    buffer_load_dwordx4 v16, s[96:99], s26 offen lds
    s_add_u32 m0, s28, 9216
    s_add_u32 s26, s26, 32768
    buffer_load_dwordx4 v16, s[96:99], s26 offen lds
    s_add_u32 m0, s28, 10240
    s_add_u32 s26, s26, 32768
    buffer_load_dwordx4 v16, s[96:99], s26 offen lds
    s_add_u32 m0, s28, 11264
    s_add_u32 s26, s26, 32768
    buffer_load_dwordx4 v16, s[96:99], s26 offen lds
    s_add_u32 m0, s28, 12288
    s_add_u32 s26, s26, 32768
    buffer_load_dwordx4 v16, s[96:99], s26 offen lds
    s_add_u32 m0, s28, 13312
    s_add_u32 s26, s26, 32768
    buffer_load_dwordx4 v16, s[96:99], s26 offen lds
    s_add_u32 m0, s28, 14336
    s_add_u32 s26, s26, 32768
    buffer_load_dwordx4 v16, s[96:99], s26 offen lds
    s_add_u32 m0, s28, 15360
    s_add_u32 s26, s26, 32768
    buffer_load_dwordx4 v16, s[96:99], s26 offen lds
    ds_read_b64_tr_b16 a[8:9], v40 offset:16384
    ds_read_b64_tr_b16 a[10:11], v40 offset:17408
    ds_read_b64_tr_b16 a[72:73], v40 offset:16416
    ds_read_b64_tr_b16 a[74:75], v40 offset:17440
    ds_read_b64_tr_b16 a[24:25], v41 offset:16384
    ds_read_b64_tr_b16 a[26:27], v41 offset:17408
    ds_read_b64_tr_b16 a[88:89], v41 offset:16416
    ds_read_b64_tr_b16 a[90:91], v41 offset:17440
    ds_read_b64_tr_b16 a[40:41], v42 offset:16384
    ds_read_b64_tr_b16 a[42:43], v42 offset:17408
    ds_read_b64_tr_b16 a[104:105], v42 offset:16416
    ds_read_b64_tr_b16 a[106:107], v42 offset:17440
    ds_read_b64_tr_b16 a[56:57], v43 offset:16384
    ds_read_b64_tr_b16 a[58:59], v43 offset:17408
    ds_read_b64_tr_b16 a[120:121], v43 offset:16416
    ds_read_b64_tr_b16 a[122:123], v43 offset:17440
    s_waitcnt lgkmcnt(0)
    s_waitcnt vmcnt(24)
    s_barrier
    s_add_u32 m0, s28, 16384
    s_add_u32 s26, s26, 32768
    buffer_load_dwordx4 v16, s[96:99], s26 offen lds
    s_add_u32 m0, s28, 17408
    s_add_u32 s26, s26, 32768
    buffer_load_dwordx4 v16, s[96:99], s26 offen lds
    s_add_u32 m0, s28, 18432
    s_add_u32 s26, s26, 32768
    buffer_load_dwordx4 v16, s[96:99], s26 offen lds
    s_add_u32 m0, s28, 19456
    s_add_u32 s26, s26, 32768
    buffer_load_dwordx4 v16, s[96:99], s26 offen lds
    s_add_u32 m0, s28, 20480
    s_add_u32 s26, s26, 32768
    buffer_load_dwordx4 v16, s[96:99], s26 offen lds
    s_add_u32 m0, s28, 21504
    s_add_u32 s26, s26, 32768
    buffer_load_dwordx4 v16, s[96:99], s26 offen lds
    s_add_u32 m0, s28, 22528
    s_add_u32 s26, s26, 32768
    buffer_load_dwordx4 v16, s[96:99], s26 offen lds
    s_add_u32 m0, s28, 23552
    s_add_u32 s26, s26, 32768
    buffer_load_dwordx4 v16, s[96:99], s26 offen lds
    ds_read_b64_tr_b16 a[12:13], v40 offset:24576
    ds_read_b64_tr_b16 a[14:15], v40 offset:25600
    ds_read_b64_tr_b16 a[76:77], v40 offset:24608
    ds_read_b64_tr_b16 a[78:79], v40 offset:25632
    ds_read_b64_tr_b16 a[28:29], v41 offset:24576
    ds_read_b64_tr_b16 a[30:31], v41 offset:25600
    ds_read_b64_tr_b16 a[92:93], v41 offset:24608
    ds_read_b64_tr_b16 a[94:95], v41 offset:25632
    ds_read_b64_tr_b16 a[44:45], v42 offset:24576
    ds_read_b64_tr_b16 a[46:47], v42 offset:25600
    ds_read_b64_tr_b16 a[108:109], v42 offset:24608
    ds_read_b64_tr_b16 a[110:111], v42 offset:25632
    ds_read_b64_tr_b16 a[60:61], v43 offset:24576
    ds_read_b64_tr_b16 a[62:63], v43 offset:25600
    ds_read_b64_tr_b16 a[124:125], v43 offset:24608
    ds_read_b64_tr_b16 a[126:127], v43 offset:25632
    s_waitcnt lgkmcnt(0)
    s_waitcnt vmcnt(24)
    s_barrier
    s_mov_b32 s96, s84
    s_and_b32 s97, s85, 0xffff
    s_mov_b32 s98, 0x400000
    s_mov_b32 s99, 0x20000
    s_mov_b32 s26, 4294934528
    s_mul_i32 s35, s21, 256
    s_add_u32 s26, s26, s35
    s_mul_i32 s35, s20, 1048576
    s_add_u32 s26, s26, s35
    s_add_u32 m0, s28, 24576
    s_add_u32 s26, s26, 32768
    buffer_load_dwordx4 v16, s[96:99], s26 offen lds
    s_add_u32 m0, s28, 25600
    s_add_u32 s26, s26, 32768
    buffer_load_dwordx4 v16, s[96:99], s26 offen lds
    s_add_u32 m0, s28, 26624
    s_add_u32 s26, s26, 32768
    buffer_load_dwordx4 v16, s[96:99], s26 offen lds
    s_add_u32 m0, s28, 27648
    s_add_u32 s26, s26, 32768
    buffer_load_dwordx4 v16, s[96:99], s26 offen lds
    s_add_u32 m0, s28, 28672
    s_add_u32 s26, s26, 32768
    buffer_load_dwordx4 v16, s[96:99], s26 offen lds
    s_add_u32 m0, s28, 29696
    s_add_u32 s26, s26, 32768
    buffer_load_dwordx4 v16, s[96:99], s26 offen lds
    s_add_u32 m0, s28, 30720
    s_add_u32 s26, s26, 32768
    buffer_load_dwordx4 v16, s[96:99], s26 offen lds
    s_add_u32 m0, s28, 31744
    s_add_u32 s26, s26, 32768
    buffer_load_dwordx4 v16, s[96:99], s26 offen lds
    ds_read_b64_tr_b16 a[128:129], v44 offset:0
    ds_read_b64_tr_b16 a[130:131], v44 offset:1024
    ds_read_b64_tr_b16 a[192:193], v44 offset:32
    ds_read_b64_tr_b16 a[194:195], v44 offset:1056
    ds_read_b64_tr_b16 a[144:145], v45 offset:0
    ds_read_b64_tr_b16 a[146:147], v45 offset:1024
    ds_read_b64_tr_b16 a[208:209], v45 offset:32
    ds_read_b64_tr_b16 a[210:211], v45 offset:1056
    ds_read_b64_tr_b16 a[160:161], v46 offset:0
    ds_read_b64_tr_b16 a[162:163], v46 offset:1024
    ds_read_b64_tr_b16 a[224:225], v46 offset:32
    ds_read_b64_tr_b16 a[226:227], v46 offset:1056
    ds_read_b64_tr_b16 a[176:177], v47 offset:0
    ds_read_b64_tr_b16 a[178:179], v47 offset:1024
    ds_read_b64_tr_b16 a[240:241], v47 offset:32
    ds_read_b64_tr_b16 a[242:243], v47 offset:1056
    s_waitcnt lgkmcnt(0)
    s_waitcnt vmcnt(24)
    s_barrier
    s_add_u32 m0, s29, 0
    s_add_u32 s26, s26, 32768
    buffer_load_dwordx4 v16, s[96:99], s26 offen lds
    s_add_u32 m0, s29, 1024
    s_add_u32 s26, s26, 32768
    buffer_load_dwordx4 v16, s[96:99], s26 offen lds
    s_add_u32 m0, s29, 2048
    s_add_u32 s26, s26, 32768
    buffer_load_dwordx4 v16, s[96:99], s26 offen lds
    s_add_u32 m0, s29, 3072
    s_add_u32 s26, s26, 32768
    buffer_load_dwordx4 v16, s[96:99], s26 offen lds
    s_add_u32 m0, s29, 4096
    s_add_u32 s26, s26, 32768
    buffer_load_dwordx4 v16, s[96:99], s26 offen lds
    s_add_u32 m0, s29, 5120
    s_add_u32 s26, s26, 32768
    buffer_load_dwordx4 v16, s[96:99], s26 offen lds
    s_add_u32 m0, s29, 6144
    s_add_u32 s26, s26, 32768
    buffer_load_dwordx4 v16, s[96:99], s26 offen lds
    s_add_u32 m0, s29, 7168
    s_add_u32 s26, s26, 32768
    buffer_load_dwordx4 v16, s[96:99], s26 offen lds
    ds_read_b64_tr_b16 a[132:133], v40 offset:0
    ds_read_b64_tr_b16 a[134:135], v40 offset:1024
    ds_read_b64_tr_b16 a[196:197], v40 offset:32
    ds_read_b64_tr_b16 a[198:199], v40 offset:1056
    ds_read_b64_tr_b16 a[148:149], v41 offset:0
    ds_read_b64_tr_b16 a[150:151], v41 offset:1024
    ds_read_b64_tr_b16 a[212:213], v41 offset:32
    ds_read_b64_tr_b16 a[214:215], v41 offset:1056
    ds_read_b64_tr_b16 a[164:165], v42 offset:0
    ds_read_b64_tr_b16 a[166:167], v42 offset:1024
    ds_read_b64_tr_b16 a[228:229], v42 offset:32
    ds_read_b64_tr_b16 a[230:231], v42 offset:1056
    ds_read_b64_tr_b16 a[180:181], v43 offset:0
    ds_read_b64_tr_b16 a[182:183], v43 offset:1024
    ds_read_b64_tr_b16 a[244:245], v43 offset:32
    ds_read_b64_tr_b16 a[246:247], v43 offset:1056
    s_waitcnt lgkmcnt(0)
    s_waitcnt vmcnt(24)
    s_barrier
    s_add_u32 m0, s28, 0
    s_add_u32 s26, s26, 32768
    buffer_load_dwordx4 v16, s[96:99], s26 offen lds
    s_add_u32 m0, s28, 1024
    s_add_u32 s26, s26, 32768
    buffer_load_dwordx4 v16, s[96:99], s26 offen lds
    s_add_u32 m0, s28, 2048
    s_add_u32 s26, s26, 32768
    buffer_load_dwordx4 v16, s[96:99], s26 offen lds
    s_add_u32 m0, s28, 3072
    s_add_u32 s26, s26, 32768
    buffer_load_dwordx4 v16, s[96:99], s26 offen lds
    s_add_u32 m0, s28, 4096
    s_add_u32 s26, s26, 32768
    buffer_load_dwordx4 v16, s[96:99], s26 offen lds
    s_add_u32 m0, s28, 5120
    s_add_u32 s26, s26, 32768
    buffer_load_dwordx4 v16, s[96:99], s26 offen lds
    s_add_u32 m0, s28, 6144
    s_add_u32 s26, s26, 32768
    buffer_load_dwordx4 v16, s[96:99], s26 offen lds
    s_add_u32 m0, s28, 7168
    s_add_u32 s26, s26, 32768
    buffer_load_dwordx4 v16, s[96:99], s26 offen lds
    ds_read_b64_tr_b16 a[136:137], v40 offset:8192
    ds_read_b64_tr_b16 a[138:139], v40 offset:9216
    ds_read_b64_tr_b16 a[200:201], v40 offset:8224
    ds_read_b64_tr_b16 a[202:203], v40 offset:9248
    ds_read_b64_tr_b16 a[152:153], v41 offset:8192
    ds_read_b64_tr_b16 a[154:155], v41 offset:9216
    ds_read_b64_tr_b16 a[216:217], v41 offset:8224
    ds_read_b64_tr_b16 a[218:219], v41 offset:9248
    ds_read_b64_tr_b16 a[168:169], v42 offset:8192
    ds_read_b64_tr_b16 a[170:171], v42 offset:9216
    ds_read_b64_tr_b16 a[232:233], v42 offset:8224
    ds_read_b64_tr_b16 a[234:235], v42 offset:9248
    ds_read_b64_tr_b16 a[184:185], v43 offset:8192
    ds_read_b64_tr_b16 a[186:187], v43 offset:9216
    ds_read_b64_tr_b16 a[248:249], v43 offset:8224
    ds_read_b64_tr_b16 a[250:251], v43 offset:9248
    s_waitcnt lgkmcnt(0)
    s_waitcnt vmcnt(24)
    s_barrier
    s_add_u32 m0, s28, 8192
    s_add_u32 s26, s26, 32768
    buffer_load_dwordx4 v16, s[96:99], s26 offen lds
    s_add_u32 m0, s28, 9216
    s_add_u32 s26, s26, 32768
    buffer_load_dwordx4 v16, s[96:99], s26 offen lds
    s_add_u32 m0, s28, 10240
    s_add_u32 s26, s26, 32768
    buffer_load_dwordx4 v16, s[96:99], s26 offen lds
    s_add_u32 m0, s28, 11264
    s_add_u32 s26, s26, 32768
    buffer_load_dwordx4 v16, s[96:99], s26 offen lds
    s_add_u32 m0, s28, 12288
    s_add_u32 s26, s26, 32768
    buffer_load_dwordx4 v16, s[96:99], s26 offen lds
    s_add_u32 m0, s28, 13312
    s_add_u32 s26, s26, 32768
    buffer_load_dwordx4 v16, s[96:99], s26 offen lds
    s_add_u32 m0, s28, 14336
    s_add_u32 s26, s26, 32768
    buffer_load_dwordx4 v16, s[96:99], s26 offen lds
    s_add_u32 m0, s28, 15360
    s_add_u32 s26, s26, 32768
    buffer_load_dwordx4 v16, s[96:99], s26 offen lds
    ds_read_b64_tr_b16 a[140:141], v40 offset:16384
    ds_read_b64_tr_b16 a[142:143], v40 offset:17408
    ds_read_b64_tr_b16 a[204:205], v40 offset:16416
    ds_read_b64_tr_b16 a[206:207], v40 offset:17440
    ds_read_b64_tr_b16 a[156:157], v41 offset:16384
    ds_read_b64_tr_b16 a[158:159], v41 offset:17408
    ds_read_b64_tr_b16 a[220:221], v41 offset:16416
    ds_read_b64_tr_b16 a[222:223], v41 offset:17440
    ds_read_b64_tr_b16 a[172:173], v42 offset:16384
    ds_read_b64_tr_b16 a[174:175], v42 offset:17408
    ds_read_b64_tr_b16 a[236:237], v42 offset:16416
    ds_read_b64_tr_b16 a[238:239], v42 offset:17440
    ds_read_b64_tr_b16 a[188:189], v43 offset:16384
    ds_read_b64_tr_b16 a[190:191], v43 offset:17408
    ds_read_b64_tr_b16 a[252:253], v43 offset:16416
    ds_read_b64_tr_b16 a[254:255], v43 offset:17440
    s_waitcnt lgkmcnt(0)
    s_waitcnt vmcnt(24)
    s_barrier
    ds_read_b64_tr_b16 v[128:129], v40 offset:24576
    ds_read_b64_tr_b16 v[130:131], v40 offset:25600
    ds_read_b64_tr_b16 v[192:193], v40 offset:24608
    ds_read_b64_tr_b16 v[194:195], v40 offset:25632
    ds_read_b64_tr_b16 v[144:145], v41 offset:24576
    ds_read_b64_tr_b16 v[146:147], v41 offset:25600
    ds_read_b64_tr_b16 v[208:209], v41 offset:24608
    ds_read_b64_tr_b16 v[210:211], v41 offset:25632
    ds_read_b64_tr_b16 v[160:161], v42 offset:24576
    ds_read_b64_tr_b16 v[162:163], v42 offset:25600
    ds_read_b64_tr_b16 v[224:225], v42 offset:24608
    ds_read_b64_tr_b16 v[226:227], v42 offset:25632
    ds_read_b64_tr_b16 v[176:177], v43 offset:24576
    ds_read_b64_tr_b16 v[178:179], v43 offset:25600
    ds_read_b64_tr_b16 v[240:241], v43 offset:24608
    ds_read_b64_tr_b16 v[242:243], v43 offset:25632
    s_waitcnt lgkmcnt(0)
    s_waitcnt vmcnt(16)
    s_barrier
    ds_read_b64_tr_b16 v[132:133], v44 offset:0
    ds_read_b64_tr_b16 v[134:135], v44 offset:1024
    ds_read_b64_tr_b16 v[196:197], v44 offset:32
    ds_read_b64_tr_b16 v[198:199], v44 offset:1056
    ds_read_b64_tr_b16 v[148:149], v45 offset:0
    ds_read_b64_tr_b16 v[150:151], v45 offset:1024
    ds_read_b64_tr_b16 v[212:213], v45 offset:32
    ds_read_b64_tr_b16 v[214:215], v45 offset:1056
    ds_read_b64_tr_b16 v[164:165], v46 offset:0
    ds_read_b64_tr_b16 v[166:167], v46 offset:1024
    ds_read_b64_tr_b16 v[228:229], v46 offset:32
    ds_read_b64_tr_b16 v[230:231], v46 offset:1056
    ds_read_b64_tr_b16 v[180:181], v47 offset:0
    ds_read_b64_tr_b16 v[182:183], v47 offset:1024
    ds_read_b64_tr_b16 v[244:245], v47 offset:32
    ds_read_b64_tr_b16 v[246:247], v47 offset:1056
    s_waitcnt lgkmcnt(0)
    s_waitcnt vmcnt(8)
    s_barrier
    ds_read_b64_tr_b16 v[136:137], v40 offset:0
    ds_read_b64_tr_b16 v[138:139], v40 offset:1024
    ds_read_b64_tr_b16 v[200:201], v40 offset:32
    ds_read_b64_tr_b16 v[202:203], v40 offset:1056
    ds_read_b64_tr_b16 v[152:153], v41 offset:0
    ds_read_b64_tr_b16 v[154:155], v41 offset:1024
    ds_read_b64_tr_b16 v[216:217], v41 offset:32
    ds_read_b64_tr_b16 v[218:219], v41 offset:1056
    ds_read_b64_tr_b16 v[168:169], v42 offset:0
    ds_read_b64_tr_b16 v[170:171], v42 offset:1024
    ds_read_b64_tr_b16 v[232:233], v42 offset:32
    ds_read_b64_tr_b16 v[234:235], v42 offset:1056
    ds_read_b64_tr_b16 v[184:185], v43 offset:0
    ds_read_b64_tr_b16 v[186:187], v43 offset:1024
    ds_read_b64_tr_b16 v[248:249], v43 offset:32
    ds_read_b64_tr_b16 v[250:251], v43 offset:1056
    s_waitcnt lgkmcnt(0)
    s_waitcnt vmcnt(0)
    s_barrier
    ds_read_b64_tr_b16 v[140:141], v40 offset:8192
    ds_read_b64_tr_b16 v[142:143], v40 offset:9216
    ds_read_b64_tr_b16 v[204:205], v40 offset:8224
    ds_read_b64_tr_b16 v[206:207], v40 offset:9248
    ds_read_b64_tr_b16 v[156:157], v41 offset:8192
    ds_read_b64_tr_b16 v[158:159], v41 offset:9216
    ds_read_b64_tr_b16 v[220:221], v41 offset:8224
    ds_read_b64_tr_b16 v[222:223], v41 offset:9248
    ds_read_b64_tr_b16 v[172:173], v42 offset:8192
    ds_read_b64_tr_b16 v[174:175], v42 offset:9216
    ds_read_b64_tr_b16 v[236:237], v42 offset:8224
    ds_read_b64_tr_b16 v[238:239], v42 offset:9248
    ds_read_b64_tr_b16 v[188:189], v43 offset:8192
    ds_read_b64_tr_b16 v[190:191], v43 offset:9216
    ds_read_b64_tr_b16 v[252:253], v43 offset:8224
    ds_read_b64_tr_b16 v[254:255], v43 offset:9248
    s_waitcnt lgkmcnt(0)
    v_and_b32 v7, 7, v5
    v_lshlrev_b32 v7, 2, v7
    v_add_u32 v8, 0, v6
    v_xor_b32 v8, v8, v5
    v_lshlrev_b32 v8, 4, v8
    v_lshl_add_u32 v8, v5, 10, v8
    v_add_u32 v9, 4, v6
    v_xor_b32 v9, v9, v5
    v_lshlrev_b32 v9, 4, v9
    v_lshl_add_u32 v9, v5, 10, v9
    v_add_u32 v10, 8, v6
    v_xor_b32 v10, v10, v5
    v_lshlrev_b32 v10, 4, v10
    v_lshl_add_u32 v10, v5, 10, v10
    v_add_u32 v11, 12, v6
    v_xor_b32 v11, v11, v5
    v_lshlrev_b32 v11, 4, v11
    v_lshl_add_u32 v11, v5, 10, v11
    s_cmp_lg_u32 s20, 0
    s_cbranch_scc1 L_wd_25
L_w_24:
    buffer_load_dword v4, v2, s[4:7], 0 offen offset:192 sc1
    s_waitcnt vmcnt(0)
    v_readfirstlane_b32 s34, v4
    s_nop 0
    s_cmp_ge_u32 s34, 16
    s_cbranch_scc1 L_wd_25
    s_sleep 2
    s_sub_u32 s30, s30, 1
    s_cbranch_scc0 L_w_24
    s_branch M_done
L_wd_25:
    s_barrier
    s_mov_b32 s43, 0
    s_sub_u32 s40, s22, 2
    s_add_u32 s41, s40, 33
    s_cmp_eq_u32 s40, 2
    s_cselect_b32 s41, 32, s41
    s_lshl_b32 s25, s40, 3
    s_lshr_b32 s42, 329222, s25
    s_and_b32 s42, s42, 255
A_loop:
    s_cmp_eq_u32 s42, 0
    s_cbranch_scc1 A_l2
    s_cmp_ge_u32 s40, 32
    s_cbranch_scc1 A_l2
    s_mov_b32 s24, s40
    s_add_u32 s40, s40, 3
    s_sub_u32 s42, s42, 1
    s_branch A_go
A_l2:
    s_cmp_ge_u32 s41, 64
    s_cbranch_scc1 M_done
    s_mov_b32 s24, s41
    s_add_u32 s41, s41, 3
    s_mov_b32 s42, 1
    s_lshl_b32 s26, s24, 7
    s_lshl_b32 s35, s20, 5
    s_add_u32 s26, s26, s35
    s_add_u32 s26, s26, 35881728
L_wf_26:
    buffer_load_dword v4, v7, s[8:11], s26 offen sc1
    s_waitcnt vmcnt(0)
    v_cmp_eq_u32 vcc, 0, v4
    s_nop 0
    s_cbranch_vccz L_wfd_27
    s_sleep 2
    s_sub_u32 s30, s30, 1
    s_cbranch_scc0 L_wf_26
    s_branch M_done
L_wfd_27:
A_go:
    s_lshl_b32 s62, s24, 16
    s_lshl_b32 s63, s20, 14
    s_add_u32 s62, s62, s63
    s_add_u32 s62, s62, 20971520
    s_add_u32 m0, s63, 0
    v_xor_b32 v14, 0, v1
    buffer_load_dwordx4 v14, s[8:11], s62 offen offset:0 lds
    v_xor_b32 v15, 16, v1
    buffer_load_dwordx4 v15, s[8:11], s62 offen offset:1024 lds
    v_xor_b32 v14, 32, v1
    buffer_load_dwordx4 v14, s[8:11], s62 offen offset:2048 lds
    v_xor_b32 v15, 48, v1
    buffer_load_dwordx4 v15, s[8:11], s62 offen offset:3072 lds
    s_add_u32 s62, s62, 4096
    s_add_u32 m0, s63, 4096
    v_xor_b32 v14, 64, v1
    buffer_load_dwordx4 v14, s[8:11], s62 offen offset:0 lds
    v_xor_b32 v15, 80, v1
    buffer_load_dwordx4 v15, s[8:11], s62 offen offset:1024 lds
    v_xor_b32 v14, 96, v1
    buffer_load_dwordx4 v14, s[8:11], s62 offen offset:2048 lds
    v_xor_b32 v15, 112, v1
    buffer_load_dwordx4 v15, s[8:11], s62 offen offset:3072 lds
    s_add_u32 s62, s62, 4096
    s_add_u32 m0, s63, 8192
    v_xor_b32 v14, 128, v1
    buffer_load_dwordx4 v14, s[8:11], s62 offen offset:0 lds
    v_xor_b32 v15, 144, v1
    buffer_load_dwordx4 v15, s[8:11], s62 offen offset:1024 lds
    v_xor_b32 v14, 160, v1
    buffer_load_dwordx4 v14, s[8:11], s62 offen offset:2048 lds
    v_xor_b32 v15, 176, v1
    buffer_load_dwordx4 v15, s[8:11], s62 offen offset:3072 lds
    s_add_u32 s62, s62, 4096
    s_add_u32 m0, s63, 12288
    v_xor_b32 v14, 192, v1
    buffer_load_dwordx4 v14, s[8:11], s62 offen offset:0 lds
    v_xor_b32 v15, 208, v1
    buffer_load_dwordx4 v15, s[8:11], s62 offen offset:1024 lds
    v_xor_b32 v14, 224, v1
    buffer_load_dwordx4 v14, s[8:11], s62 offen offset:2048 lds
    v_xor_b32 v15, 240, v1
    buffer_load_dwordx4 v15, s[8:11], s62 offen offset:3072 lds
    s_waitcnt vmcnt(0)
    s_barrier
    s_lshl_b32 s27, s24, 19
    s_lshl_b32 s26, s21, 12
    s_add_u32 s27, s27, s26
    s_lshl_b32 s26, s20, 10
    s_add_u32 s27, s27, s26
    s_add_u32 s29, s27, 75497472
    s_add_u32 s27, s27, 41943040
    s_lshl_b32 s28, s24, 19
    s_lshl_b32 s26, s21, 13
    s_add_u32 s28, s28, s26
    s_lshl_b32 s26, s20, 11
    s_add_u32 s28, s28, s26
    s_add_u32 s28, s28, 109051904
    s_mov_b32 s26, 35651584
    s_mul_i32 s35, s24, 2048
    s_add_u32 s26, s26, s35
    s_mul_i32 s35, s21, 64
    s_add_u32 s26, s26, s35
    s_lshl_b32 s45, s20, 2
    s_add_u32 s45, s45, s26
    s_add_u32 s45, s45, 16
    s_add_u32 s44, s45, 165675008
    s_cmp_eq_u32 s43, 0
    s_cselect_b32 s44, s44, s45
    ds_read_b128 v[64:67], v8 offset:0
    ds_read_b128 v[68:71], v9 offset:0
    ds_read_b128 v[72:75], v10 offset:0
    ds_read_b128 v[76:79], v11 offset:0
    ds_read_b128 v[80:83], v8 offset:256
    ds_read_b128 v[84:87], v9 offset:256
    ds_read_b128 v[88:91], v10 offset:256
    s_waitcnt lgkmcnt(6)
    v_mfma_f32_16x16x32_bf16 v[16:19], a[0:3], v[64:67], 0
    v_mfma_f32_16x16x32_bf16 v[20:23], a[64:67], v[64:67], 0
    v_mfma_f32_16x16x32_bf16 v[24:27], a[128:131], v[64:67], 0
    v_mfma_f32_16x16x32_bf16 v[28:31], a[192:195], v[64:67], 0
    v_mfma_f32_16x16x32_bf16 v[32:35], v[64:67], v[128:131], 0
    v_mfma_f32_16x16x32_bf16 v[36:39], v[64:67], v[192:195], 0
    ds_read_b128 v[92:95], v11 offset:256
    s_waitcnt lgkmcnt(6)
    v_mfma_f32_16x16x32_bf16 v[16:19], a[4:7], v[68:71], v[16:19]
    v_mfma_f32_16x16x32_bf16 v[20:23], a[68:71], v[68:71], v[20:23]
    v_mfma_f32_16x16x32_bf16 v[24:27], a[132:135], v[68:71], v[24:27]
    v_mfma_f32_16x16x32_bf16 v[28:31], a[196:199], v[68:71], v[28:31]
    v_mfma_f32_16x16x32_bf16 v[32:35], v[68:71], v[132:135], v[32:35]
    v_mfma_f32_16x16x32_bf16 v[36:39], v[68:71], v[196:199], v[36:39]
    ds_read_b128 v[64:67], v8 offset:512
    s_waitcnt lgkmcnt(6)
    v_mfma_f32_16x16x32_bf16 v[16:19], a[8:11], v[72:75], v[16:19]
    v_mfma_f32_16x16x32_bf16 v[20:23], a[72:75], v[72:75], v[20:23]
    v_mfma_f32_16x16x32_bf16 v[24:27], a[136:139], v[72:75], v[24:27]
    v_mfma_f32_16x16x32_bf16 v[28:31], a[200:203], v[72:75], v[28:31]
    v_mfma_f32_16x16x32_bf16 v[32:35], v[72:75], v[136:139], v[32:35]
    v_mfma_f32_16x16x32_bf16 v[36:39], v[72:75], v[200:203], v[36:39]
    ds_read_b128 v[68:71], v9 offset:512
    s_waitcnt lgkmcnt(6)
    v_mfma_f32_16x16x32_bf16 v[16:19], a[12:15], v[76:79], v[16:19]
    v_mfma_f32_16x16x32_bf16 v[20:23], a[76:79], v[76:79], v[20:23]
    v_mfma_f32_16x16x32_bf16 v[24:27], a[140:143], v[76:79], v[24:27]
    v_mfma_f32_16x16x32_bf16 v[28:31], a[204:207], v[76:79], v[28:31]
    v_mfma_f32_16x16x32_bf16 v[32:35], v[76:79], v[140:143], v[32:35]
    v_mfma_f32_16x16x32_bf16 v[36:39], v[76:79], v[204:207], v[36:39]
    ds_read_b128 v[72:75], v10 offset:512
    s_waitcnt lgkmcnt(6)
    v_mfma_f32_16x16x32_bf16 v[16:19], a[16:19], v[80:83], v[16:19]
    v_mfma_f32_16x16x32_bf16 v[20:23], a[80:83], v[80:83], v[20:23]
    v_mfma_f32_16x16x32_bf16 v[24:27], a[144:147], v[80:83], v[24:27]
    v_mfma_f32_16x16x32_bf16 v[28:31], a[208:211], v[80:83], v[28:31]
    v_mfma_f32_16x16x32_bf16 v[32:35], v[80:83], v[144:147], v[32:35]
    v_mfma_f32_16x16x32_bf16 v[36:39], v[80:83], v[208:211], v[36:39]
    ds_read_b128 v[76:79], v11 offset:512
    s_waitcnt lgkmcnt(6)
    v_mfma_f32_16x16x32_bf16 v[16:19], a[20:23], v[84:87], v[16:19]
    v_mfma_f32_16x16x32_bf16 v[20:23], a[84:87], v[84:87], v[20:23]
    v_mfma_f32_16x16x32_bf16 v[24:27], a[148:151], v[84:87], v[24:27]
    v_mfma_f32_16x16x32_bf16 v[28:31], a[212:215], v[84:87], v[28:31]
    v_mfma_f32_16x16x32_bf16 v[32:35], v[84:87], v[148:151], v[32:35]
    v_mfma_f32_16x16x32_bf16 v[36:39], v[84:87], v[212:215], v[36:39]
    ds_read_b128 v[80:83], v8 offset:768
    s_waitcnt lgkmcnt(6)
    v_mfma_f32_16x16x32_bf16 v[16:19], a[24:27], v[88:91], v[16:19]
    v_mfma_f32_16x16x32_bf16 v[20:23], a[88:91], v[88:91], v[20:23]
    v_mfma_f32_16x16x32_bf16 v[24:27], a[152:155], v[88:91], v[24:27]
    v_mfma_f32_16x16x32_bf16 v[28:31], a[216:219], v[88:91], v[28:31]
    v_mfma_f32_16x16x32_bf16 v[32:35], v[88:91], v[152:155], v[32:35]
    v_mfma_f32_16x16x32_bf16 v[36:39], v[88:91], v[216:219], v[36:39]
    ds_read_b128 v[84:87], v9 offset:768
    s_waitcnt lgkmcnt(6)
    v_mfma_f32_16x16x32_bf16 v[16:19], a[28:31], v[92:95], v[16:19]
    v_mfma_f32_16x16x32_bf16 v[20:23], a[92:95], v[92:95], v[20:23]
    v_mfma_f32_16x16x32_bf16 v[24:27], a[156:159], v[92:95], v[24:27]
    v_mfma_f32_16x16x32_bf16 v[28:31], a[220:223], v[92:95], v[28:31]
    v_mfma_f32_16x16x32_bf16 v[32:35], v[92:95], v[156:159], v[32:35]
    v_mfma_f32_16x16x32_bf16 v[36:39], v[92:95], v[220:223], v[36:39]
    ds_read_b128 v[88:91], v10 offset:768
    s_waitcnt lgkmcnt(6)
    v_mfma_f32_16x16x32_bf16 v[16:19], a[32:35], v[64:67], v[16:19]
    v_mfma_f32_16x16x32_bf16 v[20:23], a[96:99], v[64:67], v[20:23]
    v_mfma_f32_16x16x32_bf16 v[24:27], a[160:163], v[64:67], v[24:27]
    v_mfma_f32_16x16x32_bf16 v[28:31], a[224:227], v[64:67], v[28:31]
    v_mfma_f32_16x16x32_bf16 v[32:35], v[64:67], v[160:163], v[32:35]
    v_mfma_f32_16x16x32_bf16 v[36:39], v[64:67], v[224:227], v[36:39]
    ds_read_b128 v[92:95], v11 offset:768
    s_waitcnt lgkmcnt(6)
    v_mfma_f32_16x16x32_bf16 v[16:19], a[36:39], v[68:71], v[16:19]
    v_mfma_f32_16x16x32_bf16 v[20:23], a[100:103], v[68:71], v[20:23]
    v_mfma_f32_16x16x32_bf16 v[24:27], a[164:167], v[68:71], v[24:27]
    v_mfma_f32_16x16x32_bf16 v[28:31], a[228:231], v[68:71], v[28:31]
    v_mfma_f32_16x16x32_bf16 v[32:35], v[68:71], v[164:167], v[32:35]
    v_mfma_f32_16x16x32_bf16 v[36:39], v[68:71], v[228:231], v[36:39]
    ds_read_b128 v[64:67], v8 offset:16384
    s_waitcnt lgkmcnt(6)
    v_mfma_f32_16x16x32_bf16 v[16:19], a[40:43], v[72:75], v[16:19]
    v_mfma_f32_16x16x32_bf16 v[20:23], a[104:107], v[72:75], v[20:23]
    v_mfma_f32_16x16x32_bf16 v[24:27], a[168:171], v[72:75], v[24:27]
    v_mfma_f32_16x16x32_bf16 v[28:31], a[232:235], v[72:75], v[28:31]
    v_mfma_f32_16x16x32_bf16 v[32:35], v[72:75], v[168:171], v[32:35]
    v_mfma_f32_16x16x32_bf16 v[36:39], v[72:75], v[232:235], v[36:39]
    ds_read_b128 v[68:71], v9 offset:16384
    s_waitcnt lgkmcnt(6)
    v_mfma_f32_16x16x32_bf16 v[16:19], a[44:47], v[76:79], v[16:19]
    v_mfma_f32_16x16x32_bf16 v[20:23], a[108:111], v[76:79], v[20:23]
    v_mfma_f32_16x16x32_bf16 v[24:27], a[172:175], v[76:79], v[24:27]
    v_mfma_f32_16x16x32_bf16 v[28:31], a[236:239], v[76:79], v[28:31]
    v_mfma_f32_16x16x32_bf16 v[32:35], v[76:79], v[172:175], v[32:35]
    v_mfma_f32_16x16x32_bf16 v[36:39], v[76:79], v[236:239], v[36:39]
    ds_read_b128 v[72:75], v10 offset:16384
    s_waitcnt lgkmcnt(6)
    v_mfma_f32_16x16x32_bf16 v[16:19], a[48:51], v[80:83], v[16:19]
    v_mfma_f32_16x16x32_bf16 v[20:23], a[112:115], v[80:83], v[20:23]
    v_mfma_f32_16x16x32_bf16 v[24:27], a[176:179], v[80:83], v[24:27]
    v_mfma_f32_16x16x32_bf16 v[28:31], a[240:243], v[80:83], v[28:31]
    v_mfma_f32_16x16x32_bf16 v[32:35], v[80:83], v[176:179], v[32:35]
    v_mfma_f32_16x16x32_bf16 v[36:39], v[80:83], v[240:243], v[36:39]
    ds_read_b128 v[76:79], v11 offset:16384
    s_waitcnt lgkmcnt(6)
    v_mfma_f32_16x16x32_bf16 v[16:19], a[52:55], v[84:87], v[16:19]
    v_mfma_f32_16x16x32_bf16 v[20:23], a[116:119], v[84:87], v[20:23]
    v_mfma_f32_16x16x32_bf16 v[24:27], a[180:183], v[84:87], v[24:27]
    v_mfma_f32_16x16x32_bf16 v[28:31], a[244:247], v[84:87], v[28:31]
    v_mfma_f32_16x16x32_bf16 v[32:35], v[84:87], v[180:183], v[32:35]
    v_mfma_f32_16x16x32_bf16 v[36:39], v[84:87], v[244:247], v[36:39]
    ds_read_b128 v[80:83], v8 offset:16640
    s_waitcnt lgkmcnt(6)
    v_mfma_f32_16x16x32_bf16 v[16:19], a[56:59], v[88:91], v[16:19]
    v_mfma_f32_16x16x32_bf16 v[20:23], a[120:123], v[88:91], v[20:23]
    v_mfma_f32_16x16x32_bf16 v[24:27], a[184:187], v[88:91], v[24:27]
    v_mfma_f32_16x16x32_bf16 v[28:31], a[248:251], v[88:91], v[28:31]
    v_mfma_f32_16x16x32_bf16 v[32:35], v[88:91], v[184:187], v[32:35]
    v_mfma_f32_16x16x32_bf16 v[36:39], v[88:91], v[248:251], v[36:39]
    ds_read_b128 v[84:87], v9 offset:16640
    s_waitcnt lgkmcnt(6)
    v_mfma_f32_16x16x32_bf16 v[16:19], a[60:63], v[92:95], v[16:19]
    v_mfma_f32_16x16x32_bf16 v[20:23], a[124:127], v[92:95], v[20:23]
    v_mfma_f32_16x16x32_bf16 v[24:27], a[188:191], v[92:95], v[24:27]
    v_mfma_f32_16x16x32_bf16 v[28:31], a[252:255], v[92:95], v[28:31]
    v_mfma_f32_16x16x32_bf16 v[32:35], v[92:95], v[188:191], v[32:35]
    v_mfma_f32_16x16x32_bf16 v[36:39], v[92:95], v[252:255], v[36:39]
    ds_read_b128 v[88:91], v10 offset:16640
    s_waitcnt lgkmcnt(6)
    v_mfma_f32_16x16x32_bf16 v[40:43], a[0:3], v[64:67], 0
    v_mfma_f32_16x16x32_bf16 v[44:47], a[64:67], v[64:67], 0
    v_mfma_f32_16x16x32_bf16 v[48:51], a[128:131], v[64:67], 0
    v_mfma_f32_16x16x32_bf16 v[52:55], a[192:195], v[64:67], 0
    v_mfma_f32_16x16x32_bf16 v[56:59], v[64:67], v[128:131], 0
    v_mfma_f32_16x16x32_bf16 v[60:63], v[64:67], v[192:195], 0
    ds_read_b128 v[92:95], v11 offset:16640
    s_waitcnt lgkmcnt(6)
    v_mfma_f32_16x16x32_bf16 v[40:43], a[4:7], v[68:71], v[40:43]
    v_cvt_pk_bf16_f32 v16, v16, v17
    v_mfma_f32_16x16x32_bf16 v[44:47], a[68:71], v[68:71], v[44:47]
    v_cvt_pk_bf16_f32 v17, v18, v19
    v_mfma_f32_16x16x32_bf16 v[48:51], a[132:135], v[68:71], v[48:51]
    v_cvt_pk_bf16_f32 v18, v20, v21
    v_mfma_f32_16x16x32_bf16 v[52:55], a[196:199], v[68:71], v[52:55]
    v_cvt_pk_bf16_f32 v19, v22, v23
    v_mfma_f32_16x16x32_bf16 v[56:59], v[68:71], v[132:135], v[56:59]
    buffer_store_dwordx4 v[16:19], v1, s[8:11], s27 offen sc1
    v_mfma_f32_16x16x32_bf16 v[60:63], v[68:71], v[196:199], v[60:63]
    v_cvt_pk_bf16_f32 v24, v24, v25
    ds_read_b128 v[64:67], v8 offset:16896
    s_waitcnt lgkmcnt(6)
    v_mfma_f32_16x16x32_bf16 v[40:43], a[8:11], v[72:75], v[40:43]
    v_cvt_pk_bf16_f32 v25, v26, v27
    v_mfma_f32_16x16x32_bf16 v[44:47], a[72:75], v[72:75], v[44:47]
    v_cvt_pk_bf16_f32 v26, v28, v29
    v_mfma_f32_16x16x32_bf16 v[48:51], a[136:139], v[72:75], v[48:51]
    v_cvt_pk_bf16_f32 v27, v30, v31
    v_mfma_f32_16x16x32_bf16 v[52:55], a[200:203], v[72:75], v[52:55]
    buffer_store_dwordx4 v[24:27], v1, s[8:11], s29 offen sc1
    v_mfma_f32_16x16x32_bf16 v[56:59], v[72:75], v[136:139], v[56:59]
    s_add_u32 s27, s27, 131072
    v_mfma_f32_16x16x32_bf16 v[60:63], v[72:75], v[200:203], v[60:63]
    s_add_u32 s29, s29, 131072
    ds_read_b128 v[68:71], v9 offset:16896
    s_waitcnt lgkmcnt(6)
    v_mfma_f32_16x16x32_bf16 v[40:43], a[12:15], v[76:79], v[40:43]
    v_cvt_pk_bf16_f32 v96, v32, v33
    v_mfma_f32_16x16x32_bf16 v[44:47], a[76:79], v[76:79], v[44:47]
    v_cvt_pk_bf16_f32 v97, v34, v35
    v_mfma_f32_16x16x32_bf16 v[48:51], a[140:143], v[76:79], v[48:51]
    v_cvt_pk_bf16_f32 v100, v36, v37
    v_mfma_f32_16x16x32_bf16 v[52:55], a[204:207], v[76:79], v[52:55]
    v_cvt_pk_bf16_f32 v101, v38, v39
    v_mfma_f32_16x16x32_bf16 v[56:59], v[76:79], v[140:143], v[56:59]
    v_mfma_f32_16x16x32_bf16 v[60:63], v[76:79], v[204:207], v[60:63]
    ds_read_b128 v[72:75], v10 offset:16896
    s_waitcnt lgkmcnt(6)
    v_mfma_f32_16x16x32_bf16 v[40:43], a[16:19], v[80:83], v[40:43]
    v_mfma_f32_16x16x32_bf16 v[44:47], a[80:83], v[80:83], v[44:47]
    v_mfma_f32_16x16x32_bf16 v[48:51], a[144:147], v[80:83], v[48:51]
    v_mfma_f32_16x16x32_bf16 v[52:55], a[208:211], v[80:83], v[52:55]
    v_mfma_f32_16x16x32_bf16 v[56:59], v[80:83], v[144:147], v[56:59]
    v_mfma_f32_16x16x32_bf16 v[60:63], v[80:83], v[208:211], v[60:63]
    ds_read_b128 v[76:79], v11 offset:16896
    s_waitcnt lgkmcnt(6)
    v_mfma_f32_16x16x32_bf16 v[40:43], a[20:23], v[84:87], v[40:43]
    v_mfma_f32_16x16x32_bf16 v[44:47], a[84:87], v[84:87], v[44:47]
    v_mfma_f32_16x16x32_bf16 v[48:51], a[148:151], v[84:87], v[48:51]
    v_mfma_f32_16x16x32_bf16 v[52:55], a[212:215], v[84:87], v[52:55]
    v_mfma_f32_16x16x32_bf16 v[56:59], v[84:87], v[148:151], v[56:59]
    v_mfma_f32_16x16x32_bf16 v[60:63], v[84:87], v[212:215], v[60:63]
    ds_read_b128 v[80:83], v8 offset:17152
    s_waitcnt lgkmcnt(6)
    v_mfma_f32_16x16x32_bf16 v[40:43], a[24:27], v[88:91], v[40:43]
    v_mfma_f32_16x16x32_bf16 v[44:47], a[88:91], v[88:91], v[44:47]
    v_mfma_f32_16x16x32_bf16 v[48:51], a[152:155], v[88:91], v[48:51]
    v_mfma_f32_16x16x32_bf16 v[52:55], a[216:219], v[88:91], v[52:55]
    v_mfma_f32_16x16x32_bf16 v[56:59], v[88:91], v[152:155], v[56:59]
    v_mfma_f32_16x16x32_bf16 v[60:63], v[88:91], v[216:219], v[60:63]
    ds_read_b128 v[84:87], v9 offset:17152
    s_waitcnt lgkmcnt(6)
    v_mfma_f32_16x16x32_bf16 v[40:43], a[28:31], v[92:95], v[40:43]
    v_mfma_f32_16x16x32_bf16 v[44:47], a[92:95], v[92:95], v[44:47]
    v_mfma_f32_16x16x32_bf16 v[48:51], a[156:159], v[92:95], v[48:51]
    v_mfma_f32_16x16x32_bf16 v[52:55], a[220:223], v[92:95], v[52:55]
    v_mfma_f32_16x16x32_bf16 v[56:59], v[92:95], v[156:159], v[56:59]
    v_mfma_f32_16x16x32_bf16 v[60:63], v[92:95], v[220:223], v[60:63]
    ds_read_b128 v[88:91], v10 offset:17152
    s_waitcnt lgkmcnt(6)
    v_mfma_f32_16x16x32_bf16 v[40:43], a[32:35], v[64:67], v[40:43]
    v_mfma_f32_16x16x32_bf16 v[44:47], a[96:99], v[64:67], v[44:47]
    v_mfma_f32_16x16x32_bf16 v[48:51], a[160:163], v[64:67], v[48:51]
    v_mfma_f32_16x16x32_bf16 v[52:55], a[224:227], v[64:67], v[52:55]
    v_mfma_f32_16x16x32_bf16 v[56:59], v[64:67], v[160:163], v[56:59]
    v_mfma_f32_16x16x32_bf16 v[60:63], v[64:67], v[224:227], v[60:63]
    ds_read_b128 v[92:95], v11 offset:17152
    s_waitcnt lgkmcnt(6)
    v_mfma_f32_16x16x32_bf16 v[40:43], a[36:39], v[68:71], v[40:43]
    v_mfma_f32_16x16x32_bf16 v[44:47], a[100:103], v[68:71], v[44:47]
    v_mfma_f32_16x16x32_bf16 v[48:51], a[164:167], v[68:71], v[48:51]
    v_mfma_f32_16x16x32_bf16 v[52:55], a[228:231], v[68:71], v[52:55]
    v_mfma_f32_16x16x32_bf16 v[56:59], v[68:71], v[164:167], v[56:59]
    v_mfma_f32_16x16x32_bf16 v[60:63], v[68:71], v[228:231], v[60:63]
    ds_read_b128 v[64:67], v8 offset:32768
    s_waitcnt lgkmcnt(6)
    v_mfma_f32_16x16x32_bf16 v[40:43], a[40:43], v[72:75], v[40:43]
    v_mfma_f32_16x16x32_bf16 v[44:47], a[104:107], v[72:75], v[44:47]
    v_mfma_f32_16x16x32_bf16 v[48:51], a[168:171], v[72:75], v[48:51]
    v_mfma_f32_16x16x32_bf16 v[52:55], a[232:235], v[72:75], v[52:55]
    v_mfma_f32_16x16x32_bf16 v[56:59], v[72:75], v[168:171], v[56:59]
    v_mfma_f32_16x16x32_bf16 v[60:63], v[72:75], v[232:235], v[60:63]
    ds_read_b128 v[68:71], v9 offset:32768
    s_waitcnt lgkmcnt(6)
    v_mfma_f32_16x16x32_bf16 v[40:43], a[44:47], v[76:79], v[40:43]
    v_mfma_f32_16x16x32_bf16 v[44:47], a[108:111], v[76:79], v[44:47]
    v_mfma_f32_16x16x32_bf16 v[48:51], a[172:175], v[76:79], v[48:51]
    v_mfma_f32_16x16x32_bf16 v[52:55], a[236:239], v[76:79], v[52:55]
    v_mfma_f32_16x16x32_bf16 v[56:59], v[76:79], v[172:175], v[56:59]
    v_mfma_f32_16x16x32_bf16 v[60:63], v[76:79], v[236:239], v[60:63]
    ds_read_b128 v[72:75], v10 offset:32768
    s_waitcnt lgkmcnt(6)
    v_mfma_f32_16x16x32_bf16 v[40:43], a[48:51], v[80:83], v[40:43]
    v_mfma_f32_16x16x32_bf16 v[44:47], a[112:115], v[80:83], v[44:47]
    v_mfma_f32_16x16x32_bf16 v[48:51], a[176:179], v[80:83], v[48:51]
    v_mfma_f32_16x16x32_bf16 v[52:55], a[240:243], v[80:83], v[52:55]
    v_mfma_f32_16x16x32_bf16 v[56:59], v[80:83], v[176:179], v[56:59]
    v_mfma_f32_16x16x32_bf16 v[60:63], v[80:83], v[240:243], v[60:63]
    ds_read_b128 v[76:79], v11 offset:32768
    s_waitcnt lgkmcnt(6)
    v_mfma_f32_16x16x32_bf16 v[40:43], a[52:55], v[84:87], v[40:43]
    v_mfma_f32_16x16x32_bf16 v[44:47], a[116:119], v[84:87], v[44:47]
    v_mfma_f32_16x16x32_bf16 v[48:51], a[180:183], v[84:87], v[48:51]
    v_mfma_f32_16x16x32_bf16 v[52:55], a[244:247], v[84:87], v[52:55]
    v_mfma_f32_16x16x32_bf16 v[56:59], v[84:87], v[180:183], v[56:59]
    v_mfma_f32_16x16x32_bf16 v[60:63], v[84:87], v[244:247], v[60:63]
    ds_read_b128 v[80:83], v8 offset:33024
    s_waitcnt lgkmcnt(6)
    v_mfma_f32_16x16x32_bf16 v[40:43], a[56:59], v[88:91], v[40:43]
    v_mfma_f32_16x16x32_bf16 v[44:47], a[120:123], v[88:91], v[44:47]
    v_mfma_f32_16x16x32_bf16 v[48:51], a[184:187], v[88:91], v[48:51]
    v_mfma_f32_16x16x32_bf16 v[52:55], a[248:251], v[88:91], v[52:55]
    v_mfma_f32_16x16x32_bf16 v[56:59], v[88:91], v[184:187], v[56:59]
    v_mfma_f32_16x16x32_bf16 v[60:63], v[88:91], v[248:251], v[60:63]
    ds_read_b128 v[84:87], v9 offset:33024
    s_waitcnt lgkmcnt(6)
    v_mfma_f32_16x16x32_bf16 v[40:43], a[60:63], v[92:95], v[40:43]
    v_mfma_f32_16x16x32_bf16 v[44:47], a[124:127], v[92:95], v[44:47]
    v_mfma_f32_16x16x32_bf16 v[48:51], a[188:191], v[92:95], v[48:51]
    v_mfma_f32_16x16x32_bf16 v[52:55], a[252:255], v[92:95], v[52:55]
    v_mfma_f32_16x16x32_bf16 v[56:59], v[92:95], v[188:191], v[56:59]
    v_mfma_f32_16x16x32_bf16 v[60:63], v[92:95], v[252:255], v[60:63]
    ds_read_b128 v[88:91], v10 offset:33024
    s_waitcnt lgkmcnt(6)
    v_mfma_f32_16x16x32_bf16 v[16:19], a[0:3], v[64:67], 0
    v_mfma_f32_16x16x32_bf16 v[20:23], a[64:67], v[64:67], 0
    v_mfma_f32_16x16x32_bf16 v[24:27], a[128:131], v[64:67], 0
    v_mfma_f32_16x16x32_bf16 v[28:31], a[192:195], v[64:67], 0
    v_mfma_f32_16x16x32_bf16 v[32:35], v[64:67], v[128:131], 0
    v_mfma_f32_16x16x32_bf16 v[36:39], v[64:67], v[192:195], 0
    ds_read_b128 v[92:95], v11 offset:33024
    s_waitcnt lgkmcnt(6)
    v_mfma_f32_16x16x32_bf16 v[16:19], a[4:7], v[68:71], v[16:19]
    v_cvt_pk_bf16_f32 v40, v40, v41
    v_mfma_f32_16x16x32_bf16 v[20:23], a[68:71], v[68:71], v[20:23]
    v_cvt_pk_bf16_f32 v41, v42, v43
    v_mfma_f32_16x16x32_bf16 v[24:27], a[132:135], v[68:71], v[24:27]
    v_cvt_pk_bf16_f32 v42, v44, v45
    v_mfma_f32_16x16x32_bf16 v[28:31], a[196:199], v[68:71], v[28:31]
    v_cvt_pk_bf16_f32 v43, v46, v47
    v_mfma_f32_16x16x32_bf16 v[32:35], v[68:71], v[132:135], v[32:35]
    buffer_store_dwordx4 v[40:43], v1, s[8:11], s27 offen sc1
    v_mfma_f32_16x16x32_bf16 v[36:39], v[68:71], v[196:199], v[36:39]
    v_cvt_pk_bf16_f32 v48, v48, v49
    ds_read_b128 v[64:67], v8 offset:33280
    s_waitcnt lgkmcnt(6)
    v_mfma_f32_16x16x32_bf16 v[16:19], a[8:11], v[72:75], v[16:19]
    v_cvt_pk_bf16_f32 v49, v50, v51
    v_mfma_f32_16x16x32_bf16 v[20:23], a[72:75], v[72:75], v[20:23]
    v_cvt_pk_bf16_f32 v50, v52, v53
    v_mfma_f32_16x16x32_bf16 v[24:27], a[136:139], v[72:75], v[24:27]
    v_cvt_pk_bf16_f32 v51, v54, v55
    v_mfma_f32_16x16x32_bf16 v[28:31], a[200:203], v[72:75], v[28:31]
    buffer_store_dwordx4 v[48:51], v1, s[8:11], s29 offen sc1
    v_mfma_f32_16x16x32_bf16 v[32:35], v[72:75], v[136:139], v[32:35]
    s_add_u32 s27, s27, 131072
    v_mfma_f32_16x16x32_bf16 v[36:39], v[72:75], v[200:203], v[36:39]
    s_add_u32 s29, s29, 131072
    ds_read_b128 v[68:71], v9 offset:33280
    s_waitcnt lgkmcnt(6)
    v_mfma_f32_16x16x32_bf16 v[16:19], a[12:15], v[76:79], v[16:19]
    v_cvt_pk_bf16_f32 v98, v56, v57
    v_mfma_f32_16x16x32_bf16 v[20:23], a[76:79], v[76:79], v[20:23]
    v_cvt_pk_bf16_f32 v99, v58, v59
    v_mfma_f32_16x16x32_bf16 v[24:27], a[140:143], v[76:79], v[24:27]
    v_cvt_pk_bf16_f32 v102, v60, v61
    v_mfma_f32_16x16x32_bf16 v[28:31], a[204:207], v[76:79], v[28:31]
    v_cvt_pk_bf16_f32 v103, v62, v63
    v_mfma_f32_16x16x32_bf16 v[32:35], v[76:79], v[140:143], v[32:35]
    buffer_store_dwordx4 v[96:99], v1, s[8:11], s28 offen offset:0 sc1
    v_mfma_f32_16x16x32_bf16 v[36:39], v[76:79], v[204:207], v[36:39]
    buffer_store_dwordx4 v[100:103], v1, s[8:11], s28 offen offset:1024 sc1
    ds_read_b128 v[72:75], v10 offset:33280
    s_waitcnt lgkmcnt(6)
    v_mfma_f32_16x16x32_bf16 v[16:19], a[16:19], v[80:83], v[16:19]
    s_add_u32 s28, s28, 262144
    v_mfma_f32_16x16x32_bf16 v[20:23], a[80:83], v[80:83], v[20:23]
    v_mfma_f32_16x16x32_bf16 v[24:27], a[144:147], v[80:83], v[24:27]
    v_mfma_f32_16x16x32_bf16 v[28:31], a[208:211], v[80:83], v[28:31]
    v_mfma_f32_16x16x32_bf16 v[32:35], v[80:83], v[144:147], v[32:35]
    v_mfma_f32_16x16x32_bf16 v[36:39], v[80:83], v[208:211], v[36:39]
    ds_read_b128 v[76:79], v11 offset:33280
    s_waitcnt lgkmcnt(6)
    v_mfma_f32_16x16x32_bf16 v[16:19], a[20:23], v[84:87], v[16:19]
    v_mfma_f32_16x16x32_bf16 v[20:23], a[84:87], v[84:87], v[20:23]
    v_mfma_f32_16x16x32_bf16 v[24:27], a[148:151], v[84:87], v[24:27]
    v_mfma_f32_16x16x32_bf16 v[28:31], a[212:215], v[84:87], v[28:31]
    v_mfma_f32_16x16x32_bf16 v[32:35], v[84:87], v[148:151], v[32:35]
    v_mfma_f32_16x16x32_bf16 v[36:39], v[84:87], v[212:215], v[36:39]
    ds_read_b128 v[80:83], v8 offset:33536
    s_waitcnt lgkmcnt(6)
    v_mfma_f32_16x16x32_bf16 v[16:19], a[24:27], v[88:91], v[16:19]
    v_mfma_f32_16x16x32_bf16 v[20:23], a[88:91], v[88:91], v[20:23]
    v_mfma_f32_16x16x32_bf16 v[24:27], a[152:155], v[88:91], v[24:27]
    v_mfma_f32_16x16x32_bf16 v[28:31], a[216:219], v[88:91], v[28:31]
    v_mfma_f32_16x16x32_bf16 v[32:35], v[88:91], v[152:155], v[32:35]
    v_mfma_f32_16x16x32_bf16 v[36:39], v[88:91], v[216:219], v[36:39]
    ds_read_b128 v[84:87], v9 offset:33536
    s_waitcnt lgkmcnt(6)
    v_mfma_f32_16x16x32_bf16 v[16:19], a[28:31], v[92:95], v[16:19]
    v_mfma_f32_16x16x32_bf16 v[20:23], a[92:95], v[92:95], v[20:23]
    v_mfma_f32_16x16x32_bf16 v[24:27], a[156:159], v[92:95], v[24:27]
    v_mfma_f32_16x16x32_bf16 v[28:31], a[220:223], v[92:95], v[28:31]
    v_mfma_f32_16x16x32_bf16 v[32:35], v[92:95], v[156:159], v[32:35]
    v_mfma_f32_16x16x32_bf16 v[36:39], v[92:95], v[220:223], v[36:39]
    ds_read_b128 v[88:91], v10 offset:33536
    s_waitcnt lgkmcnt(6)
    v_mfma_f32_16x16x32_bf16 v[16:19], a[32:35], v[64:67], v[16:19]
    v_mfma_f32_16x16x32_bf16 v[20:23], a[96:99], v[64:67], v[20:23]
    v_mfma_f32_16x16x32_bf16 v[24:27], a[160:163], v[64:67], v[24:27]
    v_mfma_f32_16x16x32_bf16 v[28:31], a[224:227], v[64:67], v[28:31]
    v_mfma_f32_16x16x32_bf16 v[32:35], v[64:67], v[160:163], v[32:35]
    v_mfma_f32_16x16x32_bf16 v[36:39], v[64:67], v[224:227], v[36:39]
    ds_read_b128 v[92:95], v11 offset:33536
    s_waitcnt lgkmcnt(6)
    v_mfma_f32_16x16x32_bf16 v[16:19], a[36:39], v[68:71], v[16:19]
    v_mfma_f32_16x16x32_bf16 v[20:23], a[100:103], v[68:71], v[20:23]
    v_mfma_f32_16x16x32_bf16 v[24:27], a[164:167], v[68:71], v[24:27]
    v_mfma_f32_16x16x32_bf16 v[28:31], a[228:231], v[68:71], v[28:31]
    v_mfma_f32_16x16x32_bf16 v[32:35], v[68:71], v[164:167], v[32:35]
    v_mfma_f32_16x16x32_bf16 v[36:39], v[68:71], v[228:231], v[36:39]
    ds_read_b128 v[64:67], v8 offset:49152
    s_waitcnt lgkmcnt(6)
    v_mfma_f32_16x16x32_bf16 v[16:19], a[40:43], v[72:75], v[16:19]
    v_mfma_f32_16x16x32_bf16 v[20:23], a[104:107], v[72:75], v[20:23]
    v_mfma_f32_16x16x32_bf16 v[24:27], a[168:171], v[72:75], v[24:27]
    v_mfma_f32_16x16x32_bf16 v[28:31], a[232:235], v[72:75], v[28:31]
    v_mfma_f32_16x16x32_bf16 v[32:35], v[72:75], v[168:171], v[32:35]
    v_mfma_f32_16x16x32_bf16 v[36:39], v[72:75], v[232:235], v[36:39]
    ds_read_b128 v[68:71], v9 offset:49152
    s_waitcnt lgkmcnt(6)
    v_mfma_f32_16x16x32_bf16 v[16:19], a[44:47], v[76:79], v[16:19]
    v_mfma_f32_16x16x32_bf16 v[20:23], a[108:111], v[76:79], v[20:23]
    v_mfma_f32_16x16x32_bf16 v[24:27], a[172:175], v[76:79], v[24:27]
    v_mfma_f32_16x16x32_bf16 v[28:31], a[236:239], v[76:79], v[28:31]
    v_mfma_f32_16x16x32_bf16 v[32:35], v[76:79], v[172:175], v[32:35]
    v_mfma_f32_16x16x32_bf16 v[36:39], v[76:79], v[236:239], v[36:39]
    ds_read_b128 v[72:75], v10 offset:49152
    s_waitcnt lgkmcnt(6)
    v_mfma_f32_16x16x32_bf16 v[16:19], a[48:51], v[80:83], v[16:19]
    v_mfma_f32_16x16x32_bf16 v[20:23], a[112:115], v[80:83], v[20:23]
    v_mfma_f32_16x16x32_bf16 v[24:27], a[176:179], v[80:83], v[24:27]
    v_mfma_f32_16x16x32_bf16 v[28:31], a[240:243], v[80:83], v[28:31]
    v_mfma_f32_16x16x32_bf16 v[32:35], v[80:83], v[176:179], v[32:35]
    v_mfma_f32_16x16x32_bf16 v[36:39], v[80:83], v[240:243], v[36:39]
    ds_read_b128 v[76:79], v11 offset:49152
    s_waitcnt lgkmcnt(6)
    v_mfma_f32_16x16x32_bf16 v[16:19], a[52:55], v[84:87], v[16:19]
    v_mfma_f32_16x16x32_bf16 v[20:23], a[116:119], v[84:87], v[20:23]
    v_mfma_f32_16x16x32_bf16 v[24:27], a[180:183], v[84:87], v[24:27]
    v_mfma_f32_16x16x32_bf16 v[28:31], a[244:247], v[84:87], v[28:31]
    v_mfma_f32_16x16x32_bf16 v[32:35], v[84:87], v[180:183], v[32:35]
    v_mfma_f32_16x16x32_bf16 v[36:39], v[84:87], v[244:247], v[36:39]
    ds_read_b128 v[80:83], v8 offset:49408
    s_waitcnt lgkmcnt(6)
    v_mfma_f32_16x16x32_bf16 v[16:19], a[56:59], v[88:91], v[16:19]
    v_mfma_f32_16x16x32_bf16 v[20:23], a[120:123], v[88:91], v[20:23]
    s_waitcnt vmcnt(0)
    buffer_store_dword v3, v2, s[8:11], s44 offen sc1
    v_mfma_f32_16x16x32_bf16 v[24:27], a[184:187], v[88:91], v[24:27]
    v_mfma_f32_16x16x32_bf16 v[28:31], a[248:251], v[88:91], v[28:31]
    v_mfma_f32_16x16x32_bf16 v[32:35], v[88:91], v[184:187], v[32:35]
    v_mfma_f32_16x16x32_bf16 v[36:39], v[88:91], v[248:251], v[36:39]
    ds_read_b128 v[84:87], v9 offset:49408
    s_waitcnt lgkmcnt(6)
    v_mfma_f32_16x16x32_bf16 v[16:19], a[60:63], v[92:95], v[16:19]
    v_mfma_f32_16x16x32_bf16 v[20:23], a[124:127], v[92:95], v[20:23]
    v_mfma_f32_16x16x32_bf16 v[24:27], a[188:191], v[92:95], v[24:27]
    v_mfma_f32_16x16x32_bf16 v[28:31], a[252:255], v[92:95], v[28:31]
    v_mfma_f32_16x16x32_bf16 v[32:35], v[92:95], v[188:191], v[32:35]
    v_mfma_f32_16x16x32_bf16 v[36:39], v[92:95], v[252:255], v[36:39]
    ds_read_b128 v[88:91], v10 offset:49408
    s_waitcnt lgkmcnt(6)
    v_mfma_f32_16x16x32_bf16 v[40:43], a[0:3], v[64:67], 0
    v_mfma_f32_16x16x32_bf16 v[44:47], a[64:67], v[64:67], 0
    v_mfma_f32_16x16x32_bf16 v[48:51], a[128:131], v[64:67], 0
    v_mfma_f32_16x16x32_bf16 v[52:55], a[192:195], v[64:67], 0
    v_mfma_f32_16x16x32_bf16 v[56:59], v[64:67], v[128:131], 0
    v_mfma_f32_16x16x32_bf16 v[60:63], v[64:67], v[192:195], 0
    ds_read_b128 v[92:95], v11 offset:49408
    s_waitcnt lgkmcnt(6)
    v_mfma_f32_16x16x32_bf16 v[40:43], a[4:7], v[68:71], v[40:43]
    v_cvt_pk_bf16_f32 v16, v16, v17
    v_mfma_f32_16x16x32_bf16 v[44:47], a[68:71], v[68:71], v[44:47]
    v_cvt_pk_bf16_f32 v17, v18, v19
    v_mfma_f32_16x16x32_bf16 v[48:51], a[132:135], v[68:71], v[48:51]
    v_cvt_pk_bf16_f32 v18, v20, v21
    v_mfma_f32_16x16x32_bf16 v[52:55], a[196:199], v[68:71], v[52:55]
    v_cvt_pk_bf16_f32 v19, v22, v23
    v_mfma_f32_16x16x32_bf16 v[56:59], v[68:71], v[132:135], v[56:59]
    buffer_store_dwordx4 v[16:19], v1, s[8:11], s27 offen sc1
    v_mfma_f32_16x16x32_bf16 v[60:63], v[68:71], v[196:199], v[60:63]
    v_cvt_pk_bf16_f32 v24, v24, v25
    ds_read_b128 v[64:67], v8 offset:49664
    s_waitcnt lgkmcnt(6)
    v_mfma_f32_16x16x32_bf16 v[40:43], a[8:11], v[72:75], v[40:43]
    v_cvt_pk_bf16_f32 v25, v26, v27
    v_mfma_f32_16x16x32_bf16 v[44:47], a[72:75], v[72:75], v[44:47]
    v_cvt_pk_bf16_f32 v26, v28, v29
    v_mfma_f32_16x16x32_bf16 v[48:51], a[136:139], v[72:75], v[48:51]
    v_cvt_pk_bf16_f32 v27, v30, v31
    v_mfma_f32_16x16x32_bf16 v[52:55], a[200:203], v[72:75], v[52:55]
    buffer_store_dwordx4 v[24:27], v1, s[8:11], s29 offen sc1
    v_mfma_f32_16x16x32_bf16 v[56:59], v[72:75], v[136:139], v[56:59]
    s_add_u32 s27, s27, 131072
    v_mfma_f32_16x16x32_bf16 v[60:63], v[72:75], v[200:203], v[60:63]
    s_add_u32 s29, s29, 131072
    ds_read_b128 v[68:71], v9 offset:49664
    s_waitcnt lgkmcnt(6)
    v_mfma_f32_16x16x32_bf16 v[40:43], a[12:15], v[76:79], v[40:43]
    v_cvt_pk_bf16_f32 v104, v32, v33
    v_mfma_f32_16x16x32_bf16 v[44:47], a[76:79], v[76:79], v[44:47]
    v_cvt_pk_bf16_f32 v105, v34, v35
    v_mfma_f32_16x16x32_bf16 v[48:51], a[140:143], v[76:79], v[48:51]
    v_cvt_pk_bf16_f32 v108, v36, v37
    v_mfma_f32_16x16x32_bf16 v[52:55], a[204:207], v[76:79], v[52:55]
    v_cvt_pk_bf16_f32 v109, v38, v39
    v_mfma_f32_16x16x32_bf16 v[56:59], v[76:79], v[140:143], v[56:59]
    v_mfma_f32_16x16x32_bf16 v[60:63], v[76:79], v[204:207], v[60:63]
    ds_read_b128 v[72:75], v10 offset:49664
    s_waitcnt lgkmcnt(6)
    v_mfma_f32_16x16x32_bf16 v[40:43], a[16:19], v[80:83], v[40:43]
    v_mfma_f32_16x16x32_bf16 v[44:47], a[80:83], v[80:83], v[44:47]
    v_mfma_f32_16x16x32_bf16 v[48:51], a[144:147], v[80:83], v[48:51]
    v_mfma_f32_16x16x32_bf16 v[52:55], a[208:211], v[80:83], v[52:55]
    v_mfma_f32_16x16x32_bf16 v[56:59], v[80:83], v[144:147], v[56:59]
    v_mfma_f32_16x16x32_bf16 v[60:63], v[80:83], v[208:211], v[60:63]
    ds_read_b128 v[76:79], v11 offset:49664
    s_waitcnt lgkmcnt(6)
    v_mfma_f32_16x16x32_bf16 v[40:43], a[20:23], v[84:87], v[40:43]
    v_mfma_f32_16x16x32_bf16 v[44:47], a[84:87], v[84:87], v[44:47]
    v_mfma_f32_16x16x32_bf16 v[48:51], a[148:151], v[84:87], v[48:51]
    v_mfma_f32_16x16x32_bf16 v[52:55], a[212:215], v[84:87], v[52:55]
    v_mfma_f32_16x16x32_bf16 v[56:59], v[84:87], v[148:151], v[56:59]
    v_mfma_f32_16x16x32_bf16 v[60:63], v[84:87], v[212:215], v[60:63]
    ds_read_b128 v[80:83], v8 offset:49920
    s_waitcnt lgkmcnt(6)
    v_mfma_f32_16x16x32_bf16 v[40:43], a[24:27], v[88:91], v[40:43]
    v_mfma_f32_16x16x32_bf16 v[44:47], a[88:91], v[88:91], v[44:47]
    v_mfma_f32_16x16x32_bf16 v[48:51], a[152:155], v[88:91], v[48:51]
    v_mfma_f32_16x16x32_bf16 v[52:55], a[216:219], v[88:91], v[52:55]
    v_mfma_f32_16x16x32_bf16 v[56:59], v[88:91], v[152:155], v[56:59]
    v_mfma_f32_16x16x32_bf16 v[60:63], v[88:91], v[216:219], v[60:63]
    ds_read_b128 v[84:87], v9 offset:49920
    s_waitcnt lgkmcnt(6)
    v_mfma_f32_16x16x32_bf16 v[40:43], a[28:31], v[92:95], v[40:43]
    v_mfma_f32_16x16x32_bf16 v[44:47], a[92:95], v[92:95], v[44:47]
    v_mfma_f32_16x16x32_bf16 v[48:51], a[156:159], v[92:95], v[48:51]
    v_mfma_f32_16x16x32_bf16 v[52:55], a[220:223], v[92:95], v[52:55]
    v_mfma_f32_16x16x32_bf16 v[56:59], v[92:95], v[156:159], v[56:59]
    v_mfma_f32_16x16x32_bf16 v[60:63], v[92:95], v[220:223], v[60:63]
    ds_read_b128 v[88:91], v10 offset:49920
    s_waitcnt lgkmcnt(6)
    v_mfma_f32_16x16x32_bf16 v[40:43], a[32:35], v[64:67], v[40:43]
    v_mfma_f32_16x16x32_bf16 v[44:47], a[96:99], v[64:67], v[44:47]
    v_mfma_f32_16x16x32_bf16 v[48:51], a[160:163], v[64:67], v[48:51]
    v_mfma_f32_16x16x32_bf16 v[52:55], a[224:227], v[64:67], v[52:55]
    v_mfma_f32_16x16x32_bf16 v[56:59], v[64:67], v[160:163], v[56:59]
    v_mfma_f32_16x16x32_bf16 v[60:63], v[64:67], v[224:227], v[60:63]
    ds_read_b128 v[92:95], v11 offset:49920
    s_waitcnt lgkmcnt(6)
    v_mfma_f32_16x16x32_bf16 v[40:43], a[36:39], v[68:71], v[40:43]
    v_mfma_f32_16x16x32_bf16 v[44:47], a[100:103], v[68:71], v[44:47]
    v_mfma_f32_16x16x32_bf16 v[48:51], a[164:167], v[68:71], v[48:51]
    v_mfma_f32_16x16x32_bf16 v[52:55], a[228:231], v[68:71], v[52:55]
    v_mfma_f32_16x16x32_bf16 v[56:59], v[68:71], v[164:167], v[56:59]
    v_mfma_f32_16x16x32_bf16 v[60:63], v[68:71], v[228:231], v[60:63]
    s_waitcnt lgkmcnt(5)
    v_mfma_f32_16x16x32_bf16 v[40:43], a[40:43], v[72:75], v[40:43]
    v_mfma_f32_16x16x32_bf16 v[44:47], a[104:107], v[72:75], v[44:47]
    v_mfma_f32_16x16x32_bf16 v[48:51], a[168:171], v[72:75], v[48:51]
    v_mfma_f32_16x16x32_bf16 v[52:55], a[232:235], v[72:75], v[52:55]
    v_mfma_f32_16x16x32_bf16 v[56:59], v[72:75], v[168:171], v[56:59]
    v_mfma_f32_16x16x32_bf16 v[60:63], v[72:75], v[232:235], v[60:63]
    s_waitcnt lgkmcnt(4)
    v_mfma_f32_16x16x32_bf16 v[40:43], a[44:47], v[76:79], v[40:43]
    v_mfma_f32_16x16x32_bf16 v[44:47], a[108:111], v[76:79], v[44:47]
    v_mfma_f32_16x16x32_bf16 v[48:51], a[172:175], v[76:79], v[48:51]
    v_mfma_f32_16x16x32_bf16 v[52:55], a[236:239], v[76:79], v[52:55]
    v_mfma_f32_16x16x32_bf16 v[56:59], v[76:79], v[172:175], v[56:59]
    v_mfma_f32_16x16x32_bf16 v[60:63], v[76:79], v[236:239], v[60:63]
    s_waitcnt lgkmcnt(3)
    v_mfma_f32_16x16x32_bf16 v[40:43], a[48:51], v[80:83], v[40:43]
    v_mfma_f32_16x16x32_bf16 v[44:47], a[112:115], v[80:83], v[44:47]
    v_mfma_f32_16x16x32_bf16 v[48:51], a[176:179], v[80:83], v[48:51]
    v_mfma_f32_16x16x32_bf16 v[52:55], a[240:243], v[80:83], v[52:55]
    v_mfma_f32_16x16x32_bf16 v[56:59], v[80:83], v[176:179], v[56:59]
    v_mfma_f32_16x16x32_bf16 v[60:63], v[80:83], v[240:243], v[60:63]
    s_waitcnt lgkmcnt(2)
    v_mfma_f32_16x16x32_bf16 v[40:43], a[52:55], v[84:87], v[40:43]
    v_mfma_f32_16x16x32_bf16 v[44:47], a[116:119], v[84:87], v[44:47]
    v_mfma_f32_16x16x32_bf16 v[48:51], a[180:183], v[84:87], v[48:51]
    v_mfma_f32_16x16x32_bf16 v[52:55], a[244:247], v[84:87], v[52:55]
    v_mfma_f32_16x16x32_bf16 v[56:59], v[84:87], v[180:183], v[56:59]
    v_mfma_f32_16x16x32_bf16 v[60:63], v[84:87], v[244:247], v[60:63]
    s_waitcnt lgkmcnt(1)
    v_mfma_f32_16x16x32_bf16 v[40:43], a[56:59], v[88:91], v[40:43]
    v_mfma_f32_16x16x32_bf16 v[44:47], a[120:123], v[88:91], v[44:47]
    v_mfma_f32_16x16x32_bf16 v[48:51], a[184:187], v[88:91], v[48:51]
    v_mfma_f32_16x16x32_bf16 v[52:55], a[248:251], v[88:91], v[52:55]
    v_mfma_f32_16x16x32_bf16 v[56:59], v[88:91], v[184:187], v[56:59]
    v_mfma_f32_16x16x32_bf16 v[60:63], v[88:91], v[248:251], v[60:63]
    s_waitcnt lgkmcnt(0)
    v_mfma_f32_16x16x32_bf16 v[40:43], a[60:63], v[92:95], v[40:43]
    v_mfma_f32_16x16x32_bf16 v[44:47], a[124:127], v[92:95], v[44:47]
    v_mfma_f32_16x16x32_bf16 v[48:51], a[188:191], v[92:95], v[48:51]
    v_mfma_f32_16x16x32_bf16 v[52:55], a[252:255], v[92:95], v[52:55]
    v_mfma_f32_16x16x32_bf16 v[56:59], v[92:95], v[188:191], v[56:59]
    v_mfma_f32_16x16x32_bf16 v[60:63], v[92:95], v[252:255], v[60:63]
    v_cvt_pk_bf16_f32 v40, v40, v41
    v_cvt_pk_bf16_f32 v41, v42, v43
    v_cvt_pk_bf16_f32 v42, v44, v45
    v_cvt_pk_bf16_f32 v43, v46, v47
    buffer_store_dwordx4 v[40:43], v1, s[8:11], s27 offen sc1
    v_cvt_pk_bf16_f32 v48, v48, v49
    v_cvt_pk_bf16_f32 v49, v50, v51
    v_cvt_pk_bf16_f32 v50, v52, v53
    v_cvt_pk_bf16_f32 v51, v54, v55
    buffer_store_dwordx4 v[48:51], v1, s[8:11], s29 offen sc1
    s_add_u32 s27, s27, 131072
    s_add_u32 s29, s29, 131072
    v_cvt_pk_bf16_f32 v106, v56, v57
    v_cvt_pk_bf16_f32 v107, v58, v59
    v_cvt_pk_bf16_f32 v110, v60, v61
    v_cvt_pk_bf16_f32 v111, v62, v63
    buffer_store_dwordx4 v[104:107], v1, s[8:11], s28 offen offset:0 sc1
    buffer_store_dwordx4 v[108:111], v1, s[8:11], s28 offen offset:1024 sc1
    s_add_u32 s28, s28, 262144
    s_cmp_lg_u32 s43, 0
    s_cbranch_scc1 A_sig
    s_mov_b32 s43, 1
    s_cmp_lg_u32 s20, 0
    s_cbranch_scc1 L_wd_29
L_w_28:
    buffer_load_dword v4, v2, s[4:7], 0 offen offset:0 sc1
    s_waitcnt vmcnt(0)
    v_readfirstlane_b32 s34, v4
    s_nop 0
    s_cmp_ge_u32 s34, 160
    s_cbranch_scc1 L_wd_29
    s_sleep 2
    s_sub_u32 s30, s30, 1
    s_cbranch_scc0 L_w_28
    s_branch M_done
L_wd_29:
    s_barrier
A_sig:
    s_mov_b32 s26, 35651584
    s_mul_i32 s35, s24, 2048
    s_add_u32 s26, s26, s35
    s_mul_i32 s35, s21, 64
    s_add_u32 s26, s26, s35
    s_waitcnt vmcnt(0)
    s_barrier
    s_cmp_lg_u32 s20, 0
    s_cbranch_scc1 L_ss_30
    buffer_atomic_add v3, v2, s[8:11], s26 offen sc1
L_ss_30:
    buffer_store_dword v3, v2, s[8:11], s45 offen sc1
    s_branch A_loop
R_B:
    s_sub_u32 s22, s22, 5
    s_lshl_b32 s22, s22, 1
    s_lshr_b32 s25, s21, 4
    s_add_u32 s22, s22, s25
    s_and_b32 s21, s21, 15
    s_lshl_b32 s28, s21, 2
    s_add_u32 s28, s28, s20
    s_lshl_b32 s52, s28, 14
    s_lshl_b32 s56, s22, 8
    s_add_u32 s56, s56, 35848192
    s_lshl_b32 s57, s28, 2
    s_add_u32 s57, s57, s56
    s_add_u32 s53, s22, 2
    s_getreg_b32 s25, hwreg(HW_REG_XCC_ID, 0, 4)
    s_and_b32 s75, s25, 3
    s_lshl_b32 s75, s75, 3
    s_and_b32 s25, s25, 4
    s_lshl_b32 s76, s53, 3
    s_add_u32 s76, s76, s25
    s_add_u32 s76, s76, 64
    s_lshl_b32 s25, 1, s75
    v_mov_b32 v4, s25
    s_cmp_lg_u32 s20, 0
    s_cbranch_scc1 L_ga_31
    buffer_atomic_add v4, v2, s[4:7], s76 offen sc1
L_ga_31:
    s_lshl_b32 s25, s22, 6
    s_add_u32 s25, s25, s28
    s_lshl_b32 s25, s25, 13
    s_add_u32 s26, s25, 4096
    buffer_load_dwordx4 v[64:67], v1, s[12:15], s25 offen offset:0
    buffer_load_dwordx4 v[68:71], v1, s[12:15], s25 offen offset:1024
    buffer_load_dwordx4 v[72:75], v1, s[12:15], s25 offen offset:2048
    buffer_load_dwordx4 v[76:79], v1, s[12:15], s25 offen offset:3072
    buffer_load_dwordx4 v[80:83], v1, s[12:15], s26 offen offset:0
    buffer_load_dwordx4 v[84:87], v1, s[12:15], s26 offen offset:1024
    buffer_load_dwordx4 v[88:91], v1, s[12:15], s26 offen offset:2048
    buffer_load_dwordx4 v[92:95], v1, s[12:15], s26 offen offset:3072
    s_add_u32 s25, s25, 20971520
    s_add_u32 s26, s26, 20971520
    s_waitcnt vmcnt(4)
    v_lshlrev_b32 v96, 16, v64
    v_lshlrev_b32 v104, 16, v68
    v_lshlrev_b32 v112, 16, v72
    v_lshlrev_b32 v120, 16, v76
    v_and_b32 v97, 0xffff0000, v64
    v_and_b32 v105, 0xffff0000, v68
    v_and_b32 v113, 0xffff0000, v72
    v_and_b32 v121, 0xffff0000, v76
    v_lshlrev_b32 v98, 16, v65
    v_lshlrev_b32 v106, 16, v69
    v_lshlrev_b32 v114, 16, v73
    v_lshlrev_b32 v122, 16, v77
    v_and_b32 v99, 0xffff0000, v65
    v_and_b32 v107, 0xffff0000, v69
    v_and_b32 v115, 0xffff0000, v73
    v_and_b32 v123, 0xffff0000, v77
    v_lshlrev_b32 v100, 16, v66
    v_lshlrev_b32 v108, 16, v70
    v_lshlrev_b32 v116, 16, v74
    v_lshlrev_b32 v124, 16, v78
    v_and_b32 v101, 0xffff0000, v66
    v_and_b32 v109, 0xffff0000, v70
    v_and_b32 v117, 0xffff0000, v74
    v_and_b32 v125, 0xffff0000, v78
    v_lshlrev_b32 v102, 16, v67
    v_lshlrev_b32 v110, 16, v71
    v_lshlrev_b32 v118, 16, v75
    v_lshlrev_b32 v126, 16, v79
    v_and_b32 v103, 0xffff0000, v67
    v_and_b32 v111, 0xffff0000, v71
    v_and_b32 v119, 0xffff0000, v75
    v_and_b32 v127, 0xffff0000, v79
    v_add_f32 v40, v96, v97
    v_add_f32 v42, v104, v105
    v_add_f32 v44, v112, v113
    v_add_f32 v46, v120, v121
    v_add_f32 v40, v40, v98
    v_add_f32 v42, v42, v106
    v_add_f32 v44, v44, v114
    v_add_f32 v46, v46, v122
    v_add_f32 v40, v40, v99
    v_add_f32 v42, v42, v107
    v_add_f32 v44, v44, v115
    v_add_f32 v46, v46, v123
    v_add_f32 v40, v40, v100
    v_add_f32 v42, v42, v108
    v_add_f32 v44, v44, v116
    v_add_f32 v46, v46, v124
    v_add_f32 v40, v40, v101
    v_add_f32 v42, v42, v109
    v_add_f32 v44, v44, v117
    v_add_f32 v46, v46, v125
    v_add_f32 v40, v40, v102
    v_add_f32 v42, v42, v110
    v_add_f32 v44, v44, v118
    v_add_f32 v46, v46, v126
    v_add_f32 v40, v40, v103
    v_add_f32 v42, v42, v111
    v_add_f32 v44, v44, v119
    v_add_f32 v46, v46, v127
    v_add_f32_dpp v40, v40, v40 quad_perm:[1,0,3,2] row_mask:0xf bank_mask:0xf
    v_add_f32_dpp v42, v42, v42 quad_perm:[1,0,3,2] row_mask:0xf bank_mask:0xf
    v_add_f32_dpp v44, v44, v44 quad_perm:[1,0,3,2] row_mask:0xf bank_mask:0xf
    v_add_f32_dpp v46, v46, v46 quad_perm:[1,0,3,2] row_mask:0xf bank_mask:0xf
    v_add_f32_dpp v40, v40, v40 quad_perm:[2,3,0,1] row_mask:0xf bank_mask:0xf
    v_add_f32_dpp v42, v42, v42 quad_perm:[2,3,0,1] row_mask:0xf bank_mask:0xf
    v_add_f32_dpp v44, v44, v44 quad_perm:[2,3,0,1] row_mask:0xf bank_mask:0xf
    v_add_f32_dpp v46, v46, v46 quad_perm:[2,3,0,1] row_mask:0xf bank_mask:0xf
    v_add_f32_dpp v40, v40, v40 row_half_mirror row_mask:0xf bank_mask:0xf
    v_add_f32_dpp v42, v42, v42 row_half_mirror row_mask:0xf bank_mask:0xf
    v_add_f32_dpp v44, v44, v44 row_half_mirror row_mask:0xf bank_mask:0xf
    v_add_f32_dpp v46, v46, v46 row_half_mirror row_mask:0xf bank_mask:0xf
    v_add_f32_dpp v40, v40, v40 row_mirror row_mask:0xf bank_mask:0xf
    v_add_f32_dpp v42, v42, v42 row_mirror row_mask:0xf bank_mask:0xf
    v_add_f32_dpp v44, v44, v44 row_mirror row_mask:0xf bank_mask:0xf
    v_add_f32_dpp v46, v46, v46 row_mirror row_mask:0xf bank_mask:0xf
    v_mov_b32 v41, v40
    v_mov_b32 v43, v42
    v_mov_b32 v45, v44
    v_mov_b32 v47, v46
    v_permlane16_swap_b32 v40, v41
    v_permlane16_swap_b32 v42, v43
    v_permlane16_swap_b32 v44, v45
    v_permlane16_swap_b32 v46, v47
    v_add_f32 v40, v40, v41
    v_add_f32 v42, v42, v43
    v_add_f32 v44, v44, v45
    v_add_f32 v46, v46, v47
    v_mov_b32 v41, v40
    v_mov_b32 v43, v42
    v_mov_b32 v45, v44
    v_mov_b32 v47, v46
    v_permlane32_swap_b32 v40, v41
    v_permlane32_swap_b32 v42, v43
    v_permlane32_swap_b32 v44, v45
    v_permlane32_swap_b32 v46, v47
    v_add_f32 v40, v40, v41
    v_add_f32 v42, v42, v43
    v_add_f32 v44, v44, v45
    v_add_f32 v46, v46, v47
    v_mul_f32 v40, 0x3b000000, v40
    v_mul_f32 v42, 0x3b000000, v42
    v_mul_f32 v44, 0x3b000000, v44
    v_mul_f32 v46, 0x3b000000, v46
    v_sub_f32 v96, v96, v40
    v_sub_f32 v104, v104, v42
    v_sub_f32 v112, v112, v44
    v_sub_f32 v120, v120, v46
    v_sub_f32 v97, v97, v40
    v_sub_f32 v105, v105, v42
    v_sub_f32 v113, v113, v44
    v_sub_f32 v121, v121, v46
    v_sub_f32 v98, v98, v40
    v_sub_f32 v106, v106, v42
    v_sub_f32 v114, v114, v44
    v_sub_f32 v122, v122, v46
    v_sub_f32 v99, v99, v40
    v_sub_f32 v107, v107, v42
    v_sub_f32 v115, v115, v44
    v_sub_f32 v123, v123, v46
    v_sub_f32 v100, v100, v40
    v_sub_f32 v108, v108, v42
    v_sub_f32 v116, v116, v44
    v_sub_f32 v124, v124, v46
    v_sub_f32 v101, v101, v40
    v_sub_f32 v109, v109, v42
    v_sub_f32 v117, v117, v44
    v_sub_f32 v125, v125, v46
    v_sub_f32 v102, v102, v40
    v_sub_f32 v110, v110, v42
    v_sub_f32 v118, v118, v44
    v_sub_f32 v126, v126, v46
    v_sub_f32 v103, v103, v40
    v_sub_f32 v111, v111, v42
    v_sub_f32 v119, v119, v44
    v_sub_f32 v127, v127, v46
    v_mul_f32 v40, v96, v96
    v_mul_f32 v42, v104, v104
    v_mul_f32 v44, v112, v112
    v_mul_f32 v46, v120, v120
    v_fmac_f32 v40, v97, v97
    v_fmac_f32 v42, v105, v105
    v_fmac_f32 v44, v113, v113
    v_fmac_f32 v46, v121, v121
    v_fmac_f32 v40, v98, v98
    v_fmac_f32 v42, v106, v106
    v_fmac_f32 v44, v114, v114
    v_fmac_f32 v46, v122, v122
    v_fmac_f32 v40, v99, v99
    v_fmac_f32 v42, v107, v107
    v_fmac_f32 v44, v115, v115
    v_fmac_f32 v46, v123, v123
    v_fmac_f32 v40, v100, v100
    v_fmac_f32 v42, v108, v108
    v_fmac_f32 v44, v116, v116
    v_fmac_f32 v46, v124, v124
    v_fmac_f32 v40, v101, v101
    v_fmac_f32 v42, v109, v109
    v_fmac_f32 v44, v117, v117
    v_fmac_f32 v46, v125, v125
    v_fmac_f32 v40, v102, v102
    v_fmac_f32 v42, v110, v110
    v_fmac_f32 v44, v118, v118
    v_fmac_f32 v46, v126, v126
    v_fmac_f32 v40, v103, v103
    v_fmac_f32 v42, v111, v111
    v_fmac_f32 v44, v119, v119
    v_fmac_f32 v46, v127, v127
    v_add_f32_dpp v40, v40, v40 quad_perm:[1,0,3,2] row_mask:0xf bank_mask:0xf
    v_add_f32_dpp v42, v42, v42 quad_perm:[1,0,3,2] row_mask:0xf bank_mask:0xf
    v_add_f32_dpp v44, v44, v44 quad_perm:[1,0,3,2] row_mask:0xf bank_mask:0xf
    v_add_f32_dpp v46, v46, v46 quad_perm:[1,0,3,2] row_mask:0xf bank_mask:0xf
    v_add_f32_dpp v40, v40, v40 quad_perm:[2,3,0,1] row_mask:0xf bank_mask:0xf
    v_add_f32_dpp v42, v42, v42 quad_perm:[2,3,0,1] row_mask:0xf bank_mask:0xf
    v_add_f32_dpp v44, v44, v44 quad_perm:[2,3,0,1] row_mask:0xf bank_mask:0xf
    v_add_f32_dpp v46, v46, v46 quad_perm:[2,3,0,1] row_mask:0xf bank_mask:0xf
    v_add_f32_dpp v40, v40, v40 row_half_mirror row_mask:0xf bank_mask:0xf
    v_add_f32_dpp v42, v42, v42 row_half_mirror row_mask:0xf bank_mask:0xf
    v_add_f32_dpp v44, v44, v44 row_half_mirror row_mask:0xf bank_mask:0xf
    v_add_f32_dpp v46, v46, v46 row_half_mirror row_mask:0xf bank_mask:0xf
    v_add_f32_dpp v40, v40, v40 row_mirror row_mask:0xf bank_mask:0xf
    v_add_f32_dpp v42, v42, v42 row_mirror row_mask:0xf bank_mask:0xf
    v_add_f32_dpp v44, v44, v44 row_mirror row_mask:0xf bank_mask:0xf
    v_add_f32_dpp v46, v46, v46 row_mirror row_mask:0xf bank_mask:0xf
    v_mov_b32 v41, v40
    v_mov_b32 v43, v42
    v_mov_b32 v45, v44
    v_mov_b32 v47, v46
    v_permlane16_swap_b32 v40, v41
    v_permlane16_swap_b32 v42, v43
    v_permlane16_swap_b32 v44, v45
    v_permlane16_swap_b32 v46, v47
    v_add_f32 v40, v40, v41
    v_add_f32 v42, v42, v43
    v_add_f32 v44, v44, v45
    v_add_f32 v46, v46, v47
    v_mov_b32 v41, v40
    v_mov_b32 v43, v42
    v_mov_b32 v45, v44
    v_mov_b32 v47, v46
    v_permlane32_swap_b32 v40, v41
    v_permlane32_swap_b32 v42, v43
    v_permlane32_swap_b32 v44, v45
    v_permlane32_swap_b32 v46, v47
    v_add_f32 v40, v40, v41
    v_add_f32 v42, v42, v43
    v_add_f32 v44, v44, v45
    v_add_f32 v46, v46, v47
    v_mov_b32 v41, 0x3727c5ac
    v_mov_b32 v43, 0x3727c5ac
    v_mov_b32 v45, 0x3727c5ac
    v_mov_b32 v47, 0x3727c5ac
    v_fmac_f32 v41, 0x3b000000, v40
    v_fmac_f32 v43, 0x3b000000, v42
    v_fmac_f32 v45, 0x3b000000, v44
    v_fmac_f32 v47, 0x3b000000, v46
    v_rsq_f32 v40, v41
    v_rsq_f32 v42, v43
    v_rsq_f32 v44, v45
    v_rsq_f32 v46, v47
    v_mul_f32 v96, v96, v40
    v_mul_f32 v104, v104, v42
    v_mul_f32 v112, v112, v44
    v_mul_f32 v120, v120, v46
    v_mul_f32 v97, v97, v40
    v_mul_f32 v105, v105, v42
    v_mul_f32 v113, v113, v44
    v_mul_f32 v121, v121, v46
    v_mul_f32 v98, v98, v40
    v_mul_f32 v106, v106, v42
    v_mul_f32 v114, v114, v44
    v_mul_f32 v122, v122, v46
    v_mul_f32 v99, v99, v40
    v_mul_f32 v107, v107, v42
    v_mul_f32 v115, v115, v44
    v_mul_f32 v123, v123, v46
    v_mul_f32 v100, v100, v40
    v_mul_f32 v108, v108, v42
    v_mul_f32 v116, v116, v44
    v_mul_f32 v124, v124, v46
    v_mul_f32 v101, v101, v40
    v_mul_f32 v109, v109, v42
    v_mul_f32 v117, v117, v44
    v_mul_f32 v125, v125, v46
    v_mul_f32 v102, v102, v40
    v_mul_f32 v110, v110, v42
    v_mul_f32 v118, v118, v44
    v_mul_f32 v126, v126, v46
    v_mul_f32 v103, v103, v40
    v_mul_f32 v111, v111, v42
    v_mul_f32 v119, v119, v44
    v_mul_f32 v127, v127, v46
    v_cvt_pk_bf16_f32 v64, v96, v97
    v_cvt_pk_bf16_f32 v68, v104, v105
    v_cvt_pk_bf16_f32 v72, v112, v113
    v_cvt_pk_bf16_f32 v76, v120, v121
    v_cvt_pk_bf16_f32 v65, v98, v99
    v_cvt_pk_bf16_f32 v69, v106, v107
    v_cvt_pk_bf16_f32 v73, v114, v115
    v_cvt_pk_bf16_f32 v77, v122, v123
    v_cvt_pk_bf16_f32 v66, v100, v101
    v_cvt_pk_bf16_f32 v70, v108, v109
    v_cvt_pk_bf16_f32 v74, v116, v117
    v_cvt_pk_bf16_f32 v78, v124, v125
    v_cvt_pk_bf16_f32 v67, v102, v103
    v_cvt_pk_bf16_f32 v71, v110, v111
    v_cvt_pk_bf16_f32 v75, v118, v119
    v_cvt_pk_bf16_f32 v79, v126, v127
    buffer_store_dwordx4 v[64:67], v1, s[8:11], s25 offen offset:0 sc1
    buffer_store_dwordx4 v[68:71], v1, s[8:11], s25 offen offset:1024 sc1
    buffer_store_dwordx4 v[72:75], v1, s[8:11], s25 offen offset:2048 sc1
    buffer_store_dwordx4 v[76:79], v1, s[8:11], s25 offen offset:3072 sc1
    s_waitcnt vmcnt(4)
    v_lshlrev_b32 v96, 16, v80
    v_lshlrev_b32 v104, 16, v84
    v_lshlrev_b32 v112, 16, v88
    v_lshlrev_b32 v120, 16, v92
    v_and_b32 v97, 0xffff0000, v80
    v_and_b32 v105, 0xffff0000, v84
    v_and_b32 v113, 0xffff0000, v88
    v_and_b32 v121, 0xffff0000, v92
    v_lshlrev_b32 v98, 16, v81
    v_lshlrev_b32 v106, 16, v85
    v_lshlrev_b32 v114, 16, v89
    v_lshlrev_b32 v122, 16, v93
    v_and_b32 v99, 0xffff0000, v81
    v_and_b32 v107, 0xffff0000, v85
    v_and_b32 v115, 0xffff0000, v89
    v_and_b32 v123, 0xffff0000, v93
    v_lshlrev_b32 v100, 16, v82
    v_lshlrev_b32 v108, 16, v86
    v_lshlrev_b32 v116, 16, v90
    v_lshlrev_b32 v124, 16, v94
    v_and_b32 v101, 0xffff0000, v82
    v_and_b32 v109, 0xffff0000, v86
    v_and_b32 v117, 0xffff0000, v90
    v_and_b32 v125, 0xffff0000, v94
    v_lshlrev_b32 v102, 16, v83
    v_lshlrev_b32 v110, 16, v87
    v_lshlrev_b32 v118, 16, v91
    v_lshlrev_b32 v126, 16, v95
    v_and_b32 v103, 0xffff0000, v83
    v_and_b32 v111, 0xffff0000, v87
    v_and_b32 v119, 0xffff0000, v91
    v_and_b32 v127, 0xffff0000, v95
    v_add_f32 v40, v96, v97
    v_add_f32 v42, v104, v105
    v_add_f32 v44, v112, v113
    v_add_f32 v46, v120, v121
    v_add_f32 v40, v40, v98
    v_add_f32 v42, v42, v106
    v_add_f32 v44, v44, v114
    v_add_f32 v46, v46, v122
    v_add_f32 v40, v40, v99
    v_add_f32 v42, v42, v107
    v_add_f32 v44, v44, v115
    v_add_f32 v46, v46, v123
    v_add_f32 v40, v40, v100
    v_add_f32 v42, v42, v108
    v_add_f32 v44, v44, v116
    v_add_f32 v46, v46, v124
    v_add_f32 v40, v40, v101
    v_add_f32 v42, v42, v109
    v_add_f32 v44, v44, v117
    v_add_f32 v46, v46, v125
    v_add_f32 v40, v40, v102
    v_add_f32 v42, v42, v110
    v_add_f32 v44, v44, v118
    v_add_f32 v46, v46, v126
    v_add_f32 v40, v40, v103
    v_add_f32 v42, v42, v111
    v_add_f32 v44, v44, v119
    v_add_f32 v46, v46, v127
    v_add_f32_dpp v40, v40, v40 quad_perm:[1,0,3,2] row_mask:0xf bank_mask:0xf
    v_add_f32_dpp v42, v42, v42 quad_perm:[1,0,3,2] row_mask:0xf bank_mask:0xf
    v_add_f32_dpp v44, v44, v44 quad_perm:[1,0,3,2] row_mask:0xf bank_mask:0xf
    v_add_f32_dpp v46, v46, v46 quad_perm:[1,0,3,2] row_mask:0xf bank_mask:0xf
    v_add_f32_dpp v40, v40, v40 quad_perm:[2,3,0,1] row_mask:0xf bank_mask:0xf
    v_add_f32_dpp v42, v42, v42 quad_perm:[2,3,0,1] row_mask:0xf bank_mask:0xf
    v_add_f32_dpp v44, v44, v44 quad_perm:[2,3,0,1] row_mask:0xf bank_mask:0xf
    v_add_f32_dpp v46, v46, v46 quad_perm:[2,3,0,1] row_mask:0xf bank_mask:0xf
    v_add_f32_dpp v40, v40, v40 row_half_mirror row_mask:0xf bank_mask:0xf
    v_add_f32_dpp v42, v42, v42 row_half_mirror row_mask:0xf bank_mask:0xf
    v_add_f32_dpp v44, v44, v44 row_half_mirror row_mask:0xf bank_mask:0xf
    v_add_f32_dpp v46, v46, v46 row_half_mirror row_mask:0xf bank_mask:0xf
    v_add_f32_dpp v40, v40, v40 row_mirror row_mask:0xf bank_mask:0xf
    v_add_f32_dpp v42, v42, v42 row_mirror row_mask:0xf bank_mask:0xf
    v_add_f32_dpp v44, v44, v44 row_mirror row_mask:0xf bank_mask:0xf
    v_add_f32_dpp v46, v46, v46 row_mirror row_mask:0xf bank_mask:0xf
    v_mov_b32 v41, v40
    v_mov_b32 v43, v42
    v_mov_b32 v45, v44
    v_mov_b32 v47, v46
    v_permlane16_swap_b32 v40, v41
    v_permlane16_swap_b32 v42, v43
    v_permlane16_swap_b32 v44, v45
    v_permlane16_swap_b32 v46, v47
    v_add_f32 v40, v40, v41
    v_add_f32 v42, v42, v43
    v_add_f32 v44, v44, v45
    v_add_f32 v46, v46, v47
    v_mov_b32 v41, v40
    v_mov_b32 v43, v42
    v_mov_b32 v45, v44
    v_mov_b32 v47, v46
    v_permlane32_swap_b32 v40, v41
    v_permlane32_swap_b32 v42, v43
    v_permlane32_swap_b32 v44, v45
    v_permlane32_swap_b32 v46, v47
    v_add_f32 v40, v40, v41
    v_add_f32 v42, v42, v43
    v_add_f32 v44, v44, v45
    v_add_f32 v46, v46, v47
    v_mul_f32 v40, 0x3b000000, v40
    v_mul_f32 v42, 0x3b000000, v42
    v_mul_f32 v44, 0x3b000000, v44
    v_mul_f32 v46, 0x3b000000, v46
    v_sub_f32 v96, v96, v40
    v_sub_f32 v104, v104, v42
    v_sub_f32 v112, v112, v44
    v_sub_f32 v120, v120, v46
    v_sub_f32 v97, v97, v40
    v_sub_f32 v105, v105, v42
    v_sub_f32 v113, v113, v44
    v_sub_f32 v121, v121, v46
    v_sub_f32 v98, v98, v40
    v_sub_f32 v106, v106, v42
    v_sub_f32 v114, v114, v44
    v_sub_f32 v122, v122, v46
    v_sub_f32 v99, v99, v40
    v_sub_f32 v107, v107, v42
    v_sub_f32 v115, v115, v44
    v_sub_f32 v123, v123, v46
    v_sub_f32 v100, v100, v40
    v_sub_f32 v108, v108, v42
    v_sub_f32 v116, v116, v44
    v_sub_f32 v124, v124, v46
    v_sub_f32 v101, v101, v40
    v_sub_f32 v109, v109, v42
    v_sub_f32 v117, v117, v44
    v_sub_f32 v125, v125, v46
    v_sub_f32 v102, v102, v40
    v_sub_f32 v110, v110, v42
    v_sub_f32 v118, v118, v44
    v_sub_f32 v126, v126, v46
    v_sub_f32 v103, v103, v40
    v_sub_f32 v111, v111, v42
    v_sub_f32 v119, v119, v44
    v_sub_f32 v127, v127, v46
    v_mul_f32 v40, v96, v96
    v_mul_f32 v42, v104, v104
    v_mul_f32 v44, v112, v112
    v_mul_f32 v46, v120, v120
    v_fmac_f32 v40, v97, v97
    v_fmac_f32 v42, v105, v105
    v_fmac_f32 v44, v113, v113
    v_fmac_f32 v46, v121, v121
    v_fmac_f32 v40, v98, v98
    v_fmac_f32 v42, v106, v106
    v_fmac_f32 v44, v114, v114
    v_fmac_f32 v46, v122, v122
    v_fmac_f32 v40, v99, v99
    v_fmac_f32 v42, v107, v107
    v_fmac_f32 v44, v115, v115
    v_fmac_f32 v46, v123, v123
    v_fmac_f32 v40, v100, v100
    v_fmac_f32 v42, v108, v108
    v_fmac_f32 v44, v116, v116
    v_fmac_f32 v46, v124, v124
    v_fmac_f32 v40, v101, v101
    v_fmac_f32 v42, v109, v109
    v_fmac_f32 v44, v117, v117
    v_fmac_f32 v46, v125, v125
    v_fmac_f32 v40, v102, v102
    v_fmac_f32 v42, v110, v110
    v_fmac_f32 v44, v118, v118
    v_fmac_f32 v46, v126, v126
    v_fmac_f32 v40, v103, v103
    v_fmac_f32 v42, v111, v111
    v_fmac_f32 v44, v119, v119
    v_fmac_f32 v46, v127, v127
    v_add_f32_dpp v40, v40, v40 quad_perm:[1,0,3,2] row_mask:0xf bank_mask:0xf
    v_add_f32_dpp v42, v42, v42 quad_perm:[1,0,3,2] row_mask:0xf bank_mask:0xf
    v_add_f32_dpp v44, v44, v44 quad_perm:[1,0,3,2] row_mask:0xf bank_mask:0xf
    v_add_f32_dpp v46, v46, v46 quad_perm:[1,0,3,2] row_mask:0xf bank_mask:0xf
    v_add_f32_dpp v40, v40, v40 quad_perm:[2,3,0,1] row_mask:0xf bank_mask:0xf
    v_add_f32_dpp v42, v42, v42 quad_perm:[2,3,0,1] row_mask:0xf bank_mask:0xf
    v_add_f32_dpp v44, v44, v44 quad_perm:[2,3,0,1] row_mask:0xf bank_mask:0xf
    v_add_f32_dpp v46, v46, v46 quad_perm:[2,3,0,1] row_mask:0xf bank_mask:0xf
    v_add_f32_dpp v40, v40, v40 row_half_mirror row_mask:0xf bank_mask:0xf
    v_add_f32_dpp v42, v42, v42 row_half_mirror row_mask:0xf bank_mask:0xf
    v_add_f32_dpp v44, v44, v44 row_half_mirror row_mask:0xf bank_mask:0xf
    v_add_f32_dpp v46, v46, v46 row_half_mirror row_mask:0xf bank_mask:0xf
    v_add_f32_dpp v40, v40, v40 row_mirror row_mask:0xf bank_mask:0xf
    v_add_f32_dpp v42, v42, v42 row_mirror row_mask:0xf bank_mask:0xf
    v_add_f32_dpp v44, v44, v44 row_mirror row_mask:0xf bank_mask:0xf
    v_add_f32_dpp v46, v46, v46 row_mirror row_mask:0xf bank_mask:0xf
    v_mov_b32 v41, v40
    v_mov_b32 v43, v42
    v_mov_b32 v45, v44
    v_mov_b32 v47, v46
    v_permlane16_swap_b32 v40, v41
    v_permlane16_swap_b32 v42, v43
    v_permlane16_swap_b32 v44, v45
    v_permlane16_swap_b32 v46, v47
    v_add_f32 v40, v40, v41
    v_add_f32 v42, v42, v43
    v_add_f32 v44, v44, v45
    v_add_f32 v46, v46, v47
    v_mov_b32 v41, v40
    v_mov_b32 v43, v42
    v_mov_b32 v45, v44
    v_mov_b32 v47, v46
    v_permlane32_swap_b32 v40, v41
    v_permlane32_swap_b32 v42, v43
    v_permlane32_swap_b32 v44, v45
    v_permlane32_swap_b32 v46, v47
    v_add_f32 v40, v40, v41
    v_add_f32 v42, v42, v43
    v_add_f32 v44, v44, v45
    v_add_f32 v46, v46, v47
    v_mov_b32 v41, 0x3727c5ac
    v_mov_b32 v43, 0x3727c5ac
    v_mov_b32 v45, 0x3727c5ac
    v_mov_b32 v47, 0x3727c5ac
    v_fmac_f32 v41, 0x3b000000, v40
    v_fmac_f32 v43, 0x3b000000, v42
    v_fmac_f32 v45, 0x3b000000, v44
    v_fmac_f32 v47, 0x3b000000, v46
    v_rsq_f32 v40, v41
    v_rsq_f32 v42, v43
    v_rsq_f32 v44, v45
    v_rsq_f32 v46, v47
    v_mul_f32 v96, v96, v40
    v_mul_f32 v104, v104, v42
    v_mul_f32 v112, v112, v44
    v_mul_f32 v120, v120, v46
    v_mul_f32 v97, v97, v40
    v_mul_f32 v105, v105, v42
    v_mul_f32 v113, v113, v44
    v_mul_f32 v121, v121, v46
    v_mul_f32 v98, v98, v40
    v_mul_f32 v106, v106, v42
    v_mul_f32 v114, v114, v44
    v_mul_f32 v122, v122, v46
    v_mul_f32 v99, v99, v40
    v_mul_f32 v107, v107, v42
    v_mul_f32 v115, v115, v44
    v_mul_f32 v123, v123, v46
    v_mul_f32 v100, v100, v40
    v_mul_f32 v108, v108, v42
    v_mul_f32 v116, v116, v44
    v_mul_f32 v124, v124, v46
    v_mul_f32 v101, v101, v40
    v_mul_f32 v109, v109, v42
    v_mul_f32 v117, v117, v44
    v_mul_f32 v125, v125, v46
    v_mul_f32 v102, v102, v40
    v_mul_f32 v110, v110, v42
    v_mul_f32 v118, v118, v44
    v_mul_f32 v126, v126, v46
    v_mul_f32 v103, v103, v40
    v_mul_f32 v111, v111, v42
    v_mul_f32 v119, v119, v44
    v_mul_f32 v127, v127, v46
    v_cvt_pk_bf16_f32 v80, v96, v97
    v_cvt_pk_bf16_f32 v84, v104, v105
    v_cvt_pk_bf16_f32 v88, v112, v113
    v_cvt_pk_bf16_f32 v92, v120, v121
    v_cvt_pk_bf16_f32 v81, v98, v99
    v_cvt_pk_bf16_f32 v85, v106, v107
    v_cvt_pk_bf16_f32 v89, v114, v115
    v_cvt_pk_bf16_f32 v93, v122, v123
    v_cvt_pk_bf16_f32 v82, v100, v101
    v_cvt_pk_bf16_f32 v86, v108, v109
    v_cvt_pk_bf16_f32 v90, v116, v117
    v_cvt_pk_bf16_f32 v94, v124, v125
    v_cvt_pk_bf16_f32 v83, v102, v103
    v_cvt_pk_bf16_f32 v87, v110, v111
    v_cvt_pk_bf16_f32 v91, v118, v119
    v_cvt_pk_bf16_f32 v95, v126, v127
    buffer_store_dwordx4 v[80:83], v1, s[8:11], s26 offen offset:0 sc1
    buffer_store_dwordx4 v[84:87], v1, s[8:11], s26 offen offset:1024 sc1
    buffer_store_dwordx4 v[88:91], v1, s[8:11], s26 offen offset:2048 sc1
    buffer_store_dwordx4 v[92:95], v1, s[8:11], s26 offen offset:3072 sc1
    s_waitcnt vmcnt(0)
    s_barrier
    s_cmp_lg_u32 s20, 0
    s_cbranch_scc1 L_ia_32
    v_mov_b32 v4, 1
    buffer_atomic_add v4, v2, s[4:7], 0 offen offset:0 sc1
L_ia_32:
    s_cmp_lg_u32 s22, 0
    s_cbranch_scc1 B_ln
    s_cmp_lg_u32 s20, 0
    s_cbranch_scc1 L_ia_33
    v_mov_b32 v4, 1
    buffer_atomic_add v4, v2, s[4:7], 0 offen offset:192 sc1
L_ia_33:
B_ln:
    s_lshl_b32 s28, s20, 15
    s_lshl_b32 s29, s20, 13
    s_add_u32 s29, s29, 131072
    v_and_b32 v29, 3, v0
    v_bfe_u32 v30, v0, 2, 2
    v_bfe_u32 v31, v0, 2, 4
    v_lshl_add_u32 v32, v6, 3, v30
    v_lshlrev_b32 v33, 8, v32
    v_lshl_add_u32 v33, v29, 3, v33
    v_xor_b32 v34, s20, v30
    v_lshl_add_u32 v33, v34, 6, v33
    s_mov_b32 s27, 0
    s_lshl_b32 s26, s27, 15
    v_add_u32 v40, s26, v33
    s_lshl_b32 s26, s27, 13
    s_add_u32 s26, s26, 131072
    v_add_u32 v44, s26, v33
    s_mov_b32 s27, 1
    s_lshl_b32 s26, s27, 15
    v_add_u32 v41, s26, v33
    s_lshl_b32 s26, s27, 13
    s_add_u32 s26, s26, 131072
    v_add_u32 v45, s26, v33
    s_mov_b32 s27, 2
    s_lshl_b32 s26, s27, 15
    v_add_u32 v42, s26, v33
    s_lshl_b32 s26, s27, 13
    s_add_u32 s26, s26, 131072
    v_add_u32 v46, s26, v33
    s_mov_b32 s27, 3
    s_lshl_b32 s26, s27, 15
    v_add_u32 v43, s26, v33
    s_lshl_b32 s26, s27, 13
    s_add_u32 s26, s26, 131072
    v_add_u32 v47, s26, v33
    v_lshlrev_b32 v33, 7, v32
    v_lshl_add_u32 v33, v29, 3, v33
    v_add_u32 v35, s28, v33
    v_add_u32 v36, s29, v33
    v_bfe_u32 v33, v0, 3, 3
    v_mul_u32_u24 v34, 2752, v33
    v_and_b32 v33, 7, v0
    v_lshl_add_u32 v34, v33, 4, v34
    v_cmp_gt_u32 vcc, 6, v33
    v_mov_b32 v33, 0x40000000
    s_nop 0
    v_cndmask_b32 v34, v33, v34, vcc
    v_lshlrev_b32 v19, 2, v6
    v_xor_b32 v19, v19, v5
    v_lshlrev_b32 v19, 4, v19
    v_lshl_add_u32 v16, v6, 13, v19
    v_lshl_add_u32 v19, v6, 10, v19
    v_lshlrev_b32 v32, 8, v31
    v_lshl_add_u32 v32, v29, 4, v32
    v_xor_b32 v33, 0, v30
    v_lshl_add_u32 v33, v33, 6, v32
    v_add_u32 v20, s28, v33
    v_add_u32 v24, s29, v33
    v_xor_b32 v33, 1, v30
    v_lshl_add_u32 v33, v33, 6, v32
    v_add_u32 v21, s28, v33
    v_add_u32 v25, s29, v33
    v_xor_b32 v33, 2, v30
    v_lshl_add_u32 v33, v33, 6, v32
    v_add_u32 v22, s28, v33
    v_add_u32 v26, s29, v33
    v_xor_b32 v33, 3, v30
    v_lshl_add_u32 v33, v33, 6, v32
    v_add_u32 v23, s28, v33
    v_add_u32 v27, s29, v33
    s_mov_b32 s96, s86
    s_and_b32 s97, s87, 0xffff
    s_mov_b32 s98, 0x400000
    s_mov_b32 s99, 0x20000
    s_mov_b32 s26, 4294963200
    s_mul_i32 s35, s21, 262144
    s_add_u32 s26, s26, s35
    s_mul_i32 s35, s20, 256
    s_add_u32 s26, s26, s35
    s_add_u32 m0, s28, 0
    s_add_u32 s26, s26, 4096
    buffer_load_dwordx4 v19, s[96:99], s26 offen lds
    s_add_u32 m0, s28, 1024
    s_add_u32 s26, s26, 4096
    buffer_load_dwordx4 v19, s[96:99], s26 offen lds
    s_add_u32 m0, s28, 2048
    s_add_u32 s26, s26, 4096
    buffer_load_dwordx4 v19, s[96:99], s26 offen lds
    s_add_u32 m0, s28, 3072
    s_add_u32 s26, s26, 4096
    buffer_load_dwordx4 v19, s[96:99], s26 offen lds
    s_add_u32 m0, s28, 4096
    s_add_u32 s26, s26, 4096
    buffer_load_dwordx4 v19, s[96:99], s26 offen lds
    s_add_u32 m0, s28, 5120
    s_add_u32 s26, s26, 4096
    buffer_load_dwordx4 v19, s[96:99], s26 offen lds
    s_add_u32 m0, s28, 6144
    s_add_u32 s26, s26, 4096
    buffer_load_dwordx4 v19, s[96:99], s26 offen lds
    s_add_u32 m0, s28, 7168
    s_add_u32 s26, s26, 4096
    buffer_load_dwordx4 v19, s[96:99], s26 offen lds
    s_add_u32 m0, s28, 8192
    s_add_u32 s26, s26, 4096
    buffer_load_dwordx4 v19, s[96:99], s26 offen lds
    s_add_u32 m0, s28, 9216
    s_add_u32 s26, s26, 4096
    buffer_load_dwordx4 v19, s[96:99], s26 offen lds
    s_add_u32 m0, s28, 10240
    s_add_u32 s26, s26, 4096
    buffer_load_dwordx4 v19, s[96:99], s26 offen lds
    s_add_u32 m0, s28, 11264
    s_add_u32 s26, s26, 4096
    buffer_load_dwordx4 v19, s[96:99], s26 offen lds
    s_add_u32 m0, s28, 12288
    s_add_u32 s26, s26, 4096
    buffer_load_dwordx4 v19, s[96:99], s26 offen lds
    s_add_u32 m0, s28, 13312
    s_add_u32 s26, s26, 4096
    buffer_load_dwordx4 v19, s[96:99], s26 offen lds
    s_add_u32 m0, s28, 14336
    s_add_u32 s26, s26, 4096
    buffer_load_dwordx4 v19, s[96:99], s26 offen lds
    s_add_u32 m0, s28, 15360
    s_add_u32 s26, s26, 4096
    buffer_load_dwordx4 v19, s[96:99], s26 offen lds
    s_add_u32 m0, s28, 16384
    s_add_u32 s26, s26, 4096
    buffer_load_dwordx4 v19, s[96:99], s26 offen lds
    s_add_u32 m0, s28, 17408
    s_add_u32 s26, s26, 4096
    buffer_load_dwordx4 v19, s[96:99], s26 offen lds
    s_add_u32 m0, s28, 18432
    s_add_u32 s26, s26, 4096
    buffer_load_dwordx4 v19, s[96:99], s26 offen lds
    s_add_u32 m0, s28, 19456
    s_add_u32 s26, s26, 4096
    buffer_load_dwordx4 v19, s[96:99], s26 offen lds
    s_add_u32 m0, s28, 20480
    s_add_u32 s26, s26, 4096
    buffer_load_dwordx4 v19, s[96:99], s26 offen lds
    s_add_u32 m0, s28, 21504
    s_add_u32 s26, s26, 4096
    buffer_load_dwordx4 v19, s[96:99], s26 offen lds
    s_add_u32 m0, s28, 22528
    s_add_u32 s26, s26, 4096
    buffer_load_dwordx4 v19, s[96:99], s26 offen lds
    s_add_u32 m0, s28, 23552
    s_add_u32 s26, s26, 4096
    buffer_load_dwordx4 v19, s[96:99], s26 offen lds
    s_add_u32 m0, s28, 24576
    s_add_u32 s26, s26, 4096
    buffer_load_dwordx4 v19, s[96:99], s26 offen lds
    s_add_u32 m0, s28, 25600
    s_add_u32 s26, s26, 4096
    buffer_load_dwordx4 v19, s[96:99], s26 offen lds
    s_add_u32 m0, s28, 26624
    s_add_u32 s26, s26, 4096
    buffer_load_dwordx4 v19, s[96:99], s26 offen lds
    s_add_u32 m0, s28, 27648
    s_add_u32 s26, s26, 4096
    buffer_load_dwordx4 v19, s[96:99], s26 offen lds
    s_add_u32 m0, s28, 28672
    s_add_u32 s26, s26, 4096
    buffer_load_dwordx4 v19, s[96:99], s26 offen lds
    s_add_u32 m0, s28, 29696
    s_add_u32 s26, s26, 4096
    buffer_load_dwordx4 v19, s[96:99], s26 offen lds
    s_add_u32 m0, s28, 30720
    s_add_u32 s26, s26, 4096
    buffer_load_dwordx4 v19, s[96:99], s26 offen lds
    s_add_u32 m0, s28, 31744
    s_add_u32 s26, s26, 4096
    buffer_load_dwordx4 v19, s[96:99], s26 offen lds
    s_waitcnt vmcnt(24)
    s_add_u32 m0, s29, 0
    s_add_u32 s26, s26, 4096
    buffer_load_dwordx4 v19, s[96:99], s26 offen lds
    s_add_u32 m0, s29, 1024
    s_add_u32 s26, s26, 4096
    buffer_load_dwordx4 v19, s[96:99], s26 offen lds
    s_add_u32 m0, s29, 2048
    s_add_u32 s26, s26, 4096
    buffer_load_dwordx4 v19, s[96:99], s26 offen lds
    s_add_u32 m0, s29, 3072
    s_add_u32 s26, s26, 4096
    buffer_load_dwordx4 v19, s[96:99], s26 offen lds
    s_add_u32 m0, s29, 4096
    s_add_u32 s26, s26, 4096
    buffer_load_dwordx4 v19, s[96:99], s26 offen lds
    s_add_u32 m0, s29, 5120
    s_add_u32 s26, s26, 4096
    buffer_load_dwordx4 v19, s[96:99], s26 offen lds
    s_add_u32 m0, s29, 6144
    s_add_u32 s26, s26, 4096
    buffer_load_dwordx4 v19, s[96:99], s26 offen lds
    s_add_u32 m0, s29, 7168
    s_add_u32 s26, s26, 4096
    buffer_load_dwordx4 v19, s[96:99], s26 offen lds
    ds_read_b64_tr_b16 a[0:1], v20 offset:0
    ds_read_b64_tr_b16 a[2:3], v20 offset:4096
    ds_read_b64_tr_b16 a[16:17], v20 offset:8
    ds_read_b64_tr_b16 a[18:19], v20 offset:4104
    ds_read_b64_tr_b16 a[32:33], v21 offset:0
    ds_read_b64_tr_b16 a[34:35], v21 offset:4096
    ds_read_b64_tr_b16 a[48:49], v21 offset:8
    ds_read_b64_tr_b16 a[50:51], v21 offset:4104
    ds_read_b64_tr_b16 a[64:65], v22 offset:0
    ds_read_b64_tr_b16 a[66:67], v22 offset:4096
    ds_read_b64_tr_b16 a[80:81], v22 offset:8
    ds_read_b64_tr_b16 a[82:83], v22 offset:4104
    ds_read_b64_tr_b16 a[96:97], v23 offset:0
    ds_read_b64_tr_b16 a[98:99], v23 offset:4096
    ds_read_b64_tr_b16 a[112:113], v23 offset:8
    ds_read_b64_tr_b16 a[114:115], v23 offset:4104
    s_waitcnt lgkmcnt(0)
    s_waitcnt vmcnt(24)
    s_add_u32 m0, s28, 0
    s_add_u32 s26, s26, 4096
    buffer_load_dwordx4 v19, s[96:99], s26 offen lds
    s_add_u32 m0, s28, 1024
    s_add_u32 s26, s26, 4096
    buffer_load_dwordx4 v19, s[96:99], s26 offen lds
    s_add_u32 m0, s28, 2048
    s_add_u32 s26, s26, 4096
    buffer_load_dwordx4 v19, s[96:99], s26 offen lds
    s_add_u32 m0, s28, 3072
    s_add_u32 s26, s26, 4096
    buffer_load_dwordx4 v19, s[96:99], s26 offen lds
    s_add_u32 m0, s28, 4096
    s_add_u32 s26, s26, 4096
    buffer_load_dwordx4 v19, s[96:99], s26 offen lds
    s_add_u32 m0, s28, 5120
    s_add_u32 s26, s26, 4096
    buffer_load_dwordx4 v19, s[96:99], s26 offen lds
    s_add_u32 m0, s28, 6144
    s_add_u32 s26, s26, 4096
    buffer_load_dwordx4 v19, s[96:99], s26 offen lds
    s_add_u32 m0, s28, 7168
    s_add_u32 s26, s26, 4096
    buffer_load_dwordx4 v19, s[96:99], s26 offen lds
    ds_read_b64_tr_b16 a[4:5], v20 offset:8192
    ds_read_b64_tr_b16 a[6:7], v20 offset:12288
    ds_read_b64_tr_b16 a[20:21], v20 offset:8200
    ds_read_b64_tr_b16 a[22:23], v20 offset:12296
    ds_read_b64_tr_b16 a[36:37], v21 offset:8192
    ds_read_b64_tr_b16 a[38:39], v21 offset:12288
    ds_read_b64_tr_b16 a[52:53], v21 offset:8200
    ds_read_b64_tr_b16 a[54:55], v21 offset:12296
    ds_read_b64_tr_b16 a[68:69], v22 offset:8192
    ds_read_b64_tr_b16 a[70:71], v22 offset:12288
    ds_read_b64_tr_b16 a[84:85], v22 offset:8200
    ds_read_b64_tr_b16 a[86:87], v22 offset:12296
    ds_read_b64_tr_b16 a[100:101], v23 offset:8192
    ds_read_b64_tr_b16 a[102:103], v23 offset:12288
    ds_read_b64_tr_b16 a[116:117], v23 offset:8200
    ds_read_b64_tr_b16 a[118:119], v23 offset:12296
    s_waitcnt lgkmcnt(0)
    s_waitcnt vmcnt(24)
    s_add_u32 m0, s28, 8192
    s_add_u32 s26, s26, 4096
    buffer_load_dwordx4 v19, s[96:99], s26 offen lds
    s_add_u32 m0, s28, 9216
    s_add_u32 s26, s26, 4096
    buffer_load_dwordx4 v19, s[96:99], s26 offen lds
    s_add_u32 m0, s28, 10240
    s_add_u32 s26, s26, 4096
    buffer_load_dwordx4 v19, s[96:99], s26 offen lds
    s_add_u32 m0, s28, 11264
    s_add_u32 s26, s26, 4096
    buffer_load_dwordx4 v19, s[96:99], s26 offen lds
    s_add_u32 m0, s28, 12288
    s_add_u32 s26, s26, 4096
    buffer_load_dwordx4 v19, s[96:99], s26 offen lds
    s_add_u32 m0, s28, 13312
    s_add_u32 s26, s26, 4096
    buffer_load_dwordx4 v19, s[96:99], s26 offen lds
    s_add_u32 m0, s28, 14336
    s_add_u32 s26, s26, 4096
    buffer_load_dwordx4 v19, s[96:99], s26 offen lds
    s_add_u32 m0, s28, 15360
    s_add_u32 s26, s26, 4096
    buffer_load_dwordx4 v19, s[96:99], s26 offen lds
    ds_read_b64_tr_b16 a[8:9], v20 offset:16384
    ds_read_b64_tr_b16 a[10:11], v20 offset:20480
    ds_read_b64_tr_b16 a[24:25], v20 offset:16392
    ds_read_b64_tr_b16 a[26:27], v20 offset:20488
    ds_read_b64_tr_b16 a[40:41], v21 offset:16384
    ds_read_b64_tr_b16 a[42:43], v21 offset:20480
    ds_read_b64_tr_b16 a[56:57], v21 offset:16392
    ds_read_b64_tr_b16 a[58:59], v21 offset:20488
    ds_read_b64_tr_b16 a[72:73], v22 offset:16384
    ds_read_b64_tr_b16 a[74:75], v22 offset:20480
    ds_read_b64_tr_b16 a[88:89], v22 offset:16392
    ds_read_b64_tr_b16 a[90:91], v22 offset:20488
    ds_read_b64_tr_b16 a[104:105], v23 offset:16384
    ds_read_b64_tr_b16 a[106:107], v23 offset:20480
    ds_read_b64_tr_b16 a[120:121], v23 offset:16392
    ds_read_b64_tr_b16 a[122:123], v23 offset:20488
    s_waitcnt lgkmcnt(0)
    s_waitcnt vmcnt(24)
    s_add_u32 m0, s28, 16384
    s_add_u32 s26, s26, 4096
    buffer_load_dwordx4 v19, s[96:99], s26 offen lds
    s_add_u32 m0, s28, 17408
    s_add_u32 s26, s26, 4096
    buffer_load_dwordx4 v19, s[96:99], s26 offen lds
    s_add_u32 m0, s28, 18432
    s_add_u32 s26, s26, 4096
    buffer_load_dwordx4 v19, s[96:99], s26 offen lds
    s_add_u32 m0, s28, 19456
    s_add_u32 s26, s26, 4096
    buffer_load_dwordx4 v19, s[96:99], s26 offen lds
    s_add_u32 m0, s28, 20480
    s_add_u32 s26, s26, 4096
    buffer_load_dwordx4 v19, s[96:99], s26 offen lds
    s_add_u32 m0, s28, 21504
    s_add_u32 s26, s26, 4096
    buffer_load_dwordx4 v19, s[96:99], s26 offen lds
    s_add_u32 m0, s28, 22528
    s_add_u32 s26, s26, 4096
    buffer_load_dwordx4 v19, s[96:99], s26 offen lds
    s_add_u32 m0, s28, 23552
    s_add_u32 s26, s26, 4096
    buffer_load_dwordx4 v19, s[96:99], s26 offen lds
    ds_read_b64_tr_b16 a[12:13], v20 offset:24576
    ds_read_b64_tr_b16 a[14:15], v20 offset:28672
    ds_read_b64_tr_b16 a[28:29], v20 offset:24584
    ds_read_b64_tr_b16 a[30:31], v20 offset:28680
    ds_read_b64_tr_b16 a[44:45], v21 offset:24576
    ds_read_b64_tr_b16 a[46:47], v21 offset:28672
    ds_read_b64_tr_b16 a[60:61], v21 offset:24584
    ds_read_b64_tr_b16 a[62:63], v21 offset:28680
    ds_read_b64_tr_b16 a[76:77], v22 offset:24576
    ds_read_b64_tr_b16 a[78:79], v22 offset:28672
    ds_read_b64_tr_b16 a[92:93], v22 offset:24584
    ds_read_b64_tr_b16 a[94:95], v22 offset:28680
    ds_read_b64_tr_b16 a[108:109], v23 offset:24576
    ds_read_b64_tr_b16 a[110:111], v23 offset:28672
    ds_read_b64_tr_b16 a[124:125], v23 offset:24584
    ds_read_b64_tr_b16 a[126:127], v23 offset:28680
    s_waitcnt lgkmcnt(0)
    s_waitcnt vmcnt(24)
    ds_read_b64_tr_b16 a[128:129], v24 offset:0
    ds_read_b64_tr_b16 a[130:131], v24 offset:4096
    ds_read_b64_tr_b16 a[144:145], v24 offset:8
    ds_read_b64_tr_b16 a[146:147], v24 offset:4104
    ds_read_b64_tr_b16 a[160:161], v25 offset:0
    ds_read_b64_tr_b16 a[162:163], v25 offset:4096
    ds_read_b64_tr_b16 a[176:177], v25 offset:8
    ds_read_b64_tr_b16 a[178:179], v25 offset:4104
    ds_read_b64_tr_b16 a[192:193], v26 offset:0
    ds_read_b64_tr_b16 a[194:195], v26 offset:4096
    ds_read_b64_tr_b16 a[208:209], v26 offset:8
    ds_read_b64_tr_b16 a[210:211], v26 offset:4104
    ds_read_b64_tr_b16 a[224:225], v27 offset:0
    ds_read_b64_tr_b16 a[226:227], v27 offset:4096
    ds_read_b64_tr_b16 a[240:241], v27 offset:8
    ds_read_b64_tr_b16 a[242:243], v27 offset:4104
    s_waitcnt lgkmcnt(0)
    s_waitcnt vmcnt(16)
    ds_read_b64_tr_b16 a[132:133], v20 offset:0
    ds_read_b64_tr_b16 a[134:135], v20 offset:4096
    ds_read_b64_tr_b16 a[148:149], v20 offset:8
    ds_read_b64_tr_b16 a[150:151], v20 offset:4104
    ds_read_b64_tr_b16 a[164:165], v21 offset:0
    ds_read_b64_tr_b16 a[166:167], v21 offset:4096
    ds_read_b64_tr_b16 a[180:181], v21 offset:8
    ds_read_b64_tr_b16 a[182:183], v21 offset:4104
    ds_read_b64_tr_b16 a[196:197], v22 offset:0
    ds_read_b64_tr_b16 a[198:199], v22 offset:4096
    ds_read_b64_tr_b16 a[212:213], v22 offset:8
    ds_read_b64_tr_b16 a[214:215], v22 offset:4104
    ds_read_b64_tr_b16 a[228:229], v23 offset:0
    ds_read_b64_tr_b16 a[230:231], v23 offset:4096
    ds_read_b64_tr_b16 a[244:245], v23 offset:8
    ds_read_b64_tr_b16 a[246:247], v23 offset:4104
    s_waitcnt lgkmcnt(0)
    s_waitcnt vmcnt(8)
    ds_read_b64_tr_b16 a[136:137], v20 offset:8192
    ds_read_b64_tr_b16 a[138:139], v20 offset:12288
    ds_read_b64_tr_b16 a[152:153], v20 offset:8200
    ds_read_b64_tr_b16 a[154:155], v20 offset:12296
    ds_read_b64_tr_b16 a[168:169], v21 offset:8192
    ds_read_b64_tr_b16 a[170:171], v21 offset:12288
    ds_read_b64_tr_b16 a[184:185], v21 offset:8200
    ds_read_b64_tr_b16 a[186:187], v21 offset:12296
    ds_read_b64_tr_b16 a[200:201], v22 offset:8192
    ds_read_b64_tr_b16 a[202:203], v22 offset:12288
    ds_read_b64_tr_b16 a[216:217], v22 offset:8200
    ds_read_b64_tr_b16 a[218:219], v22 offset:12296
    ds_read_b64_tr_b16 a[232:233], v23 offset:8192
    ds_read_b64_tr_b16 a[234:235], v23 offset:12288
    ds_read_b64_tr_b16 a[248:249], v23 offset:8200
    ds_read_b64_tr_b16 a[250:251], v23 offset:12296
    s_waitcnt lgkmcnt(0)
    s_waitcnt vmcnt(0)
    ds_read_b64_tr_b16 a[140:141], v20 offset:16384
    ds_read_b64_tr_b16 a[142:143], v20 offset:20480
    ds_read_b64_tr_b16 a[156:157], v20 offset:16392
    ds_read_b64_tr_b16 a[158:159], v20 offset:20488
    ds_read_b64_tr_b16 a[172:173], v21 offset:16384
    ds_read_b64_tr_b16 a[174:175], v21 offset:20480
    ds_read_b64_tr_b16 a[188:189], v21 offset:16392
    ds_read_b64_tr_b16 a[190:191], v21 offset:20488
    ds_read_b64_tr_b16 a[204:205], v22 offset:16384
    ds_read_b64_tr_b16 a[206:207], v22 offset:20480
    ds_read_b64_tr_b16 a[220:221], v22 offset:16392
    ds_read_b64_tr_b16 a[222:223], v22 offset:20488
    ds_read_b64_tr_b16 a[236:237], v23 offset:16384
    ds_read_b64_tr_b16 a[238:239], v23 offset:20480
    ds_read_b64_tr_b16 a[252:253], v23 offset:16392
    ds_read_b64_tr_b16 a[254:255], v23 offset:20488
    s_waitcnt lgkmcnt(0)
    v_lshlrev_b32 v8, 2, v6
    v_sub_u32 v7, v5, v8
    v_cmp_le_i32 s[40:41], 0, v7
    v_cmp_le_i32 s[42:43], 1, v7
    v_cmp_le_i32 s[44:45], 2, v7
    v_cmp_le_i32 s[46:47], 3, v7
    v_and_b32 v0, 1, v5
    v_lshrrev_b32 v8, 2, v5
    v_lshl_add_u32 v0, v8, 1, v0
    v_lshl_add_u32 v0, v6, 4, v0
    v_add_u32 v0, 8, v0
    v_lshlrev_b32 v0, 4, v0
    v_and_b32 v15, 7, v5
    v_lshl_add_u32 v15, v6, 4, v15
    v_lshlrev_b32 v15, 4, v15
    v_and_b32 v8, 8, v5
    v_add_u32 v15, v15, v8
    v_mov_b32 v9, 0xd028965f
    v_lshrrev_b32 v12, 1, v5
    v_mul_u32_u24 v12, 33024, v12
    v_and_b32 v13, 1, v5
    v_lshl_add_u32 v12, v13, 6, v12
    v_lshl_add_u32 v12, v6, 4, v12
    s_lshr_b32 s48, s20, 1
    s_and_b32 s49, s20, 1
    s_lshl_b32 s25, s48, 14
    s_lshl_b32 s26, s49, 12
    s_add_u32 s25, s25, s26
    v_add_u32 v10, s25, v1
    s_lshl_b32 s50, s21, 13
    s_add_u32 s50, s50, s26
    s_mov_b32 s23, 0
    s_mov_b32 s24, s22
    s_mov_b32 s33, 0
    s_mov_b32 s54, 0
    s_cmp_lg_u32 s20, 0
    s_cbranch_scc1 L_wd_35
L_w_34:
    buffer_load_dword v4, v2, s[4:7], 0 offen offset:0 sc1
    s_waitcnt vmcnt(0)
    v_readfirstlane_b32 s34, v4
    s_nop 0
    s_cmp_ge_u32 s34, 160
    s_cbranch_scc1 L_wd_35
    s_sleep 2
    s_sub_u32 s30, s30, 1
    s_cbranch_scc0 L_w_34
    s_branch M_done
L_wd_35:
    s_barrier
    buffer_load_dword v4, v2, s[4:7], s76 offen sc1
    s_waitcnt vmcnt(0)
    v_readfirstlane_b32 s34, v4
    s_nop 0
    s_lshr_b32 s34, s34, s75
    s_and_b32 s34, s34, 255
    s_cmp_eq_u32 s34, 16
    s_cbranch_scc1 B_loopL
B_loopG:
    s_cmp_lg_u32 s54, 0
    s_cbranch_scc1 L_bp_36
    s_mov_b32 s26, 35651584
    s_mul_i32 s35, s24, 2048
    s_add_u32 s26, s26, s35
    s_mul_i32 s35, s21, 128
    s_add_u32 s26, s26, s35
    s_mul_i32 s35, s49, 64
    s_add_u32 s26, s26, s35
L_w_37:
    buffer_load_dword v4, v2, s[8:11], s26 offen sc1
    s_waitcnt vmcnt(0)
    v_readfirstlane_b32 s34, v4
    s_nop 0
    s_cmp_ge_u32 s34, 1
    s_cbranch_scc1 L_wd_38
    s_sleep 2
    s_sub_u32 s30, s30, 1
    s_cbranch_scc0 L_w_37
    s_branch M_done
L_wd_38:
    s_lshl_b32 s58, s24, 1
    s_add_u32 s58, s58, s48
    s_lshl_b32 s58, s58, 18
    s_add_u32 s59, s58, s50
    s_add_u32 s58, s59, s50
    s_add_u32 s58, s58, 109051904
    s_add_u32 s60, s59, 75497472
    s_add_u32 s59, s59, 41943040
    buffer_load_dwordx4 v[192:195], v1, s[8:11], s58 offen offset:0 sc1
    buffer_load_dwordx4 v[196:199], v1, s[8:11], s58 offen offset:1024 sc1
    buffer_load_dwordx4 v[200:203], v1, s[8:11], s58 offen offset:2048 sc1
    buffer_load_dwordx4 v[204:207], v1, s[8:11], s58 offen offset:3072 sc1
    s_add_u32 s58, s58, 4096
    buffer_load_dwordx4 v[208:211], v1, s[8:11], s58 offen offset:0 sc1
    buffer_load_dwordx4 v[212:215], v1, s[8:11], s58 offen offset:1024 sc1
    buffer_load_dwordx4 v[216:219], v1, s[8:11], s58 offen offset:2048 sc1
    buffer_load_dwordx4 v[220:223], v1, s[8:11], s58 offen offset:3072 sc1
    buffer_load_dwordx4 v[160:163], v1, s[8:11], s60 offen offset:0 sc1
    buffer_load_dwordx4 v[164:167], v1, s[8:11], s60 offen offset:1024 sc1
    buffer_load_dwordx4 v[168:171], v1, s[8:11], s60 offen offset:2048 sc1
    buffer_load_dwordx4 v[172:175], v1, s[8:11], s60 offen offset:3072 sc1
    s_add_u32 s60, s60, 131072
    buffer_load_dwordx4 v[176:179], v1, s[8:11], s60 offen offset:0 sc1
    buffer_load_dwordx4 v[180:183], v1, s[8:11], s60 offen offset:1024 sc1
    buffer_load_dwordx4 v[184:187], v1, s[8:11], s60 offen offset:2048 sc1
    buffer_load_dwordx4 v[188:191], v1, s[8:11], s60 offen offset:3072 sc1
    buffer_load_dwordx4 v[224:227], v1, s[8:11], s59 offen offset:0 sc1
    buffer_load_dwordx4 v[228:231], v1, s[8:11], s59 offen offset:1024 sc1
    buffer_load_dwordx4 v[232:235], v1, s[8:11], s59 offen offset:2048 sc1
    buffer_load_dwordx4 v[236:239], v1, s[8:11], s59 offen offset:3072 sc1
    s_add_u32 s59, s59, 131072
    buffer_load_dwordx4 v[240:243], v1, s[8:11], s59 offen offset:0 sc1
    buffer_load_dwordx4 v[244:247], v1, s[8:11], s59 offen offset:1024 sc1
    buffer_load_dwordx4 v[248:251], v1, s[8:11], s59 offen offset:2048 sc1
    buffer_load_dwordx4 v[252:255], v1, s[8:11], s59 offen offset:3072 sc1
    s_mov_b32 s61, 0
L_bp_36:
    s_cmp_ge_u32 s61, 16
    s_cbranch_scc1 L_bq_39
    s_mov_b32 s26, 35782656
    s_mul_i32 s35, s24, 1024
    s_add_u32 s26, s26, s35
    s_mul_i32 s35, s21, 64
    s_add_u32 s26, s26, s35
L_w_40:
    buffer_load_dword v4, v2, s[8:11], s26 offen sc1
    s_waitcnt vmcnt(0)
    v_readfirstlane_b32 s34, v4
    s_nop 0
    s_cmp_ge_u32 s34, 16
    s_cbranch_scc1 L_wd_41
    s_sleep 1
    s_sub_u32 s30, s30, 1
    s_cbranch_scc0 L_w_40
    s_branch M_done
L_wd_41:
    s_lshl_b32 s25, s24, 1
    s_add_u32 s25, s25, s48
    s_lshl_b32 s25, s25, 17
    s_add_u32 s25, s25, s50
    s_add_u32 s25, s25, 142606336
    buffer_load_dwordx4 v[128:131], v0, s[8:11], s25 offen offset:0 sc1
    buffer_load_dwordx4 v[132:135], v0, s[8:11], s25 offen offset:1024 sc1
    buffer_load_dwordx4 v[136:139], v0, s[8:11], s25 offen offset:2048 sc1
    buffer_load_dwordx4 v[140:143], v0, s[8:11], s25 offen offset:3072 sc1
    buffer_load_dwordx2 v[144:145], v15, s[8:11], s25 offen offset:0 sc1
    buffer_load_dwordx2 v[146:147], v15, s[8:11], s25 offen offset:1024 sc1
    buffer_load_dwordx2 v[148:149], v15, s[8:11], s25 offen offset:2048 sc1
    buffer_load_dwordx2 v[150:151], v15, s[8:11], s25 offen offset:3072 sc1
L_bq_39:
    s_cmp_lt_u32 s24, 32
    s_cselect_b32 s55, 25, -21
    s_sub_u32 s35, s24, 7
    s_cmp_lt_u32 s35, 46
    s_cselect_b32 s55, s55, 4
    s_add_u32 s55, s55, s24
    s_min_u32 s55, s55, 63
    s_mov_b32 s26, 35651584
    s_mul_i32 s35, s55, 2048
    s_add_u32 s26, s26, s35
    s_mul_i32 s35, s21, 128
    s_add_u32 s26, s26, s35
    s_mul_i32 s35, s49, 64
    s_add_u32 s26, s26, s35
    buffer_load_dword v116, v2, s[8:11], s26 offen sc1
    v_mov_b32 v37, 0
    v_mov_b32 v41, 0
    v_mov_b32 v112, 0
    v_mov_b32 v114, 0
    s_waitcnt vmcnt(9)
    v_mfma_f32_16x16x32_bf16 v[20:23], v[160:163], v[224:227], 0
    v_mfma_f32_16x16x32_bf16 v[28:31], v[160:163], v[240:243], 0
    v_mfma_f32_16x16x32_bf16 v[32:35], v[176:179], v[240:243], 0
    v_mfma_f32_16x16x32_bf16 v[20:23], v[164:167], v[228:231], v[20:23]
    v_mfma_f32_16x16x32_bf16 v[28:31], v[164:167], v[244:247], v[28:31]
    v_mfma_f32_16x16x32_bf16 v[32:35], v[180:183], v[244:247], v[32:35]
    v_mfma_f32_16x16x32_bf16 v[20:23], v[168:171], v[232:235], v[20:23]
    v_mfma_f32_16x16x32_bf16 v[28:31], v[168:171], v[248:251], v[28:31]
    v_mfma_f32_16x16x32_bf16 v[32:35], v[184:187], v[248:251], v[32:35]
    v_mfma_f32_16x16x32_bf16 v[20:23], v[172:175], v[236:239], v[20:23]
    v_mfma_f32_16x16x32_bf16 v[28:31], v[172:175], v[252:255], v[28:31]
    v_mfma_f32_16x16x32_bf16 v[32:35], v[188:191], v[252:255], v[32:35]
    s_waitcnt vmcnt(5)
    v_mfma_f32_16x16x32_bf16 v[16:19], v[128:131], v[224:227], 0
    v_mfma_f32_16x16x32_bf16 v[24:27], v[128:131], v[240:243], 0
    v_mfma_f32_16x16x32_bf16 v[16:19], v[132:135], v[228:231], v[16:19]
    v_mfma_f32_16x16x32_bf16 v[24:27], v[132:135], v[244:247], v[24:27]
    v_mfma_f32_16x16x32_bf16 v[16:19], v[136:139], v[232:235], v[16:19]
    v_mfma_f32_16x16x32_bf16 v[24:27], v[136:139], v[248:251], v[24:27]
    v_mfma_f32_16x16x32_bf16 v[16:19], v[140:143], v[236:239], v[16:19]
    v_mfma_f32_16x16x32_bf16 v[24:27], v[140:143], v[252:255], v[24:27]
    v_cndmask_b32 v20, v9, v20, s[40:41]
    v_cndmask_b32 v32, v9, v32, s[40:41]
    v_cndmask_b32 v21, v9, v21, s[42:43]
    v_cndmask_b32 v33, v9, v33, s[42:43]
    v_cndmask_b32 v22, v9, v22, s[44:45]
    v_cndmask_b32 v34, v9, v34, s[44:45]
    v_cndmask_b32 v23, v9, v23, s[46:47]
    v_cndmask_b32 v35, v9, v35, s[46:47]
    v_max3_f32 v11, v26, v27, v28
    v_max3_f32 v7, v18, v19, v20
    v_max3_f32 v11, v11, v29, v30
    v_max3_f32 v7, v7, v21, v22
    v_max3_f32 v11, v11, v31, v32
    v_max_f32 v7, v7, v23
    v_max3_f32 v11, v11, v33, v34
    v_mov_b32 v8, v7
    v_max_f32 v11, v11, v35
    s_nop 0
    v_permlane16_swap_b32 v7, v8
    v_mov_b32 v14, v11
    v_max_f32 v7, v7, v8
    s_nop 0
    v_permlane16_swap_b32 v11, v14
    v_mov_b32 v8, v7
    v_max_f32 v11, v11, v14
    s_nop 0
    v_permlane32_swap_b32 v7, v8
    v_mov_b32 v14, v11
    v_max_f32 v7, v7, v8
    s_nop 0
    v_permlane32_swap_b32 v11, v14
    v_mul_f32 v7, 0xbe0293ee, v7
    v_max_f32 v11, v11, v14
    v_fma_f32 v18, v18, s31, v7
    v_mul_f32 v11, 0xbe0293ee, v11
    v_fma_f32 v19, v19, s31, v7
    v_fma_f32 v26, v26, s31, v11
    v_fma_f32 v20, v20, s31, v7
    v_fma_f32 v27, v27, s31, v11
    v_fma_f32 v21, v21, s31, v7
    v_fma_f32 v28, v28, s31, v11
    v_fma_f32 v22, v22, s31, v7
    v_fma_f32 v29, v29, s31, v11
    v_fma_f32 v23, v23, s31, v7
    v_fma_f32 v30, v30, s31, v11
    v_exp_f32 v18, v18
    v_fma_f32 v31, v31, s31, v11
    v_exp_f32 v19, v19
    v_fma_f32 v32, v32, s31, v11
    v_exp_f32 v20, v20
    v_fma_f32 v33, v33, s31, v11
    v_exp_f32 v21, v21
    v_fma_f32 v34, v34, s31, v11
    v_exp_f32 v22, v22
    v_fma_f32 v35, v35, s31, v11
    v_exp_f32 v23, v23
    v_exp_f32 v26, v26
    v_cvt_pk_bf16_f32 v36, v18, v19
    v_exp_f32 v27, v27
    v_cvt_pk_bf16_f32 v113, v18, v19
    v_exp_f32 v28, v28
    v_cvt_pk_bf16_f32 v38, v20, v21
    v_exp_f32 v29, v29
    v_cvt_pk_bf16_f32 v39, v22, v23
    v_exp_f32 v30, v30
    v_exp_f32 v31, v31
    v_exp_f32 v32, v32
    v_exp_f32 v33, v33
    v_exp_f32 v34, v34
    v_exp_f32 v35, v35
    v_cvt_pk_bf16_f32 v40, v26, v27
    v_cvt_pk_bf16_f32 v115, v26, v27
    v_cvt_pk_bf16_f32 v44, v28, v29
    v_cvt_pk_bf16_f32 v45, v30, v31
    v_cvt_pk_bf16_f32 v46, v32, v33
    v_cvt_pk_bf16_f32 v47, v34, v35
    s_waitcnt vmcnt(1)
    s_nop 0
    v_mfma_f32_16x16x32_bf16 v[80:83], v[192:195], v[44:47], 0
    v_add_f32 v11, v26, v27
    v_add_f32 v7, v18, v19
    v_mfma_f32_16x16x16_bf16 v[48:51], v[192:193], v[38:39], 0
    v_add_f32 v11, v11, v28
    v_add_f32 v7, v7, v20
    v_mfma_f32_16x16x32_bf16 v[84:87], v[196:199], v[44:47], 0
    v_add_f32 v11, v11, v29
    v_add_f32 v7, v7, v21
    v_mfma_f32_16x16x16_bf16 v[52:55], v[196:197], v[38:39], 0
    v_add_f32 v11, v11, v30
    v_add_f32 v7, v7, v22
    v_mfma_f32_16x16x32_bf16 v[88:91], v[200:203], v[44:47], 0
    v_add_f32 v11, v11, v31
    v_add_f32 v7, v7, v23
    v_mfma_f32_16x16x16_bf16 v[56:59], v[200:201], v[38:39], 0
    v_add_f32 v11, v11, v32
    v_mov_b32 v8, v7
    v_mfma_f32_16x16x32_bf16 v[92:95], v[204:207], v[44:47], 0
    v_add_f32 v11, v11, v33
    v_permlane16_swap_b32 v7, v8
    v_mfma_f32_16x16x16_bf16 v[60:63], v[204:205], v[38:39], 0
    v_add_f32 v11, v11, v34
    v_add_f32 v7, v7, v8
    v_mfma_f32_16x16x32_bf16 v[96:99], v[208:211], v[44:47], 0
    v_add_f32 v11, v11, v35
    v_mov_b32 v8, v7
    v_mfma_f32_16x16x16_bf16 v[64:67], v[208:209], v[38:39], 0
    v_mov_b32 v14, v11
    v_permlane32_swap_b32 v7, v8
    v_mfma_f32_16x16x32_bf16 v[100:103], v[212:215], v[44:47], 0
    v_permlane16_swap_b32 v11, v14
    v_add_f32 v7, v7, v8
    v_mfma_f32_16x16x16_bf16 v[68:71], v[212:213], v[38:39], 0
    v_add_f32 v11, v11, v14
    v_rcp_f32 v7, v7
    v_mfma_f32_16x16x32_bf16 v[104:107], v[216:219], v[44:47], 0
    v_mov_b32 v14, v11
    v_mfma_f32_16x16x16_bf16 v[72:75], v[216:217], v[38:39], 0
    s_nop 0
    v_permlane32_swap_b32 v11, v14
    v_mfma_f32_16x16x32_bf16 v[108:111], v[220:223], v[44:47], 0
    v_add_f32 v11, v11, v14
    v_mfma_f32_16x16x16_bf16 v[76:79], v[220:221], v[38:39], 0
    v_rcp_f32 v11, v11
    v_mfma_f32_16x16x16_bf16 v[80:83], v[144:145], v[40:41], v[80:83]
    v_mfma_f32_16x16x16_bf16 v[48:51], v[144:145], v[36:37], v[48:51]
    v_mfma_f32_16x16x16_bf16 v[84:87], v[144:145], v[114:115], v[84:87]
    v_mfma_f32_16x16x16_bf16 v[52:55], v[144:145], v[112:113], v[52:55]
    v_mfma_f32_16x16x16_bf16 v[88:91], v[146:147], v[40:41], v[88:91]
    v_mfma_f32_16x16x16_bf16 v[56:59], v[146:147], v[36:37], v[56:59]
    v_mfma_f32_16x16x16_bf16 v[92:95], v[146:147], v[114:115], v[92:95]
    v_mfma_f32_16x16x16_bf16 v[60:63], v[146:147], v[112:113], v[60:63]
    v_mfma_f32_16x16x16_bf16 v[96:99], v[148:149], v[40:41], v[96:99]
    v_mfma_f32_16x16x16_bf16 v[64:67], v[148:149], v[36:37], v[64:67]
    v_mfma_f32_16x16x16_bf16 v[100:103], v[148:149], v[114:115], v[100:103]
    v_mfma_f32_16x16x16_bf16 v[68:71], v[148:149], v[112:113], v[68:71]
    v_mfma_f32_16x16x16_bf16 v[104:107], v[150:151], v[40:41], v[104:107]
    v_mfma_f32_16x16x16_bf16 v[72:75], v[150:151], v[36:37], v[72:75]
    v_mfma_f32_16x16x16_bf16 v[108:111], v[150:151], v[114:115], v[108:111]
    v_mfma_f32_16x16x16_bf16 v[76:79], v[150:151], v[112:113], v[76:79]
    v_mul_f32 v48, v48, v7
    v_mul_f32 v49, v49, v7
    v_mul_f32 v50, v50, v7
    v_mul_f32 v51, v51, v7
    v_mul_f32 v52, v52, v7
    v_mul_f32 v53, v53, v7
    v_mul_f32 v54, v54, v7
    v_mul_f32 v55, v55, v7
    v_mul_f32 v56, v56, v7
    v_mul_f32 v57, v57, v7
    v_mul_f32 v58, v58, v7
    v_mul_f32 v59, v59, v7
    v_mul_f32 v60, v60, v7
    v_mul_f32 v61, v61, v7
    v_mul_f32 v62, v62, v7
    v_mul_f32 v63, v63, v7
    v_mul_f32 v64, v64, v7
    v_mul_f32 v65, v65, v7
    v_mul_f32 v66, v66, v7
    v_mul_f32 v67, v67, v7
    v_mul_f32 v68, v68, v7
    v_mul_f32 v69, v69, v7
    v_mul_f32 v70, v70, v7
    v_mul_f32 v71, v71, v7
    v_mul_f32 v72, v72, v7
    v_mul_f32 v73, v73, v7
    v_mul_f32 v74, v74, v7
    v_mul_f32 v75, v75, v7
    v_mul_f32 v76, v76, v7
    v_mul_f32 v77, v77, v7
    v_mul_f32 v78, v78, v7
    v_mul_f32 v79, v79, v7
    v_cvt_pk_bf16_f32 v48, v48, v49
    v_cvt_pk_bf16_f32 v49, v50, v51
    v_cvt_pk_bf16_f32 v50, v52, v53
    v_cvt_pk_bf16_f32 v51, v54, v55
    v_cvt_pk_bf16_f32 v52, v56, v57
    v_cvt_pk_bf16_f32 v53, v58, v59
    v_cvt_pk_bf16_f32 v54, v60, v61
    v_cvt_pk_bf16_f32 v55, v62, v63
    v_cvt_pk_bf16_f32 v56, v64, v65
    v_cvt_pk_bf16_f32 v57, v66, v67
    v_cvt_pk_bf16_f32 v58, v68, v69
    v_cvt_pk_bf16_f32 v59, v70, v71
    v_cvt_pk_bf16_f32 v60, v72, v73
    v_cvt_pk_bf16_f32 v61, v74, v75
    v_cvt_pk_bf16_f32 v62, v76, v77
    v_cvt_pk_bf16_f32 v63, v78, v79
    ds_write_b128 v10, v[48:51] offset:0
    ds_write_b128 v10, v[52:55] offset:1024
    ds_write_b128 v10, v[56:59] offset:2048
    ds_write_b128 v10, v[60:63] offset:3072
    v_mul_f32 v80, v80, v11
    v_mul_f32 v81, v81, v11
    v_mul_f32 v82, v82, v11
    v_mul_f32 v83, v83, v11
    v_mul_f32 v84, v84, v11
    v_mul_f32 v85, v85, v11
    v_mul_f32 v86, v86, v11
    v_mul_f32 v87, v87, v11
    v_mul_f32 v88, v88, v11
    v_mul_f32 v89, v89, v11
    v_mul_f32 v90, v90, v11
    v_mul_f32 v91, v91, v11
    v_mul_f32 v92, v92, v11
    v_mul_f32 v93, v93, v11
    v_mul_f32 v94, v94, v11
    v_mul_f32 v95, v95, v11
    v_mul_f32 v96, v96, v11
    v_mul_f32 v97, v97, v11
    v_mul_f32 v98, v98, v11
    v_mul_f32 v99, v99, v11
    v_mul_f32 v100, v100, v11
    v_mul_f32 v101, v101, v11
    v_mul_f32 v102, v102, v11
    v_mul_f32 v103, v103, v11
    v_mul_f32 v104, v104, v11
    v_mul_f32 v105, v105, v11
    v_mul_f32 v106, v106, v11
    v_mul_f32 v107, v107, v11
    v_mul_f32 v108, v108, v11
    v_mul_f32 v109, v109, v11
    v_mul_f32 v110, v110, v11
    v_mul_f32 v111, v111, v11
    v_cvt_pk_bf16_f32 v80, v80, v81
    v_cvt_pk_bf16_f32 v81, v82, v83
    v_cvt_pk_bf16_f32 v82, v84, v85
    v_cvt_pk_bf16_f32 v83, v86, v87
    v_cvt_pk_bf16_f32 v84, v88, v89
    v_cvt_pk_bf16_f32 v85, v90, v91
    v_cvt_pk_bf16_f32 v86, v92, v93
    v_cvt_pk_bf16_f32 v87, v94, v95
    v_cvt_pk_bf16_f32 v88, v96, v97
    v_cvt_pk_bf16_f32 v89, v98, v99
    v_cvt_pk_bf16_f32 v90, v100, v101
    v_cvt_pk_bf16_f32 v91, v102, v103
    v_cvt_pk_bf16_f32 v92, v104, v105
    v_cvt_pk_bf16_f32 v93, v106, v107
    v_cvt_pk_bf16_f32 v94, v108, v109
    v_cvt_pk_bf16_f32 v95, v110, v111
    ds_write_b128 v10, v[80:83] offset:8192
    ds_write_b128 v10, v[84:87] offset:9216
    ds_write_b128 v10, v[88:91] offset:10240
    ds_write_b128 v10, v[92:95] offset:11264
    s_waitcnt vmcnt(0)
    v_readfirstlane_b32 s54, v116
    s_lshl_b32 s28, s21, 1
    s_add_u32 s28, s28, s48
    s_lshl_b32 s28, s28, 2
    s_add_u32 s28, s28, s49
    s_and_b32 s29, s24, 31
    s_lshl_b32 s29, s29, 7
    s_add_u32 s29, s29, s28
    s_lshl_b32 s29, s29, 9
    v_and_b32 v11, 0x30, v1
    v_and_b32 v14, 0x40, v1
    v_lshl_add_u32 v11, v14, 4, v11
    v_lshrrev_b32 v14, 9, v1
    v_lshl_add_u32 v11, v14, 7, v11
    v_bfe_u32 v14, v1, 7, 1
    v_lshl_add_u32 v11, v14, 6, v11
    v_bfe_u32 v14, v1, 8, 1
    v_lshl_add_u32 v11, v14, 3, v11
    s_cmp_eq_u32 s23, 0
    s_cbranch_scc0 L_bx_42
    buffer_load_dwordx2 v[16:17], v11, s[12:15], s29 offen offset:0
    buffer_load_dwordx2 v[18:19], v11, s[12:15], s29 offen offset:256
    s_branch L_by_43
L_bx_42:
    s_add_u32 s25, s29, 33554432
    buffer_load_dwordx2 v[16:17], v11, s[8:11], s25 offen offset:0 sc1
    buffer_load_dwordx2 v[18:19], v11, s[8:11], s25 offen offset:256 sc1
L_by_43:
    s_waitcnt lgkmcnt(0)
    s_barrier
    s_lshl_b32 s27, s22, 1
    s_and_b32 s25, s33, 1
    s_add_u32 s27, s27, s25
    s_lshl_b32 s27, s27, 21
    s_add_u32 s27, s27, 159383552
    s_lshl_b32 s25, s21, 11
    s_lshl_b32 s26, s20, 9
    s_add_u32 s25, s25, s26
    s_add_u32 s25, s25, s27
    v_add_u32 v13, 0, v1
    ds_read_b128 v[32:35], v13 offset:0
    ds_read_b128 v[36:39], v13 offset:1024
    ds_read_b128 v[40:43], v13 offset:2048
    ds_read_b128 v[44:47], v13 offset:3072
    ds_read_b128 v[48:51], v13 offset:4096
    ds_read_b128 v[52:55], v13 offset:5120
    ds_read_b128 v[56:59], v13 offset:6144
    ds_read_b128 v[60:63], v13 offset:7168
    s_waitcnt lgkmcnt(7)
    v_mfma_f32_16x16x32_bf16 v[96:99], a[0:3], v[32:35], 0
    s_waitcnt lgkmcnt(6)
    v_mfma_f32_16x16x32_bf16 v[96:99], a[4:7], v[36:39], v[96:99]
    s_lshl_b32 s58, s55, 1
    s_add_u32 s58, s58, s48
    s_lshl_b32 s58, s58, 18
    s_add_u32 s59, s58, s50
    s_add_u32 s58, s59, s50
    s_add_u32 s58, s58, 109051904
    s_add_u32 s60, s59, 75497472
    s_add_u32 s59, s59, 41943040
    buffer_load_dwordx4 v[192:195], v1, s[8:11], s58 offen offset:0 sc1
    s_waitcnt lgkmcnt(5)
    v_mfma_f32_16x16x32_bf16 v[96:99], a[8:11], v[40:43], v[96:99]
    s_waitcnt lgkmcnt(4)
    v_mfma_f32_16x16x32_bf16 v[96:99], a[12:15], v[44:47], v[96:99]
    s_waitcnt lgkmcnt(3)
    v_mfma_f32_16x16x32_bf16 v[96:99], a[128:131], v[48:51], v[96:99]
    s_waitcnt lgkmcnt(2)
    v_mfma_f32_16x16x32_bf16 v[96:99], a[132:135], v[52:55], v[96:99]
    s_waitcnt lgkmcnt(1)
    v_mfma_f32_16x16x32_bf16 v[96:99], a[136:139], v[56:59], v[96:99]
    s_waitcnt lgkmcnt(0)
    v_mfma_f32_16x16x32_bf16 v[96:99], a[140:143], v[60:63], v[96:99]
    v_mfma_f32_16x16x32_bf16 v[100:103], a[16:19], v[32:35], 0
    v_mfma_f32_16x16x32_bf16 v[100:103], a[20:23], v[36:39], v[100:103]
    v_mfma_f32_16x16x32_bf16 v[100:103], a[24:27], v[40:43], v[100:103]
    buffer_load_dwordx4 v[196:199], v1, s[8:11], s58 offen offset:1024 sc1
    v_mfma_f32_16x16x32_bf16 v[100:103], a[28:31], v[44:47], v[100:103]
    v_mfma_f32_16x16x32_bf16 v[100:103], a[144:147], v[48:51], v[100:103]
    v_mfma_f32_16x16x32_bf16 v[100:103], a[148:151], v[52:55], v[100:103]
    v_mfma_f32_16x16x32_bf16 v[100:103], a[152:155], v[56:59], v[100:103]
    v_mfma_f32_16x16x32_bf16 v[100:103], a[156:159], v[60:63], v[100:103]
    v_mfma_f32_16x16x32_bf16 v[104:107], a[32:35], v[32:35], 0
    v_mfma_f32_16x16x32_bf16 v[104:107], a[36:39], v[36:39], v[104:107]
    v_mfma_f32_16x16x32_bf16 v[104:107], a[40:43], v[40:43], v[104:107]
    v_mfma_f32_16x16x32_bf16 v[104:107], a[44:47], v[44:47], v[104:107]
    buffer_load_dwordx4 v[200:203], v1, s[8:11], s58 offen offset:2048 sc1
    v_mfma_f32_16x16x32_bf16 v[104:107], a[160:163], v[48:51], v[104:107]
    v_mfma_f32_16x16x32_bf16 v[104:107], a[164:167], v[52:55], v[104:107]
    v_mfma_f32_16x16x32_bf16 v[104:107], a[168:171], v[56:59], v[104:107]
    v_mfma_f32_16x16x32_bf16 v[104:107], a[172:175], v[60:63], v[104:107]
    v_mfma_f32_16x16x32_bf16 v[108:111], a[48:51], v[32:35], 0
    v_mfma_f32_16x16x32_bf16 v[108:111], a[52:55], v[36:39], v[108:111]
    v_mfma_f32_16x16x32_bf16 v[108:111], a[56:59], v[40:43], v[108:111]
    v_mfma_f32_16x16x32_bf16 v[108:111], a[60:63], v[44:47], v[108:111]
    v_mfma_f32_16x16x32_bf16 v[108:111], a[176:179], v[48:51], v[108:111]
    buffer_load_dwordx4 v[204:207], v1, s[8:11], s58 offen offset:3072 sc1
    v_mfma_f32_16x16x32_bf16 v[108:111], a[180:183], v[52:55], v[108:111]
    v_mfma_f32_16x16x32_bf16 v[108:111], a[184:187], v[56:59], v[108:111]
    v_mfma_f32_16x16x32_bf16 v[108:111], a[188:191], v[60:63], v[108:111]
    v_mfma_f32_16x16x32_bf16 v[112:115], a[64:67], v[32:35], 0
    v_mfma_f32_16x16x32_bf16 v[112:115], a[68:71], v[36:39], v[112:115]
    v_mfma_f32_16x16x32_bf16 v[112:115], a[72:75], v[40:43], v[112:115]
    v_mfma_f32_16x16x32_bf16 v[112:115], a[76:79], v[44:47], v[112:115]
    v_mfma_f32_16x16x32_bf16 v[112:115], a[192:195], v[48:51], v[112:115]
    v_mfma_f32_16x16x32_bf16 v[112:115], a[196:199], v[52:55], v[112:115]
    s_add_u32 s58, s58, 4096
    buffer_load_dwordx4 v[208:211], v1, s[8:11], s58 offen offset:0 sc1
    v_mfma_f32_16x16x32_bf16 v[112:115], a[200:203], v[56:59], v[112:115]
    v_mfma_f32_16x16x32_bf16 v[112:115], a[204:207], v[60:63], v[112:115]
    v_mfma_f32_16x16x32_bf16 v[116:119], a[80:83], v[32:35], 0
    ds_read_b128 v[64:67], v13 offset:8192
    v_mfma_f32_16x16x32_bf16 v[116:119], a[84:87], v[36:39], v[116:119]
    ds_read_b128 v[68:71], v13 offset:9216
    v_mfma_f32_16x16x32_bf16 v[116:119], a[88:91], v[40:43], v[116:119]
    ds_read_b128 v[72:75], v13 offset:10240
    v_mfma_f32_16x16x32_bf16 v[116:119], a[92:95], v[44:47], v[116:119]
    ds_read_b128 v[76:79], v13 offset:11264
    v_mfma_f32_16x16x32_bf16 v[116:119], a[208:211], v[48:51], v[116:119]
    ds_read_b128 v[80:83], v13 offset:12288
    v_mfma_f32_16x16x32_bf16 v[116:119], a[212:215], v[52:55], v[116:119]
    ds_read_b128 v[84:87], v13 offset:13312
    v_mfma_f32_16x16x32_bf16 v[116:119], a[216:219], v[56:59], v[116:119]
    ds_read_b128 v[88:91], v13 offset:14336
    buffer_load_dwordx4 v[212:215], v1, s[8:11], s58 offen offset:1024 sc1
    v_mfma_f32_16x16x32_bf16 v[116:119], a[220:223], v[60:63], v[116:119]
    ds_read_b128 v[92:95], v13 offset:15360
    v_mfma_f32_16x16x32_bf16 v[120:123], a[96:99], v[32:35], 0
    v_mfma_f32_16x16x32_bf16 v[120:123], a[100:103], v[36:39], v[120:123]
    v_mfma_f32_16x16x32_bf16 v[120:123], a[104:107], v[40:43], v[120:123]
    v_mfma_f32_16x16x32_bf16 v[120:123], a[108:111], v[44:47], v[120:123]
    v_mfma_f32_16x16x32_bf16 v[120:123], a[224:227], v[48:51], v[120:123]
    v_mfma_f32_16x16x32_bf16 v[120:123], a[228:231], v[52:55], v[120:123]
    v_mfma_f32_16x16x32_bf16 v[120:123], a[232:235], v[56:59], v[120:123]
    v_mfma_f32_16x16x32_bf16 v[120:123], a[236:239], v[60:63], v[120:123]
    buffer_load_dwordx4 v[216:219], v1, s[8:11], s58 offen offset:2048 sc1
    v_mfma_f32_16x16x32_bf16 v[124:127], a[112:115], v[32:35], 0
    v_mfma_f32_16x16x32_bf16 v[124:127], a[116:119], v[36:39], v[124:127]
    v_mfma_f32_16x16x32_bf16 v[124:127], a[120:123], v[40:43], v[124:127]
    v_mfma_f32_16x16x32_bf16 v[124:127], a[124:127], v[44:47], v[124:127]
    v_mfma_f32_16x16x32_bf16 v[124:127], a[240:243], v[48:51], v[124:127]
    v_mfma_f32_16x16x32_bf16 v[124:127], a[244:247], v[52:55], v[124:127]
    v_mfma_f32_16x16x32_bf16 v[124:127], a[248:251], v[56:59], v[124:127]
    v_mfma_f32_16x16x32_bf16 v[124:127], a[252:255], v[60:63], v[124:127]
    s_waitcnt lgkmcnt(0)
    v_mfma_f32_16x16x32_bf16 v[128:131], a[0:3], v[64:67], 0
    buffer_load_dwordx4 v[220:223], v1, s[8:11], s58 offen offset:3072 sc1
    v_mfma_f32_16x16x32_bf16 v[128:131], a[4:7], v[68:71], v[128:131]
    v_mfma_f32_16x16x32_bf16 v[128:131], a[8:11], v[72:75], v[128:131]
    v_cvt_pk_bf16_f32 v96, v96, v97
    v_mfma_f32_16x16x32_bf16 v[128:131], a[12:15], v[76:79], v[128:131]
    v_cvt_pk_bf16_f32 v97, v98, v99
    v_mfma_f32_16x16x32_bf16 v[128:131], a[128:131], v[80:83], v[128:131]
    v_cvt_pk_bf16_f32 v98, v100, v101
    v_mfma_f32_16x16x32_bf16 v[128:131], a[132:135], v[84:87], v[128:131]
    v_cvt_pk_bf16_f32 v99, v102, v103
    v_mfma_f32_16x16x32_bf16 v[128:131], a[136:139], v[88:91], v[128:131]
    buffer_store_dwordx4 v[96:99], v12, s[8:11], s25 offen offset:0 sc1
    v_mfma_f32_16x16x32_bf16 v[128:131], a[140:143], v[92:95], v[128:131]
    v_cvt_pk_bf16_f32 v104, v104, v105
    v_mfma_f32_16x16x32_bf16 v[132:135], a[16:19], v[64:67], 0
    v_cvt_pk_bf16_f32 v105, v106, v107
    v_mfma_f32_16x16x32_bf16 v[132:135], a[20:23], v[68:71], v[132:135]
    v_cvt_pk_bf16_f32 v106, v108, v109
    buffer_load_dwordx4 v[160:163], v1, s[8:11], s60 offen offset:0 sc1
    v_mfma_f32_16x16x32_bf16 v[132:135], a[24:27], v[72:75], v[132:135]
    v_cvt_pk_bf16_f32 v107, v110, v111
    v_mfma_f32_16x16x32_bf16 v[132:135], a[28:31], v[76:79], v[132:135]
    buffer_store_dwordx4 v[104:107], v12, s[8:11], s25 offen offset:128 sc1
    v_mfma_f32_16x16x32_bf16 v[132:135], a[144:147], v[80:83], v[132:135]
    v_cvt_pk_bf16_f32 v112, v112, v113
    v_mfma_f32_16x16x32_bf16 v[132:135], a[148:151], v[84:87], v[132:135]
    v_cvt_pk_bf16_f32 v113, v114, v115
    v_mfma_f32_16x16x32_bf16 v[132:135], a[152:155], v[88:91], v[132:135]
    v_cvt_pk_bf16_f32 v114, v116, v117
    v_mfma_f32_16x16x32_bf16 v[132:135], a[156:159], v[92:95], v[132:135]
    v_cvt_pk_bf16_f32 v115, v118, v119
    v_mfma_f32_16x16x32_bf16 v[136:139], a[32:35], v[64:67], 0
    buffer_store_dwordx4 v[112:115], v12, s[8:11], s25 offen offset:256 sc1
    v_mfma_f32_16x16x32_bf16 v[136:139], a[36:39], v[68:71], v[136:139]
    v_cvt_pk_bf16_f32 v120, v120, v121
    v_mfma_f32_16x16x32_bf16 v[136:139], a[40:43], v[72:75], v[136:139]
    v_cvt_pk_bf16_f32 v121, v122, v123
    buffer_load_dwordx4 v[164:167], v1, s[8:11], s60 offen offset:1024 sc1
    v_mfma_f32_16x16x32_bf16 v[136:139], a[44:47], v[76:79], v[136:139]
    v_cvt_pk_bf16_f32 v122, v124, v125
    v_mfma_f32_16x16x32_bf16 v[136:139], a[160:163], v[80:83], v[136:139]
    v_cvt_pk_bf16_f32 v123, v126, v127
    v_mfma_f32_16x16x32_bf16 v[136:139], a[164:167], v[84:87], v[136:139]
    buffer_store_dwordx4 v[120:123], v12, s[8:11], s25 offen offset:384 sc1
    v_mfma_f32_16x16x32_bf16 v[136:139], a[168:171], v[88:91], v[136:139]
    s_add_u32 s25, s25, 264192
    v_mfma_f32_16x16x32_bf16 v[136:139], a[172:175], v[92:95], v[136:139]
    v_mfma_f32_16x16x32_bf16 v[140:143], a[48:51], v[64:67], 0
    v_mfma_f32_16x16x32_bf16 v[140:143], a[52:55], v[68:71], v[140:143]
    v_mfma_f32_16x16x32_bf16 v[140:143], a[56:59], v[72:75], v[140:143]
    v_mfma_f32_16x16x32_bf16 v[140:143], a[60:63], v[76:79], v[140:143]
    buffer_load_dwordx4 v[168:171], v1, s[8:11], s60 offen offset:2048 sc1
    v_mfma_f32_16x16x32_bf16 v[140:143], a[176:179], v[80:83], v[140:143]
    v_mfma_f32_16x16x32_bf16 v[140:143], a[180:183], v[84:87], v[140:143]
    v_mfma_f32_16x16x32_bf16 v[140:143], a[184:187], v[88:91], v[140:143]
    v_mfma_f32_16x16x32_bf16 v[140:143], a[188:191], v[92:95], v[140:143]
    v_mfma_f32_16x16x32_bf16 v[144:147], a[64:67], v[64:67], 0
    v_mfma_f32_16x16x32_bf16 v[144:147], a[68:71], v[68:71], v[144:147]
    v_mfma_f32_16x16x32_bf16 v[144:147], a[72:75], v[72:75], v[144:147]
    v_mfma_f32_16x16x32_bf16 v[144:147], a[76:79], v[76:79], v[144:147]
    v_mfma_f32_16x16x32_bf16 v[144:147], a[192:195], v[80:83], v[144:147]
    buffer_load_dwordx4 v[172:175], v1, s[8:11], s60 offen offset:3072 sc1
    v_mfma_f32_16x16x32_bf16 v[144:147], a[196:199], v[84:87], v[144:147]
    v_mfma_f32_16x16x32_bf16 v[144:147], a[200:203], v[88:91], v[144:147]
    v_mfma_f32_16x16x32_bf16 v[144:147], a[204:207], v[92:95], v[144:147]
    v_mfma_f32_16x16x32_bf16 v[148:151], a[80:83], v[64:67], 0
    ds_read_b128 v[32:35], v13 offset:16384
    v_mfma_f32_16x16x32_bf16 v[148:151], a[84:87], v[68:71], v[148:151]
    ds_read_b128 v[36:39], v13 offset:17408
    v_mfma_f32_16x16x32_bf16 v[148:151], a[88:91], v[72:75], v[148:151]
    ds_read_b128 v[40:43], v13 offset:18432
    v_mfma_f32_16x16x32_bf16 v[148:151], a[92:95], v[76:79], v[148:151]
    ds_read_b128 v[44:47], v13 offset:19456
    v_mfma_f32_16x16x32_bf16 v[148:151], a[208:211], v[80:83], v[148:151]
    ds_read_b128 v[48:51], v13 offset:20480
    v_mfma_f32_16x16x32_bf16 v[148:151], a[212:215], v[84:87], v[148:151]
    ds_read_b128 v[52:55], v13 offset:21504
    s_add_u32 s60, s60, 131072
    buffer_load_dwordx4 v[176:179], v1, s[8:11], s60 offen offset:0 sc1
    v_mfma_f32_16x16x32_bf16 v[148:151], a[216:219], v[88:91], v[148:151]
    ds_read_b128 v[56:59], v13 offset:22528
    v_mfma_f32_16x16x32_bf16 v[148:151], a[220:223], v[92:95], v[148:151]
    ds_read_b128 v[60:63], v13 offset:23552
    v_mfma_f32_16x16x32_bf16 v[152:155], a[96:99], v[64:67], 0
    v_mfma_f32_16x16x32_bf16 v[152:155], a[100:103], v[68:71], v[152:155]
    v_mfma_f32_16x16x32_bf16 v[152:155], a[104:107], v[72:75], v[152:155]
    v_mfma_f32_16x16x32_bf16 v[152:155], a[108:111], v[76:79], v[152:155]
    v_mfma_f32_16x16x32_bf16 v[152:155], a[224:227], v[80:83], v[152:155]
    v_mfma_f32_16x16x32_bf16 v[152:155], a[228:231], v[84:87], v[152:155]
    v_mfma_f32_16x16x32_bf16 v[152:155], a[232:235], v[88:91], v[152:155]
    buffer_load_dwordx4 v[180:183], v1, s[8:11], s60 offen offset:1024 sc1
    v_mfma_f32_16x16x32_bf16 v[152:155], a[236:239], v[92:95], v[152:155]
    v_mfma_f32_16x16x32_bf16 v[156:159], a[112:115], v[64:67], 0
    v_mfma_f32_16x16x32_bf16 v[156:159], a[116:119], v[68:71], v[156:159]
    v_mfma_f32_16x16x32_bf16 v[156:159], a[120:123], v[72:75], v[156:159]
    v_mfma_f32_16x16x32_bf16 v[156:159], a[124:127], v[76:79], v[156:159]
    v_mfma_f32_16x16x32_bf16 v[156:159], a[240:243], v[80:83], v[156:159]
    v_mfma_f32_16x16x32_bf16 v[156:159], a[244:247], v[84:87], v[156:159]
    v_mfma_f32_16x16x32_bf16 v[156:159], a[248:251], v[88:91], v[156:159]
    v_mfma_f32_16x16x32_bf16 v[156:159], a[252:255], v[92:95], v[156:159]
    buffer_load_dwordx4 v[184:187], v1, s[8:11], s60 offen offset:2048 sc1
    s_waitcnt lgkmcnt(0)
    v_mfma_f32_16x16x32_bf16 v[96:99], a[0:3], v[32:35], 0
    v_mfma_f32_16x16x32_bf16 v[96:99], a[4:7], v[36:39], v[96:99]
    v_mfma_f32_16x16x32_bf16 v[96:99], a[8:11], v[40:43], v[96:99]
    v_cvt_pk_bf16_f32 v128, v128, v129
    v_mfma_f32_16x16x32_bf16 v[96:99], a[12:15], v[44:47], v[96:99]
    v_cvt_pk_bf16_f32 v129, v130, v131
    v_mfma_f32_16x16x32_bf16 v[96:99], a[128:131], v[48:51], v[96:99]
    v_cvt_pk_bf16_f32 v130, v132, v133
    v_mfma_f32_16x16x32_bf16 v[96:99], a[132:135], v[52:55], v[96:99]
    v_cvt_pk_bf16_f32 v131, v134, v135
    v_mfma_f32_16x16x32_bf16 v[96:99], a[136:139], v[56:59], v[96:99]
    buffer_store_dwordx4 v[128:131], v12, s[8:11], s25 offen offset:0 sc1
    v_mfma_f32_16x16x32_bf16 v[96:99], a[140:143], v[60:63], v[96:99]
    v_cvt_pk_bf16_f32 v136, v136, v137
    v_mfma_f32_16x16x32_bf16 v[100:103], a[16:19], v[32:35], 0
    v_cvt_pk_bf16_f32 v137, v138, v139
    buffer_load_dwordx4 v[188:191], v1, s[8:11], s60 offen offset:3072 sc1
    v_mfma_f32_16x16x32_bf16 v[100:103], a[20:23], v[36:39], v[100:103]
    v_cvt_pk_bf16_f32 v138, v140, v141
    v_mfma_f32_16x16x32_bf16 v[100:103], a[24:27], v[40:43], v[100:103]
    v_cvt_pk_bf16_f32 v139, v142, v143
    v_mfma_f32_16x16x32_bf16 v[100:103], a[28:31], v[44:47], v[100:103]
    buffer_store_dwordx4 v[136:139], v12, s[8:11], s25 offen offset:128 sc1
    v_mfma_f32_16x16x32_bf16 v[100:103], a[144:147], v[48:51], v[100:103]
    v_cvt_pk_bf16_f32 v144, v144, v145
    v_mfma_f32_16x16x32_bf16 v[100:103], a[148:151], v[52:55], v[100:103]
    v_cvt_pk_bf16_f32 v145, v146, v147
    v_mfma_f32_16x16x32_bf16 v[100:103], a[152:155], v[56:59], v[100:103]
    v_cvt_pk_bf16_f32 v146, v148, v149
    v_mfma_f32_16x16x32_bf16 v[100:103], a[156:159], v[60:63], v[100:103]
    v_cvt_pk_bf16_f32 v147, v150, v151
    v_mfma_f32_16x16x32_bf16 v[104:107], a[32:35], v[32:35], 0
    buffer_store_dwordx4 v[144:147], v12, s[8:11], s25 offen offset:256 sc1
    v_mfma_f32_16x16x32_bf16 v[104:107], a[36:39], v[36:39], v[104:107]
    v_cvt_pk_bf16_f32 v152, v152, v153
    buffer_load_dwordx4 v[224:227], v1, s[8:11], s59 offen offset:0 sc1
    v_mfma_f32_16x16x32_bf16 v[104:107], a[40:43], v[40:43], v[104:107]
    v_cvt_pk_bf16_f32 v153, v154, v155
    v_mfma_f32_16x16x32_bf16 v[104:107], a[44:47], v[44:47], v[104:107]
    v_cvt_pk_bf16_f32 v154, v156, v157
    v_mfma_f32_16x16x32_bf16 v[104:107], a[160:163], v[48:51], v[104:107]
    v_cvt_pk_bf16_f32 v155, v158, v159
    v_mfma_f32_16x16x32_bf16 v[104:107], a[164:167], v[52:55], v[104:107]
    buffer_store_dwordx4 v[152:155], v12, s[8:11], s25 offen offset:384 sc1
    v_mfma_f32_16x16x32_bf16 v[104:107], a[168:171], v[56:59], v[104:107]
    s_add_u32 s25, s25, 264192
    v_mfma_f32_16x16x32_bf16 v[104:107], a[172:175], v[60:63], v[104:107]
    v_mfma_f32_16x16x32_bf16 v[108:111], a[48:51], v[32:35], 0
    v_mfma_f32_16x16x32_bf16 v[108:111], a[52:55], v[36:39], v[108:111]
    v_mfma_f32_16x16x32_bf16 v[108:111], a[56:59], v[40:43], v[108:111]
    buffer_load_dwordx4 v[228:231], v1, s[8:11], s59 offen offset:1024 sc1
    v_mfma_f32_16x16x32_bf16 v[108:111], a[60:63], v[44:47], v[108:111]
    v_mfma_f32_16x16x32_bf16 v[108:111], a[176:179], v[48:51], v[108:111]
    v_mfma_f32_16x16x32_bf16 v[108:111], a[180:183], v[52:55], v[108:111]
    v_mfma_f32_16x16x32_bf16 v[108:111], a[184:187], v[56:59], v[108:111]
    v_mfma_f32_16x16x32_bf16 v[108:111], a[188:191], v[60:63], v[108:111]
    v_mfma_f32_16x16x32_bf16 v[112:115], a[64:67], v[32:35], 0
    v_mfma_f32_16x16x32_bf16 v[112:115], a[68:71], v[36:39], v[112:115]
    v_mfma_f32_16x16x32_bf16 v[112:115], a[72:75], v[40:43], v[112:115]
    v_mfma_f32_16x16x32_bf16 v[112:115], a[76:79], v[44:47], v[112:115]
    buffer_load_dwordx4 v[232:235], v1, s[8:11], s59 offen offset:2048 sc1
    v_mfma_f32_16x16x32_bf16 v[112:115], a[192:195], v[48:51], v[112:115]
    v_mfma_f32_16x16x32_bf16 v[112:115], a[196:199], v[52:55], v[112:115]
    v_mfma_f32_16x16x32_bf16 v[112:115], a[200:203], v[56:59], v[112:115]
    v_mfma_f32_16x16x32_bf16 v[112:115], a[204:207], v[60:63], v[112:115]
    v_mfma_f32_16x16x32_bf16 v[116:119], a[80:83], v[32:35], 0
    ds_read_b128 v[64:67], v13 offset:24576
    v_mfma_f32_16x16x32_bf16 v[116:119], a[84:87], v[36:39], v[116:119]
    ds_read_b128 v[68:71], v13 offset:25600
    v_mfma_f32_16x16x32_bf16 v[116:119], a[88:91], v[40:43], v[116:119]
    ds_read_b128 v[72:75], v13 offset:26624
    v_mfma_f32_16x16x32_bf16 v[116:119], a[92:95], v[44:47], v[116:119]
    ds_read_b128 v[76:79], v13 offset:27648
    v_mfma_f32_16x16x32_bf16 v[116:119], a[208:211], v[48:51], v[116:119]
    ds_read_b128 v[80:83], v13 offset:28672
    buffer_load_dwordx4 v[236:239], v1, s[8:11], s59 offen offset:3072 sc1
    v_mfma_f32_16x16x32_bf16 v[116:119], a[212:215], v[52:55], v[116:119]
    ds_read_b128 v[84:87], v13 offset:29696
    v_mfma_f32_16x16x32_bf16 v[116:119], a[216:219], v[56:59], v[116:119]
    ds_read_b128 v[88:91], v13 offset:30720
    v_mfma_f32_16x16x32_bf16 v[116:119], a[220:223], v[60:63], v[116:119]
    ds_read_b128 v[92:95], v13 offset:31744
    v_mfma_f32_16x16x32_bf16 v[120:123], a[96:99], v[32:35], 0
    v_mfma_f32_16x16x32_bf16 v[120:123], a[100:103], v[36:39], v[120:123]
    v_mfma_f32_16x16x32_bf16 v[120:123], a[104:107], v[40:43], v[120:123]
    v_mfma_f32_16x16x32_bf16 v[120:123], a[108:111], v[44:47], v[120:123]
    v_mfma_f32_16x16x32_bf16 v[120:123], a[224:227], v[48:51], v[120:123]
    v_mfma_f32_16x16x32_bf16 v[120:123], a[228:231], v[52:55], v[120:123]
    s_add_u32 s59, s59, 131072
    buffer_load_dwordx4 v[240:243], v1, s[8:11], s59 offen offset:0 sc1
    v_mfma_f32_16x16x32_bf16 v[120:123], a[232:235], v[56:59], v[120:123]
    v_mfma_f32_16x16x32_bf16 v[120:123], a[236:239], v[60:63], v[120:123]
    v_mfma_f32_16x16x32_bf16 v[124:127], a[112:115], v[32:35], 0
    v_mfma_f32_16x16x32_bf16 v[124:127], a[116:119], v[36:39], v[124:127]
    v_mfma_f32_16x16x32_bf16 v[124:127], a[120:123], v[40:43], v[124:127]
    v_mfma_f32_16x16x32_bf16 v[124:127], a[124:127], v[44:47], v[124:127]
    v_mfma_f32_16x16x32_bf16 v[124:127], a[240:243], v[48:51], v[124:127]
    v_mfma_f32_16x16x32_bf16 v[124:127], a[244:247], v[52:55], v[124:127]
    v_mfma_f32_16x16x32_bf16 v[124:127], a[248:251], v[56:59], v[124:127]
    buffer_load_dwordx4 v[244:247], v1, s[8:11], s59 offen offset:1024 sc1
    v_mfma_f32_16x16x32_bf16 v[124:127], a[252:255], v[60:63], v[124:127]
    s_waitcnt lgkmcnt(0)
    v_mfma_f32_16x16x32_bf16 v[128:131], a[0:3], v[64:67], 0
    v_mfma_f32_16x16x32_bf16 v[128:131], a[4:7], v[68:71], v[128:131]
    v_mfma_f32_16x16x32_bf16 v[128:131], a[8:11], v[72:75], v[128:131]
    v_cvt_pk_bf16_f32 v96, v96, v97
    v_mfma_f32_16x16x32_bf16 v[128:131], a[12:15], v[76:79], v[128:131]
    v_cvt_pk_bf16_f32 v97, v98, v99
    v_mfma_f32_16x16x32_bf16 v[128:131], a[128:131], v[80:83], v[128:131]
    v_cvt_pk_bf16_f32 v98, v100, v101
    v_mfma_f32_16x16x32_bf16 v[128:131], a[132:135], v[84:87], v[128:131]
    v_cvt_pk_bf16_f32 v99, v102, v103
    v_mfma_f32_16x16x32_bf16 v[128:131], a[136:139], v[88:91], v[128:131]
    buffer_store_dwordx4 v[96:99], v12, s[8:11], s25 offen offset:0 sc1
    v_mfma_f32_16x16x32_bf16 v[128:131], a[140:143], v[92:95], v[128:131]
    v_cvt_pk_bf16_f32 v104, v104, v105
    buffer_load_dwordx4 v[248:251], v1, s[8:11], s59 offen offset:2048 sc1
    v_mfma_f32_16x16x32_bf16 v[132:135], a[16:19], v[64:67], 0
    v_cvt_pk_bf16_f32 v105, v106, v107
    v_mfma_f32_16x16x32_bf16 v[132:135], a[20:23], v[68:71], v[132:135]
    v_cvt_pk_bf16_f32 v106, v108, v109
    v_mfma_f32_16x16x32_bf16 v[132:135], a[24:27], v[72:75], v[132:135]
    v_cvt_pk_bf16_f32 v107, v110, v111
    v_mfma_f32_16x16x32_bf16 v[132:135], a[28:31], v[76:79], v[132:135]
    buffer_store_dwordx4 v[104:107], v12, s[8:11], s25 offen offset:128 sc1
    v_mfma_f32_16x16x32_bf16 v[132:135], a[144:147], v[80:83], v[132:135]
    v_cvt_pk_bf16_f32 v112, v112, v113
    v_mfma_f32_16x16x32_bf16 v[132:135], a[148:151], v[84:87], v[132:135]
    v_cvt_pk_bf16_f32 v113, v114, v115
    v_mfma_f32_16x16x32_bf16 v[132:135], a[152:155], v[88:91], v[132:135]
    v_cvt_pk_bf16_f32 v114, v116, v117
    v_mfma_f32_16x16x32_bf16 v[132:135], a[156:159], v[92:95], v[132:135]
    v_cvt_pk_bf16_f32 v115, v118, v119
    v_mfma_f32_16x16x32_bf16 v[136:139], a[32:35], v[64:67], 0
    buffer_store_dwordx4 v[112:115], v12, s[8:11], s25 offen offset:256 sc1
    buffer_load_dwordx4 v[252:255], v1, s[8:11], s59 offen offset:3072 sc1
    v_mfma_f32_16x16x32_bf16 v[136:139], a[36:39], v[68:71], v[136:139]
    v_cvt_pk_bf16_f32 v120, v120, v121
    v_mfma_f32_16x16x32_bf16 v[136:139], a[40:43], v[72:75], v[136:139]
    v_cvt_pk_bf16_f32 v121, v122, v123
    v_mfma_f32_16x16x32_bf16 v[136:139], a[44:47], v[76:79], v[136:139]
    v_cvt_pk_bf16_f32 v122, v124, v125
    v_mfma_f32_16x16x32_bf16 v[136:139], a[160:163], v[80:83], v[136:139]
    v_cvt_pk_bf16_f32 v123, v126, v127
    v_mfma_f32_16x16x32_bf16 v[136:139], a[164:167], v[84:87], v[136:139]
    buffer_store_dwordx4 v[120:123], v12, s[8:11], s25 offen offset:384 sc1
    v_mfma_f32_16x16x32_bf16 v[136:139], a[168:171], v[88:91], v[136:139]
    s_add_u32 s25, s25, 264192
    v_mfma_f32_16x16x32_bf16 v[136:139], a[172:175], v[92:95], v[136:139]
    v_mfma_f32_16x16x32_bf16 v[140:143], a[48:51], v[64:67], 0
    v_mfma_f32_16x16x32_bf16 v[140:143], a[52:55], v[68:71], v[140:143]
    v_mfma_f32_16x16x32_bf16 v[140:143], a[56:59], v[72:75], v[140:143]
    v_mfma_f32_16x16x32_bf16 v[140:143], a[60:63], v[76:79], v[140:143]
    v_cvt_pk_bf16_f32 v128, v128, v129
    v_mfma_f32_16x16x32_bf16 v[140:143], a[176:179], v[80:83], v[140:143]
    v_cvt_pk_bf16_f32 v129, v130, v131
    v_mfma_f32_16x16x32_bf16 v[140:143], a[180:183], v[84:87], v[140:143]
    v_cvt_pk_bf16_f32 v130, v132, v133
    v_mfma_f32_16x16x32_bf16 v[140:143], a[184:187], v[88:91], v[140:143]
    v_cvt_pk_bf16_f32 v131, v134, v135
    v_mfma_f32_16x16x32_bf16 v[140:143], a[188:191], v[92:95], v[140:143]
    buffer_store_dwordx4 v[128:131], v12, s[8:11], s25 offen offset:0 sc1
    v_mfma_f32_16x16x32_bf16 v[144:147], a[64:67], v[64:67], 0
    v_mfma_f32_16x16x32_bf16 v[144:147], a[68:71], v[68:71], v[144:147]
    v_mfma_f32_16x16x32_bf16 v[144:147], a[72:75], v[72:75], v[144:147]
    v_mfma_f32_16x16x32_bf16 v[144:147], a[76:79], v[76:79], v[144:147]
    v_cvt_pk_bf16_f32 v136, v136, v137
    v_mfma_f32_16x16x32_bf16 v[144:147], a[192:195], v[80:83], v[144:147]
    v_cvt_pk_bf16_f32 v137, v138, v139
    v_mfma_f32_16x16x32_bf16 v[144:147], a[196:199], v[84:87], v[144:147]
    v_cvt_pk_bf16_f32 v138, v140, v141
    v_mfma_f32_16x16x32_bf16 v[144:147], a[200:203], v[88:91], v[144:147]
    v_cvt_pk_bf16_f32 v139, v142, v143
    v_mfma_f32_16x16x32_bf16 v[144:147], a[204:207], v[92:95], v[144:147]
    buffer_store_dwordx4 v[136:139], v12, s[8:11], s25 offen offset:128 sc1
    v_mfma_f32_16x16x32_bf16 v[148:151], a[80:83], v[64:67], 0
    v_mfma_f32_16x16x32_bf16 v[148:151], a[84:87], v[68:71], v[148:151]
    v_mfma_f32_16x16x32_bf16 v[148:151], a[88:91], v[72:75], v[148:151]
    v_mfma_f32_16x16x32_bf16 v[148:151], a[92:95], v[76:79], v[148:151]
    v_mfma_f32_16x16x32_bf16 v[148:151], a[208:211], v[80:83], v[148:151]
    v_mfma_f32_16x16x32_bf16 v[148:151], a[212:215], v[84:87], v[148:151]
    v_mfma_f32_16x16x32_bf16 v[148:151], a[216:219], v[88:91], v[148:151]
    v_mfma_f32_16x16x32_bf16 v[148:151], a[220:223], v[92:95], v[148:151]
    v_mfma_f32_16x16x32_bf16 v[152:155], a[96:99], v[64:67], 0
    v_mfma_f32_16x16x32_bf16 v[152:155], a[100:103], v[68:71], v[152:155]
    v_mfma_f32_16x16x32_bf16 v[152:155], a[104:107], v[72:75], v[152:155]
    v_mfma_f32_16x16x32_bf16 v[152:155], a[108:111], v[76:79], v[152:155]
    v_cvt_pk_bf16_f32 v144, v144, v145
    v_mfma_f32_16x16x32_bf16 v[152:155], a[224:227], v[80:83], v[152:155]
    v_cvt_pk_bf16_f32 v145, v146, v147
    v_mfma_f32_16x16x32_bf16 v[152:155], a[228:231], v[84:87], v[152:155]
    v_cvt_pk_bf16_f32 v146, v148, v149
    v_mfma_f32_16x16x32_bf16 v[152:155], a[232:235], v[88:91], v[152:155]
    v_cvt_pk_bf16_f32 v147, v150, v151
    v_mfma_f32_16x16x32_bf16 v[152:155], a[236:239], v[92:95], v[152:155]
    buffer_store_dwordx4 v[144:147], v12, s[8:11], s25 offen offset:256 sc1
    v_mfma_f32_16x16x32_bf16 v[156:159], a[112:115], v[64:67], 0
    v_mfma_f32_16x16x32_bf16 v[156:159], a[116:119], v[68:71], v[156:159]
    v_mfma_f32_16x16x32_bf16 v[156:159], a[120:123], v[72:75], v[156:159]
    v_mfma_f32_16x16x32_bf16 v[156:159], a[124:127], v[76:79], v[156:159]
    v_mfma_f32_16x16x32_bf16 v[156:159], a[240:243], v[80:83], v[156:159]
    v_mfma_f32_16x16x32_bf16 v[156:159], a[244:247], v[84:87], v[156:159]
    v_mfma_f32_16x16x32_bf16 v[156:159], a[248:251], v[88:91], v[156:159]
    v_mfma_f32_16x16x32_bf16 v[156:159], a[252:255], v[92:95], v[156:159]
    v_cvt_pk_bf16_f32 v152, v152, v153
    v_cvt_pk_bf16_f32 v153, v154, v155
    s_nop 5
    v_cvt_pk_bf16_f32 v154, v156, v157
    v_cvt_pk_bf16_f32 v155, v158, v159
    buffer_store_dwordx4 v[152:155], v12, s[8:11], s25 offen offset:384 sc1
    s_add_u32 s25, s25, 264192
    s_andn2_b32 s25, s52, 0x4000
    s_add_u32 s27, s27, s25
    s_lshr_b32 s25, s25, 7
    s_add_u32 s27, s27, s25
    s_lshl_b32 s25, s49, 10
    s_add_u32 s27, s27, s25
    s_mov_b32 s26, 35782656
    s_mul_i32 s35, s55, 1024
    s_add_u32 s26, s26, s35
    s_mul_i32 s35, s21, 64
    s_add_u32 s26, s26, s35
    s_add_u32 s34, s33, 1
    v_mov_b32 v4, s34
    v_lshrrev_b32 v13, 2, v1
    v_and_b32 v13, 255, v13
    s_waitcnt vmcnt(0)
    buffer_store_dword v4, v2, s[8:11], s57 offen sc1
    v_and_b32 v56, 1, v5
    v_lshlrev_b32 v56, 4, v56
    v_mov_b32 v57, 0x3f80
    v_lshlrev_b32 v56, v56, v57
    v_lshrrev_b32 v57, 1, v5
    v_lshlrev_b32 v58, 4, v5
    v_lshl_add_u32 v58, v6, 11, v58
    v_cmp_eq_u32 vcc, 0, v57
    s_nop 1
    v_cndmask_b32 v24, 0, v56, vcc
    v_cmp_eq_u32 vcc, 1, v57
    s_nop 1
    v_cndmask_b32 v25, 0, v56, vcc
    v_cmp_eq_u32 vcc, 2, v57
    s_nop 1
    v_cndmask_b32 v26, 0, v56, vcc
    v_cmp_eq_u32 vcc, 3, v57
    s_nop 1
    v_cndmask_b32 v27, 0, v56, vcc
    v_cmp_eq_u32 vcc, 4, v57
    s_nop 1
    v_cndmask_b32 v28, 0, v56, vcc
    v_cmp_eq_u32 vcc, 5, v57
    s_nop 1
    v_cndmask_b32 v29, 0, v56, vcc
    v_cmp_eq_u32 vcc, 6, v57
    s_nop 1
    v_cndmask_b32 v30, 0, v56, vcc
    v_cmp_eq_u32 vcc, 7, v57
    s_nop 1
    v_cndmask_b32 v31, 0, v56, vcc
L_pp_44:
    buffer_load_dword v4, v13, s[8:11], s56 offen sc1
    s_sub_u32 s30, s30, 1
    s_cbranch_scc1 M_done
    s_waitcnt vmcnt(0)
    v_cmp_gt_u32 vcc, s34, v4
    s_nop 0
    s_cbranch_vccnz L_pp_44
    buffer_load_dwordx4 v[64:67], v58, s[8:11], s27 offen offset:0 sc1
    buffer_load_dwordx4 v[68:71], v58, s[8:11], s27 offen offset:256 sc1
    buffer_load_dwordx4 v[72:75], v58, s[8:11], s27 offen offset:512 sc1
    buffer_load_dwordx4 v[76:79], v58, s[8:11], s27 offen offset:768 sc1
    s_add_u32 s27, s27, 8192
    buffer_load_dwordx4 v[80:83], v58, s[8:11], s27 offen offset:0 sc1
    buffer_load_dwordx4 v[84:87], v58, s[8:11], s27 offen offset:256 sc1
    buffer_load_dwordx4 v[88:91], v58, s[8:11], s27 offen offset:512 sc1
    buffer_load_dwordx4 v[92:95], v58, s[8:11], s27 offen offset:768 sc1
    s_add_u32 s27, s27, 8192
    buffer_load_dwordx4 v[96:99], v58, s[8:11], s27 offen offset:0 sc1
    buffer_load_dwordx4 v[100:103], v58, s[8:11], s27 offen offset:256 sc1
    buffer_load_dwordx4 v[104:107], v58, s[8:11], s27 offen offset:512 sc1
    buffer_load_dwordx4 v[108:111], v58, s[8:11], s27 offen offset:768 sc1
    s_add_u32 s27, s27, 8192
    buffer_load_dwordx4 v[112:115], v58, s[8:11], s27 offen offset:0 sc1
    buffer_load_dwordx4 v[116:119], v58, s[8:11], s27 offen offset:256 sc1
    buffer_load_dwordx4 v[120:123], v58, s[8:11], s27 offen offset:512 sc1
    buffer_load_dwordx4 v[124:127], v58, s[8:11], s27 offen offset:768 sc1
    s_add_u32 s27, s27, 8192
    buffer_load_dword v14, v2, s[8:11], s26 offen sc1
    s_waitcnt vmcnt(16)
    v_mfma_f32_16x16x32_bf16 v[32:35], v[24:27], v[64:67], 0
    s_waitcnt vmcnt(15)
    v_mfma_f32_16x16x32_bf16 v[32:35], v[28:31], v[68:71], v[32:35]
    s_waitcnt vmcnt(14)
    v_mfma_f32_16x16x32_bf16 v[36:39], v[24:27], v[72:75], 0
    s_waitcnt vmcnt(13)
    v_mfma_f32_16x16x32_bf16 v[36:39], v[28:31], v[76:79], v[36:39]
    s_waitcnt vmcnt(12)
    v_mfma_f32_16x16x32_bf16 v[32:35], v[24:27], v[80:83], v[32:35]
    s_waitcnt vmcnt(11)
    v_mfma_f32_16x16x32_bf16 v[32:35], v[28:31], v[84:87], v[32:35]
    s_waitcnt vmcnt(10)
    v_mfma_f32_16x16x32_bf16 v[36:39], v[24:27], v[88:91], v[36:39]
    s_waitcnt vmcnt(9)
    v_mfma_f32_16x16x32_bf16 v[36:39], v[28:31], v[92:95], v[36:39]
    s_waitcnt vmcnt(8)
    v_mfma_f32_16x16x32_bf16 v[32:35], v[24:27], v[96:99], v[32:35]
    s_waitcnt vmcnt(7)
    v_mfma_f32_16x16x32_bf16 v[32:35], v[28:31], v[100:103], v[32:35]
    s_waitcnt vmcnt(6)
    v_mfma_f32_16x16x32_bf16 v[36:39], v[24:27], v[104:107], v[36:39]
    s_waitcnt vmcnt(5)
    v_mfma_f32_16x16x32_bf16 v[36:39], v[28:31], v[108:111], v[36:39]
    s_waitcnt vmcnt(4)
    v_mfma_f32_16x16x32_bf16 v[32:35], v[24:27], v[112:115], v[32:35]
    s_waitcnt vmcnt(3)
    v_mfma_f32_16x16x32_bf16 v[32:35], v[28:31], v[116:119], v[32:35]
    s_waitcnt vmcnt(2)
    v_mfma_f32_16x16x32_bf16 v[36:39], v[24:27], v[120:123], v[36:39]
    s_waitcnt vmcnt(1)
    v_mfma_f32_16x16x32_bf16 v[36:39], v[28:31], v[124:127], v[36:39]
    v_cvt_pk_bf16_f32 v64, v32, v33
    v_cvt_pk_bf16_f32 v65, v34, v35
    s_nop 5
    v_cvt_pk_bf16_f32 v66, v36, v37
    v_cvt_pk_bf16_f32 v67, v38, v39
    v_lshlrev_b32 v32, 16, v64
    v_and_b32 v33, 0xffff0000, v64
    v_lshlrev_b32 v34, 16, v65
    v_and_b32 v35, 0xffff0000, v65
    v_lshlrev_b32 v36, 16, v66
    v_and_b32 v37, 0xffff0000, v66
    v_lshlrev_b32 v38, 16, v67
    v_and_b32 v39, 0xffff0000, v67
    v_lshlrev_b32 v40, 16, v16
    v_and_b32 v41, 0xffff0000, v16
    v_lshlrev_b32 v42, 16, v17
    v_and_b32 v43, 0xffff0000, v17
    v_lshlrev_b32 v44, 16, v18
    v_and_b32 v45, 0xffff0000, v18
    v_lshlrev_b32 v46, 16, v19
    v_and_b32 v47, 0xffff0000, v19
    v_add_f32 v32, v32, v40
    v_add_f32 v33, v33, v41
    v_add_f32 v34, v34, v42
    v_add_f32 v35, v35, v43
    v_add_f32 v36, v36, v44
    v_add_f32 v37, v37, v45
    v_add_f32 v38, v38, v46
    v_add_f32 v39, v39, v47
    v_cvt_pk_bf16_f32 v16, v32, v33
    v_cvt_pk_bf16_f32 v17, v34, v35
    v_cvt_pk_bf16_f32 v18, v36, v37
    v_cvt_pk_bf16_f32 v19, v38, v39
    v_lshlrev_b32 v32, 16, v16
    v_and_b32 v33, 0xffff0000, v16
    v_lshlrev_b32 v34, 16, v17
    v_and_b32 v35, 0xffff0000, v17
    v_lshlrev_b32 v36, 16, v18
    v_and_b32 v37, 0xffff0000, v18
    v_lshlrev_b32 v38, 16, v19
    v_and_b32 v39, 0xffff0000, v19
    s_lshl_b32 s25, s23, 21
    s_add_u32 s29, s29, s25
    s_add_u32 s25, s29, 25165824
    buffer_store_dwordx2 v[16:17], v11, s[8:11], s25 offen offset:0 sc1
    buffer_store_dwordx2 v[18:19], v11, s[8:11], s25 offen offset:256 sc1
    v_lshrrev_b32 v7, 3, v1
    v_and_b32 v7, 8, v7
    s_lshl_b32 s25, s20, 4
    s_add_u32 s25, s25, 65536
    v_add_u32 v7, s25, v7
    v_pk_add_f32 v[40:41], v[32:33], v[34:35]
    v_pk_add_f32 v[40:41], v[40:41], v[36:37]
    v_pk_add_f32 v[40:41], v[40:41], v[38:39]
    v_add_f32 v24, v40, v41
    s_nop 1
    v_add_f32_dpp v24, v24, v24 quad_perm:[1,0,3,2] row_mask:0xf bank_mask:0xf
    s_nop 1
    v_add_f32_dpp v24, v24, v24 quad_perm:[2,3,0,1] row_mask:0xf bank_mask:0xf
    s_nop 1
    v_add_f32_dpp v24, v24, v24 row_ror:8 row_mask:0xf bank_mask:0xf
    v_mov_b32 v42, v24
    s_nop 1
    v_permlane16_swap_b32 v24, v42
    v_add_f32 v24, v24, v42
    v_mov_b32 v42, v24
    s_nop 1
    v_permlane32_swap_b32 v24, v42
    v_add_f32 v24, v24, v42
    v_mul_f32 v24, 0xbb800000, v24
    v_pk_add_f32 v[32:33], v[32:33], v[24:25] op_sel_hi:[1,0]
    v_pk_add_f32 v[34:35], v[34:35], v[24:25] op_sel_hi:[1,0]
    v_pk_add_f32 v[36:37], v[36:37], v[24:25] op_sel_hi:[1,0]
    v_pk_add_f32 v[38:39], v[38:39], v[24:25] op_sel_hi:[1,0]
    v_pk_mul_f32 v[40:41], v[32:33], v[32:33]
    v_pk_fma_f32 v[40:41], v[34:35], v[34:35], v[40:41]
    v_pk_fma_f32 v[40:41], v[36:37], v[36:37], v[40:41]
    v_pk_fma_f32 v[40:41], v[38:39], v[38:39], v[40:41]
    v_add_f32 v25, v40, v41
    s_nop 1
    v_add_f32_dpp v25, v25, v25 quad_perm:[1,0,3,2] row_mask:0xf bank_mask:0xf
    s_nop 1
    v_add_f32_dpp v25, v25, v25 quad_perm:[2,3,0,1] row_mask:0xf bank_mask:0xf
    s_nop 1
    v_add_f32_dpp v25, v25, v25 row_ror:8 row_mask:0xf bank_mask:0xf
    v_mov_b32 v42, v25
    s_nop 1
    v_permlane16_swap_b32 v25, v42
    v_add_f32 v25, v25, v42
    v_mov_b32 v42, v25
    s_nop 1
    v_permlane32_swap_b32 v25, v42
    v_add_f32 v25, v25, v42
    ds_write_b64 v7, v[24:25]
    v_xor_b32 v7, 16, v7
    s_waitcnt lgkmcnt(0)
    s_barrier
    ds_read_b64 v[40:41], v7
    s_waitcnt lgkmcnt(0)
    v_sub_f32 v24, v40, v24
    v_add_f32 v25, v25, v41
    v_mul_f32 v24, 0.5, v24
    v_mul_f32 v40, v24, v24
    v_fmac_f32 v25, 0x44000000, v40
    v_pk_add_f32 v[32:33], v[32:33], v[24:25] op_sel_hi:[1,0]
    v_pk_add_f32 v[34:35], v[34:35], v[24:25] op_sel_hi:[1,0]
    v_pk_add_f32 v[36:37], v[36:37], v[24:25] op_sel_hi:[1,0]
    v_pk_add_f32 v[38:39], v[38:39], v[24:25] op_sel_hi:[1,0]
    v_mov_b32 v40, 0x3727c5ac
    v_fmac_f32 v40, 0x3b000000, v25
    v_rsq_f32 v24, v40
    s_nop 0
    v_pk_mul_f32 v[32:33], v[32:33], v[24:25] op_sel_hi:[1,0]
    v_pk_mul_f32 v[34:35], v[34:35], v[24:25] op_sel_hi:[1,0]
    v_pk_mul_f32 v[36:37], v[36:37], v[24:25] op_sel_hi:[1,0]
    v_pk_mul_f32 v[38:39], v[38:39], v[24:25] op_sel_hi:[1,0]
    v_cvt_pk_bf16_f32 v20, v32, v33
    v_cvt_pk_bf16_f32 v21, v34, v35
    v_cvt_pk_bf16_f32 v22, v36, v37
    v_cvt_pk_bf16_f32 v23, v38, v39
    s_add_u32 s25, s29, 29360128
    buffer_store_dwordx2 v[20:21], v11, s[8:11], s25 offen offset:0 sc1
    buffer_store_dwordx2 v[22:23], v11, s[8:11], s25 offen offset:256 sc1
    s_waitcnt vmcnt(4)
    v_readfirstlane_b32 s61, v14
    s_nop 0
    s_cmp_lt_u32 s61, 16
    s_cbranch_scc1 L_bn_45
    s_lshl_b32 s25, s55, 1
    s_add_u32 s25, s25, s48
    s_lshl_b32 s25, s25, 17
    s_add_u32 s25, s25, s50
    s_add_u32 s25, s25, 142606336
    buffer_load_dwordx4 v[128:131], v0, s[8:11], s25 offen offset:0 sc1
    buffer_load_dwordx4 v[132:135], v0, s[8:11], s25 offen offset:1024 sc1
    buffer_load_dwordx4 v[136:139], v0, s[8:11], s25 offen offset:2048 sc1
    buffer_load_dwordx4 v[140:143], v0, s[8:11], s25 offen offset:3072 sc1
    buffer_load_dwordx2 v[144:145], v15, s[8:11], s25 offen offset:0 sc1
    buffer_load_dwordx2 v[146:147], v15, s[8:11], s25 offen offset:1024 sc1
    buffer_load_dwordx2 v[148:149], v15, s[8:11], s25 offen offset:2048 sc1
    buffer_load_dwordx2 v[150:151], v15, s[8:11], s25 offen offset:3072 sc1
    s_waitcnt vmcnt(8)
    s_branch L_bs_46
L_bn_45:
    s_waitcnt vmcnt(0)
L_bs_46:
    s_lshl_b32 s26, s24, 8
    s_lshr_b32 s35, s52, 12
    s_add_u32 s26, s26, s35
    s_add_u32 s26, s26, 35869184
    s_waitcnt vmcnt(63)
    buffer_store_dword v3, v2, s[8:11], s26 offen sc1
    s_cmp_ge_u32 s24, 60
    s_cbranch_scc1 M_done
    s_mov_b32 s24, s55
    s_lshr_b32 s23, s24, 5
    s_add_u32 s33, s33, 1
    s_branch B_loopG
B_loopL:
    s_cmp_lg_u32 s54, 0
    s_cbranch_scc1 L_bp_47
    s_mov_b32 s26, 35651584
    s_mul_i32 s35, s24, 2048
    s_add_u32 s26, s26, s35
    s_mul_i32 s35, s21, 128
    s_add_u32 s26, s26, s35
    s_mul_i32 s35, s49, 64
    s_add_u32 s26, s26, s35
L_w_48:
    buffer_load_dword v4, v2, s[8:11], s26 offen sc1
    s_waitcnt vmcnt(0)
    v_readfirstlane_b32 s34, v4
    s_nop 0
    s_cmp_ge_u32 s34, 1
    s_cbranch_scc1 L_wd_49
    s_sleep 2
    s_sub_u32 s30, s30, 1
    s_cbranch_scc0 L_w_48
    s_branch M_done
L_wd_49:
    s_lshl_b32 s58, s24, 1
    s_add_u32 s58, s58, s48
    s_lshl_b32 s58, s58, 18
    s_add_u32 s59, s58, s50
    s_add_u32 s58, s59, s50
    s_add_u32 s58, s58, 109051904
    s_add_u32 s60, s59, 75497472
    s_add_u32 s59, s59, 41943040
    buffer_load_dwordx4 v[192:195], v1, s[8:11], s58 offen offset:0 sc1
    buffer_load_dwordx4 v[196:199], v1, s[8:11], s58 offen offset:1024 sc1
    buffer_load_dwordx4 v[200:203], v1, s[8:11], s58 offen offset:2048 sc1
    buffer_load_dwordx4 v[204:207], v1, s[8:11], s58 offen offset:3072 sc1
    s_add_u32 s58, s58, 4096
    buffer_load_dwordx4 v[208:211], v1, s[8:11], s58 offen offset:0 sc1
    buffer_load_dwordx4 v[212:215], v1, s[8:11], s58 offen offset:1024 sc1
    buffer_load_dwordx4 v[216:219], v1, s[8:11], s58 offen offset:2048 sc1
    buffer_load_dwordx4 v[220:223], v1, s[8:11], s58 offen offset:3072 sc1
    buffer_load_dwordx4 v[160:163], v1, s[8:11], s60 offen offset:0 sc1
    buffer_load_dwordx4 v[164:167], v1, s[8:11], s60 offen offset:1024 sc1
    buffer_load_dwordx4 v[168:171], v1, s[8:11], s60 offen offset:2048 sc1
    buffer_load_dwordx4 v[172:175], v1, s[8:11], s60 offen offset:3072 sc1
    s_add_u32 s60, s60, 131072
    buffer_load_dwordx4 v[176:179], v1, s[8:11], s60 offen offset:0 sc1
    buffer_load_dwordx4 v[180:183], v1, s[8:11], s60 offen offset:1024 sc1
    buffer_load_dwordx4 v[184:187], v1, s[8:11], s60 offen offset:2048 sc1
    buffer_load_dwordx4 v[188:191], v1, s[8:11], s60 offen offset:3072 sc1
    buffer_load_dwordx4 v[224:227], v1, s[8:11], s59 offen offset:0 sc1
    buffer_load_dwordx4 v[228:231], v1, s[8:11], s59 offen offset:1024 sc1
    buffer_load_dwordx4 v[232:235], v1, s[8:11], s59 offen offset:2048 sc1
    buffer_load_dwordx4 v[236:239], v1, s[8:11], s59 offen offset:3072 sc1
    s_add_u32 s59, s59, 131072
    buffer_load_dwordx4 v[240:243], v1, s[8:11], s59 offen offset:0 sc1
    buffer_load_dwordx4 v[244:247], v1, s[8:11], s59 offen offset:1024 sc1
    buffer_load_dwordx4 v[248:251], v1, s[8:11], s59 offen offset:2048 sc1
    buffer_load_dwordx4 v[252:255], v1, s[8:11], s59 offen offset:3072 sc1
    s_mov_b32 s61, 0
L_bp_47:
    s_cmp_ge_u32 s61, 16
    s_cbranch_scc1 L_bq_50
    s_mov_b32 s26, 35782656
    s_mul_i32 s35, s24, 1024
    s_add_u32 s26, s26, s35
    s_mul_i32 s35, s21, 64
    s_add_u32 s26, s26, s35
L_w_51:
    buffer_load_dword v4, v2, s[8:11], s26 offen sc1
    s_waitcnt vmcnt(0)
    v_readfirstlane_b32 s34, v4
    s_nop 0
    s_cmp_ge_u32 s34, 16
    s_cbranch_scc1 L_wd_52
    s_sleep 1
    s_sub_u32 s30, s30, 1
    s_cbranch_scc0 L_w_51
    s_branch M_done
L_wd_52:
    s_lshl_b32 s25, s24, 1
    s_add_u32 s25, s25, s48
    s_lshl_b32 s25, s25, 17
    s_add_u32 s25, s25, s50
    s_add_u32 s25, s25, 142606336
    buffer_load_dwordx4 v[128:131], v0, s[8:11], s25 offen offset:0 sc1
    buffer_load_dwordx4 v[132:135], v0, s[8:11], s25 offen offset:1024 sc1
    buffer_load_dwordx4 v[136:139], v0, s[8:11], s25 offen offset:2048 sc1
    buffer_load_dwordx4 v[140:143], v0, s[8:11], s25 offen offset:3072 sc1
    buffer_load_dwordx2 v[144:145], v15, s[8:11], s25 offen offset:0 sc1
    buffer_load_dwordx2 v[146:147], v15, s[8:11], s25 offen offset:1024 sc1
    buffer_load_dwordx2 v[148:149], v15, s[8:11], s25 offen offset:2048 sc1
    buffer_load_dwordx2 v[150:151], v15, s[8:11], s25 offen offset:3072 sc1
L_bq_50:
    s_cmp_lt_u32 s24, 32
    s_cselect_b32 s55, 25, -21
    s_sub_u32 s35, s24, 7
    s_cmp_lt_u32 s35, 46
    s_cselect_b32 s55, s55, 4
    s_add_u32 s55, s55, s24
    s_min_u32 s55, s55, 63
    s_mov_b32 s26, 35651584
    s_mul_i32 s35, s55, 2048
    s_add_u32 s26, s26, s35
    s_mul_i32 s35, s21, 128
    s_add_u32 s26, s26, s35
    s_mul_i32 s35, s49, 64
    s_add_u32 s26, s26, s35
    buffer_load_dword v116, v2, s[8:11], s26 offen sc1
    v_mov_b32 v37, 0
    v_mov_b32 v41, 0
    v_mov_b32 v112, 0
    v_mov_b32 v114, 0
    s_waitcnt vmcnt(9)
    v_mfma_f32_16x16x32_bf16 v[20:23], v[160:163], v[224:227], 0
    v_mfma_f32_16x16x32_bf16 v[28:31], v[160:163], v[240:243], 0
    v_mfma_f32_16x16x32_bf16 v[32:35], v[176:179], v[240:243], 0
    v_mfma_f32_16x16x32_bf16 v[20:23], v[164:167], v[228:231], v[20:23]
    v_mfma_f32_16x16x32_bf16 v[28:31], v[164:167], v[244:247], v[28:31]
    v_mfma_f32_16x16x32_bf16 v[32:35], v[180:183], v[244:247], v[32:35]
    v_mfma_f32_16x16x32_bf16 v[20:23], v[168:171], v[232:235], v[20:23]
    v_mfma_f32_16x16x32_bf16 v[28:31], v[168:171], v[248:251], v[28:31]
    v_mfma_f32_16x16x32_bf16 v[32:35], v[184:187], v[248:251], v[32:35]
    v_mfma_f32_16x16x32_bf16 v[20:23], v[172:175], v[236:239], v[20:23]
    v_mfma_f32_16x16x32_bf16 v[28:31], v[172:175], v[252:255], v[28:31]
    v_mfma_f32_16x16x32_bf16 v[32:35], v[188:191], v[252:255], v[32:35]
    s_waitcnt vmcnt(5)
    v_mfma_f32_16x16x32_bf16 v[16:19], v[128:131], v[224:227], 0
    v_mfma_f32_16x16x32_bf16 v[24:27], v[128:131], v[240:243], 0
    v_mfma_f32_16x16x32_bf16 v[16:19], v[132:135], v[228:231], v[16:19]
    v_mfma_f32_16x16x32_bf16 v[24:27], v[132:135], v[244:247], v[24:27]
    v_mfma_f32_16x16x32_bf16 v[16:19], v[136:139], v[232:235], v[16:19]
    v_mfma_f32_16x16x32_bf16 v[24:27], v[136:139], v[248:251], v[24:27]
    v_mfma_f32_16x16x32_bf16 v[16:19], v[140:143], v[236:239], v[16:19]
    v_mfma_f32_16x16x32_bf16 v[24:27], v[140:143], v[252:255], v[24:27]
    v_cndmask_b32 v20, v9, v20, s[40:41]
    v_cndmask_b32 v32, v9, v32, s[40:41]
    v_cndmask_b32 v21, v9, v21, s[42:43]
    v_cndmask_b32 v33, v9, v33, s[42:43]
    v_cndmask_b32 v22, v9, v22, s[44:45]
    v_cndmask_b32 v34, v9, v34, s[44:45]
    v_cndmask_b32 v23, v9, v23, s[46:47]
    v_cndmask_b32 v35, v9, v35, s[46:47]
    v_max3_f32 v11, v26, v27, v28
    v_max3_f32 v7, v18, v19, v20
    v_max3_f32 v11, v11, v29, v30
    v_max3_f32 v7, v7, v21, v22
    v_max3_f32 v11, v11, v31, v32
    v_max_f32 v7, v7, v23
    v_max3_f32 v11, v11, v33, v34
    v_mov_b32 v8, v7
    v_max_f32 v11, v11, v35
    s_nop 0
    v_permlane16_swap_b32 v7, v8
    v_mov_b32 v14, v11
    v_max_f32 v7, v7, v8
    s_nop 0
    v_permlane16_swap_b32 v11, v14
    v_mov_b32 v8, v7
    v_max_f32 v11, v11, v14
    s_nop 0
    v_permlane32_swap_b32 v7, v8
    v_mov_b32 v14, v11
    v_max_f32 v7, v7, v8
    s_nop 0
    v_permlane32_swap_b32 v11, v14
    v_mul_f32 v7, 0xbe0293ee, v7
    v_max_f32 v11, v11, v14
    v_fma_f32 v18, v18, s31, v7
    v_mul_f32 v11, 0xbe0293ee, v11
    v_fma_f32 v19, v19, s31, v7
    v_fma_f32 v26, v26, s31, v11
    v_fma_f32 v20, v20, s31, v7
    v_fma_f32 v27, v27, s31, v11
    v_fma_f32 v21, v21, s31, v7
    v_fma_f32 v28, v28, s31, v11
    v_fma_f32 v22, v22, s31, v7
    v_fma_f32 v29, v29, s31, v11
    v_fma_f32 v23, v23, s31, v7
    v_fma_f32 v30, v30, s31, v11
    v_exp_f32 v18, v18
    v_fma_f32 v31, v31, s31, v11
    v_exp_f32 v19, v19
    v_fma_f32 v32, v32, s31, v11
    v_exp_f32 v20, v20
    v_fma_f32 v33, v33, s31, v11
    v_exp_f32 v21, v21
    v_fma_f32 v34, v34, s31, v11
    v_exp_f32 v22, v22
    v_fma_f32 v35, v35, s31, v11
    v_exp_f32 v23, v23
    v_exp_f32 v26, v26
    v_cvt_pk_bf16_f32 v36, v18, v19
    v_exp_f32 v27, v27
    v_cvt_pk_bf16_f32 v113, v18, v19
    v_exp_f32 v28, v28
    v_cvt_pk_bf16_f32 v38, v20, v21
    v_exp_f32 v29, v29
    v_cvt_pk_bf16_f32 v39, v22, v23
    v_exp_f32 v30, v30
    v_exp_f32 v31, v31
    v_exp_f32 v32, v32
    v_exp_f32 v33, v33
    v_exp_f32 v34, v34
    v_exp_f32 v35, v35
    v_cvt_pk_bf16_f32 v40, v26, v27
    v_cvt_pk_bf16_f32 v115, v26, v27
    v_cvt_pk_bf16_f32 v44, v28, v29
    v_cvt_pk_bf16_f32 v45, v30, v31
    v_cvt_pk_bf16_f32 v46, v32, v33
    v_cvt_pk_bf16_f32 v47, v34, v35
    s_waitcnt vmcnt(1)
    s_nop 0
    v_mfma_f32_16x16x32_bf16 v[80:83], v[192:195], v[44:47], 0
    v_add_f32 v11, v26, v27
    v_add_f32 v7, v18, v19
    v_mfma_f32_16x16x16_bf16 v[48:51], v[192:193], v[38:39], 0
    v_add_f32 v11, v11, v28
    v_add_f32 v7, v7, v20
    v_mfma_f32_16x16x32_bf16 v[84:87], v[196:199], v[44:47], 0
    v_add_f32 v11, v11, v29
    v_add_f32 v7, v7, v21
    v_mfma_f32_16x16x16_bf16 v[52:55], v[196:197], v[38:39], 0
    v_add_f32 v11, v11, v30
    v_add_f32 v7, v7, v22
    v_mfma_f32_16x16x32_bf16 v[88:91], v[200:203], v[44:47], 0
    v_add_f32 v11, v11, v31
    v_add_f32 v7, v7, v23
    v_mfma_f32_16x16x16_bf16 v[56:59], v[200:201], v[38:39], 0
    v_add_f32 v11, v11, v32
    v_mov_b32 v8, v7
    v_mfma_f32_16x16x32_bf16 v[92:95], v[204:207], v[44:47], 0
    v_add_f32 v11, v11, v33
    v_permlane16_swap_b32 v7, v8
    v_mfma_f32_16x16x16_bf16 v[60:63], v[204:205], v[38:39], 0
    v_add_f32 v11, v11, v34
    v_add_f32 v7, v7, v8
    v_mfma_f32_16x16x32_bf16 v[96:99], v[208:211], v[44:47], 0
    v_add_f32 v11, v11, v35
    v_mov_b32 v8, v7
    v_mfma_f32_16x16x16_bf16 v[64:67], v[208:209], v[38:39], 0
    v_mov_b32 v14, v11
    v_permlane32_swap_b32 v7, v8
    v_mfma_f32_16x16x32_bf16 v[100:103], v[212:215], v[44:47], 0
    v_permlane16_swap_b32 v11, v14
    v_add_f32 v7, v7, v8
    v_mfma_f32_16x16x16_bf16 v[68:71], v[212:213], v[38:39], 0
    v_add_f32 v11, v11, v14
    v_rcp_f32 v7, v7
    v_mfma_f32_16x16x32_bf16 v[104:107], v[216:219], v[44:47], 0
    v_mov_b32 v14, v11
    v_mfma_f32_16x16x16_bf16 v[72:75], v[216:217], v[38:39], 0
    s_nop 0
    v_permlane32_swap_b32 v11, v14
    v_mfma_f32_16x16x32_bf16 v[108:111], v[220:223], v[44:47], 0
    v_add_f32 v11, v11, v14
    v_mfma_f32_16x16x16_bf16 v[76:79], v[220:221], v[38:39], 0
    v_rcp_f32 v11, v11
    v_mfma_f32_16x16x16_bf16 v[80:83], v[144:145], v[40:41], v[80:83]
    v_mfma_f32_16x16x16_bf16 v[48:51], v[144:145], v[36:37], v[48:51]
    v_mfma_f32_16x16x16_bf16 v[84:87], v[144:145], v[114:115], v[84:87]
    v_mfma_f32_16x16x16_bf16 v[52:55], v[144:145], v[112:113], v[52:55]
    v_mfma_f32_16x16x16_bf16 v[88:91], v[146:147], v[40:41], v[88:91]
    v_mfma_f32_16x16x16_bf16 v[56:59], v[146:147], v[36:37], v[56:59]
    v_mfma_f32_16x16x16_bf16 v[92:95], v[146:147], v[114:115], v[92:95]
    v_mfma_f32_16x16x16_bf16 v[60:63], v[146:147], v[112:113], v[60:63]
    v_mfma_f32_16x16x16_bf16 v[96:99], v[148:149], v[40:41], v[96:99]
    v_mfma_f32_16x16x16_bf16 v[64:67], v[148:149], v[36:37], v[64:67]
    v_mfma_f32_16x16x16_bf16 v[100:103], v[148:149], v[114:115], v[100:103]
    v_mfma_f32_16x16x16_bf16 v[68:71], v[148:149], v[112:113], v[68:71]
    v_mfma_f32_16x16x16_bf16 v[104:107], v[150:151], v[40:41], v[104:107]
    v_mfma_f32_16x16x16_bf16 v[72:75], v[150:151], v[36:37], v[72:75]
    v_mfma_f32_16x16x16_bf16 v[108:111], v[150:151], v[114:115], v[108:111]
    v_mfma_f32_16x16x16_bf16 v[76:79], v[150:151], v[112:113], v[76:79]
    v_mul_f32 v48, v48, v7
    v_mul_f32 v49, v49, v7
    v_mul_f32 v50, v50, v7
    v_mul_f32 v51, v51, v7
    v_mul_f32 v52, v52, v7
    v_mul_f32 v53, v53, v7
    v_mul_f32 v54, v54, v7
    v_mul_f32 v55, v55, v7
    v_mul_f32 v56, v56, v7
    v_mul_f32 v57, v57, v7
    v_mul_f32 v58, v58, v7
    v_mul_f32 v59, v59, v7
    v_mul_f32 v60, v60, v7
    v_mul_f32 v61, v61, v7
    v_mul_f32 v62, v62, v7
    v_mul_f32 v63, v63, v7
    v_mul_f32 v64, v64, v7
    v_mul_f32 v65, v65, v7
    v_mul_f32 v66, v66, v7
    v_mul_f32 v67, v67, v7
    v_mul_f32 v68, v68, v7
    v_mul_f32 v69, v69, v7
    v_mul_f32 v70, v70, v7
    v_mul_f32 v71, v71, v7
    v_mul_f32 v72, v72, v7
    v_mul_f32 v73, v73, v7
    v_mul_f32 v74, v74, v7
    v_mul_f32 v75, v75, v7
    v_mul_f32 v76, v76, v7
    v_mul_f32 v77, v77, v7
    v_mul_f32 v78, v78, v7
    v_mul_f32 v79, v79, v7
    v_cvt_pk_bf16_f32 v48, v48, v49
    v_cvt_pk_bf16_f32 v49, v50, v51
    v_cvt_pk_bf16_f32 v50, v52, v53
    v_cvt_pk_bf16_f32 v51, v54, v55
    v_cvt_pk_bf16_f32 v52, v56, v57
    v_cvt_pk_bf16_f32 v53, v58, v59
    v_cvt_pk_bf16_f32 v54, v60, v61
    v_cvt_pk_bf16_f32 v55, v62, v63
    v_cvt_pk_bf16_f32 v56, v64, v65
    v_cvt_pk_bf16_f32 v57, v66, v67
    v_cvt_pk_bf16_f32 v58, v68, v69
    v_cvt_pk_bf16_f32 v59, v70, v71
    v_cvt_pk_bf16_f32 v60, v72, v73
    v_cvt_pk_bf16_f32 v61, v74, v75
    v_cvt_pk_bf16_f32 v62, v76, v77
    v_cvt_pk_bf16_f32 v63, v78, v79
    ds_write_b128 v10, v[48:51] offset:0
    ds_write_b128 v10, v[52:55] offset:1024
    ds_write_b128 v10, v[56:59] offset:2048
    ds_write_b128 v10, v[60:63] offset:3072
    v_mul_f32 v80, v80, v11
    v_mul_f32 v81, v81, v11
    v_mul_f32 v82, v82, v11
    v_mul_f32 v83, v83, v11
    v_mul_f32 v84, v84, v11
    v_mul_f32 v85, v85, v11
    v_mul_f32 v86, v86, v11
    v_mul_f32 v87, v87, v11
    v_mul_f32 v88, v88, v11
    v_mul_f32 v89, v89, v11
    v_mul_f32 v90, v90, v11
    v_mul_f32 v91, v91, v11
    v_mul_f32 v92, v92, v11
    v_mul_f32 v93, v93, v11
    v_mul_f32 v94, v94, v11
    v_mul_f32 v95, v95, v11
    v_mul_f32 v96, v96, v11
    v_mul_f32 v97, v97, v11
    v_mul_f32 v98, v98, v11
    v_mul_f32 v99, v99, v11
    v_mul_f32 v100, v100, v11
    v_mul_f32 v101, v101, v11
    v_mul_f32 v102, v102, v11
    v_mul_f32 v103, v103, v11
    v_mul_f32 v104, v104, v11
    v_mul_f32 v105, v105, v11
    v_mul_f32 v106, v106, v11
    v_mul_f32 v107, v107, v11
    v_mul_f32 v108, v108, v11
    v_mul_f32 v109, v109, v11
    v_mul_f32 v110, v110, v11
    v_mul_f32 v111, v111, v11
    v_cvt_pk_bf16_f32 v80, v80, v81
    v_cvt_pk_bf16_f32 v81, v82, v83
    v_cvt_pk_bf16_f32 v82, v84, v85
    v_cvt_pk_bf16_f32 v83, v86, v87
    v_cvt_pk_bf16_f32 v84, v88, v89
    v_cvt_pk_bf16_f32 v85, v90, v91
    v_cvt_pk_bf16_f32 v86, v92, v93
    v_cvt_pk_bf16_f32 v87, v94, v95
    v_cvt_pk_bf16_f32 v88, v96, v97
    v_cvt_pk_bf16_f32 v89, v98, v99
    v_cvt_pk_bf16_f32 v90, v100, v101
    v_cvt_pk_bf16_f32 v91, v102, v103
    v_cvt_pk_bf16_f32 v92, v104, v105
    v_cvt_pk_bf16_f32 v93, v106, v107
    v_cvt_pk_bf16_f32 v94, v108, v109
    v_cvt_pk_bf16_f32 v95, v110, v111
    ds_write_b128 v10, v[80:83] offset:8192
    ds_write_b128 v10, v[84:87] offset:9216
    ds_write_b128 v10, v[88:91] offset:10240
    ds_write_b128 v10, v[92:95] offset:11264
    s_waitcnt vmcnt(0)
    v_readfirstlane_b32 s54, v116
    s_lshl_b32 s28, s21, 1
    s_add_u32 s28, s28, s48
    s_lshl_b32 s28, s28, 2
    s_add_u32 s28, s28, s49
    s_and_b32 s29, s24, 31
    s_lshl_b32 s29, s29, 7
    s_add_u32 s29, s29, s28
    s_lshl_b32 s29, s29, 9
    v_and_b32 v11, 0x30, v1
    v_and_b32 v14, 0x40, v1
    v_lshl_add_u32 v11, v14, 4, v11
    v_lshrrev_b32 v14, 9, v1
    v_lshl_add_u32 v11, v14, 7, v11
    v_bfe_u32 v14, v1, 7, 1
    v_lshl_add_u32 v11, v14, 6, v11
    v_bfe_u32 v14, v1, 8, 1
    v_lshl_add_u32 v11, v14, 3, v11
    s_cmp_eq_u32 s23, 0
    s_cbranch_scc0 L_bx_53
    buffer_load_dwordx2 v[16:17], v11, s[12:15], s29 offen offset:0
    buffer_load_dwordx2 v[18:19], v11, s[12:15], s29 offen offset:256
    s_branch L_by_54
L_bx_53:
    s_add_u32 s25, s29, 33554432
    buffer_load_dwordx2 v[16:17], v11, s[8:11], s25 offen offset:0 sc1
    buffer_load_dwordx2 v[18:19], v11, s[8:11], s25 offen offset:256 sc1
L_by_54:
    s_waitcnt lgkmcnt(0)
    s_barrier
    s_lshl_b32 s27, s22, 1
    s_and_b32 s25, s33, 1
    s_add_u32 s27, s27, s25
    s_lshl_b32 s27, s27, 21
    s_add_u32 s27, s27, 159383552
    s_lshl_b32 s25, s21, 11
    s_lshl_b32 s26, s20, 9
    s_add_u32 s25, s25, s26
    s_add_u32 s25, s25, s27
    v_add_u32 v13, 0, v1
    ds_read_b128 v[32:35], v13 offset:0
    ds_read_b128 v[36:39], v13 offset:1024
    ds_read_b128 v[40:43], v13 offset:2048
    ds_read_b128 v[44:47], v13 offset:3072
    ds_read_b128 v[48:51], v13 offset:4096
    ds_read_b128 v[52:55], v13 offset:5120
    ds_read_b128 v[56:59], v13 offset:6144
    ds_read_b128 v[60:63], v13 offset:7168
    s_waitcnt lgkmcnt(7)
    v_mfma_f32_16x16x32_bf16 v[96:99], a[0:3], v[32:35], 0
    s_waitcnt lgkmcnt(6)
    v_mfma_f32_16x16x32_bf16 v[96:99], a[4:7], v[36:39], v[96:99]
    s_lshl_b32 s58, s55, 1
    s_add_u32 s58, s58, s48
    s_lshl_b32 s58, s58, 18
    s_add_u32 s59, s58, s50
    s_add_u32 s58, s59, s50
    s_add_u32 s58, s58, 109051904
    s_add_u32 s60, s59, 75497472
    s_add_u32 s59, s59, 41943040
    buffer_load_dwordx4 v[192:195], v1, s[8:11], s58 offen offset:0 sc1
    s_waitcnt lgkmcnt(5)
    v_mfma_f32_16x16x32_bf16 v[96:99], a[8:11], v[40:43], v[96:99]
    s_waitcnt lgkmcnt(4)
    v_mfma_f32_16x16x32_bf16 v[96:99], a[12:15], v[44:47], v[96:99]
    s_waitcnt lgkmcnt(3)
    v_mfma_f32_16x16x32_bf16 v[96:99], a[128:131], v[48:51], v[96:99]
    s_waitcnt lgkmcnt(2)
    v_mfma_f32_16x16x32_bf16 v[96:99], a[132:135], v[52:55], v[96:99]
    s_waitcnt lgkmcnt(1)
    v_mfma_f32_16x16x32_bf16 v[96:99], a[136:139], v[56:59], v[96:99]
    s_waitcnt lgkmcnt(0)
    v_mfma_f32_16x16x32_bf16 v[96:99], a[140:143], v[60:63], v[96:99]
    v_mfma_f32_16x16x32_bf16 v[100:103], a[16:19], v[32:35], 0
    v_mfma_f32_16x16x32_bf16 v[100:103], a[20:23], v[36:39], v[100:103]
    v_mfma_f32_16x16x32_bf16 v[100:103], a[24:27], v[40:43], v[100:103]
    buffer_load_dwordx4 v[196:199], v1, s[8:11], s58 offen offset:1024 sc1
    v_mfma_f32_16x16x32_bf16 v[100:103], a[28:31], v[44:47], v[100:103]
    v_mfma_f32_16x16x32_bf16 v[100:103], a[144:147], v[48:51], v[100:103]
    v_mfma_f32_16x16x32_bf16 v[100:103], a[148:151], v[52:55], v[100:103]
    v_mfma_f32_16x16x32_bf16 v[100:103], a[152:155], v[56:59], v[100:103]
    v_mfma_f32_16x16x32_bf16 v[100:103], a[156:159], v[60:63], v[100:103]
    v_mfma_f32_16x16x32_bf16 v[104:107], a[32:35], v[32:35], 0
    v_mfma_f32_16x16x32_bf16 v[104:107], a[36:39], v[36:39], v[104:107]
    v_mfma_f32_16x16x32_bf16 v[104:107], a[40:43], v[40:43], v[104:107]
    v_mfma_f32_16x16x32_bf16 v[104:107], a[44:47], v[44:47], v[104:107]
    buffer_load_dwordx4 v[200:203], v1, s[8:11], s58 offen offset:2048 sc1
    v_mfma_f32_16x16x32_bf16 v[104:107], a[160:163], v[48:51], v[104:107]
    v_mfma_f32_16x16x32_bf16 v[104:107], a[164:167], v[52:55], v[104:107]
    v_mfma_f32_16x16x32_bf16 v[104:107], a[168:171], v[56:59], v[104:107]
    v_mfma_f32_16x16x32_bf16 v[104:107], a[172:175], v[60:63], v[104:107]
    v_mfma_f32_16x16x32_bf16 v[108:111], a[48:51], v[32:35], 0
    v_mfma_f32_16x16x32_bf16 v[108:111], a[52:55], v[36:39], v[108:111]
    v_mfma_f32_16x16x32_bf16 v[108:111], a[56:59], v[40:43], v[108:111]
    v_mfma_f32_16x16x32_bf16 v[108:111], a[60:63], v[44:47], v[108:111]
    v_mfma_f32_16x16x32_bf16 v[108:111], a[176:179], v[48:51], v[108:111]
    buffer_load_dwordx4 v[204:207], v1, s[8:11], s58 offen offset:3072 sc1
    v_mfma_f32_16x16x32_bf16 v[108:111], a[180:183], v[52:55], v[108:111]
    v_mfma_f32_16x16x32_bf16 v[108:111], a[184:187], v[56:59], v[108:111]
    v_mfma_f32_16x16x32_bf16 v[108:111], a[188:191], v[60:63], v[108:111]
    v_mfma_f32_16x16x32_bf16 v[112:115], a[64:67], v[32:35], 0
    v_mfma_f32_16x16x32_bf16 v[112:115], a[68:71], v[36:39], v[112:115]
    v_mfma_f32_16x16x32_bf16 v[112:115], a[72:75], v[40:43], v[112:115]
    v_mfma_f32_16x16x32_bf16 v[112:115], a[76:79], v[44:47], v[112:115]
    v_mfma_f32_16x16x32_bf16 v[112:115], a[192:195], v[48:51], v[112:115]
    v_mfma_f32_16x16x32_bf16 v[112:115], a[196:199], v[52:55], v[112:115]
    s_add_u32 s58, s58, 4096
    buffer_load_dwordx4 v[208:211], v1, s[8:11], s58 offen offset:0 sc1
    v_mfma_f32_16x16x32_bf16 v[112:115], a[200:203], v[56:59], v[112:115]
    v_mfma_f32_16x16x32_bf16 v[112:115], a[204:207], v[60:63], v[112:115]
    v_mfma_f32_16x16x32_bf16 v[116:119], a[80:83], v[32:35], 0
    ds_read_b128 v[64:67], v13 offset:8192
    v_mfma_f32_16x16x32_bf16 v[116:119], a[84:87], v[36:39], v[116:119]
    ds_read_b128 v[68:71], v13 offset:9216
    v_mfma_f32_16x16x32_bf16 v[116:119], a[88:91], v[40:43], v[116:119]
    ds_read_b128 v[72:75], v13 offset:10240
    v_mfma_f32_16x16x32_bf16 v[116:119], a[92:95], v[44:47], v[116:119]
    ds_read_b128 v[76:79], v13 offset:11264
    v_mfma_f32_16x16x32_bf16 v[116:119], a[208:211], v[48:51], v[116:119]
    ds_read_b128 v[80:83], v13 offset:12288
    v_mfma_f32_16x16x32_bf16 v[116:119], a[212:215], v[52:55], v[116:119]
    ds_read_b128 v[84:87], v13 offset:13312
    v_mfma_f32_16x16x32_bf16 v[116:119], a[216:219], v[56:59], v[116:119]
    ds_read_b128 v[88:91], v13 offset:14336
    buffer_load_dwordx4 v[212:215], v1, s[8:11], s58 offen offset:1024 sc1
    v_mfma_f32_16x16x32_bf16 v[116:119], a[220:223], v[60:63], v[116:119]
    ds_read_b128 v[92:95], v13 offset:15360
    v_mfma_f32_16x16x32_bf16 v[120:123], a[96:99], v[32:35], 0
    v_mfma_f32_16x16x32_bf16 v[120:123], a[100:103], v[36:39], v[120:123]
    v_mfma_f32_16x16x32_bf16 v[120:123], a[104:107], v[40:43], v[120:123]
    v_mfma_f32_16x16x32_bf16 v[120:123], a[108:111], v[44:47], v[120:123]
    v_mfma_f32_16x16x32_bf16 v[120:123], a[224:227], v[48:51], v[120:123]
    v_mfma_f32_16x16x32_bf16 v[120:123], a[228:231], v[52:55], v[120:123]
    v_mfma_f32_16x16x32_bf16 v[120:123], a[232:235], v[56:59], v[120:123]
    v_mfma_f32_16x16x32_bf16 v[120:123], a[236:239], v[60:63], v[120:123]
    buffer_load_dwordx4 v[216:219], v1, s[8:11], s58 offen offset:2048 sc1
    v_mfma_f32_16x16x32_bf16 v[124:127], a[112:115], v[32:35], 0
    v_mfma_f32_16x16x32_bf16 v[124:127], a[116:119], v[36:39], v[124:127]
    v_mfma_f32_16x16x32_bf16 v[124:127], a[120:123], v[40:43], v[124:127]
    v_mfma_f32_16x16x32_bf16 v[124:127], a[124:127], v[44:47], v[124:127]
    v_mfma_f32_16x16x32_bf16 v[124:127], a[240:243], v[48:51], v[124:127]
    v_mfma_f32_16x16x32_bf16 v[124:127], a[244:247], v[52:55], v[124:127]
    v_mfma_f32_16x16x32_bf16 v[124:127], a[248:251], v[56:59], v[124:127]
    v_mfma_f32_16x16x32_bf16 v[124:127], a[252:255], v[60:63], v[124:127]
    s_waitcnt lgkmcnt(0)
    v_mfma_f32_16x16x32_bf16 v[128:131], a[0:3], v[64:67], 0
    buffer_load_dwordx4 v[220:223], v1, s[8:11], s58 offen offset:3072 sc1
    v_mfma_f32_16x16x32_bf16 v[128:131], a[4:7], v[68:71], v[128:131]
    v_mfma_f32_16x16x32_bf16 v[128:131], a[8:11], v[72:75], v[128:131]
    v_cvt_pk_bf16_f32 v96, v96, v97
    v_mfma_f32_16x16x32_bf16 v[128:131], a[12:15], v[76:79], v[128:131]
    v_cvt_pk_bf16_f32 v97, v98, v99
    v_mfma_f32_16x16x32_bf16 v[128:131], a[128:131], v[80:83], v[128:131]
    v_cvt_pk_bf16_f32 v98, v100, v101
    v_mfma_f32_16x16x32_bf16 v[128:131], a[132:135], v[84:87], v[128:131]
    v_cvt_pk_bf16_f32 v99, v102, v103
    v_mfma_f32_16x16x32_bf16 v[128:131], a[136:139], v[88:91], v[128:131]
    buffer_store_dwordx4 v[96:99], v12, s[8:11], s25 offen offset:0
    v_mfma_f32_16x16x32_bf16 v[128:131], a[140:143], v[92:95], v[128:131]
    v_cvt_pk_bf16_f32 v104, v104, v105
    v_mfma_f32_16x16x32_bf16 v[132:135], a[16:19], v[64:67], 0
    v_cvt_pk_bf16_f32 v105, v106, v107
    v_mfma_f32_16x16x32_bf16 v[132:135], a[20:23], v[68:71], v[132:135]
    v_cvt_pk_bf16_f32 v106, v108, v109
    buffer_load_dwordx4 v[160:163], v1, s[8:11], s60 offen offset:0 sc1
    v_mfma_f32_16x16x32_bf16 v[132:135], a[24:27], v[72:75], v[132:135]
    v_cvt_pk_bf16_f32 v107, v110, v111
    v_mfma_f32_16x16x32_bf16 v[132:135], a[28:31], v[76:79], v[132:135]
    buffer_store_dwordx4 v[104:107], v12, s[8:11], s25 offen offset:128
    v_mfma_f32_16x16x32_bf16 v[132:135], a[144:147], v[80:83], v[132:135]
    v_cvt_pk_bf16_f32 v112, v112, v113
    v_mfma_f32_16x16x32_bf16 v[132:135], a[148:151], v[84:87], v[132:135]
    v_cvt_pk_bf16_f32 v113, v114, v115
    v_mfma_f32_16x16x32_bf16 v[132:135], a[152:155], v[88:91], v[132:135]
    v_cvt_pk_bf16_f32 v114, v116, v117
    v_mfma_f32_16x16x32_bf16 v[132:135], a[156:159], v[92:95], v[132:135]
    v_cvt_pk_bf16_f32 v115, v118, v119
    v_mfma_f32_16x16x32_bf16 v[136:139], a[32:35], v[64:67], 0
    buffer_store_dwordx4 v[112:115], v12, s[8:11], s25 offen offset:256
    v_mfma_f32_16x16x32_bf16 v[136:139], a[36:39], v[68:71], v[136:139]
    v_cvt_pk_bf16_f32 v120, v120, v121
    v_mfma_f32_16x16x32_bf16 v[136:139], a[40:43], v[72:75], v[136:139]
    v_cvt_pk_bf16_f32 v121, v122, v123
    buffer_load_dwordx4 v[164:167], v1, s[8:11], s60 offen offset:1024 sc1
    v_mfma_f32_16x16x32_bf16 v[136:139], a[44:47], v[76:79], v[136:139]
    v_cvt_pk_bf16_f32 v122, v124, v125
    v_mfma_f32_16x16x32_bf16 v[136:139], a[160:163], v[80:83], v[136:139]
    v_cvt_pk_bf16_f32 v123, v126, v127
    v_mfma_f32_16x16x32_bf16 v[136:139], a[164:167], v[84:87], v[136:139]
    buffer_store_dwordx4 v[120:123], v12, s[8:11], s25 offen offset:384
    v_mfma_f32_16x16x32_bf16 v[136:139], a[168:171], v[88:91], v[136:139]
    s_add_u32 s25, s25, 264192
    v_mfma_f32_16x16x32_bf16 v[136:139], a[172:175], v[92:95], v[136:139]
    v_mfma_f32_16x16x32_bf16 v[140:143], a[48:51], v[64:67], 0
    v_mfma_f32_16x16x32_bf16 v[140:143], a[52:55], v[68:71], v[140:143]
    v_mfma_f32_16x16x32_bf16 v[140:143], a[56:59], v[72:75], v[140:143]
    v_mfma_f32_16x16x32_bf16 v[140:143], a[60:63], v[76:79], v[140:143]
    buffer_load_dwordx4 v[168:171], v1, s[8:11], s60 offen offset:2048 sc1
    v_mfma_f32_16x16x32_bf16 v[140:143], a[176:179], v[80:83], v[140:143]
    v_mfma_f32_16x16x32_bf16 v[140:143], a[180:183], v[84:87], v[140:143]
    v_mfma_f32_16x16x32_bf16 v[140:143], a[184:187], v[88:91], v[140:143]
    v_mfma_f32_16x16x32_bf16 v[140:143], a[188:191], v[92:95], v[140:143]
    v_mfma_f32_16x16x32_bf16 v[144:147], a[64:67], v[64:67], 0
    v_mfma_f32_16x16x32_bf16 v[144:147], a[68:71], v[68:71], v[144:147]
    v_mfma_f32_16x16x32_bf16 v[144:147], a[72:75], v[72:75], v[144:147]
    v_mfma_f32_16x16x32_bf16 v[144:147], a[76:79], v[76:79], v[144:147]
    v_mfma_f32_16x16x32_bf16 v[144:147], a[192:195], v[80:83], v[144:147]
    buffer_load_dwordx4 v[172:175], v1, s[8:11], s60 offen offset:3072 sc1
    v_mfma_f32_16x16x32_bf16 v[144:147], a[196:199], v[84:87], v[144:147]
    v_mfma_f32_16x16x32_bf16 v[144:147], a[200:203], v[88:91], v[144:147]
    v_mfma_f32_16x16x32_bf16 v[144:147], a[204:207], v[92:95], v[144:147]
    v_mfma_f32_16x16x32_bf16 v[148:151], a[80:83], v[64:67], 0
    ds_read_b128 v[32:35], v13 offset:16384
    v_mfma_f32_16x16x32_bf16 v[148:151], a[84:87], v[68:71], v[148:151]
    ds_read_b128 v[36:39], v13 offset:17408
    v_mfma_f32_16x16x32_bf16 v[148:151], a[88:91], v[72:75], v[148:151]
    ds_read_b128 v[40:43], v13 offset:18432
    v_mfma_f32_16x16x32_bf16 v[148:151], a[92:95], v[76:79], v[148:151]
    ds_read_b128 v[44:47], v13 offset:19456
    v_mfma_f32_16x16x32_bf16 v[148:151], a[208:211], v[80:83], v[148:151]
    ds_read_b128 v[48:51], v13 offset:20480
    v_mfma_f32_16x16x32_bf16 v[148:151], a[212:215], v[84:87], v[148:151]
    ds_read_b128 v[52:55], v13 offset:21504
    s_add_u32 s60, s60, 131072
    buffer_load_dwordx4 v[176:179], v1, s[8:11], s60 offen offset:0 sc1
    v_mfma_f32_16x16x32_bf16 v[148:151], a[216:219], v[88:91], v[148:151]
    ds_read_b128 v[56:59], v13 offset:22528
    v_mfma_f32_16x16x32_bf16 v[148:151], a[220:223], v[92:95], v[148:151]
    ds_read_b128 v[60:63], v13 offset:23552
    v_mfma_f32_16x16x32_bf16 v[152:155], a[96:99], v[64:67], 0
    v_mfma_f32_16x16x32_bf16 v[152:155], a[100:103], v[68:71], v[152:155]
    v_mfma_f32_16x16x32_bf16 v[152:155], a[104:107], v[72:75], v[152:155]
    v_mfma_f32_16x16x32_bf16 v[152:155], a[108:111], v[76:79], v[152:155]
    v_mfma_f32_16x16x32_bf16 v[152:155], a[224:227], v[80:83], v[152:155]
    v_mfma_f32_16x16x32_bf16 v[152:155], a[228:231], v[84:87], v[152:155]
    v_mfma_f32_16x16x32_bf16 v[152:155], a[232:235], v[88:91], v[152:155]
    buffer_load_dwordx4 v[180:183], v1, s[8:11], s60 offen offset:1024 sc1
    v_mfma_f32_16x16x32_bf16 v[152:155], a[236:239], v[92:95], v[152:155]
    v_mfma_f32_16x16x32_bf16 v[156:159], a[112:115], v[64:67], 0
    v_mfma_f32_16x16x32_bf16 v[156:159], a[116:119], v[68:71], v[156:159]
    v_mfma_f32_16x16x32_bf16 v[156:159], a[120:123], v[72:75], v[156:159]
    v_mfma_f32_16x16x32_bf16 v[156:159], a[124:127], v[76:79], v[156:159]
    v_mfma_f32_16x16x32_bf16 v[156:159], a[240:243], v[80:83], v[156:159]
    v_mfma_f32_16x16x32_bf16 v[156:159], a[244:247], v[84:87], v[156:159]
    v_mfma_f32_16x16x32_bf16 v[156:159], a[248:251], v[88:91], v[156:159]
    v_mfma_f32_16x16x32_bf16 v[156:159], a[252:255], v[92:95], v[156:159]
    buffer_load_dwordx4 v[184:187], v1, s[8:11], s60 offen offset:2048 sc1
    s_waitcnt lgkmcnt(0)
    v_mfma_f32_16x16x32_bf16 v[96:99], a[0:3], v[32:35], 0
    v_mfma_f32_16x16x32_bf16 v[96:99], a[4:7], v[36:39], v[96:99]
    v_mfma_f32_16x16x32_bf16 v[96:99], a[8:11], v[40:43], v[96:99]
    v_cvt_pk_bf16_f32 v128, v128, v129
    v_mfma_f32_16x16x32_bf16 v[96:99], a[12:15], v[44:47], v[96:99]
    v_cvt_pk_bf16_f32 v129, v130, v131
    v_mfma_f32_16x16x32_bf16 v[96:99], a[128:131], v[48:51], v[96:99]
    v_cvt_pk_bf16_f32 v130, v132, v133
    v_mfma_f32_16x16x32_bf16 v[96:99], a[132:135], v[52:55], v[96:99]
    v_cvt_pk_bf16_f32 v131, v134, v135
    v_mfma_f32_16x16x32_bf16 v[96:99], a[136:139], v[56:59], v[96:99]
    buffer_store_dwordx4 v[128:131], v12, s[8:11], s25 offen offset:0
    v_mfma_f32_16x16x32_bf16 v[96:99], a[140:143], v[60:63], v[96:99]
    v_cvt_pk_bf16_f32 v136, v136, v137
    v_mfma_f32_16x16x32_bf16 v[100:103], a[16:19], v[32:35], 0
    v_cvt_pk_bf16_f32 v137, v138, v139
    buffer_load_dwordx4 v[188:191], v1, s[8:11], s60 offen offset:3072 sc1
    v_mfma_f32_16x16x32_bf16 v[100:103], a[20:23], v[36:39], v[100:103]
    v_cvt_pk_bf16_f32 v138, v140, v141
    v_mfma_f32_16x16x32_bf16 v[100:103], a[24:27], v[40:43], v[100:103]
    v_cvt_pk_bf16_f32 v139, v142, v143
    v_mfma_f32_16x16x32_bf16 v[100:103], a[28:31], v[44:47], v[100:103]
    buffer_store_dwordx4 v[136:139], v12, s[8:11], s25 offen offset:128
    v_mfma_f32_16x16x32_bf16 v[100:103], a[144:147], v[48:51], v[100:103]
    v_cvt_pk_bf16_f32 v144, v144, v145
    v_mfma_f32_16x16x32_bf16 v[100:103], a[148:151], v[52:55], v[100:103]
    v_cvt_pk_bf16_f32 v145, v146, v147
    v_mfma_f32_16x16x32_bf16 v[100:103], a[152:155], v[56:59], v[100:103]
    v_cvt_pk_bf16_f32 v146, v148, v149
    v_mfma_f32_16x16x32_bf16 v[100:103], a[156:159], v[60:63], v[100:103]
    v_cvt_pk_bf16_f32 v147, v150, v151
    v_mfma_f32_16x16x32_bf16 v[104:107], a[32:35], v[32:35], 0
    buffer_store_dwordx4 v[144:147], v12, s[8:11], s25 offen offset:256
    v_mfma_f32_16x16x32_bf16 v[104:107], a[36:39], v[36:39], v[104:107]
    v_cvt_pk_bf16_f32 v152, v152, v153
    buffer_load_dwordx4 v[224:227], v1, s[8:11], s59 offen offset:0 sc1
    v_mfma_f32_16x16x32_bf16 v[104:107], a[40:43], v[40:43], v[104:107]
    v_cvt_pk_bf16_f32 v153, v154, v155
    v_mfma_f32_16x16x32_bf16 v[104:107], a[44:47], v[44:47], v[104:107]
    v_cvt_pk_bf16_f32 v154, v156, v157
    v_mfma_f32_16x16x32_bf16 v[104:107], a[160:163], v[48:51], v[104:107]
    v_cvt_pk_bf16_f32 v155, v158, v159
    v_mfma_f32_16x16x32_bf16 v[104:107], a[164:167], v[52:55], v[104:107]
    buffer_store_dwordx4 v[152:155], v12, s[8:11], s25 offen offset:384
    v_mfma_f32_16x16x32_bf16 v[104:107], a[168:171], v[56:59], v[104:107]
    s_add_u32 s25, s25, 264192
    v_mfma_f32_16x16x32_bf16 v[104:107], a[172:175], v[60:63], v[104:107]
    v_mfma_f32_16x16x32_bf16 v[108:111], a[48:51], v[32:35], 0
    v_mfma_f32_16x16x32_bf16 v[108:111], a[52:55], v[36:39], v[108:111]
    v_mfma_f32_16x16x32_bf16 v[108:111], a[56:59], v[40:43], v[108:111]
    buffer_load_dwordx4 v[228:231], v1, s[8:11], s59 offen offset:1024 sc1
    v_mfma_f32_16x16x32_bf16 v[108:111], a[60:63], v[44:47], v[108:111]
    v_mfma_f32_16x16x32_bf16 v[108:111], a[176:179], v[48:51], v[108:111]
    v_mfma_f32_16x16x32_bf16 v[108:111], a[180:183], v[52:55], v[108:111]
    v_mfma_f32_16x16x32_bf16 v[108:111], a[184:187], v[56:59], v[108:111]
    v_mfma_f32_16x16x32_bf16 v[108:111], a[188:191], v[60:63], v[108:111]
    v_mfma_f32_16x16x32_bf16 v[112:115], a[64:67], v[32:35], 0
    v_mfma_f32_16x16x32_bf16 v[112:115], a[68:71], v[36:39], v[112:115]
    v_mfma_f32_16x16x32_bf16 v[112:115], a[72:75], v[40:43], v[112:115]
    v_mfma_f32_16x16x32_bf16 v[112:115], a[76:79], v[44:47], v[112:115]
    buffer_load_dwordx4 v[232:235], v1, s[8:11], s59 offen offset:2048 sc1
    v_mfma_f32_16x16x32_bf16 v[112:115], a[192:195], v[48:51], v[112:115]
    v_mfma_f32_16x16x32_bf16 v[112:115], a[196:199], v[52:55], v[112:115]
    v_mfma_f32_16x16x32_bf16 v[112:115], a[200:203], v[56:59], v[112:115]
    v_mfma_f32_16x16x32_bf16 v[112:115], a[204:207], v[60:63], v[112:115]
    v_mfma_f32_16x16x32_bf16 v[116:119], a[80:83], v[32:35], 0
    ds_read_b128 v[64:67], v13 offset:24576
    v_mfma_f32_16x16x32_bf16 v[116:119], a[84:87], v[36:39], v[116:119]
    ds_read_b128 v[68:71], v13 offset:25600
    v_mfma_f32_16x16x32_bf16 v[116:119], a[88:91], v[40:43], v[116:119]
    ds_read_b128 v[72:75], v13 offset:26624
    v_mfma_f32_16x16x32_bf16 v[116:119], a[92:95], v[44:47], v[116:119]
    ds_read_b128 v[76:79], v13 offset:27648
    v_mfma_f32_16x16x32_bf16 v[116:119], a[208:211], v[48:51], v[116:119]
    ds_read_b128 v[80:83], v13 offset:28672
    buffer_load_dwordx4 v[236:239], v1, s[8:11], s59 offen offset:3072 sc1
    v_mfma_f32_16x16x32_bf16 v[116:119], a[212:215], v[52:55], v[116:119]
    ds_read_b128 v[84:87], v13 offset:29696
    v_mfma_f32_16x16x32_bf16 v[116:119], a[216:219], v[56:59], v[116:119]
    ds_read_b128 v[88:91], v13 offset:30720
    v_mfma_f32_16x16x32_bf16 v[116:119], a[220:223], v[60:63], v[116:119]
    ds_read_b128 v[92:95], v13 offset:31744
    v_mfma_f32_16x16x32_bf16 v[120:123], a[96:99], v[32:35], 0
    v_mfma_f32_16x16x32_bf16 v[120:123], a[100:103], v[36:39], v[120:123]
    v_mfma_f32_16x16x32_bf16 v[120:123], a[104:107], v[40:43], v[120:123]
    v_mfma_f32_16x16x32_bf16 v[120:123], a[108:111], v[44:47], v[120:123]
    v_mfma_f32_16x16x32_bf16 v[120:123], a[224:227], v[48:51], v[120:123]
    v_mfma_f32_16x16x32_bf16 v[120:123], a[228:231], v[52:55], v[120:123]
    s_add_u32 s59, s59, 131072
    buffer_load_dwordx4 v[240:243], v1, s[8:11], s59 offen offset:0 sc1
    v_mfma_f32_16x16x32_bf16 v[120:123], a[232:235], v[56:59], v[120:123]
    v_mfma_f32_16x16x32_bf16 v[120:123], a[236:239], v[60:63], v[120:123]
    v_mfma_f32_16x16x32_bf16 v[124:127], a[112:115], v[32:35], 0
    v_mfma_f32_16x16x32_bf16 v[124:127], a[116:119], v[36:39], v[124:127]
    v_mfma_f32_16x16x32_bf16 v[124:127], a[120:123], v[40:43], v[124:127]
    v_mfma_f32_16x16x32_bf16 v[124:127], a[124:127], v[44:47], v[124:127]
    v_mfma_f32_16x16x32_bf16 v[124:127], a[240:243], v[48:51], v[124:127]
    v_mfma_f32_16x16x32_bf16 v[124:127], a[244:247], v[52:55], v[124:127]
    v_mfma_f32_16x16x32_bf16 v[124:127], a[248:251], v[56:59], v[124:127]
    buffer_load_dwordx4 v[244:247], v1, s[8:11], s59 offen offset:1024 sc1
    v_mfma_f32_16x16x32_bf16 v[124:127], a[252:255], v[60:63], v[124:127]
    s_waitcnt lgkmcnt(0)
    v_mfma_f32_16x16x32_bf16 v[128:131], a[0:3], v[64:67], 0
    v_mfma_f32_16x16x32_bf16 v[128:131], a[4:7], v[68:71], v[128:131]
    v_mfma_f32_16x16x32_bf16 v[128:131], a[8:11], v[72:75], v[128:131]
    v_cvt_pk_bf16_f32 v96, v96, v97
    v_mfma_f32_16x16x32_bf16 v[128:131], a[12:15], v[76:79], v[128:131]
    v_cvt_pk_bf16_f32 v97, v98, v99
    v_mfma_f32_16x16x32_bf16 v[128:131], a[128:131], v[80:83], v[128:131]
    v_cvt_pk_bf16_f32 v98, v100, v101
    v_mfma_f32_16x16x32_bf16 v[128:131], a[132:135], v[84:87], v[128:131]
    v_cvt_pk_bf16_f32 v99, v102, v103
    v_mfma_f32_16x16x32_bf16 v[128:131], a[136:139], v[88:91], v[128:131]
    buffer_store_dwordx4 v[96:99], v12, s[8:11], s25 offen offset:0
    v_mfma_f32_16x16x32_bf16 v[128:131], a[140:143], v[92:95], v[128:131]
    v_cvt_pk_bf16_f32 v104, v104, v105
    buffer_load_dwordx4 v[248:251], v1, s[8:11], s59 offen offset:2048 sc1
    v_mfma_f32_16x16x32_bf16 v[132:135], a[16:19], v[64:67], 0
    v_cvt_pk_bf16_f32 v105, v106, v107
    v_mfma_f32_16x16x32_bf16 v[132:135], a[20:23], v[68:71], v[132:135]
    v_cvt_pk_bf16_f32 v106, v108, v109
    v_mfma_f32_16x16x32_bf16 v[132:135], a[24:27], v[72:75], v[132:135]
    v_cvt_pk_bf16_f32 v107, v110, v111
    v_mfma_f32_16x16x32_bf16 v[132:135], a[28:31], v[76:79], v[132:135]
    buffer_store_dwordx4 v[104:107], v12, s[8:11], s25 offen offset:128
    v_mfma_f32_16x16x32_bf16 v[132:135], a[144:147], v[80:83], v[132:135]
    v_cvt_pk_bf16_f32 v112, v112, v113
    v_mfma_f32_16x16x32_bf16 v[132:135], a[148:151], v[84:87], v[132:135]
    v_cvt_pk_bf16_f32 v113, v114, v115
    v_mfma_f32_16x16x32_bf16 v[132:135], a[152:155], v[88:91], v[132:135]
    v_cvt_pk_bf16_f32 v114, v116, v117
    v_mfma_f32_16x16x32_bf16 v[132:135], a[156:159], v[92:95], v[132:135]
    v_cvt_pk_bf16_f32 v115, v118, v119
    v_mfma_f32_16x16x32_bf16 v[136:139], a[32:35], v[64:67], 0
    buffer_store_dwordx4 v[112:115], v12, s[8:11], s25 offen offset:256
    buffer_load_dwordx4 v[252:255], v1, s[8:11], s59 offen offset:3072 sc1
    v_mfma_f32_16x16x32_bf16 v[136:139], a[36:39], v[68:71], v[136:139]
    v_cvt_pk_bf16_f32 v120, v120, v121
    v_mfma_f32_16x16x32_bf16 v[136:139], a[40:43], v[72:75], v[136:139]
    v_cvt_pk_bf16_f32 v121, v122, v123
    v_mfma_f32_16x16x32_bf16 v[136:139], a[44:47], v[76:79], v[136:139]
    v_cvt_pk_bf16_f32 v122, v124, v125
    v_mfma_f32_16x16x32_bf16 v[136:139], a[160:163], v[80:83], v[136:139]
    v_cvt_pk_bf16_f32 v123, v126, v127
    v_mfma_f32_16x16x32_bf16 v[136:139], a[164:167], v[84:87], v[136:139]
    buffer_store_dwordx4 v[120:123], v12, s[8:11], s25 offen offset:384
    v_mfma_f32_16x16x32_bf16 v[136:139], a[168:171], v[88:91], v[136:139]
    s_add_u32 s25, s25, 264192
    v_mfma_f32_16x16x32_bf16 v[136:139], a[172:175], v[92:95], v[136:139]
    v_mfma_f32_16x16x32_bf16 v[140:143], a[48:51], v[64:67], 0
    v_mfma_f32_16x16x32_bf16 v[140:143], a[52:55], v[68:71], v[140:143]
    v_mfma_f32_16x16x32_bf16 v[140:143], a[56:59], v[72:75], v[140:143]
    v_mfma_f32_16x16x32_bf16 v[140:143], a[60:63], v[76:79], v[140:143]
    v_cvt_pk_bf16_f32 v128, v128, v129
    v_mfma_f32_16x16x32_bf16 v[140:143], a[176:179], v[80:83], v[140:143]
    v_cvt_pk_bf16_f32 v129, v130, v131
    v_mfma_f32_16x16x32_bf16 v[140:143], a[180:183], v[84:87], v[140:143]
    v_cvt_pk_bf16_f32 v130, v132, v133
    v_mfma_f32_16x16x32_bf16 v[140:143], a[184:187], v[88:91], v[140:143]
    v_cvt_pk_bf16_f32 v131, v134, v135
    v_mfma_f32_16x16x32_bf16 v[140:143], a[188:191], v[92:95], v[140:143]
    buffer_store_dwordx4 v[128:131], v12, s[8:11], s25 offen offset:0
    v_mfma_f32_16x16x32_bf16 v[144:147], a[64:67], v[64:67], 0
    v_mfma_f32_16x16x32_bf16 v[144:147], a[68:71], v[68:71], v[144:147]
    v_mfma_f32_16x16x32_bf16 v[144:147], a[72:75], v[72:75], v[144:147]
    v_mfma_f32_16x16x32_bf16 v[144:147], a[76:79], v[76:79], v[144:147]
    v_cvt_pk_bf16_f32 v136, v136, v137
    v_mfma_f32_16x16x32_bf16 v[144:147], a[192:195], v[80:83], v[144:147]
    v_cvt_pk_bf16_f32 v137, v138, v139
    v_mfma_f32_16x16x32_bf16 v[144:147], a[196:199], v[84:87], v[144:147]
    v_cvt_pk_bf16_f32 v138, v140, v141
    v_mfma_f32_16x16x32_bf16 v[144:147], a[200:203], v[88:91], v[144:147]
    v_cvt_pk_bf16_f32 v139, v142, v143
    v_mfma_f32_16x16x32_bf16 v[144:147], a[204:207], v[92:95], v[144:147]
    buffer_store_dwordx4 v[136:139], v12, s[8:11], s25 offen offset:128
    v_mfma_f32_16x16x32_bf16 v[148:151], a[80:83], v[64:67], 0
    v_mfma_f32_16x16x32_bf16 v[148:151], a[84:87], v[68:71], v[148:151]
    v_mfma_f32_16x16x32_bf16 v[148:151], a[88:91], v[72:75], v[148:151]
    v_mfma_f32_16x16x32_bf16 v[148:151], a[92:95], v[76:79], v[148:151]
    v_mfma_f32_16x16x32_bf16 v[148:151], a[208:211], v[80:83], v[148:151]
    v_mfma_f32_16x16x32_bf16 v[148:151], a[212:215], v[84:87], v[148:151]
    v_mfma_f32_16x16x32_bf16 v[148:151], a[216:219], v[88:91], v[148:151]
    v_mfma_f32_16x16x32_bf16 v[148:151], a[220:223], v[92:95], v[148:151]
    v_mfma_f32_16x16x32_bf16 v[152:155], a[96:99], v[64:67], 0
    v_mfma_f32_16x16x32_bf16 v[152:155], a[100:103], v[68:71], v[152:155]
    v_mfma_f32_16x16x32_bf16 v[152:155], a[104:107], v[72:75], v[152:155]
    v_mfma_f32_16x16x32_bf16 v[152:155], a[108:111], v[76:79], v[152:155]
    v_cvt_pk_bf16_f32 v144, v144, v145
    v_mfma_f32_16x16x32_bf16 v[152:155], a[224:227], v[80:83], v[152:155]
    v_cvt_pk_bf16_f32 v145, v146, v147
    v_mfma_f32_16x16x32_bf16 v[152:155], a[228:231], v[84:87], v[152:155]
    v_cvt_pk_bf16_f32 v146, v148, v149
    v_mfma_f32_16x16x32_bf16 v[152:155], a[232:235], v[88:91], v[152:155]
    v_cvt_pk_bf16_f32 v147, v150, v151
    v_mfma_f32_16x16x32_bf16 v[152:155], a[236:239], v[92:95], v[152:155]
    buffer_store_dwordx4 v[144:147], v12, s[8:11], s25 offen offset:256
    v_mfma_f32_16x16x32_bf16 v[156:159], a[112:115], v[64:67], 0
    v_mfma_f32_16x16x32_bf16 v[156:159], a[116:119], v[68:71], v[156:159]
    v_mfma_f32_16x16x32_bf16 v[156:159], a[120:123], v[72:75], v[156:159]
    v_mfma_f32_16x16x32_bf16 v[156:159], a[124:127], v[76:79], v[156:159]
    v_mfma_f32_16x16x32_bf16 v[156:159], a[240:243], v[80:83], v[156:159]
    v_mfma_f32_16x16x32_bf16 v[156:159], a[244:247], v[84:87], v[156:159]
    v_mfma_f32_16x16x32_bf16 v[156:159], a[248:251], v[88:91], v[156:159]
    v_mfma_f32_16x16x32_bf16 v[156:159], a[252:255], v[92:95], v[156:159]
    v_cvt_pk_bf16_f32 v152, v152, v153
    v_cvt_pk_bf16_f32 v153, v154, v155
    s_nop 5
    v_cvt_pk_bf16_f32 v154, v156, v157
    v_cvt_pk_bf16_f32 v155, v158, v159
    buffer_store_dwordx4 v[152:155], v12, s[8:11], s25 offen offset:384
    s_add_u32 s25, s25, 264192
    s_andn2_b32 s25, s52, 0x4000
    s_add_u32 s27, s27, s25
    s_lshr_b32 s25, s25, 7
    s_add_u32 s27, s27, s25
    s_lshl_b32 s25, s49, 10
    s_add_u32 s27, s27, s25
    s_mov_b32 s26, 35782656
    s_mul_i32 s35, s55, 1024
    s_add_u32 s26, s26, s35
    s_mul_i32 s35, s21, 64
    s_add_u32 s26, s26, s35
    s_add_u32 s34, s33, 1
    v_mov_b32 v4, s34
    v_lshrrev_b32 v13, 2, v1
    v_and_b32 v13, 255, v13
    s_waitcnt vmcnt(0)
    buffer_store_dword v4, v2, s[8:11], s57 offen
    v_and_b32 v56, 1, v5
    v_lshlrev_b32 v56, 4, v56
    v_mov_b32 v57, 0x3f80
    v_lshlrev_b32 v56, v56, v57
    v_lshrrev_b32 v57, 1, v5
    v_lshlrev_b32 v58, 4, v5
    v_lshl_add_u32 v58, v6, 11, v58
    v_cmp_eq_u32 vcc, 0, v57
    s_nop 1
    v_cndmask_b32 v24, 0, v56, vcc
    v_cmp_eq_u32 vcc, 1, v57
    s_nop 1
    v_cndmask_b32 v25, 0, v56, vcc
    v_cmp_eq_u32 vcc, 2, v57
    s_nop 1
    v_cndmask_b32 v26, 0, v56, vcc
    v_cmp_eq_u32 vcc, 3, v57
    s_nop 1
    v_cndmask_b32 v27, 0, v56, vcc
    v_cmp_eq_u32 vcc, 4, v57
    s_nop 1
    v_cndmask_b32 v28, 0, v56, vcc
    v_cmp_eq_u32 vcc, 5, v57
    s_nop 1
    v_cndmask_b32 v29, 0, v56, vcc
    v_cmp_eq_u32 vcc, 6, v57
    s_nop 1
    v_cndmask_b32 v30, 0, v56, vcc
    v_cmp_eq_u32 vcc, 7, v57
    s_nop 1
    v_cndmask_b32 v31, 0, v56, vcc
L_pp_55:
    buffer_load_dword v4, v13, s[8:11], s56 offen sc1
    s_sub_u32 s30, s30, 1
    s_cbranch_scc1 M_done
    s_waitcnt vmcnt(0)
    v_cmp_gt_u32 vcc, s34, v4
    s_nop 0
    s_cbranch_vccnz L_pp_55
    buffer_load_dwordx4 v[64:67], v58, s[8:11], s27 offen offset:0 sc1
    buffer_load_dwordx4 v[68:71], v58, s[8:11], s27 offen offset:256 sc1
    buffer_load_dwordx4 v[72:75], v58, s[8:11], s27 offen offset:512 sc1
    buffer_load_dwordx4 v[76:79], v58, s[8:11], s27 offen offset:768 sc1
    s_add_u32 s27, s27, 8192
    buffer_load_dwordx4 v[80:83], v58, s[8:11], s27 offen offset:0 sc1
    buffer_load_dwordx4 v[84:87], v58, s[8:11], s27 offen offset:256 sc1
    buffer_load_dwordx4 v[88:91], v58, s[8:11], s27 offen offset:512 sc1
    buffer_load_dwordx4 v[92:95], v58, s[8:11], s27 offen offset:768 sc1
    s_add_u32 s27, s27, 8192
    buffer_load_dwordx4 v[96:99], v58, s[8:11], s27 offen offset:0 sc1
    buffer_load_dwordx4 v[100:103], v58, s[8:11], s27 offen offset:256 sc1
    buffer_load_dwordx4 v[104:107], v58, s[8:11], s27 offen offset:512 sc1
    buffer_load_dwordx4 v[108:111], v58, s[8:11], s27 offen offset:768 sc1
    s_add_u32 s27, s27, 8192
    buffer_load_dwordx4 v[112:115], v58, s[8:11], s27 offen offset:0 sc1
    buffer_load_dwordx4 v[116:119], v58, s[8:11], s27 offen offset:256 sc1
    buffer_load_dwordx4 v[120:123], v58, s[8:11], s27 offen offset:512 sc1
    buffer_load_dwordx4 v[124:127], v58, s[8:11], s27 offen offset:768 sc1
    s_add_u32 s27, s27, 8192
    buffer_load_dword v14, v2, s[8:11], s26 offen sc1
    s_waitcnt vmcnt(16)
    v_mfma_f32_16x16x32_bf16 v[32:35], v[24:27], v[64:67], 0
    s_waitcnt vmcnt(15)
    v_mfma_f32_16x16x32_bf16 v[32:35], v[28:31], v[68:71], v[32:35]
    s_waitcnt vmcnt(14)
    v_mfma_f32_16x16x32_bf16 v[36:39], v[24:27], v[72:75], 0
    s_waitcnt vmcnt(13)
    v_mfma_f32_16x16x32_bf16 v[36:39], v[28:31], v[76:79], v[36:39]
    s_waitcnt vmcnt(12)
    v_mfma_f32_16x16x32_bf16 v[32:35], v[24:27], v[80:83], v[32:35]
    s_waitcnt vmcnt(11)
    v_mfma_f32_16x16x32_bf16 v[32:35], v[28:31], v[84:87], v[32:35]
    s_waitcnt vmcnt(10)
    v_mfma_f32_16x16x32_bf16 v[36:39], v[24:27], v[88:91], v[36:39]
    s_waitcnt vmcnt(9)
    v_mfma_f32_16x16x32_bf16 v[36:39], v[28:31], v[92:95], v[36:39]
    s_waitcnt vmcnt(8)
    v_mfma_f32_16x16x32_bf16 v[32:35], v[24:27], v[96:99], v[32:35]
    s_waitcnt vmcnt(7)
    v_mfma_f32_16x16x32_bf16 v[32:35], v[28:31], v[100:103], v[32:35]
    s_waitcnt vmcnt(6)
    v_mfma_f32_16x16x32_bf16 v[36:39], v[24:27], v[104:107], v[36:39]
    s_waitcnt vmcnt(5)
    v_mfma_f32_16x16x32_bf16 v[36:39], v[28:31], v[108:111], v[36:39]
    s_waitcnt vmcnt(4)
    v_mfma_f32_16x16x32_bf16 v[32:35], v[24:27], v[112:115], v[32:35]
    s_waitcnt vmcnt(3)
    v_mfma_f32_16x16x32_bf16 v[32:35], v[28:31], v[116:119], v[32:35]
    s_waitcnt vmcnt(2)
    v_mfma_f32_16x16x32_bf16 v[36:39], v[24:27], v[120:123], v[36:39]
    s_waitcnt vmcnt(1)
    v_mfma_f32_16x16x32_bf16 v[36:39], v[28:31], v[124:127], v[36:39]
    v_cvt_pk_bf16_f32 v64, v32, v33
    v_cvt_pk_bf16_f32 v65, v34, v35
    s_nop 5
    v_cvt_pk_bf16_f32 v66, v36, v37
    v_cvt_pk_bf16_f32 v67, v38, v39
    v_lshlrev_b32 v32, 16, v64
    v_and_b32 v33, 0xffff0000, v64
    v_lshlrev_b32 v34, 16, v65
    v_and_b32 v35, 0xffff0000, v65
    v_lshlrev_b32 v36, 16, v66
    v_and_b32 v37, 0xffff0000, v66
    v_lshlrev_b32 v38, 16, v67
    v_and_b32 v39, 0xffff0000, v67
    v_lshlrev_b32 v40, 16, v16
    v_and_b32 v41, 0xffff0000, v16
    v_lshlrev_b32 v42, 16, v17
    v_and_b32 v43, 0xffff0000, v17
    v_lshlrev_b32 v44, 16, v18
    v_and_b32 v45, 0xffff0000, v18
    v_lshlrev_b32 v46, 16, v19
    v_and_b32 v47, 0xffff0000, v19
    v_add_f32 v32, v32, v40
    v_add_f32 v33, v33, v41
    v_add_f32 v34, v34, v42
    v_add_f32 v35, v35, v43
    v_add_f32 v36, v36, v44
    v_add_f32 v37, v37, v45
    v_add_f32 v38, v38, v46
    v_add_f32 v39, v39, v47
    v_cvt_pk_bf16_f32 v16, v32, v33
    v_cvt_pk_bf16_f32 v17, v34, v35
    v_cvt_pk_bf16_f32 v18, v36, v37
    v_cvt_pk_bf16_f32 v19, v38, v39
    v_lshlrev_b32 v32, 16, v16
    v_and_b32 v33, 0xffff0000, v16
    v_lshlrev_b32 v34, 16, v17
    v_and_b32 v35, 0xffff0000, v17
    v_lshlrev_b32 v36, 16, v18
    v_and_b32 v37, 0xffff0000, v18
    v_lshlrev_b32 v38, 16, v19
    v_and_b32 v39, 0xffff0000, v19
    s_lshl_b32 s25, s23, 21
    s_add_u32 s29, s29, s25
    s_add_u32 s25, s29, 25165824
    buffer_store_dwordx2 v[16:17], v11, s[8:11], s25 offen offset:0 sc1
    buffer_store_dwordx2 v[18:19], v11, s[8:11], s25 offen offset:256 sc1
    v_lshrrev_b32 v7, 3, v1
    v_and_b32 v7, 8, v7
    s_lshl_b32 s25, s20, 4
    s_add_u32 s25, s25, 65536
    v_add_u32 v7, s25, v7
    v_pk_add_f32 v[40:41], v[32:33], v[34:35]
    v_pk_add_f32 v[40:41], v[40:41], v[36:37]
    v_pk_add_f32 v[40:41], v[40:41], v[38:39]
    v_add_f32 v24, v40, v41
    s_nop 1
    v_add_f32_dpp v24, v24, v24 quad_perm:[1,0,3,2] row_mask:0xf bank_mask:0xf
    s_nop 1
    v_add_f32_dpp v24, v24, v24 quad_perm:[2,3,0,1] row_mask:0xf bank_mask:0xf
    s_nop 1
    v_add_f32_dpp v24, v24, v24 row_ror:8 row_mask:0xf bank_mask:0xf
    v_mov_b32 v42, v24
    s_nop 1
    v_permlane16_swap_b32 v24, v42
    v_add_f32 v24, v24, v42
    v_mov_b32 v42, v24
    s_nop 1
    v_permlane32_swap_b32 v24, v42
    v_add_f32 v24, v24, v42
    v_mul_f32 v24, 0xbb800000, v24
    v_pk_add_f32 v[32:33], v[32:33], v[24:25] op_sel_hi:[1,0]
    v_pk_add_f32 v[34:35], v[34:35], v[24:25] op_sel_hi:[1,0]
    v_pk_add_f32 v[36:37], v[36:37], v[24:25] op_sel_hi:[1,0]
    v_pk_add_f32 v[38:39], v[38:39], v[24:25] op_sel_hi:[1,0]
    v_pk_mul_f32 v[40:41], v[32:33], v[32:33]
    v_pk_fma_f32 v[40:41], v[34:35], v[34:35], v[40:41]
    v_pk_fma_f32 v[40:41], v[36:37], v[36:37], v[40:41]
    v_pk_fma_f32 v[40:41], v[38:39], v[38:39], v[40:41]
    v_add_f32 v25, v40, v41
    s_nop 1
    v_add_f32_dpp v25, v25, v25 quad_perm:[1,0,3,2] row_mask:0xf bank_mask:0xf
    s_nop 1
    v_add_f32_dpp v25, v25, v25 quad_perm:[2,3,0,1] row_mask:0xf bank_mask:0xf
    s_nop 1
    v_add_f32_dpp v25, v25, v25 row_ror:8 row_mask:0xf bank_mask:0xf
    v_mov_b32 v42, v25
    s_nop 1
    v_permlane16_swap_b32 v25, v42
    v_add_f32 v25, v25, v42
    v_mov_b32 v42, v25
    s_nop 1
    v_permlane32_swap_b32 v25, v42
    v_add_f32 v25, v25, v42
    ds_write_b64 v7, v[24:25]
    v_xor_b32 v7, 16, v7
    s_waitcnt lgkmcnt(0)
    s_barrier
    ds_read_b64 v[40:41], v7
    s_waitcnt lgkmcnt(0)
    v_sub_f32 v24, v40, v24
    v_add_f32 v25, v25, v41
    v_mul_f32 v24, 0.5, v24
    v_mul_f32 v40, v24, v24
    v_fmac_f32 v25, 0x44000000, v40
    v_pk_add_f32 v[32:33], v[32:33], v[24:25] op_sel_hi:[1,0]
    v_pk_add_f32 v[34:35], v[34:35], v[24:25] op_sel_hi:[1,0]
    v_pk_add_f32 v[36:37], v[36:37], v[24:25] op_sel_hi:[1,0]
    v_pk_add_f32 v[38:39], v[38:39], v[24:25] op_sel_hi:[1,0]
    v_mov_b32 v40, 0x3727c5ac
    v_fmac_f32 v40, 0x3b000000, v25
    v_rsq_f32 v24, v40
    s_nop 0
    v_pk_mul_f32 v[32:33], v[32:33], v[24:25] op_sel_hi:[1,0]
    v_pk_mul_f32 v[34:35], v[34:35], v[24:25] op_sel_hi:[1,0]
    v_pk_mul_f32 v[36:37], v[36:37], v[24:25] op_sel_hi:[1,0]
    v_pk_mul_f32 v[38:39], v[38:39], v[24:25] op_sel_hi:[1,0]
    v_cvt_pk_bf16_f32 v20, v32, v33
    v_cvt_pk_bf16_f32 v21, v34, v35
    v_cvt_pk_bf16_f32 v22, v36, v37
    v_cvt_pk_bf16_f32 v23, v38, v39
    s_add_u32 s25, s29, 29360128
    buffer_store_dwordx2 v[20:21], v11, s[8:11], s25 offen offset:0 sc1
    buffer_store_dwordx2 v[22:23], v11, s[8:11], s25 offen offset:256 sc1
    s_waitcnt vmcnt(4)
    v_readfirstlane_b32 s61, v14
    s_nop 0
    s_cmp_lt_u32 s61, 16
    s_cbranch_scc1 L_bn_56
    s_lshl_b32 s25, s55, 1
    s_add_u32 s25, s25, s48
    s_lshl_b32 s25, s25, 17
    s_add_u32 s25, s25, s50
    s_add_u32 s25, s25, 142606336
    buffer_load_dwordx4 v[128:131], v0, s[8:11], s25 offen offset:0 sc1
    buffer_load_dwordx4 v[132:135], v0, s[8:11], s25 offen offset:1024 sc1
    buffer_load_dwordx4 v[136:139], v0, s[8:11], s25 offen offset:2048 sc1
    buffer_load_dwordx4 v[140:143], v0, s[8:11], s25 offen offset:3072 sc1
    buffer_load_dwordx2 v[144:145], v15, s[8:11], s25 offen offset:0 sc1
    buffer_load_dwordx2 v[146:147], v15, s[8:11], s25 offen offset:1024 sc1
    buffer_load_dwordx2 v[148:149], v15, s[8:11], s25 offen offset:2048 sc1
    buffer_load_dwordx2 v[150:151], v15, s[8:11], s25 offen offset:3072 sc1
    s_waitcnt vmcnt(8)
    s_branch L_bs_57
L_bn_56:
    s_waitcnt vmcnt(0)
L_bs_57:
    s_lshl_b32 s26, s24, 8
    s_lshr_b32 s35, s52, 12
    s_add_u32 s26, s26, s35
    s_add_u32 s26, s26, 35869184
    s_waitcnt vmcnt(63)
    buffer_store_dword v3, v2, s[8:11], s26 offen sc1
    s_cmp_ge_u32 s24, 60
    s_cbranch_scc1 M_done
    s_mov_b32 s24, s55
    s_lshr_b32 s23, s24, 5
    s_add_u32 s33, s33, 1
    s_branch B_loopL
R_F:
    s_lshr_b32 s22, s21, 3
    s_and_b32 s21, s21, 7
    s_lshl_b32 s28, s21, 2
    s_add_u32 s28, s28, s20
    s_lshl_b32 s52, s28, 14
    s_lshl_b32 s56, s22, 8
    s_add_u32 s56, s56, 35856384
    s_lshl_b32 s57, s28, 2
    s_add_u32 s57, s57, s56
    s_add_u32 s53, s22, 6
    s_getreg_b32 s25, hwreg(HW_REG_XCC_ID, 0, 4)
    s_and_b32 s75, s25, 3
    s_lshl_b32 s75, s75, 3
    s_and_b32 s25, s25, 4
    s_lshl_b32 s76, s53, 3
    s_add_u32 s76, s76, s25
    s_add_u32 s76, s76, 64
    s_lshl_b32 s25, 1, s75
    v_mov_b32 v4, s25
    s_cmp_lg_u32 s20, 0
    s_cbranch_scc1 L_ga_58
    buffer_atomic_add v4, v2, s[4:7], s76 offen sc1
L_ga_58:
    s_lshl_b32 s25, s22, 5
    s_add_u32 s25, s25, s28
    s_lshl_b32 s26, s25, 11
    s_add_u32 s26, s26, 35651584
    v_mov_b64 v[16:17], 0
    v_mov_b64 v[18:19], 0
    v_mov_b64 v[64:65], -1
    v_mov_b64 v[66:67], -1
    v_mov_b64 v[68:69], -1
    v_mov_b64 v[70:71], -1
    v_mov_b64 v[72:73], -1
    v_mov_b64 v[74:75], -1
    v_mov_b64 v[76:77], -1
    v_mov_b64 v[78:79], -1
    v_mov_b64 v[80:81], -1
    v_mov_b64 v[82:83], -1
    v_mov_b64 v[84:85], -1
    v_mov_b64 v[86:87], -1
    v_mov_b64 v[88:89], -1
    v_mov_b64 v[90:91], -1
    v_mov_b64 v[92:93], -1
    v_mov_b64 v[94:95], -1
    buffer_store_dwordx4 v[16:19], v1, s[8:11], s26 offen offset:0 sc1
    buffer_store_dwordx4 v[16:19], v1, s[8:11], s26 offen offset:1024 sc1
    s_mul_i32 s26, s25, 18432
    s_add_u32 s26, s26, 37748736
    buffer_store_dwordx4 v[64:67], v1, s[8:11], s26 offen offset:0 sc1
    buffer_store_dwordx4 v[64:67], v1, s[8:11], s26 offen offset:1024 sc1
    buffer_store_dwordx4 v[64:67], v1, s[8:11], s26 offen offset:2048 sc1
    buffer_store_dwordx4 v[64:67], v1, s[8:11], s26 offen offset:3072 sc1
    s_add_u32 s26, s26, 4096
    buffer_store_dwordx4 v[64:67], v1, s[8:11], s26 offen offset:0 sc1
    buffer_store_dwordx4 v[64:67], v1, s[8:11], s26 offen offset:1024 sc1
    buffer_store_dwordx4 v[64:67], v1, s[8:11], s26 offen offset:2048 sc1
    buffer_store_dwordx4 v[64:67], v1, s[8:11], s26 offen offset:3072 sc1
    s_add_u32 s26, s26, 4096
    buffer_store_dwordx4 v[64:67], v1, s[8:11], s26 offen offset:0 sc1
    buffer_store_dwordx4 v[64:67], v1, s[8:11], s26 offen offset:1024 sc1
    buffer_store_dwordx4 v[64:67], v1, s[8:11], s26 offen offset:2048 sc1
    buffer_store_dwordx4 v[64:67], v1, s[8:11], s26 offen offset:3072 sc1
    s_add_u32 s26, s26, 4096
    buffer_store_dwordx4 v[64:67], v1, s[8:11], s26 offen offset:0 sc1
    buffer_store_dwordx4 v[64:67], v1, s[8:11], s26 offen offset:1024 sc1
    buffer_store_dwordx4 v[64:67], v1, s[8:11], s26 offen offset:2048 sc1
    buffer_store_dwordx4 v[64:67], v1, s[8:11], s26 offen offset:3072 sc1
    s_add_u32 s26, s26, 4096
    buffer_store_dwordx4 v[64:67], v1, s[8:11], s26 offen offset:0 sc1
    buffer_store_dwordx4 v[64:67], v1, s[8:11], s26 offen offset:1024 sc1
    s_and_b32 s26, s25, 63
    s_cmp_lg_u32 s26, 0
    s_cbranch_scc1 F_fill
    s_mov_b32 s96, s92
    s_and_b32 s97, s93, 0xffff
    s_mov_b32 s98, 0x2000
    s_mov_b32 s99, 0x20000
    v_lshrrev_b32 v20, 2, v5
    v_lshlrev_b32 v20, 11, v20
    v_and_b32 v21, 1, v5
    v_lshl_add_u32 v20, v21, 10, v20
    v_lshl_add_u32 v20, v6, 5, v20
    v_and_b32 v21, 2, v5
    v_lshl_add_u32 v20, v21, 1, v20
    buffer_load_dword v64, v20, s[96:99], 0 offen offset:0
    buffer_load_dword v65, v20, s[96:99], 0 offen offset:8
    buffer_load_dword v66, v20, s[96:99], 0 offen offset:16
    buffer_load_dword v67, v20, s[96:99], 0 offen offset:24
    buffer_load_dword v68, v20, s[96:99], 0 offen offset:128
    buffer_load_dword v69, v20, s[96:99], 0 offen offset:136
    buffer_load_dword v70, v20, s[96:99], 0 offen offset:144
    buffer_load_dword v71, v20, s[96:99], 0 offen offset:152
    buffer_load_dword v72, v20, s[96:99], 0 offen offset:256
    buffer_load_dword v73, v20, s[96:99], 0 offen offset:264
    buffer_load_dword v74, v20, s[96:99], 0 offen offset:272
    buffer_load_dword v75, v20, s[96:99], 0 offen offset:280
    buffer_load_dword v76, v20, s[96:99], 0 offen offset:384
    buffer_load_dword v77, v20, s[96:99], 0 offen offset:392
    buffer_load_dword v78, v20, s[96:99], 0 offen offset:400
    buffer_load_dword v79, v20, s[96:99], 0 offen offset:408
    buffer_load_dword v80, v20, s[96:99], 0 offen offset:512
    buffer_load_dword v81, v20, s[96:99], 0 offen offset:520
    buffer_load_dword v82, v20, s[96:99], 0 offen offset:528
    buffer_load_dword v83, v20, s[96:99], 0 offen offset:536
    buffer_load_dword v84, v20, s[96:99], 0 offen offset:640
    buffer_load_dword v85, v20, s[96:99], 0 offen offset:648
    buffer_load_dword v86, v20, s[96:99], 0 offen offset:656
    buffer_load_dword v87, v20, s[96:99], 0 offen offset:664
    buffer_load_dword v88, v20, s[96:99], 0 offen offset:768
    buffer_load_dword v89, v20, s[96:99], 0 offen offset:776
    buffer_load_dword v90, v20, s[96:99], 0 offen offset:784
    buffer_load_dword v91, v20, s[96:99], 0 offen offset:792
    buffer_load_dword v92, v20, s[96:99], 0 offen offset:896
    buffer_load_dword v93, v20, s[96:99], 0 offen offset:904
    buffer_load_dword v94, v20, s[96:99], 0 offen offset:912
    buffer_load_dword v95, v20, s[96:99], 0 offen offset:920
    s_waitcnt vmcnt(0)
    v_min_u32 v64, -2, v64
    v_min_u32 v65, -2, v65
    v_min_u32 v66, -2, v66
    v_min_u32 v67, -2, v67
    v_min_u32 v68, -2, v68
    v_min_u32 v69, -2, v69
    v_min_u32 v70, -2, v70
    v_min_u32 v71, -2, v71
    v_min_u32 v72, -2, v72
    v_min_u32 v73, -2, v73
    v_min_u32 v74, -2, v74
    v_min_u32 v75, -2, v75
    v_min_u32 v76, -2, v76
    v_min_u32 v77, -2, v77
    v_min_u32 v78, -2, v78
    v_min_u32 v79, -2, v79
    v_min_u32 v80, -2, v80
    v_min_u32 v81, -2, v81
    v_min_u32 v82, -2, v82
    v_min_u32 v83, -2, v83
    v_min_u32 v84, -2, v84
    v_min_u32 v85, -2, v85
    v_min_u32 v86, -2, v86
    v_min_u32 v87, -2, v87
    v_min_u32 v88, -2, v88
    v_min_u32 v89, -2, v89
    v_min_u32 v90, -2, v90
    v_min_u32 v91, -2, v91
    v_min_u32 v92, -2, v92
    v_min_u32 v93, -2, v93
    v_min_u32 v94, -2, v94
    v_min_u32 v95, -2, v95
F_fill:
    s_lshl_b32 s26, s25, 13
    s_add_u32 s26, s26, 36700160
    s_add_u32 s27, s26, 4096
    buffer_store_dwordx4 v[64:67], v1, s[8:11], s26 offen offset:0 sc1
    buffer_store_dwordx4 v[68:71], v1, s[8:11], s26 offen offset:1024 sc1
    buffer_store_dwordx4 v[72:75], v1, s[8:11], s26 offen offset:2048 sc1
    buffer_store_dwordx4 v[76:79], v1, s[8:11], s26 offen offset:3072 sc1
    buffer_store_dwordx4 v[80:83], v1, s[8:11], s27 offen offset:0 sc1
    buffer_store_dwordx4 v[84:87], v1, s[8:11], s27 offen offset:1024 sc1
    buffer_store_dwordx4 v[88:91], v1, s[8:11], s27 offen offset:2048 sc1
    buffer_store_dwordx4 v[92:95], v1, s[8:11], s27 offen offset:3072 sc1
    s_waitcnt vmcnt(0)
    s_barrier
    s_cmp_lg_u32 s20, 0
    s_cbranch_scc1 L_ia_59
    v_mov_b32 v4, 1
    buffer_atomic_add v4, v2, s[4:7], 0 offen offset:0 sc1
L_ia_59:
    s_cmp_lg_u32 s20, 0
    s_cbranch_scc1 L_wd_61
L_w_60:
    buffer_load_dword v4, v2, s[4:7], 0 offen offset:224 sc1
    s_waitcnt vmcnt(0)
    v_readfirstlane_b32 s34, v4
    s_nop 0
    s_cmp_ge_u32 s34, 32
    s_cbranch_scc1 L_wd_61
    s_sleep 2
    s_sub_u32 s30, s30, 1
    s_cbranch_scc0 L_w_60
    s_branch M_done
L_wd_61:
    s_barrier
    s_lshl_b32 s28, s20, 15
    s_lshl_b32 s29, s20, 13
    s_add_u32 s29, s29, 131072
    v_and_b32 v29, 3, v0
    v_bfe_u32 v30, v0, 2, 2
    v_bfe_u32 v31, v0, 2, 4
    v_lshl_add_u32 v32, v6, 3, v30
    v_lshlrev_b32 v33, 8, v32
    v_lshl_add_u32 v33, v29, 3, v33
    v_xor_b32 v34, s20, v30
    v_lshl_add_u32 v33, v34, 6, v33
    s_mov_b32 s27, 0
    s_lshl_b32 s26, s27, 15
    v_add_u32 v40, s26, v33
    s_lshl_b32 s26, s27, 13
    s_add_u32 s26, s26, 131072
    v_add_u32 v44, s26, v33
    s_mov_b32 s27, 1
    s_lshl_b32 s26, s27, 15
    v_add_u32 v41, s26, v33
    s_lshl_b32 s26, s27, 13
    s_add_u32 s26, s26, 131072
    v_add_u32 v45, s26, v33
    s_mov_b32 s27, 2
    s_lshl_b32 s26, s27, 15
    v_add_u32 v42, s26, v33
    s_lshl_b32 s26, s27, 13
    s_add_u32 s26, s26, 131072
    v_add_u32 v46, s26, v33
    s_mov_b32 s27, 3
    s_lshl_b32 s26, s27, 15
    v_add_u32 v43, s26, v33
    s_lshl_b32 s26, s27, 13
    s_add_u32 s26, s26, 131072
    v_add_u32 v47, s26, v33
    v_lshlrev_b32 v33, 7, v32
    v_lshl_add_u32 v33, v29, 3, v33
    v_add_u32 v35, s28, v33
    v_add_u32 v36, s29, v33
    v_bfe_u32 v33, v0, 3, 3
    v_mul_u32_u24 v34, 2752, v33
    v_and_b32 v33, 7, v0
    v_lshl_add_u32 v34, v33, 4, v34
    v_cmp_gt_u32 vcc, 6, v33
    v_mov_b32 v33, 0x40000000
    s_nop 0
    v_cndmask_b32 v34, v33, v34, vcc
    v_lshlrev_b32 v19, 2, v6
    v_xor_b32 v19, v19, v5
    v_lshlrev_b32 v19, 4, v19
    v_lshl_add_u32 v16, v6, 13, v19
    v_lshl_add_u32 v19, v6, 10, v19
    v_lshlrev_b32 v32, 8, v31
    v_lshl_add_u32 v32, v29, 4, v32
    v_xor_b32 v33, 0, v30
    v_lshl_add_u32 v33, v33, 6, v32
    v_add_u32 v20, s28, v33
    v_add_u32 v24, s29, v33
    v_xor_b32 v33, 1, v30
    v_lshl_add_u32 v33, v33, 6, v32
    v_add_u32 v21, s28, v33
    v_add_u32 v25, s29, v33
    v_xor_b32 v33, 2, v30
    v_lshl_add_u32 v33, v33, 6, v32
    v_add_u32 v22, s28, v33
    v_add_u32 v26, s29, v33
    v_xor_b32 v33, 3, v30
    v_lshl_add_u32 v33, v33, 6, v32
    v_add_u32 v23, s28, v33
    v_add_u32 v27, s29, v33
    s_mov_b32 s96, s88
    s_and_b32 s97, s89, 0xffff
    s_mov_b32 s98, 0x158000
    s_mov_b32 s99, 0x20000
    s_mov_b32 s26, 4294945280
    s_mul_i32 s35, s21, 384
    s_add_u32 s26, s26, s35
    s_mul_i32 s35, s20, 96
    s_add_u32 s26, s26, s35
    s_add_u32 m0, s28, 0
    s_add_u32 s26, s26, 22016
    buffer_load_dwordx4 v34, s[96:99], s26 offen lds
    s_add_u32 m0, s28, 1024
    s_add_u32 s26, s26, 22016
    buffer_load_dwordx4 v34, s[96:99], s26 offen lds
    s_add_u32 m0, s28, 2048
    s_add_u32 s26, s26, 22016
    buffer_load_dwordx4 v34, s[96:99], s26 offen lds
    s_add_u32 m0, s28, 3072
    s_add_u32 s26, s26, 22016
    buffer_load_dwordx4 v34, s[96:99], s26 offen lds
    s_add_u32 m0, s28, 4096
    s_add_u32 s26, s26, 22016
    buffer_load_dwordx4 v34, s[96:99], s26 offen lds
    s_add_u32 m0, s28, 5120
    s_add_u32 s26, s26, 22016
    buffer_load_dwordx4 v34, s[96:99], s26 offen lds
    s_add_u32 m0, s28, 6144
    s_add_u32 s26, s26, 22016
    buffer_load_dwordx4 v34, s[96:99], s26 offen lds
    s_add_u32 m0, s28, 7168
    s_add_u32 s26, s26, 22016
    buffer_load_dwordx4 v34, s[96:99], s26 offen lds
    s_add_u32 m0, s28, 8192
    s_add_u32 s26, s26, 22016
    buffer_load_dwordx4 v34, s[96:99], s26 offen lds
    s_add_u32 m0, s28, 9216
    s_add_u32 s26, s26, 22016
    buffer_load_dwordx4 v34, s[96:99], s26 offen lds
    s_add_u32 m0, s28, 10240
    s_add_u32 s26, s26, 22016
    buffer_load_dwordx4 v34, s[96:99], s26 offen lds
    s_add_u32 m0, s28, 11264
    s_add_u32 s26, s26, 22016
    buffer_load_dwordx4 v34, s[96:99], s26 offen lds
    s_add_u32 m0, s28, 12288
    s_add_u32 s26, s26, 22016
    buffer_load_dwordx4 v34, s[96:99], s26 offen lds
    s_add_u32 m0, s28, 13312
    s_add_u32 s26, s26, 22016
    buffer_load_dwordx4 v34, s[96:99], s26 offen lds
    s_add_u32 m0, s28, 14336
    s_add_u32 s26, s26, 22016
    buffer_load_dwordx4 v34, s[96:99], s26 offen lds
    s_add_u32 m0, s28, 15360
    s_add_u32 s26, s26, 22016
    buffer_load_dwordx4 v34, s[96:99], s26 offen lds
    s_add_u32 m0, s28, 16384
    s_add_u32 s26, s26, 22016
    buffer_load_dwordx4 v34, s[96:99], s26 offen lds
    s_add_u32 m0, s28, 17408
    s_add_u32 s26, s26, 22016
    buffer_load_dwordx4 v34, s[96:99], s26 offen lds
    s_add_u32 m0, s28, 18432
    s_add_u32 s26, s26, 22016
    buffer_load_dwordx4 v34, s[96:99], s26 offen lds
    s_add_u32 m0, s28, 19456
    s_add_u32 s26, s26, 22016
    buffer_load_dwordx4 v34, s[96:99], s26 offen lds
    s_add_u32 m0, s28, 20480
    s_add_u32 s26, s26, 22016
    buffer_load_dwordx4 v34, s[96:99], s26 offen lds
    s_add_u32 m0, s28, 21504
    s_add_u32 s26, s26, 22016
    buffer_load_dwordx4 v34, s[96:99], s26 offen lds
    s_add_u32 m0, s28, 22528
    s_add_u32 s26, s26, 22016
    buffer_load_dwordx4 v34, s[96:99], s26 offen lds
    s_add_u32 m0, s28, 23552
    s_add_u32 s26, s26, 22016
    buffer_load_dwordx4 v34, s[96:99], s26 offen lds
    s_add_u32 m0, s28, 24576
    s_add_u32 s26, s26, 22016
    buffer_load_dwordx4 v34, s[96:99], s26 offen lds
    s_add_u32 m0, s28, 25600
    s_add_u32 s26, s26, 22016
    buffer_load_dwordx4 v34, s[96:99], s26 offen lds
    s_add_u32 m0, s28, 26624
    s_add_u32 s26, s26, 22016
    buffer_load_dwordx4 v34, s[96:99], s26 offen lds
    s_add_u32 m0, s28, 27648
    s_add_u32 s26, s26, 22016
    buffer_load_dwordx4 v34, s[96:99], s26 offen lds
    s_add_u32 m0, s28, 28672
    s_add_u32 s26, s26, 22016
    buffer_load_dwordx4 v34, s[96:99], s26 offen lds
    s_add_u32 m0, s28, 29696
    s_add_u32 s26, s26, 22016
    buffer_load_dwordx4 v34, s[96:99], s26 offen lds
    s_add_u32 m0, s28, 30720
    s_add_u32 s26, s26, 22016
    buffer_load_dwordx4 v34, s[96:99], s26 offen lds
    s_add_u32 m0, s28, 31744
    s_add_u32 s26, s26, 22016
    buffer_load_dwordx4 v34, s[96:99], s26 offen lds
    s_waitcnt vmcnt(24)
    s_add_u32 m0, s29, 0
    s_add_u32 s26, s26, 22016
    buffer_load_dwordx4 v34, s[96:99], s26 offen lds
    s_add_u32 m0, s29, 1024
    s_add_u32 s26, s26, 22016
    buffer_load_dwordx4 v34, s[96:99], s26 offen lds
    s_add_u32 m0, s29, 2048
    s_add_u32 s26, s26, 22016
    buffer_load_dwordx4 v34, s[96:99], s26 offen lds
    s_add_u32 m0, s29, 3072
    s_add_u32 s26, s26, 22016
    buffer_load_dwordx4 v34, s[96:99], s26 offen lds
    s_add_u32 m0, s29, 4096
    s_add_u32 s26, s26, 22016
    buffer_load_dwordx4 v34, s[96:99], s26 offen lds
    s_add_u32 m0, s29, 5120
    s_add_u32 s26, s26, 22016
    buffer_load_dwordx4 v34, s[96:99], s26 offen lds
    s_add_u32 m0, s29, 6144
    s_add_u32 s26, s26, 22016
    buffer_load_dwordx4 v34, s[96:99], s26 offen lds
    s_add_u32 m0, s29, 7168
    s_add_u32 s26, s26, 22016
    buffer_load_dwordx4 v34, s[96:99], s26 offen lds
    ds_read_b64_tr_b16 a[0:1], v35 offset:0
    ds_read_b64_tr_b16 a[2:3], v35 offset:512
    ds_read_b64_tr_b16 a[64:65], v35 offset:32
    ds_read_b64_tr_b16 a[66:67], v35 offset:544
    ds_read_b64_tr_b16 a[128:129], v35 offset:64
    ds_read_b64_tr_b16 a[130:131], v35 offset:576
    ds_read_b64_tr_b16 a[4:5], v35 offset:4096
    ds_read_b64_tr_b16 a[6:7], v35 offset:4608
    ds_read_b64_tr_b16 a[68:69], v35 offset:4128
    ds_read_b64_tr_b16 a[70:71], v35 offset:4640
    ds_read_b64_tr_b16 a[132:133], v35 offset:4160
    ds_read_b64_tr_b16 a[134:135], v35 offset:4672
    s_waitcnt lgkmcnt(0)
    s_waitcnt vmcnt(24)
    s_add_u32 m0, s28, 0
    s_add_u32 s26, s26, 22016
    buffer_load_dwordx4 v34, s[96:99], s26 offen lds
    s_add_u32 m0, s28, 1024
    s_add_u32 s26, s26, 22016
    buffer_load_dwordx4 v34, s[96:99], s26 offen lds
    s_add_u32 m0, s28, 2048
    s_add_u32 s26, s26, 22016
    buffer_load_dwordx4 v34, s[96:99], s26 offen lds
    s_add_u32 m0, s28, 3072
    s_add_u32 s26, s26, 22016
    buffer_load_dwordx4 v34, s[96:99], s26 offen lds
    s_add_u32 m0, s28, 4096
    s_add_u32 s26, s26, 22016
    buffer_load_dwordx4 v34, s[96:99], s26 offen lds
    s_add_u32 m0, s28, 5120
    s_add_u32 s26, s26, 22016
    buffer_load_dwordx4 v34, s[96:99], s26 offen lds
    s_add_u32 m0, s28, 6144
    s_add_u32 s26, s26, 22016
    buffer_load_dwordx4 v34, s[96:99], s26 offen lds
    s_add_u32 m0, s28, 7168
    s_add_u32 s26, s26, 22016
    buffer_load_dwordx4 v34, s[96:99], s26 offen lds
    ds_read_b64_tr_b16 a[8:9], v35 offset:8192
    ds_read_b64_tr_b16 a[10:11], v35 offset:8704
    ds_read_b64_tr_b16 a[72:73], v35 offset:8224
    ds_read_b64_tr_b16 a[74:75], v35 offset:8736
    ds_read_b64_tr_b16 a[136:137], v35 offset:8256
    ds_read_b64_tr_b16 a[138:139], v35 offset:8768
    ds_read_b64_tr_b16 a[12:13], v35 offset:12288
    ds_read_b64_tr_b16 a[14:15], v35 offset:12800
    ds_read_b64_tr_b16 a[76:77], v35 offset:12320
    ds_read_b64_tr_b16 a[78:79], v35 offset:12832
    ds_read_b64_tr_b16 a[140:141], v35 offset:12352
    ds_read_b64_tr_b16 a[142:143], v35 offset:12864
    s_waitcnt lgkmcnt(0)
    s_waitcnt vmcnt(24)
    s_add_u32 m0, s28, 8192
    s_add_u32 s26, s26, 22016
    buffer_load_dwordx4 v34, s[96:99], s26 offen lds
    s_add_u32 m0, s28, 9216
    s_add_u32 s26, s26, 22016
    buffer_load_dwordx4 v34, s[96:99], s26 offen lds
    s_add_u32 m0, s28, 10240
    s_add_u32 s26, s26, 22016
    buffer_load_dwordx4 v34, s[96:99], s26 offen lds
    s_add_u32 m0, s28, 11264
    s_add_u32 s26, s26, 22016
    buffer_load_dwordx4 v34, s[96:99], s26 offen lds
    s_add_u32 m0, s28, 12288
    s_add_u32 s26, s26, 22016
    buffer_load_dwordx4 v34, s[96:99], s26 offen lds
    s_add_u32 m0, s28, 13312
    s_add_u32 s26, s26, 22016
    buffer_load_dwordx4 v34, s[96:99], s26 offen lds
    s_add_u32 m0, s28, 14336
    s_add_u32 s26, s26, 22016
    buffer_load_dwordx4 v34, s[96:99], s26 offen lds
    s_add_u32 m0, s28, 15360
    s_add_u32 s26, s26, 22016
    buffer_load_dwordx4 v34, s[96:99], s26 offen lds
    ds_read_b64_tr_b16 a[16:17], v35 offset:16384
    ds_read_b64_tr_b16 a[18:19], v35 offset:16896
    ds_read_b64_tr_b16 a[80:81], v35 offset:16416
    ds_read_b64_tr_b16 a[82:83], v35 offset:16928
    ds_read_b64_tr_b16 a[144:145], v35 offset:16448
    ds_read_b64_tr_b16 a[146:147], v35 offset:16960
    ds_read_b64_tr_b16 a[20:21], v35 offset:20480
    ds_read_b64_tr_b16 a[22:23], v35 offset:20992
    ds_read_b64_tr_b16 a[84:85], v35 offset:20512
    ds_read_b64_tr_b16 a[86:87], v35 offset:21024
    ds_read_b64_tr_b16 a[148:149], v35 offset:20544
    ds_read_b64_tr_b16 a[150:151], v35 offset:21056
    s_waitcnt lgkmcnt(0)
    s_waitcnt vmcnt(24)
    s_add_u32 m0, s28, 16384
    s_add_u32 s26, s26, 22016
    buffer_load_dwordx4 v34, s[96:99], s26 offen lds
    s_add_u32 m0, s28, 17408
    s_add_u32 s26, s26, 22016
    buffer_load_dwordx4 v34, s[96:99], s26 offen lds
    s_add_u32 m0, s28, 18432
    s_add_u32 s26, s26, 22016
    buffer_load_dwordx4 v34, s[96:99], s26 offen lds
    s_add_u32 m0, s28, 19456
    s_add_u32 s26, s26, 22016
    buffer_load_dwordx4 v34, s[96:99], s26 offen lds
    s_add_u32 m0, s28, 20480
    s_add_u32 s26, s26, 22016
    buffer_load_dwordx4 v34, s[96:99], s26 offen lds
    s_add_u32 m0, s28, 21504
    s_add_u32 s26, s26, 22016
    buffer_load_dwordx4 v34, s[96:99], s26 offen lds
    s_add_u32 m0, s28, 22528
    s_add_u32 s26, s26, 22016
    buffer_load_dwordx4 v34, s[96:99], s26 offen lds
    s_add_u32 m0, s28, 23552
    s_add_u32 s26, s26, 22016
    buffer_load_dwordx4 v34, s[96:99], s26 offen lds
    ds_read_b64_tr_b16 a[24:25], v35 offset:24576
    ds_read_b64_tr_b16 a[26:27], v35 offset:25088
    ds_read_b64_tr_b16 a[88:89], v35 offset:24608
    ds_read_b64_tr_b16 a[90:91], v35 offset:25120
    ds_read_b64_tr_b16 a[152:153], v35 offset:24640
    ds_read_b64_tr_b16 a[154:155], v35 offset:25152
    ds_read_b64_tr_b16 a[28:29], v35 offset:28672
    ds_read_b64_tr_b16 a[30:31], v35 offset:29184
    ds_read_b64_tr_b16 a[92:93], v35 offset:28704
    ds_read_b64_tr_b16 a[94:95], v35 offset:29216
    ds_read_b64_tr_b16 a[156:157], v35 offset:28736
    ds_read_b64_tr_b16 a[158:159], v35 offset:29248
    s_waitcnt lgkmcnt(0)
    s_waitcnt vmcnt(24)
    s_mov_b32 s96, s90
    s_and_b32 s97, s91, 0xffff
    s_mov_b32 s98, 0x158000
    s_mov_b32 s99, 0x20000
    s_mov_b32 s26, 4294963200
    s_mul_i32 s35, s21, 196608
    s_add_u32 s26, s26, s35
    s_mul_i32 s35, s20, 256
    s_add_u32 s26, s26, s35
    s_add_u32 m0, s28, 24576
    s_add_u32 s26, s26, 4096
    buffer_load_dwordx4 v19, s[96:99], s26 offen lds
    s_add_u32 m0, s28, 25600
    s_add_u32 s26, s26, 4096
    buffer_load_dwordx4 v19, s[96:99], s26 offen lds
    s_add_u32 m0, s28, 26624
    s_add_u32 s26, s26, 4096
    buffer_load_dwordx4 v19, s[96:99], s26 offen lds
    s_add_u32 m0, s28, 27648
    s_add_u32 s26, s26, 4096
    buffer_load_dwordx4 v19, s[96:99], s26 offen lds
    s_add_u32 m0, s28, 28672
    s_add_u32 s26, s26, 4096
    buffer_load_dwordx4 v19, s[96:99], s26 offen lds
    s_add_u32 m0, s28, 29696
    s_add_u32 s26, s26, 4096
    buffer_load_dwordx4 v19, s[96:99], s26 offen lds
    s_add_u32 m0, s28, 30720
    s_add_u32 s26, s26, 4096
    buffer_load_dwordx4 v19, s[96:99], s26 offen lds
    s_add_u32 m0, s28, 31744
    s_add_u32 s26, s26, 4096
    buffer_load_dwordx4 v19, s[96:99], s26 offen lds
    ds_read_b64_tr_b16 a[32:33], v36 offset:0
    ds_read_b64_tr_b16 a[34:35], v36 offset:512
    ds_read_b64_tr_b16 a[96:97], v36 offset:32
    ds_read_b64_tr_b16 a[98:99], v36 offset:544
    ds_read_b64_tr_b16 a[160:161], v36 offset:64
    ds_read_b64_tr_b16 a[162:163], v36 offset:576
    ds_read_b64_tr_b16 a[36:37], v36 offset:4096
    ds_read_b64_tr_b16 a[38:39], v36 offset:4608
    ds_read_b64_tr_b16 a[100:101], v36 offset:4128
    ds_read_b64_tr_b16 a[102:103], v36 offset:4640
    ds_read_b64_tr_b16 a[164:165], v36 offset:4160
    ds_read_b64_tr_b16 a[166:167], v36 offset:4672
    s_waitcnt lgkmcnt(0)
    s_waitcnt vmcnt(24)
    s_add_u32 m0, s29, 0
    s_add_u32 s26, s26, 4096
    buffer_load_dwordx4 v19, s[96:99], s26 offen lds
    s_add_u32 m0, s29, 1024
    s_add_u32 s26, s26, 4096
    buffer_load_dwordx4 v19, s[96:99], s26 offen lds
    s_add_u32 m0, s29, 2048
    s_add_u32 s26, s26, 4096
    buffer_load_dwordx4 v19, s[96:99], s26 offen lds
    s_add_u32 m0, s29, 3072
    s_add_u32 s26, s26, 4096
    buffer_load_dwordx4 v19, s[96:99], s26 offen lds
    s_add_u32 m0, s29, 4096
    s_add_u32 s26, s26, 4096
    buffer_load_dwordx4 v19, s[96:99], s26 offen lds
    s_add_u32 m0, s29, 5120
    s_add_u32 s26, s26, 4096
    buffer_load_dwordx4 v19, s[96:99], s26 offen lds
    s_add_u32 m0, s29, 6144
    s_add_u32 s26, s26, 4096
    buffer_load_dwordx4 v19, s[96:99], s26 offen lds
    s_add_u32 m0, s29, 7168
    s_add_u32 s26, s26, 4096
    buffer_load_dwordx4 v19, s[96:99], s26 offen lds
    ds_read_b64_tr_b16 a[40:41], v35 offset:0
    ds_read_b64_tr_b16 a[42:43], v35 offset:512
    ds_read_b64_tr_b16 a[104:105], v35 offset:32
    ds_read_b64_tr_b16 a[106:107], v35 offset:544
    ds_read_b64_tr_b16 a[168:169], v35 offset:64
    ds_read_b64_tr_b16 a[170:171], v35 offset:576
    ds_read_b64_tr_b16 a[44:45], v35 offset:4096
    ds_read_b64_tr_b16 a[46:47], v35 offset:4608
    ds_read_b64_tr_b16 a[108:109], v35 offset:4128
    ds_read_b64_tr_b16 a[110:111], v35 offset:4640
    ds_read_b64_tr_b16 a[172:173], v35 offset:4160
    ds_read_b64_tr_b16 a[174:175], v35 offset:4672
    s_waitcnt lgkmcnt(0)
    s_waitcnt vmcnt(24)
    s_add_u32 m0, s28, 0
    s_add_u32 s26, s26, 4096
    buffer_load_dwordx4 v19, s[96:99], s26 offen lds
    s_add_u32 m0, s28, 1024
    s_add_u32 s26, s26, 4096
    buffer_load_dwordx4 v19, s[96:99], s26 offen lds
    s_add_u32 m0, s28, 2048
    s_add_u32 s26, s26, 4096
    buffer_load_dwordx4 v19, s[96:99], s26 offen lds
    s_add_u32 m0, s28, 3072
    s_add_u32 s26, s26, 4096
    buffer_load_dwordx4 v19, s[96:99], s26 offen lds
    s_add_u32 m0, s28, 4096
    s_add_u32 s26, s26, 4096
    buffer_load_dwordx4 v19, s[96:99], s26 offen lds
    s_add_u32 m0, s28, 5120
    s_add_u32 s26, s26, 4096
    buffer_load_dwordx4 v19, s[96:99], s26 offen lds
    s_add_u32 m0, s28, 6144
    s_add_u32 s26, s26, 4096
    buffer_load_dwordx4 v19, s[96:99], s26 offen lds
    s_add_u32 m0, s28, 7168
    s_add_u32 s26, s26, 4096
    buffer_load_dwordx4 v19, s[96:99], s26 offen lds
    ds_read_b64_tr_b16 a[48:49], v35 offset:8192
    ds_read_b64_tr_b16 a[50:51], v35 offset:8704
    ds_read_b64_tr_b16 a[112:113], v35 offset:8224
    ds_read_b64_tr_b16 a[114:115], v35 offset:8736
    ds_read_b64_tr_b16 a[176:177], v35 offset:8256
    ds_read_b64_tr_b16 a[178:179], v35 offset:8768
    ds_read_b64_tr_b16 a[52:53], v35 offset:12288
    ds_read_b64_tr_b16 a[54:55], v35 offset:12800
    ds_read_b64_tr_b16 a[116:117], v35 offset:12320
    ds_read_b64_tr_b16 a[118:119], v35 offset:12832
    ds_read_b64_tr_b16 a[180:181], v35 offset:12352
    ds_read_b64_tr_b16 a[182:183], v35 offset:12864
    s_waitcnt lgkmcnt(0)
    s_waitcnt vmcnt(24)
    s_add_u32 m0, s28, 8192
    s_add_u32 s26, s26, 4096
    buffer_load_dwordx4 v19, s[96:99], s26 offen lds
    s_add_u32 m0, s28, 9216
    s_add_u32 s26, s26, 4096
    buffer_load_dwordx4 v19, s[96:99], s26 offen lds
    s_add_u32 m0, s28, 10240
    s_add_u32 s26, s26, 4096
    buffer_load_dwordx4 v19, s[96:99], s26 offen lds
    s_add_u32 m0, s28, 11264
    s_add_u32 s26, s26, 4096
    buffer_load_dwordx4 v19, s[96:99], s26 offen lds
    s_add_u32 m0, s28, 12288
    s_add_u32 s26, s26, 4096
    buffer_load_dwordx4 v19, s[96:99], s26 offen lds
    s_add_u32 m0, s28, 13312
    s_add_u32 s26, s26, 4096
    buffer_load_dwordx4 v19, s[96:99], s26 offen lds
    s_add_u32 m0, s28, 14336
    s_add_u32 s26, s26, 4096
    buffer_load_dwordx4 v19, s[96:99], s26 offen lds
    s_add_u32 m0, s28, 15360
    s_add_u32 s26, s26, 4096
    buffer_load_dwordx4 v19, s[96:99], s26 offen lds
    ds_read_b64_tr_b16 a[56:57], v35 offset:16384
    ds_read_b64_tr_b16 a[58:59], v35 offset:16896
    ds_read_b64_tr_b16 a[120:121], v35 offset:16416
    ds_read_b64_tr_b16 a[122:123], v35 offset:16928
    ds_read_b64_tr_b16 a[184:185], v35 offset:16448
    ds_read_b64_tr_b16 a[186:187], v35 offset:16960
    ds_read_b64_tr_b16 a[60:61], v35 offset:20480
    ds_read_b64_tr_b16 a[62:63], v35 offset:20992
    ds_read_b64_tr_b16 a[124:125], v35 offset:20512
    ds_read_b64_tr_b16 a[126:127], v35 offset:21024
    ds_read_b64_tr_b16 a[188:189], v35 offset:20544
    ds_read_b64_tr_b16 a[190:191], v35 offset:21056
    s_waitcnt lgkmcnt(0)
    s_waitcnt vmcnt(24)
    s_add_u32 m0, s28, 16384
    s_add_u32 s26, s26, 4096
    buffer_load_dwordx4 v19, s[96:99], s26 offen lds
    s_add_u32 m0, s28, 17408
    s_add_u32 s26, s26, 4096
    buffer_load_dwordx4 v19, s[96:99], s26 offen lds
    s_add_u32 m0, s28, 18432
    s_add_u32 s26, s26, 4096
    buffer_load_dwordx4 v19, s[96:99], s26 offen lds
    s_add_u32 m0, s28, 19456
    s_add_u32 s26, s26, 4096
    buffer_load_dwordx4 v19, s[96:99], s26 offen lds
    s_add_u32 m0, s28, 20480
    s_add_u32 s26, s26, 4096
    buffer_load_dwordx4 v19, s[96:99], s26 offen lds
    s_add_u32 m0, s28, 21504
    s_add_u32 s26, s26, 4096
    buffer_load_dwordx4 v19, s[96:99], s26 offen lds
    s_add_u32 m0, s28, 22528
    s_add_u32 s26, s26, 4096
    buffer_load_dwordx4 v19, s[96:99], s26 offen lds
    s_add_u32 m0, s28, 23552
    s_add_u32 s26, s26, 4096
    buffer_load_dwordx4 v19, s[96:99], s26 offen lds
    ds_read_b64_tr_b16 a[192:193], v20 offset:24576
    ds_read_b64_tr_b16 a[194:195], v20 offset:28672
    ds_read_b64_tr_b16 a[216:217], v20 offset:24584
    ds_read_b64_tr_b16 a[218:219], v20 offset:28680
    ds_read_b64_tr_b16 a[240:241], v21 offset:24576
    ds_read_b64_tr_b16 a[242:243], v21 offset:28672
    ds_read_b64_tr_b16 v[136:137], v21 offset:24584
    ds_read_b64_tr_b16 v[138:139], v21 offset:28680
    ds_read_b64_tr_b16 v[160:161], v22 offset:24576
    ds_read_b64_tr_b16 v[162:163], v22 offset:28672
    ds_read_b64_tr_b16 v[184:185], v22 offset:24584
    ds_read_b64_tr_b16 v[186:187], v22 offset:28680
    ds_read_b64_tr_b16 v[208:209], v23 offset:24576
    ds_read_b64_tr_b16 v[210:211], v23 offset:28672
    ds_read_b64_tr_b16 v[232:233], v23 offset:24584
    ds_read_b64_tr_b16 v[234:235], v23 offset:28680
    s_waitcnt lgkmcnt(0)
    s_waitcnt vmcnt(24)
    s_add_u32 m0, s28, 24576
    s_add_u32 s26, s26, 4096
    buffer_load_dwordx4 v19, s[96:99], s26 offen lds
    s_add_u32 m0, s28, 25600
    s_add_u32 s26, s26, 4096
    buffer_load_dwordx4 v19, s[96:99], s26 offen lds
    s_add_u32 m0, s28, 26624
    s_add_u32 s26, s26, 4096
    buffer_load_dwordx4 v19, s[96:99], s26 offen lds
    s_add_u32 m0, s28, 27648
    s_add_u32 s26, s26, 4096
    buffer_load_dwordx4 v19, s[96:99], s26 offen lds
    s_add_u32 m0, s28, 28672
    s_add_u32 s26, s26, 4096
    buffer_load_dwordx4 v19, s[96:99], s26 offen lds
    s_add_u32 m0, s28, 29696
    s_add_u32 s26, s26, 4096
    buffer_load_dwordx4 v19, s[96:99], s26 offen lds
    s_add_u32 m0, s28, 30720
    s_add_u32 s26, s26, 4096
    buffer_load_dwordx4 v19, s[96:99], s26 offen lds
    s_add_u32 m0, s28, 31744
    s_add_u32 s26, s26, 4096
    buffer_load_dwordx4 v19, s[96:99], s26 offen lds
    ds_read_b64_tr_b16 a[196:197], v24 offset:0
    ds_read_b64_tr_b16 a[198:199], v24 offset:4096
    ds_read_b64_tr_b16 a[220:221], v24 offset:8
    ds_read_b64_tr_b16 a[222:223], v24 offset:4104
    ds_read_b64_tr_b16 a[244:245], v25 offset:0
    ds_read_b64_tr_b16 a[246:247], v25 offset:4096
    ds_read_b64_tr_b16 v[140:141], v25 offset:8
    ds_read_b64_tr_b16 v[142:143], v25 offset:4104
    ds_read_b64_tr_b16 v[164:165], v26 offset:0
    ds_read_b64_tr_b16 v[166:167], v26 offset:4096
    ds_read_b64_tr_b16 v[188:189], v26 offset:8
    ds_read_b64_tr_b16 v[190:191], v26 offset:4104
    ds_read_b64_tr_b16 v[212:213], v27 offset:0
    ds_read_b64_tr_b16 v[214:215], v27 offset:4096
    ds_read_b64_tr_b16 v[236:237], v27 offset:8
    ds_read_b64_tr_b16 v[238:239], v27 offset:4104
    s_waitcnt lgkmcnt(0)
    s_waitcnt vmcnt(24)
    ds_read_b64_tr_b16 a[200:201], v20 offset:0
    ds_read_b64_tr_b16 a[202:203], v20 offset:4096
    ds_read_b64_tr_b16 a[224:225], v20 offset:8
    ds_read_b64_tr_b16 a[226:227], v20 offset:4104
    ds_read_b64_tr_b16 a[248:249], v21 offset:0
    ds_read_b64_tr_b16 a[250:251], v21 offset:4096
    ds_read_b64_tr_b16 v[144:145], v21 offset:8
    ds_read_b64_tr_b16 v[146:147], v21 offset:4104
    ds_read_b64_tr_b16 v[168:169], v22 offset:0
    ds_read_b64_tr_b16 v[170:171], v22 offset:4096
    ds_read_b64_tr_b16 v[192:193], v22 offset:8
    ds_read_b64_tr_b16 v[194:195], v22 offset:4104
    ds_read_b64_tr_b16 v[216:217], v23 offset:0
    ds_read_b64_tr_b16 v[218:219], v23 offset:4096
    ds_read_b64_tr_b16 v[240:241], v23 offset:8
    ds_read_b64_tr_b16 v[242:243], v23 offset:4104
    s_waitcnt lgkmcnt(0)
    s_waitcnt vmcnt(16)
    ds_read_b64_tr_b16 a[204:205], v20 offset:8192
    ds_read_b64_tr_b16 a[206:207], v20 offset:12288
    ds_read_b64_tr_b16 a[228:229], v20 offset:8200
    ds_read_b64_tr_b16 a[230:231], v20 offset:12296
    ds_read_b64_tr_b16 a[252:253], v21 offset:8192
    ds_read_b64_tr_b16 a[254:255], v21 offset:12288
    ds_read_b64_tr_b16 v[148:149], v21 offset:8200
    ds_read_b64_tr_b16 v[150:151], v21 offset:12296
    ds_read_b64_tr_b16 v[172:173], v22 offset:8192
    ds_read_b64_tr_b16 v[174:175], v22 offset:12288
    ds_read_b64_tr_b16 v[196:197], v22 offset:8200
    ds_read_b64_tr_b16 v[198:199], v22 offset:12296
    ds_read_b64_tr_b16 v[220:221], v23 offset:8192
    ds_read_b64_tr_b16 v[222:223], v23 offset:12288
    ds_read_b64_tr_b16 v[244:245], v23 offset:8200
    ds_read_b64_tr_b16 v[246:247], v23 offset:12296
    s_waitcnt lgkmcnt(0)
    s_waitcnt vmcnt(8)
    ds_read_b64_tr_b16 a[208:209], v20 offset:16384
    ds_read_b64_tr_b16 a[210:211], v20 offset:20480
    ds_read_b64_tr_b16 a[232:233], v20 offset:16392
    ds_read_b64_tr_b16 a[234:235], v20 offset:20488
    ds_read_b64_tr_b16 v[128:129], v21 offset:16384
    ds_read_b64_tr_b16 v[130:131], v21 offset:20480
    ds_read_b64_tr_b16 v[152:153], v21 offset:16392
    ds_read_b64_tr_b16 v[154:155], v21 offset:20488
    ds_read_b64_tr_b16 v[176:177], v22 offset:16384
    ds_read_b64_tr_b16 v[178:179], v22 offset:20480
    ds_read_b64_tr_b16 v[200:201], v22 offset:16392
    ds_read_b64_tr_b16 v[202:203], v22 offset:20488
    ds_read_b64_tr_b16 v[224:225], v23 offset:16384
    ds_read_b64_tr_b16 v[226:227], v23 offset:20480
    ds_read_b64_tr_b16 v[248:249], v23 offset:16392
    ds_read_b64_tr_b16 v[250:251], v23 offset:20488
    s_waitcnt lgkmcnt(0)
    s_waitcnt vmcnt(0)
    ds_read_b64_tr_b16 a[212:213], v20 offset:24576
    ds_read_b64_tr_b16 a[214:215], v20 offset:28672
    ds_read_b64_tr_b16 a[236:237], v20 offset:24584
    ds_read_b64_tr_b16 a[238:239], v20 offset:28680
    ds_read_b64_tr_b16 v[132:133], v21 offset:24576
    ds_read_b64_tr_b16 v[134:135], v21 offset:28672
    ds_read_b64_tr_b16 v[156:157], v21 offset:24584
    ds_read_b64_tr_b16 v[158:159], v21 offset:28680
    ds_read_b64_tr_b16 v[180:181], v22 offset:24576
    ds_read_b64_tr_b16 v[182:183], v22 offset:28672
    ds_read_b64_tr_b16 v[204:205], v22 offset:24584
    ds_read_b64_tr_b16 v[206:207], v22 offset:28680
    ds_read_b64_tr_b16 v[228:229], v23 offset:24576
    ds_read_b64_tr_b16 v[230:231], v23 offset:28672
    ds_read_b64_tr_b16 v[252:253], v23 offset:24584
    ds_read_b64_tr_b16 v[254:255], v23 offset:28680
    s_waitcnt lgkmcnt(0)
    s_cmp_lg_u32 s21, 7
    s_cbranch_scc1 F_wok
    v_accvgpr_write_b32 a196, 0
    v_accvgpr_write_b32 a197, 0
    v_accvgpr_write_b32 a198, 0
    v_accvgpr_write_b32 a199, 0
    v_accvgpr_write_b32 a200, 0
    v_accvgpr_write_b32 a201, 0
    v_accvgpr_write_b32 a202, 0
    v_accvgpr_write_b32 a203, 0
    v_accvgpr_write_b32 a204, 0
    v_accvgpr_write_b32 a205, 0
    v_accvgpr_write_b32 a206, 0
    v_accvgpr_write_b32 a207, 0
    v_accvgpr_write_b32 a208, 0
    v_accvgpr_write_b32 a209, 0
    v_accvgpr_write_b32 a210, 0
    v_accvgpr_write_b32 a211, 0
    v_accvgpr_write_b32 a212, 0
    v_accvgpr_write_b32 a213, 0
    v_accvgpr_write_b32 a214, 0
    v_accvgpr_write_b32 a215, 0
    v_accvgpr_write_b32 a220, 0
    v_accvgpr_write_b32 a221, 0
    v_accvgpr_write_b32 a222, 0
    v_accvgpr_write_b32 a223, 0
    v_accvgpr_write_b32 a224, 0
    v_accvgpr_write_b32 a225, 0
    v_accvgpr_write_b32 a226, 0
    v_accvgpr_write_b32 a227, 0
    v_accvgpr_write_b32 a228, 0
    v_accvgpr_write_b32 a229, 0
    v_accvgpr_write_b32 a230, 0
    v_accvgpr_write_b32 a231, 0
    v_accvgpr_write_b32 a232, 0
    v_accvgpr_write_b32 a233, 0
    v_accvgpr_write_b32 a234, 0
    v_accvgpr_write_b32 a235, 0
    v_accvgpr_write_b32 a236, 0
    v_accvgpr_write_b32 a237, 0
    v_accvgpr_write_b32 a238, 0
    v_accvgpr_write_b32 a239, 0
    v_accvgpr_write_b32 a244, 0
    v_accvgpr_write_b32 a245, 0
    v_accvgpr_write_b32 a246, 0
    v_accvgpr_write_b32 a247, 0
    v_accvgpr_write_b32 a248, 0
    v_accvgpr_write_b32 a249, 0
    v_accvgpr_write_b32 a250, 0
    v_accvgpr_write_b32 a251, 0
    v_accvgpr_write_b32 a252, 0
    v_accvgpr_write_b32 a253, 0
    v_accvgpr_write_b32 a254, 0
    v_accvgpr_write_b32 a255, 0
    v_mov_b32 v128, 0
    v_mov_b32 v129, 0
    v_mov_b32 v130, 0
    v_mov_b32 v131, 0
    v_mov_b32 v132, 0
    v_mov_b32 v133, 0
    v_mov_b32 v134, 0
    v_mov_b32 v135, 0
    v_mov_b32 v140, 0
    v_mov_b32 v141, 0
    v_mov_b32 v142, 0
    v_mov_b32 v143, 0
    v_mov_b32 v144, 0
    v_mov_b32 v145, 0
    v_mov_b32 v146, 0
    v_mov_b32 v147, 0
    v_mov_b32 v148, 0
    v_mov_b32 v149, 0
    v_mov_b32 v150, 0
    v_mov_b32 v151, 0
    v_mov_b32 v152, 0
    v_mov_b32 v153, 0
    v_mov_b32 v154, 0
    v_mov_b32 v155, 0
    v_mov_b32 v156, 0
    v_mov_b32 v157, 0
    v_mov_b32 v158, 0
    v_mov_b32 v159, 0
    v_mov_b32 v164, 0
    v_mov_b32 v165, 0
    v_mov_b32 v166, 0
    v_mov_b32 v167, 0
    v_mov_b32 v168, 0
    v_mov_b32 v169, 0
    v_mov_b32 v170, 0
    v_mov_b32 v171, 0
    v_mov_b32 v172, 0
    v_mov_b32 v173, 0
    v_mov_b32 v174, 0
    v_mov_b32 v175, 0
    v_mov_b32 v176, 0
    v_mov_b32 v177, 0
    v_mov_b32 v178, 0
    v_mov_b32 v179, 0
    v_mov_b32 v180, 0
    v_mov_b32 v181, 0
    v_mov_b32 v182, 0
    v_mov_b32 v183, 0
    v_mov_b32 v188, 0
    v_mov_b32 v189, 0
    v_mov_b32 v190, 0
    v_mov_b32 v191, 0
    v_mov_b32 v192, 0
    v_mov_b32 v193, 0
    v_mov_b32 v194, 0
    v_mov_b32 v195, 0
    v_mov_b32 v196, 0
    v_mov_b32 v197, 0
    v_mov_b32 v198, 0
    v_mov_b32 v199, 0
    v_mov_b32 v200, 0
    v_mov_b32 v201, 0
    v_mov_b32 v202, 0
    v_mov_b32 v203, 0
    v_mov_b32 v204, 0
    v_mov_b32 v205, 0
    v_mov_b32 v206, 0
    v_mov_b32 v207, 0
    v_mov_b32 v212, 0
    v_mov_b32 v213, 0
    v_mov_b32 v214, 0
    v_mov_b32 v215, 0
    v_mov_b32 v216, 0
    v_mov_b32 v217, 0
    v_mov_b32 v218, 0
    v_mov_b32 v219, 0
    v_mov_b32 v220, 0
    v_mov_b32 v221, 0
    v_mov_b32 v222, 0
    v_mov_b32 v223, 0
    v_mov_b32 v224, 0
    v_mov_b32 v225, 0
    v_mov_b32 v226, 0
    v_mov_b32 v227, 0
    v_mov_b32 v228, 0
    v_mov_b32 v229, 0
    v_mov_b32 v230, 0
    v_mov_b32 v231, 0
    v_mov_b32 v236, 0
    v_mov_b32 v237, 0
    v_mov_b32 v238, 0
    v_mov_b32 v239, 0
    v_mov_b32 v240, 0
    v_mov_b32 v241, 0
    v_mov_b32 v242, 0
    v_mov_b32 v243, 0
    v_mov_b32 v244, 0
    v_mov_b32 v245, 0
    v_mov_b32 v246, 0
    v_mov_b32 v247, 0
    v_mov_b32 v248, 0
    v_mov_b32 v249, 0
    v_mov_b32 v250, 0
    v_mov_b32 v251, 0
    v_mov_b32 v252, 0
    v_mov_b32 v253, 0
    v_mov_b32 v254, 0
    v_mov_b32 v255, 0
    v_accvgpr_write_b32 a128, 0
    v_accvgpr_write_b32 a129, 0
    v_accvgpr_write_b32 a130, 0
    v_accvgpr_write_b32 a131, 0
    v_accvgpr_write_b32 a132, 0
    v_accvgpr_write_b32 a133, 0
    v_accvgpr_write_b32 a134, 0
    v_accvgpr_write_b32 a135, 0
    v_accvgpr_write_b32 a136, 0
    v_accvgpr_write_b32 a137, 0
    v_accvgpr_write_b32 a138, 0
    v_accvgpr_write_b32 a139, 0
    v_accvgpr_write_b32 a140, 0
    v_accvgpr_write_b32 a141, 0
    v_accvgpr_write_b32 a142, 0
    v_accvgpr_write_b32 a143, 0
    v_accvgpr_write_b32 a144, 0
    v_accvgpr_write_b32 a145, 0
    v_accvgpr_write_b32 a146, 0
    v_accvgpr_write_b32 a147, 0
    v_accvgpr_write_b32 a148, 0
    v_accvgpr_write_b32 a149, 0
    v_accvgpr_write_b32 a150, 0
    v_accvgpr_write_b32 a151, 0
    v_accvgpr_write_b32 a152, 0
    v_accvgpr_write_b32 a153, 0
    v_accvgpr_write_b32 a154, 0
    v_accvgpr_write_b32 a155, 0
    v_accvgpr_write_b32 a156, 0
    v_accvgpr_write_b32 a157, 0
    v_accvgpr_write_b32 a158, 0
    v_accvgpr_write_b32 a159, 0
    v_accvgpr_write_b32 a160, 0
    v_accvgpr_write_b32 a161, 0
    v_accvgpr_write_b32 a162, 0
    v_accvgpr_write_b32 a163, 0
    v_accvgpr_write_b32 a164, 0
    v_accvgpr_write_b32 a165, 0
    v_accvgpr_write_b32 a166, 0
    v_accvgpr_write_b32 a167, 0
    v_accvgpr_write_b32 a168, 0
    v_accvgpr_write_b32 a169, 0
    v_accvgpr_write_b32 a170, 0
    v_accvgpr_write_b32 a171, 0
    v_accvgpr_write_b32 a172, 0
    v_accvgpr_write_b32 a173, 0
    v_accvgpr_write_b32 a174, 0
    v_accvgpr_write_b32 a175, 0
    v_accvgpr_write_b32 a176, 0
    v_accvgpr_write_b32 a177, 0
    v_accvgpr_write_b32 a178, 0
    v_accvgpr_write_b32 a179, 0
    v_accvgpr_write_b32 a180, 0
    v_accvgpr_write_b32 a181, 0
    v_accvgpr_write_b32 a182, 0
    v_accvgpr_write_b32 a183, 0
    v_accvgpr_write_b32 a184, 0
    v_accvgpr_write_b32 a185, 0
    v_accvgpr_write_b32 a186, 0
    v_accvgpr_write_b32 a187, 0
    v_accvgpr_write_b32 a188, 0
    v_accvgpr_write_b32 a189, 0
    v_accvgpr_write_b32 a190, 0
    v_accvgpr_write_b32 a191, 0
    s_cmp_eq_u32 s20, 0
    s_cbranch_scc1 F_wok
    v_accvgpr_write_b32 a0, 0
    v_accvgpr_write_b32 a1, 0
    v_accvgpr_write_b32 a2, 0
    v_accvgpr_write_b32 a3, 0
    v_accvgpr_write_b32 a4, 0
    v_accvgpr_write_b32 a5, 0
    v_accvgpr_write_b32 a6, 0
    v_accvgpr_write_b32 a7, 0
    v_accvgpr_write_b32 a8, 0
    v_accvgpr_write_b32 a9, 0
    v_accvgpr_write_b32 a10, 0
    v_accvgpr_write_b32 a11, 0
    v_accvgpr_write_b32 a12, 0
    v_accvgpr_write_b32 a13, 0
    v_accvgpr_write_b32 a14, 0
    v_accvgpr_write_b32 a15, 0
    v_accvgpr_write_b32 a16, 0
    v_accvgpr_write_b32 a17, 0
    v_accvgpr_write_b32 a18, 0
    v_accvgpr_write_b32 a19, 0
    v_accvgpr_write_b32 a20, 0
    v_accvgpr_write_b32 a21, 0
    v_accvgpr_write_b32 a22, 0
    v_accvgpr_write_b32 a23, 0
    v_accvgpr_write_b32 a24, 0
    v_accvgpr_write_b32 a25, 0
    v_accvgpr_write_b32 a26, 0
    v_accvgpr_write_b32 a27, 0
    v_accvgpr_write_b32 a28, 0
    v_accvgpr_write_b32 a29, 0
    v_accvgpr_write_b32 a30, 0
    v_accvgpr_write_b32 a31, 0
    v_accvgpr_write_b32 a32, 0
    v_accvgpr_write_b32 a33, 0
    v_accvgpr_write_b32 a34, 0
    v_accvgpr_write_b32 a35, 0
    v_accvgpr_write_b32 a36, 0
    v_accvgpr_write_b32 a37, 0
    v_accvgpr_write_b32 a38, 0
    v_accvgpr_write_b32 a39, 0
    v_accvgpr_write_b32 a40, 0
    v_accvgpr_write_b32 a41, 0
    v_accvgpr_write_b32 a42, 0
    v_accvgpr_write_b32 a43, 0
    v_accvgpr_write_b32 a44, 0
    v_accvgpr_write_b32 a45, 0
    v_accvgpr_write_b32 a46, 0
    v_accvgpr_write_b32 a47, 0
    v_accvgpr_write_b32 a48, 0
    v_accvgpr_write_b32 a49, 0
    v_accvgpr_write_b32 a50, 0
    v_accvgpr_write_b32 a51, 0
    v_accvgpr_write_b32 a52, 0
    v_accvgpr_write_b32 a53, 0
    v_accvgpr_write_b32 a54, 0
    v_accvgpr_write_b32 a55, 0
    v_accvgpr_write_b32 a56, 0
    v_accvgpr_write_b32 a57, 0
    v_accvgpr_write_b32 a58, 0
    v_accvgpr_write_b32 a59, 0
    v_accvgpr_write_b32 a60, 0
    v_accvgpr_write_b32 a61, 0
    v_accvgpr_write_b32 a62, 0
    v_accvgpr_write_b32 a63, 0
    v_accvgpr_write_b32 a64, 0
    v_accvgpr_write_b32 a65, 0
    v_accvgpr_write_b32 a66, 0
    v_accvgpr_write_b32 a67, 0
    v_accvgpr_write_b32 a68, 0
    v_accvgpr_write_b32 a69, 0
    v_accvgpr_write_b32 a70, 0
    v_accvgpr_write_b32 a71, 0
    v_accvgpr_write_b32 a72, 0
    v_accvgpr_write_b32 a73, 0
    v_accvgpr_write_b32 a74, 0
    v_accvgpr_write_b32 a75, 0
    v_accvgpr_write_b32 a76, 0
    v_accvgpr_write_b32 a77, 0
    v_accvgpr_write_b32 a78, 0
    v_accvgpr_write_b32 a79, 0
    v_accvgpr_write_b32 a80, 0
    v_accvgpr_write_b32 a81, 0
    v_accvgpr_write_b32 a82, 0
    v_accvgpr_write_b32 a83, 0
    v_accvgpr_write_b32 a84, 0
    v_accvgpr_write_b32 a85, 0
    v_accvgpr_write_b32 a86, 0
    v_accvgpr_write_b32 a87, 0
    v_accvgpr_write_b32 a88, 0
    v_accvgpr_write_b32 a89, 0
    v_accvgpr_write_b32 a90, 0
    v_accvgpr_write_b32 a91, 0
    v_accvgpr_write_b32 a92, 0
    v_accvgpr_write_b32 a93, 0
    v_accvgpr_write_b32 a94, 0
    v_accvgpr_write_b32 a95, 0
    v_accvgpr_write_b32 a96, 0
    v_accvgpr_write_b32 a97, 0
    v_accvgpr_write_b32 a98, 0
    v_accvgpr_write_b32 a99, 0
    v_accvgpr_write_b32 a100, 0
    v_accvgpr_write_b32 a101, 0
    v_accvgpr_write_b32 a102, 0
    v_accvgpr_write_b32 a103, 0
    v_accvgpr_write_b32 a104, 0
    v_accvgpr_write_b32 a105, 0
    v_accvgpr_write_b32 a106, 0
    v_accvgpr_write_b32 a107, 0
    v_accvgpr_write_b32 a108, 0
    v_accvgpr_write_b32 a109, 0
    v_accvgpr_write_b32 a110, 0
    v_accvgpr_write_b32 a111, 0
    v_accvgpr_write_b32 a112, 0
    v_accvgpr_write_b32 a113, 0
    v_accvgpr_write_b32 a114, 0
    v_accvgpr_write_b32 a115, 0
    v_accvgpr_write_b32 a116, 0
    v_accvgpr_write_b32 a117, 0
    v_accvgpr_write_b32 a118, 0
    v_accvgpr_write_b32 a119, 0
    v_accvgpr_write_b32 a120, 0
    v_accvgpr_write_b32 a121, 0
    v_accvgpr_write_b32 a122, 0
    v_accvgpr_write_b32 a123, 0
    v_accvgpr_write_b32 a124, 0
    v_accvgpr_write_b32 a125, 0
    v_accvgpr_write_b32 a126, 0
    v_accvgpr_write_b32 a127, 0
F_wok:
    v_and_b32 v7, 15, v5
    v_lshlrev_b32 v7, 2, v7
    v_add_u32 v8, 0, v6
    v_xor_b32 v8, v8, v5
    v_lshlrev_b32 v8, 4, v8
    v_lshl_add_u32 v8, v5, 10, v8
    v_add_u32 v9, 4, v6
    v_xor_b32 v9, v9, v5
    v_lshlrev_b32 v9, 4, v9
    v_lshl_add_u32 v9, v5, 10, v9
    v_add_u32 v10, 8, v6
    v_xor_b32 v10, v10, v5
    v_lshlrev_b32 v10, 4, v10
    v_lshl_add_u32 v10, v5, 10, v10
    v_add_u32 v11, 12, v6
    v_xor_b32 v11, v11, v5
    v_lshlrev_b32 v11, 4, v11
    v_lshl_add_u32 v11, v5, 10, v11
    s_mov_b32 s54, 0
    s_mov_b32 s64, 0xbfb8aa3b
    s_mov_b32 s65, s64
    s_mov_b32 s66, 1.0
    s_mov_b32 s67, 1.0
    s_mov_b32 s23, 0
    s_mov_b32 s24, s22
    s_mov_b32 s33, 0
    s_cmp_lg_u32 s20, 0
    s_cbranch_scc1 L_wd_63
L_w_62:
    buffer_load_dword v4, v2, s[4:7], 0 offen offset:0 sc1
    s_waitcnt vmcnt(0)
    v_readfirstlane_b32 s34, v4
    s_nop 0
    s_cmp_ge_u32 s34, 160
    s_cbranch_scc1 L_wd_63
    s_sleep 2
    s_sub_u32 s30, s30, 1
    s_cbranch_scc0 L_w_62
    s_branch M_done
L_wd_63:
    s_barrier
    buffer_load_dword v4, v2, s[4:7], s76 offen sc1
    s_waitcnt vmcnt(0)
    v_readfirstlane_b32 s34, v4
    s_nop 0
    s_lshr_b32 s34, s34, s75
    s_and_b32 s34, s34, 255
    s_cmp_eq_u32 s34, 8
    s_cbranch_scc1 F_loopL
F_loopG:
    s_cmp_lg_u32 s54, 0
    s_cbranch_scc1 L_fp_64
    s_lshl_b32 s26, s24, 8
    s_lshl_b32 s35, s20, 6
    s_add_u32 s26, s26, s35
    s_add_u32 s26, s26, 35869184
L_wf_65:
    buffer_load_dword v4, v7, s[8:11], s26 offen sc1
    s_waitcnt vmcnt(0)
    v_cmp_eq_u32 vcc, 0, v4
    s_nop 0
    s_cbranch_vccz L_wfd_66
    s_sleep 2
    s_sub_u32 s30, s30, 1
    s_cbranch_scc0 L_wf_65
    s_branch M_done
L_wfd_66:
    s_lshl_b32 s62, s24, 16
    s_lshl_b32 s63, s20, 14
    s_add_u32 s62, s62, s63
    s_add_u32 s62, s62, 29360128
    s_add_u32 m0, s63, 0
    v_xor_b32 v14, 0, v1
    buffer_load_dwordx4 v14, s[8:11], s62 offen offset:0 lds
    v_xor_b32 v15, 16, v1
    buffer_load_dwordx4 v15, s[8:11], s62 offen offset:1024 lds
    v_xor_b32 v14, 32, v1
    buffer_load_dwordx4 v14, s[8:11], s62 offen offset:2048 lds
    v_xor_b32 v15, 48, v1
    buffer_load_dwordx4 v15, s[8:11], s62 offen offset:3072 lds
    s_add_u32 s62, s62, 4096
    s_add_u32 m0, s63, 4096
    v_xor_b32 v14, 64, v1
    buffer_load_dwordx4 v14, s[8:11], s62 offen offset:0 lds
    v_xor_b32 v15, 80, v1
    buffer_load_dwordx4 v15, s[8:11], s62 offen offset:1024 lds
    v_xor_b32 v14, 96, v1
    buffer_load_dwordx4 v14, s[8:11], s62 offen offset:2048 lds
    v_xor_b32 v15, 112, v1
    buffer_load_dwordx4 v15, s[8:11], s62 offen offset:3072 lds
    s_add_u32 s62, s62, 4096
    s_add_u32 m0, s63, 8192
    v_xor_b32 v14, 128, v1
    buffer_load_dwordx4 v14, s[8:11], s62 offen offset:0 lds
    v_xor_b32 v15, 144, v1
    buffer_load_dwordx4 v15, s[8:11], s62 offen offset:1024 lds
    v_xor_b32 v14, 160, v1
    buffer_load_dwordx4 v14, s[8:11], s62 offen offset:2048 lds
    v_xor_b32 v15, 176, v1
    buffer_load_dwordx4 v15, s[8:11], s62 offen offset:3072 lds
    s_add_u32 s62, s62, 4096
    s_add_u32 m0, s63, 12288
    v_xor_b32 v14, 192, v1
    buffer_load_dwordx4 v14, s[8:11], s62 offen offset:0 lds
    v_xor_b32 v15, 208, v1
    buffer_load_dwordx4 v15, s[8:11], s62 offen offset:1024 lds
    v_xor_b32 v14, 224, v1
    buffer_load_dwordx4 v14, s[8:11], s62 offen offset:2048 lds
    v_xor_b32 v15, 240, v1
    buffer_load_dwordx4 v15, s[8:11], s62 offen offset:3072 lds
L_fp_64:
    s_waitcnt vmcnt(0)
    s_barrier
    s_lshl_b32 s28, s21, 3
    s_lshl_b32 s26, s20, 1
    s_add_u32 s28, s28, s26
    s_and_b32 s29, s24, 31
    s_lshl_b32 s29, s29, 6
    s_add_u32 s29, s29, s28
    s_lshl_b32 s29, s29, 10
    s_lshl_b32 s26, s23, 21
    s_add_u32 s26, s26, s29
    s_add_u32 s26, s26, 25165824
    s_lshl_b32 s58, s20, 11
    s_add_u32 s58, s58, 98304
    s_mov_b32 m0, s58
    s_nop 0
    buffer_load_dwordx4 v1, s[8:11], s26 offen sc1 lds
    buffer_load_dwordx4 v1, s[8:11], s26 offen offset:1024 sc1 lds
    s_mul_i32 s25, s20, 3
    s_add_u32 s25, s25, 0
    s_lshr_b32 s26, s25, 1
    s_lshl_b32 s26, s26, 10
    s_and_b32 s25, s25, 1
    s_lshl_b32 s25, s25, 3
    s_add_u32 s25, s25, s26
    s_add_u32 s25, s25, 65536
    v_add_u32 v96, s25, v1
    s_mul_i32 s25, s20, 3
    s_add_u32 s25, s25, 1
    s_lshr_b32 s26, s25, 1
    s_lshl_b32 s26, s26, 10
    s_and_b32 s25, s25, 1
    s_lshl_b32 s25, s25, 3
    s_add_u32 s25, s25, s26
    s_add_u32 s25, s25, 65536
    v_add_u32 v97, s25, v1
    s_mul_i32 s25, s20, 3
    s_add_u32 s25, s25, 2
    s_lshr_b32 s26, s25, 1
    s_lshl_b32 s26, s26, 10
    s_and_b32 s25, s25, 1
    s_lshl_b32 s25, s25, 3
    s_add_u32 s25, s25, s26
    s_add_u32 s25, s25, 65536
    v_add_u32 v98, s25, v1
    ds_read_b128 v[64:67], v8 offset:0
    ds_read_b128 v[68:71], v9 offset:0
    ds_read_b128 v[72:75], v10 offset:0
    ds_read_b128 v[76:79], v11 offset:0
    ds_read_b128 v[80:83], v8 offset:256
    ds_read_b128 v[84:87], v9 offset:256
    ds_read_b128 v[88:91], v10 offset:256
    s_waitcnt lgkmcnt(6)
    v_mfma_f32_16x16x32_bf16 v[16:19], a[0:3], v[64:67], 0
    v_mfma_f32_16x16x32_bf16 v[20:23], a[64:67], v[64:67], 0
    v_mfma_f32_16x16x32_bf16 v[24:27], a[128:131], v[64:67], 0
    ds_read_b128 v[92:95], v11 offset:256
    s_waitcnt lgkmcnt(6)
    v_mfma_f32_16x16x32_bf16 v[16:19], a[4:7], v[68:71], v[16:19]
    v_mfma_f32_16x16x32_bf16 v[20:23], a[68:71], v[68:71], v[20:23]
    v_mfma_f32_16x16x32_bf16 v[24:27], a[132:135], v[68:71], v[24:27]
    ds_read_b128 v[64:67], v8 offset:512
    s_waitcnt lgkmcnt(6)
    v_mfma_f32_16x16x32_bf16 v[16:19], a[8:11], v[72:75], v[16:19]
    v_mfma_f32_16x16x32_bf16 v[20:23], a[72:75], v[72:75], v[20:23]
    v_mfma_f32_16x16x32_bf16 v[24:27], a[136:139], v[72:75], v[24:27]
    ds_read_b128 v[68:71], v9 offset:512
    s_waitcnt lgkmcnt(6)
    v_mfma_f32_16x16x32_bf16 v[16:19], a[12:15], v[76:79], v[16:19]
    v_mfma_f32_16x16x32_bf16 v[20:23], a[76:79], v[76:79], v[20:23]
    v_mfma_f32_16x16x32_bf16 v[24:27], a[140:143], v[76:79], v[24:27]
    ds_read_b128 v[72:75], v10 offset:512
    s_waitcnt lgkmcnt(6)
    v_mfma_f32_16x16x32_bf16 v[16:19], a[16:19], v[80:83], v[16:19]
    v_mfma_f32_16x16x32_bf16 v[20:23], a[80:83], v[80:83], v[20:23]
    v_mfma_f32_16x16x32_bf16 v[24:27], a[144:147], v[80:83], v[24:27]
    ds_read_b128 v[76:79], v11 offset:512
    s_waitcnt lgkmcnt(6)
    v_mfma_f32_16x16x32_bf16 v[16:19], a[20:23], v[84:87], v[16:19]
    v_mfma_f32_16x16x32_bf16 v[20:23], a[84:87], v[84:87], v[20:23]
    v_mfma_f32_16x16x32_bf16 v[24:27], a[148:151], v[84:87], v[24:27]
    ds_read_b128 v[80:83], v8 offset:768
    s_waitcnt lgkmcnt(6)
    v_mfma_f32_16x16x32_bf16 v[16:19], a[24:27], v[88:91], v[16:19]
    v_mfma_f32_16x16x32_bf16 v[20:23], a[88:91], v[88:91], v[20:23]
    v_mfma_f32_16x16x32_bf16 v[24:27], a[152:155], v[88:91], v[24:27]
    ds_read_b128 v[84:87], v9 offset:768
    s_waitcnt lgkmcnt(6)
    v_mfma_f32_16x16x32_bf16 v[16:19], a[28:31], v[92:95], v[16:19]
    v_mfma_f32_16x16x32_bf16 v[20:23], a[92:95], v[92:95], v[20:23]
    v_mfma_f32_16x16x32_bf16 v[24:27], a[156:159], v[92:95], v[24:27]
    ds_read_b128 v[88:91], v10 offset:768
    s_waitcnt lgkmcnt(6)
    v_mfma_f32_16x16x32_bf16 v[16:19], a[32:35], v[64:67], v[16:19]
    v_mfma_f32_16x16x32_bf16 v[20:23], a[96:99], v[64:67], v[20:23]
    v_mfma_f32_16x16x32_bf16 v[24:27], a[160:163], v[64:67], v[24:27]
    ds_read_b128 v[92:95], v11 offset:768
    s_waitcnt lgkmcnt(6)
    v_mfma_f32_16x16x32_bf16 v[16:19], a[36:39], v[68:71], v[16:19]
    v_mfma_f32_16x16x32_bf16 v[20:23], a[100:103], v[68:71], v[20:23]
    v_mfma_f32_16x16x32_bf16 v[24:27], a[164:167], v[68:71], v[24:27]
    ds_read_b128 v[64:67], v8 offset:16384
    s_waitcnt lgkmcnt(6)
    v_mfma_f32_16x16x32_bf16 v[16:19], a[40:43], v[72:75], v[16:19]
    v_mfma_f32_16x16x32_bf16 v[20:23], a[104:107], v[72:75], v[20:23]
    v_mfma_f32_16x16x32_bf16 v[24:27], a[168:171], v[72:75], v[24:27]
    ds_read_b128 v[68:71], v9 offset:16384
    s_waitcnt lgkmcnt(6)
    v_mfma_f32_16x16x32_bf16 v[16:19], a[44:47], v[76:79], v[16:19]
    v_mfma_f32_16x16x32_bf16 v[20:23], a[108:111], v[76:79], v[20:23]
    v_mfma_f32_16x16x32_bf16 v[24:27], a[172:175], v[76:79], v[24:27]
    ds_read_b128 v[72:75], v10 offset:16384
    s_waitcnt lgkmcnt(6)
    v_mfma_f32_16x16x32_bf16 v[16:19], a[48:51], v[80:83], v[16:19]
    v_mfma_f32_16x16x32_bf16 v[20:23], a[112:115], v[80:83], v[20:23]
    v_mfma_f32_16x16x32_bf16 v[24:27], a[176:179], v[80:83], v[24:27]
    ds_read_b128 v[76:79], v11 offset:16384
    s_waitcnt lgkmcnt(6)
    v_mfma_f32_16x16x32_bf16 v[16:19], a[52:55], v[84:87], v[16:19]
    v_mfma_f32_16x16x32_bf16 v[20:23], a[116:119], v[84:87], v[20:23]
    v_mfma_f32_16x16x32_bf16 v[24:27], a[180:183], v[84:87], v[24:27]
    ds_read_b128 v[80:83], v8 offset:16640
    s_waitcnt lgkmcnt(6)
    v_mfma_f32_16x16x32_bf16 v[16:19], a[56:59], v[88:91], v[16:19]
    v_mfma_f32_16x16x32_bf16 v[20:23], a[120:123], v[88:91], v[20:23]
    v_mfma_f32_16x16x32_bf16 v[24:27], a[184:187], v[88:91], v[24:27]
    ds_read_b128 v[84:87], v9 offset:16640
    s_waitcnt lgkmcnt(6)
    v_mfma_f32_16x16x32_bf16 v[16:19], a[60:63], v[92:95], v[16:19]
    v_mfma_f32_16x16x32_bf16 v[20:23], a[124:127], v[92:95], v[20:23]
    v_mfma_f32_16x16x32_bf16 v[24:27], a[188:191], v[92:95], v[24:27]
    ds_read_b128 v[88:91], v10 offset:16640
    s_waitcnt lgkmcnt(6)
    v_mfma_f32_16x16x32_bf16 v[28:31], a[0:3], v[64:67], 0
    v_mfma_f32_16x16x32_bf16 v[32:35], a[64:67], v[64:67], 0
    v_mfma_f32_16x16x32_bf16 v[36:39], a[128:131], v[64:67], 0
    ds_read_b128 v[92:95], v11 offset:16640
    s_waitcnt lgkmcnt(6)
    v_mfma_f32_16x16x32_bf16 v[28:31], a[4:7], v[68:71], v[28:31]
    v_mul_f32 v100, s64, v16
    v_mul_f32 v101, s64, v17
    v_mfma_f32_16x16x32_bf16 v[32:35], a[68:71], v[68:71], v[32:35]
    v_mul_f32 v102, s64, v18
    v_mul_f32 v103, s64, v19
    v_mfma_f32_16x16x32_bf16 v[36:39], a[132:135], v[68:71], v[36:39]
    v_exp_f32 v100, v100
    ds_read_b128 v[64:67], v8 offset:16896
    s_waitcnt lgkmcnt(6)
    v_mfma_f32_16x16x32_bf16 v[28:31], a[8:11], v[72:75], v[28:31]
    v_exp_f32 v101, v101
    v_mfma_f32_16x16x32_bf16 v[32:35], a[72:75], v[72:75], v[32:35]
    v_exp_f32 v102, v102
    v_mfma_f32_16x16x32_bf16 v[36:39], a[136:139], v[72:75], v[36:39]
    v_exp_f32 v103, v103
    ds_read_b128 v[68:71], v9 offset:16896
    s_waitcnt lgkmcnt(6)
    v_mfma_f32_16x16x32_bf16 v[28:31], a[12:15], v[76:79], v[28:31]
    v_add_f32 v100, 1.0, v100
    v_add_f32 v101, 1.0, v101
    v_mfma_f32_16x16x32_bf16 v[32:35], a[76:79], v[76:79], v[32:35]
    v_add_f32 v102, 1.0, v102
    v_add_f32 v103, 1.0, v103
    v_mfma_f32_16x16x32_bf16 v[36:39], a[140:143], v[76:79], v[36:39]
    v_rcp_f32 v100, v100
    ds_read_b128 v[72:75], v10 offset:16896
    s_waitcnt lgkmcnt(6)
    v_mfma_f32_16x16x32_bf16 v[28:31], a[16:19], v[80:83], v[28:31]
    v_rcp_f32 v101, v101
    v_mfma_f32_16x16x32_bf16 v[32:35], a[80:83], v[80:83], v[32:35]
    v_rcp_f32 v102, v102
    v_mfma_f32_16x16x32_bf16 v[36:39], a[144:147], v[80:83], v[36:39]
    v_rcp_f32 v103, v103
    ds_read_b128 v[76:79], v11 offset:16896
    s_waitcnt lgkmcnt(6)
    v_mfma_f32_16x16x32_bf16 v[28:31], a[20:23], v[84:87], v[28:31]
    v_mul_f32 v16, v16, v100
    v_mul_f32 v17, v17, v101
    v_mfma_f32_16x16x32_bf16 v[32:35], a[84:87], v[84:87], v[32:35]
    v_mul_f32 v18, v18, v102
    v_mul_f32 v19, v19, v103
    v_mfma_f32_16x16x32_bf16 v[36:39], a[148:151], v[84:87], v[36:39]
    v_cvt_pk_bf16_f32 v16, v16, v17
    v_cvt_pk_bf16_f32 v17, v18, v19
    ds_read_b128 v[80:83], v8 offset:17152
    s_waitcnt lgkmcnt(6)
    v_mfma_f32_16x16x32_bf16 v[28:31], a[24:27], v[88:91], v[28:31]
    v_mul_f32 v104, s64, v20
    v_mul_f32 v105, s64, v21
    v_mfma_f32_16x16x32_bf16 v[32:35], a[88:91], v[88:91], v[32:35]
    v_mul_f32 v106, s64, v22
    v_mul_f32 v107, s64, v23
    v_mfma_f32_16x16x32_bf16 v[36:39], a[152:155], v[88:91], v[36:39]
    v_exp_f32 v104, v104
    ds_read_b128 v[84:87], v9 offset:17152
    s_waitcnt lgkmcnt(6)
    v_mfma_f32_16x16x32_bf16 v[28:31], a[28:31], v[92:95], v[28:31]
    v_exp_f32 v105, v105
    v_mfma_f32_16x16x32_bf16 v[32:35], a[92:95], v[92:95], v[32:35]
    v_exp_f32 v106, v106
    v_mfma_f32_16x16x32_bf16 v[36:39], a[156:159], v[92:95], v[36:39]
    v_exp_f32 v107, v107
    ds_read_b128 v[88:91], v10 offset:17152
    s_waitcnt lgkmcnt(6)
    v_mfma_f32_16x16x32_bf16 v[28:31], a[32:35], v[64:67], v[28:31]
    v_add_f32 v104, 1.0, v104
    v_add_f32 v105, 1.0, v105
    v_mfma_f32_16x16x32_bf16 v[32:35], a[96:99], v[64:67], v[32:35]
    v_add_f32 v106, 1.0, v106
    v_add_f32 v107, 1.0, v107
    v_mfma_f32_16x16x32_bf16 v[36:39], a[160:163], v[64:67], v[36:39]
    v_rcp_f32 v104, v104
    ds_read_b128 v[92:95], v11 offset:17152
    s_waitcnt lgkmcnt(6)
    v_mfma_f32_16x16x32_bf16 v[28:31], a[36:39], v[68:71], v[28:31]
    v_rcp_f32 v105, v105
    v_mfma_f32_16x16x32_bf16 v[32:35], a[100:103], v[68:71], v[32:35]
    v_rcp_f32 v106, v106
    v_mfma_f32_16x16x32_bf16 v[36:39], a[164:167], v[68:71], v[36:39]
    v_rcp_f32 v107, v107
    ds_read_b128 v[64:67], v8 offset:32768
    s_waitcnt lgkmcnt(6)
    v_mfma_f32_16x16x32_bf16 v[28:31], a[40:43], v[72:75], v[28:31]
    v_mul_f32 v20, v20, v104
    v_mul_f32 v21, v21, v105
    v_mfma_f32_16x16x32_bf16 v[32:35], a[104:107], v[72:75], v[32:35]
    v_mul_f32 v22, v22, v106
    v_mul_f32 v23, v23, v107
    v_mfma_f32_16x16x32_bf16 v[36:39], a[168:171], v[72:75], v[36:39]
    v_cvt_pk_bf16_f32 v20, v20, v21
    v_cvt_pk_bf16_f32 v21, v22, v23
    ds_read_b128 v[68:71], v9 offset:32768
    s_waitcnt lgkmcnt(6)
    v_mfma_f32_16x16x32_bf16 v[28:31], a[44:47], v[76:79], v[28:31]
    v_mul_f32 v108, s64, v24
    v_mul_f32 v109, s64, v25
    v_mfma_f32_16x16x32_bf16 v[32:35], a[108:111], v[76:79], v[32:35]
    v_mul_f32 v110, s64, v26
    v_mul_f32 v111, s64, v27
    v_mfma_f32_16x16x32_bf16 v[36:39], a[172:175], v[76:79], v[36:39]
    v_exp_f32 v108, v108
    ds_read_b128 v[72:75], v10 offset:32768
    s_waitcnt lgkmcnt(6)
    v_mfma_f32_16x16x32_bf16 v[28:31], a[48:51], v[80:83], v[28:31]
    v_exp_f32 v109, v109
    v_mfma_f32_16x16x32_bf16 v[32:35], a[112:115], v[80:83], v[32:35]
    v_exp_f32 v110, v110
    v_mfma_f32_16x16x32_bf16 v[36:39], a[176:179], v[80:83], v[36:39]
    v_exp_f32 v111, v111
    ds_read_b128 v[76:79], v11 offset:32768
    s_waitcnt lgkmcnt(6)
    v_mfma_f32_16x16x32_bf16 v[28:31], a[52:55], v[84:87], v[28:31]
    v_add_f32 v108, 1.0, v108
    v_add_f32 v109, 1.0, v109
    v_mfma_f32_16x16x32_bf16 v[32:35], a[116:119], v[84:87], v[32:35]
    v_add_f32 v110, 1.0, v110
    v_add_f32 v111, 1.0, v111
    v_mfma_f32_16x16x32_bf16 v[36:39], a[180:183], v[84:87], v[36:39]
    v_rcp_f32 v108, v108
    ds_read_b128 v[80:83], v8 offset:33024
    s_waitcnt lgkmcnt(6)
    v_mfma_f32_16x16x32_bf16 v[28:31], a[56:59], v[88:91], v[28:31]
    v_rcp_f32 v109, v109
    v_mfma_f32_16x16x32_bf16 v[32:35], a[120:123], v[88:91], v[32:35]
    v_rcp_f32 v110, v110
    v_mfma_f32_16x16x32_bf16 v[36:39], a[184:187], v[88:91], v[36:39]
    v_rcp_f32 v111, v111
    ds_read_b128 v[84:87], v9 offset:33024
    s_waitcnt lgkmcnt(6)
    v_mfma_f32_16x16x32_bf16 v[28:31], a[60:63], v[92:95], v[28:31]
    v_mul_f32 v24, v24, v108
    v_mul_f32 v25, v25, v109
    v_mfma_f32_16x16x32_bf16 v[32:35], a[124:127], v[92:95], v[32:35]
    v_mul_f32 v26, v26, v110
    v_mul_f32 v27, v27, v111
    v_mfma_f32_16x16x32_bf16 v[36:39], a[188:191], v[92:95], v[36:39]
    v_cvt_pk_bf16_f32 v24, v24, v25
    v_cvt_pk_bf16_f32 v25, v26, v27
    ds_read_b128 v[88:91], v10 offset:33024
    s_waitcnt lgkmcnt(6)
    v_mfma_f32_16x16x32_bf16 v[40:43], a[0:3], v[64:67], 0
    v_mfma_f32_16x16x32_bf16 v[44:47], a[64:67], v[64:67], 0
    v_mfma_f32_16x16x32_bf16 v[48:51], a[128:131], v[64:67], 0
    ds_read_b128 v[92:95], v11 offset:33024
    s_waitcnt lgkmcnt(6)
    v_mfma_f32_16x16x32_bf16 v[40:43], a[4:7], v[68:71], v[40:43]
    v_mul_f32 v100, s64, v28
    v_mul_f32 v101, s64, v29
    v_mfma_f32_16x16x32_bf16 v[44:47], a[68:71], v[68:71], v[44:47]
    v_mul_f32 v102, s64, v30
    v_mul_f32 v103, s64, v31
    v_mfma_f32_16x16x32_bf16 v[48:51], a[132:135], v[68:71], v[48:51]
    v_exp_f32 v100, v100
    ds_read_b128 v[64:67], v8 offset:33280
    s_waitcnt lgkmcnt(6)
    v_mfma_f32_16x16x32_bf16 v[40:43], a[8:11], v[72:75], v[40:43]
    v_exp_f32 v101, v101
    v_mfma_f32_16x16x32_bf16 v[44:47], a[72:75], v[72:75], v[44:47]
    v_exp_f32 v102, v102
    v_mfma_f32_16x16x32_bf16 v[48:51], a[136:139], v[72:75], v[48:51]
    v_exp_f32 v103, v103
    ds_read_b128 v[68:71], v9 offset:33280
    s_waitcnt lgkmcnt(6)
    v_mfma_f32_16x16x32_bf16 v[40:43], a[12:15], v[76:79], v[40:43]
    v_add_f32 v100, 1.0, v100
    v_add_f32 v101, 1.0, v101
    v_mfma_f32_16x16x32_bf16 v[44:47], a[76:79], v[76:79], v[44:47]
    v_add_f32 v102, 1.0, v102
    v_add_f32 v103, 1.0, v103
    v_mfma_f32_16x16x32_bf16 v[48:51], a[140:143], v[76:79], v[48:51]
    v_rcp_f32 v100, v100
    ds_read_b128 v[72:75], v10 offset:33280
    s_waitcnt lgkmcnt(6)
    v_mfma_f32_16x16x32_bf16 v[40:43], a[16:19], v[80:83], v[40:43]
    v_rcp_f32 v101, v101
    v_mfma_f32_16x16x32_bf16 v[44:47], a[80:83], v[80:83], v[44:47]
    v_rcp_f32 v102, v102
    v_mfma_f32_16x16x32_bf16 v[48:51], a[144:147], v[80:83], v[48:51]
    v_rcp_f32 v103, v103
    ds_read_b128 v[76:79], v11 offset:33280
    s_waitcnt lgkmcnt(6)
    v_mfma_f32_16x16x32_bf16 v[40:43], a[20:23], v[84:87], v[40:43]
    v_mul_f32 v28, v28, v100
    v_mul_f32 v29, v29, v101
    v_mfma_f32_16x16x32_bf16 v[44:47], a[84:87], v[84:87], v[44:47]
    v_mul_f32 v30, v30, v102
    v_mul_f32 v31, v31, v103
    v_mfma_f32_16x16x32_bf16 v[48:51], a[148:151], v[84:87], v[48:51]
    v_cvt_pk_bf16_f32 v28, v28, v29
    v_cvt_pk_bf16_f32 v29, v30, v31
    ds_read_b128 v[80:83], v8 offset:33536
    s_waitcnt lgkmcnt(6)
    v_mfma_f32_16x16x32_bf16 v[40:43], a[24:27], v[88:91], v[40:43]
    v_mul_f32 v104, s64, v32
    v_mul_f32 v105, s64, v33
    v_mfma_f32_16x16x32_bf16 v[44:47], a[88:91], v[88:91], v[44:47]
    v_mul_f32 v106, s64, v34
    v_mul_f32 v107, s64, v35
    v_mfma_f32_16x16x32_bf16 v[48:51], a[152:155], v[88:91], v[48:51]
    v_exp_f32 v104, v104
    ds_read_b128 v[84:87], v9 offset:33536
    s_waitcnt lgkmcnt(6)
    v_mfma_f32_16x16x32_bf16 v[40:43], a[28:31], v[92:95], v[40:43]
    v_exp_f32 v105, v105
    v_mfma_f32_16x16x32_bf16 v[44:47], a[92:95], v[92:95], v[44:47]
    v_exp_f32 v106, v106
    v_mfma_f32_16x16x32_bf16 v[48:51], a[156:159], v[92:95], v[48:51]
    v_exp_f32 v107, v107
    ds_read_b128 v[88:91], v10 offset:33536
    s_waitcnt lgkmcnt(6)
    v_mfma_f32_16x16x32_bf16 v[40:43], a[32:35], v[64:67], v[40:43]
    v_add_f32 v104, 1.0, v104
    v_add_f32 v105, 1.0, v105
    v_mfma_f32_16x16x32_bf16 v[44:47], a[96:99], v[64:67], v[44:47]
    v_add_f32 v106, 1.0, v106
    v_add_f32 v107, 1.0, v107
    v_mfma_f32_16x16x32_bf16 v[48:51], a[160:163], v[64:67], v[48:51]
    v_rcp_f32 v104, v104
    ds_read_b128 v[92:95], v11 offset:33536
    s_waitcnt lgkmcnt(6)
    v_mfma_f32_16x16x32_bf16 v[40:43], a[36:39], v[68:71], v[40:43]
    v_rcp_f32 v105, v105
    v_mfma_f32_16x16x32_bf16 v[44:47], a[100:103], v[68:71], v[44:47]
    v_rcp_f32 v106, v106
    v_mfma_f32_16x16x32_bf16 v[48:51], a[164:167], v[68:71], v[48:51]
    v_rcp_f32 v107, v107
    ds_read_b128 v[64:67], v8 offset:49152
    s_waitcnt lgkmcnt(6)
    v_mfma_f32_16x16x32_bf16 v[40:43], a[40:43], v[72:75], v[40:43]
    v_mul_f32 v32, v32, v104
    v_mul_f32 v33, v33, v105
    v_mfma_f32_16x16x32_bf16 v[44:47], a[104:107], v[72:75], v[44:47]
    v_mul_f32 v34, v34, v106
    v_mul_f32 v35, v35, v107
    v_mfma_f32_16x16x32_bf16 v[48:51], a[168:171], v[72:75], v[48:51]
    v_cvt_pk_bf16_f32 v32, v32, v33
    v_cvt_pk_bf16_f32 v33, v34, v35
    ds_read_b128 v[68:71], v9 offset:49152
    s_waitcnt lgkmcnt(6)
    v_mfma_f32_16x16x32_bf16 v[40:43], a[44:47], v[76:79], v[40:43]
    v_mul_f32 v108, s64, v36
    v_mul_f32 v109, s64, v37
    v_mfma_f32_16x16x32_bf16 v[44:47], a[108:111], v[76:79], v[44:47]
    v_mul_f32 v110, s64, v38
    v_mul_f32 v111, s64, v39
    v_mfma_f32_16x16x32_bf16 v[48:51], a[172:175], v[76:79], v[48:51]
    v_exp_f32 v108, v108
    ds_read_b128 v[72:75], v10 offset:49152
    s_waitcnt lgkmcnt(6)
    v_mfma_f32_16x16x32_bf16 v[40:43], a[48:51], v[80:83], v[40:43]
    v_exp_f32 v109, v109
    v_mfma_f32_16x16x32_bf16 v[44:47], a[112:115], v[80:83], v[44:47]
    v_exp_f32 v110, v110
    v_mfma_f32_16x16x32_bf16 v[48:51], a[176:179], v[80:83], v[48:51]
    v_exp_f32 v111, v111
    ds_read_b128 v[76:79], v11 offset:49152
    s_waitcnt lgkmcnt(6)
    v_mfma_f32_16x16x32_bf16 v[40:43], a[52:55], v[84:87], v[40:43]
    v_add_f32 v108, 1.0, v108
    v_add_f32 v109, 1.0, v109
    v_mfma_f32_16x16x32_bf16 v[44:47], a[116:119], v[84:87], v[44:47]
    v_add_f32 v110, 1.0, v110
    v_add_f32 v111, 1.0, v111
    v_mfma_f32_16x16x32_bf16 v[48:51], a[180:183], v[84:87], v[48:51]
    v_rcp_f32 v108, v108
    ds_read_b128 v[80:83], v8 offset:49408
    s_waitcnt lgkmcnt(6)
    v_mfma_f32_16x16x32_bf16 v[40:43], a[56:59], v[88:91], v[40:43]
    v_rcp_f32 v109, v109
    v_mfma_f32_16x16x32_bf16 v[44:47], a[120:123], v[88:91], v[44:47]
    v_rcp_f32 v110, v110
    v_mfma_f32_16x16x32_bf16 v[48:51], a[184:187], v[88:91], v[48:51]
    v_rcp_f32 v111, v111
    ds_read_b128 v[84:87], v9 offset:49408
    s_waitcnt lgkmcnt(6)
    v_mfma_f32_16x16x32_bf16 v[40:43], a[60:63], v[92:95], v[40:43]
    v_mul_f32 v36, v36, v108
    v_mul_f32 v37, v37, v109
    v_mfma_f32_16x16x32_bf16 v[44:47], a[124:127], v[92:95], v[44:47]
    v_mul_f32 v38, v38, v110
    v_mul_f32 v39, v39, v111
    v_mfma_f32_16x16x32_bf16 v[48:51], a[188:191], v[92:95], v[48:51]
    v_cvt_pk_bf16_f32 v36, v36, v37
    v_cvt_pk_bf16_f32 v37, v38, v39
    ds_read_b128 v[88:91], v10 offset:49408
    s_waitcnt lgkmcnt(6)
    v_mfma_f32_16x16x32_bf16 v[52:55], a[0:3], v[64:67], 0
    v_mfma_f32_16x16x32_bf16 v[56:59], a[64:67], v[64:67], 0
    v_mfma_f32_16x16x32_bf16 v[60:63], a[128:131], v[64:67], 0
    ds_read_b128 v[92:95], v11 offset:49408
    s_waitcnt lgkmcnt(6)
    v_mfma_f32_16x16x32_bf16 v[52:55], a[4:7], v[68:71], v[52:55]
    v_mul_f32 v100, s64, v40
    v_mul_f32 v101, s64, v41
    v_mfma_f32_16x16x32_bf16 v[56:59], a[68:71], v[68:71], v[56:59]
    v_mul_f32 v102, s64, v42
    v_mul_f32 v103, s64, v43
    v_mfma_f32_16x16x32_bf16 v[60:63], a[132:135], v[68:71], v[60:63]
    v_exp_f32 v100, v100
    ds_read_b128 v[64:67], v8 offset:49664
    s_waitcnt lgkmcnt(6)
    v_mfma_f32_16x16x32_bf16 v[52:55], a[8:11], v[72:75], v[52:55]
    v_exp_f32 v101, v101
    v_mfma_f32_16x16x32_bf16 v[56:59], a[72:75], v[72:75], v[56:59]
    v_exp_f32 v102, v102
    v_mfma_f32_16x16x32_bf16 v[60:63], a[136:139], v[72:75], v[60:63]
    v_exp_f32 v103, v103
    ds_read_b128 v[68:71], v9 offset:49664
    s_waitcnt lgkmcnt(6)
    v_mfma_f32_16x16x32_bf16 v[52:55], a[12:15], v[76:79], v[52:55]
    v_add_f32 v100, 1.0, v100
    v_add_f32 v101, 1.0, v101
    v_mfma_f32_16x16x32_bf16 v[56:59], a[76:79], v[76:79], v[56:59]
    v_add_f32 v102, 1.0, v102
    v_add_f32 v103, 1.0, v103
    v_mfma_f32_16x16x32_bf16 v[60:63], a[140:143], v[76:79], v[60:63]
    v_rcp_f32 v100, v100
    ds_read_b128 v[72:75], v10 offset:49664
    s_waitcnt lgkmcnt(6)
    v_mfma_f32_16x16x32_bf16 v[52:55], a[16:19], v[80:83], v[52:55]
    v_rcp_f32 v101, v101
    v_mfma_f32_16x16x32_bf16 v[56:59], a[80:83], v[80:83], v[56:59]
    v_rcp_f32 v102, v102
    v_mfma_f32_16x16x32_bf16 v[60:63], a[144:147], v[80:83], v[60:63]
    v_rcp_f32 v103, v103
    ds_read_b128 v[76:79], v11 offset:49664
    s_waitcnt lgkmcnt(6)
    v_mfma_f32_16x16x32_bf16 v[52:55], a[20:23], v[84:87], v[52:55]
    v_mul_f32 v40, v40, v100
    v_mul_f32 v41, v41, v101
    v_mfma_f32_16x16x32_bf16 v[56:59], a[84:87], v[84:87], v[56:59]
    v_mul_f32 v42, v42, v102
    v_mul_f32 v43, v43, v103
    v_mfma_f32_16x16x32_bf16 v[60:63], a[148:151], v[84:87], v[60:63]
    v_cvt_pk_bf16_f32 v40, v40, v41
    v_cvt_pk_bf16_f32 v41, v42, v43
    ds_read_b128 v[80:83], v8 offset:49920
    s_waitcnt lgkmcnt(6)
    v_mfma_f32_16x16x32_bf16 v[52:55], a[24:27], v[88:91], v[52:55]
    v_mul_f32 v104, s64, v44
    v_mul_f32 v105, s64, v45
    v_mfma_f32_16x16x32_bf16 v[56:59], a[88:91], v[88:91], v[56:59]
    v_mul_f32 v106, s64, v46
    v_mul_f32 v107, s64, v47
    v_mfma_f32_16x16x32_bf16 v[60:63], a[152:155], v[88:91], v[60:63]
    v_exp_f32 v104, v104
    ds_read_b128 v[84:87], v9 offset:49920
    s_waitcnt lgkmcnt(6)
    v_mfma_f32_16x16x32_bf16 v[52:55], a[28:31], v[92:95], v[52:55]
    v_exp_f32 v105, v105
    v_mfma_f32_16x16x32_bf16 v[56:59], a[92:95], v[92:95], v[56:59]
    v_exp_f32 v106, v106
    v_mfma_f32_16x16x32_bf16 v[60:63], a[156:159], v[92:95], v[60:63]
    v_exp_f32 v107, v107
    ds_read_b128 v[88:91], v10 offset:49920
    s_waitcnt lgkmcnt(6)
    v_mfma_f32_16x16x32_bf16 v[52:55], a[32:35], v[64:67], v[52:55]
    v_add_f32 v104, 1.0, v104
    v_add_f32 v105, 1.0, v105
    v_mfma_f32_16x16x32_bf16 v[56:59], a[96:99], v[64:67], v[56:59]
    v_add_f32 v106, 1.0, v106
    v_add_f32 v107, 1.0, v107
    v_mfma_f32_16x16x32_bf16 v[60:63], a[160:163], v[64:67], v[60:63]
    v_rcp_f32 v104, v104
    ds_read_b128 v[92:95], v11 offset:49920
    s_waitcnt lgkmcnt(6)
    v_mfma_f32_16x16x32_bf16 v[52:55], a[36:39], v[68:71], v[52:55]
    v_rcp_f32 v105, v105
    v_mfma_f32_16x16x32_bf16 v[56:59], a[100:103], v[68:71], v[56:59]
    v_rcp_f32 v106, v106
    v_mfma_f32_16x16x32_bf16 v[60:63], a[164:167], v[68:71], v[60:63]
    v_rcp_f32 v107, v107
    s_waitcnt lgkmcnt(5)
    v_mfma_f32_16x16x32_bf16 v[52:55], a[40:43], v[72:75], v[52:55]
    v_mul_f32 v44, v44, v104
    v_mul_f32 v45, v45, v105
    v_mfma_f32_16x16x32_bf16 v[56:59], a[104:107], v[72:75], v[56:59]
    v_mul_f32 v46, v46, v106
    v_mul_f32 v47, v47, v107
    v_mfma_f32_16x16x32_bf16 v[60:63], a[168:171], v[72:75], v[60:63]
    v_cvt_pk_bf16_f32 v44, v44, v45
    v_cvt_pk_bf16_f32 v45, v46, v47
    s_waitcnt lgkmcnt(4)
    v_mfma_f32_16x16x32_bf16 v[52:55], a[44:47], v[76:79], v[52:55]
    v_mul_f32 v108, s64, v48
    v_mul_f32 v109, s64, v49
    v_mfma_f32_16x16x32_bf16 v[56:59], a[108:111], v[76:79], v[56:59]
    v_mul_f32 v110, s64, v50
    v_mul_f32 v111, s64, v51
    v_mfma_f32_16x16x32_bf16 v[60:63], a[172:175], v[76:79], v[60:63]
    v_exp_f32 v108, v108
    s_waitcnt lgkmcnt(3)
    v_mfma_f32_16x16x32_bf16 v[52:55], a[48:51], v[80:83], v[52:55]
    v_exp_f32 v109, v109
    v_mfma_f32_16x16x32_bf16 v[56:59], a[112:115], v[80:83], v[56:59]
    v_exp_f32 v110, v110
    v_mfma_f32_16x16x32_bf16 v[60:63], a[176:179], v[80:83], v[60:63]
    v_exp_f32 v111, v111
    s_waitcnt lgkmcnt(2)
    v_mfma_f32_16x16x32_bf16 v[52:55], a[52:55], v[84:87], v[52:55]
    v_add_f32 v108, 1.0, v108
    v_add_f32 v109, 1.0, v109
    v_mfma_f32_16x16x32_bf16 v[56:59], a[116:119], v[84:87], v[56:59]
    v_add_f32 v110, 1.0, v110
    v_add_f32 v111, 1.0, v111
    v_mfma_f32_16x16x32_bf16 v[60:63], a[180:183], v[84:87], v[60:63]
    v_rcp_f32 v108, v108
    s_waitcnt lgkmcnt(1)
    v_mfma_f32_16x16x32_bf16 v[52:55], a[56:59], v[88:91], v[52:55]
    v_rcp_f32 v109, v109
    v_mfma_f32_16x16x32_bf16 v[56:59], a[120:123], v[88:91], v[56:59]
    v_rcp_f32 v110, v110
    v_mfma_f32_16x16x32_bf16 v[60:63], a[184:187], v[88:91], v[60:63]
    v_rcp_f32 v111, v111
    s_waitcnt lgkmcnt(0)
    v_mfma_f32_16x16x32_bf16 v[52:55], a[60:63], v[92:95], v[52:55]
    v_mul_f32 v48, v48, v108
    v_mul_f32 v49, v49, v109
    v_mfma_f32_16x16x32_bf16 v[56:59], a[124:127], v[92:95], v[56:59]
    v_mul_f32 v50, v50, v110
    v_mul_f32 v51, v51, v111
    v_mfma_f32_16x16x32_bf16 v[60:63], a[188:191], v[92:95], v[60:63]
    v_cvt_pk_bf16_f32 v48, v48, v49
    v_cvt_pk_bf16_f32 v49, v50, v51
    v_mul_f32 v100, s64, v52
    v_mul_f32 v101, s64, v53
    v_mul_f32 v102, s64, v54
    v_mul_f32 v103, s64, v55
    v_exp_f32 v100, v100
    v_exp_f32 v101, v101
    v_exp_f32 v102, v102
    v_exp_f32 v103, v103
    v_add_f32 v100, 1.0, v100
    v_add_f32 v101, 1.0, v101
    v_add_f32 v102, 1.0, v102
    v_add_f32 v103, 1.0, v103
    v_rcp_f32 v100, v100
    v_rcp_f32 v101, v101
    v_rcp_f32 v102, v102
    v_rcp_f32 v103, v103
    v_mul_f32 v52, v52, v100
    v_mul_f32 v53, v53, v101
    v_mul_f32 v54, v54, v102
    v_mul_f32 v55, v55, v103
    v_cvt_pk_bf16_f32 v52, v52, v53
    v_cvt_pk_bf16_f32 v53, v54, v55
    v_mul_f32 v104, s64, v56
    v_mul_f32 v105, s64, v57
    v_mul_f32 v106, s64, v58
    v_mul_f32 v107, s64, v59
    v_exp_f32 v104, v104
    v_exp_f32 v105, v105
    v_exp_f32 v106, v106
    v_exp_f32 v107, v107
    v_add_f32 v104, 1.0, v104
    v_add_f32 v105, 1.0, v105
    v_add_f32 v106, 1.0, v106
    v_add_f32 v107, 1.0, v107
    v_rcp_f32 v104, v104
    v_rcp_f32 v105, v105
    v_rcp_f32 v106, v106
    v_rcp_f32 v107, v107
    v_mul_f32 v56, v56, v104
    v_mul_f32 v57, v57, v105
    v_mul_f32 v58, v58, v106
    v_mul_f32 v59, v59, v107
    v_cvt_pk_bf16_f32 v56, v56, v57
    v_cvt_pk_bf16_f32 v57, v58, v59
    v_mul_f32 v108, s64, v60
    v_mul_f32 v109, s64, v61
    v_mul_f32 v110, s64, v62
    v_mul_f32 v111, s64, v63
    v_exp_f32 v108, v108
    v_exp_f32 v109, v109
    v_exp_f32 v110, v110
    v_exp_f32 v111, v111
    v_add_f32 v108, 1.0, v108
    v_add_f32 v109, 1.0, v109
    v_add_f32 v110, 1.0, v110
    v_add_f32 v111, 1.0, v111
    v_rcp_f32 v108, v108
    v_rcp_f32 v109, v109
    v_rcp_f32 v110, v110
    v_rcp_f32 v111, v111
    v_mul_f32 v60, v60, v108
    v_mul_f32 v61, v61, v109
    v_mul_f32 v62, v62, v110
    v_mul_f32 v63, v63, v111
    v_cvt_pk_bf16_f32 v60, v60, v61
    v_cvt_pk_bf16_f32 v61, v62, v63
    ds_write_b64 v96, v[16:17] offset:0
    ds_write_b64 v97, v[20:21] offset:0
    ds_write_b64 v98, v[24:25] offset:0
    ds_write_b64 v96, v[28:29] offset:6144
    ds_write_b64 v97, v[32:33] offset:6144
    ds_write_b64 v98, v[36:37] offset:6144
    ds_write_b64 v96, v[40:41] offset:12288
    ds_write_b64 v97, v[44:45] offset:12288
    ds_write_b64 v98, v[48:49] offset:12288
    ds_write_b64 v96, v[52:53] offset:18432
    ds_write_b64 v97, v[56:57] offset:18432
    ds_write_b64 v98, v[60:61] offset:18432
    s_cmp_lt_u32 s24, 32
    s_cselect_b32 s55, 24, -20
    s_sub_u32 s35, s24, 8
    s_cmp_lt_u32 s35, 44
    s_cselect_b32 s55, s55, 4
    s_add_u32 s55, s55, s24
    s_min_u32 s55, s55, 63
    s_lshl_b32 s59, s55, 8
    s_lshl_b32 s35, s20, 6
    s_add_u32 s59, s59, s35
    s_add_u32 s59, s59, 35869184
    s_mov_b32 s54, 0
    v_lshrrev_b32 v12, 1, v5
    v_mul_u32_u24 v12, 16640, v12
    v_and_b32 v13, 1, v5
    v_lshl_add_u32 v12, v13, 6, v12
    v_lshl_add_u32 v12, v6, 4, v12
    s_waitcnt lgkmcnt(0)
    s_barrier
    s_lshl_b32 s27, s22, 1
    s_and_b32 s25, s33, 1
    s_add_u32 s27, s27, s25
    s_lshl_b32 s27, s27, 20
    s_add_u32 s27, s27, 176160768
    s_lshl_b32 s25, s21, 11
    s_lshl_b32 s26, s20, 9
    s_add_u32 s25, s25, s26
    s_add_u32 s25, s25, s27
    v_add_u32 v13, 65536, v1
    ds_read_b128 v[16:19], v13 offset:0
    ds_read_b128 v[20:23], v13 offset:1024
    ds_read_b128 v[24:27], v13 offset:2048
    ds_read_b128 v[28:31], v13 offset:3072
    ds_read_b128 v[32:35], v13 offset:4096
    ds_read_b128 v[36:39], v13 offset:5120
    s_waitcnt lgkmcnt(5)
    v_mfma_f32_16x16x32_bf16 v[64:67], a[192:195], v[16:19], 0
    s_waitcnt lgkmcnt(4)
    v_mfma_f32_16x16x32_bf16 v[64:67], a[196:199], v[20:23], v[64:67]
    s_waitcnt lgkmcnt(3)
    v_mfma_f32_16x16x32_bf16 v[64:67], a[200:203], v[24:27], v[64:67]
    s_waitcnt lgkmcnt(2)
    v_mfma_f32_16x16x32_bf16 v[64:67], a[204:207], v[28:31], v[64:67]
    s_waitcnt lgkmcnt(1)
    v_mfma_f32_16x16x32_bf16 v[64:67], a[208:211], v[32:35], v[64:67]
    s_waitcnt lgkmcnt(0)
    v_mfma_f32_16x16x32_bf16 v[64:67], a[212:215], v[36:39], v[64:67]
    v_mfma_f32_16x16x32_bf16 v[68:71], a[216:219], v[16:19], 0
    v_mfma_f32_16x16x32_bf16 v[68:71], a[220:223], v[20:23], v[68:71]
    v_mfma_f32_16x16x32_bf16 v[68:71], a[224:227], v[24:27], v[68:71]
    v_mfma_f32_16x16x32_bf16 v[68:71], a[228:231], v[28:31], v[68:71]
    v_mfma_f32_16x16x32_bf16 v[68:71], a[232:235], v[32:35], v[68:71]
    v_mfma_f32_16x16x32_bf16 v[68:71], a[236:239], v[36:39], v[68:71]
    v_mfma_f32_16x16x32_bf16 v[72:75], a[240:243], v[16:19], 0
    v_mfma_f32_16x16x32_bf16 v[72:75], a[244:247], v[20:23], v[72:75]
    v_mfma_f32_16x16x32_bf16 v[72:75], a[248:251], v[24:27], v[72:75]
    v_mfma_f32_16x16x32_bf16 v[72:75], a[252:255], v[28:31], v[72:75]
    v_mfma_f32_16x16x32_bf16 v[72:75], v[128:131], v[32:35], v[72:75]
    v_mfma_f32_16x16x32_bf16 v[72:75], v[132:135], v[36:39], v[72:75]
    v_mfma_f32_16x16x32_bf16 v[76:79], v[136:139], v[16:19], 0
    v_mfma_f32_16x16x32_bf16 v[76:79], v[140:143], v[20:23], v[76:79]
    v_mfma_f32_16x16x32_bf16 v[76:79], v[144:147], v[24:27], v[76:79]
    v_mfma_f32_16x16x32_bf16 v[76:79], v[148:151], v[28:31], v[76:79]
    v_mfma_f32_16x16x32_bf16 v[76:79], v[152:155], v[32:35], v[76:79]
    v_mfma_f32_16x16x32_bf16 v[76:79], v[156:159], v[36:39], v[76:79]
    v_mfma_f32_16x16x32_bf16 v[80:83], v[160:163], v[16:19], 0
    v_mfma_f32_16x16x32_bf16 v[80:83], v[164:167], v[20:23], v[80:83]
    v_mfma_f32_16x16x32_bf16 v[80:83], v[168:171], v[24:27], v[80:83]
    v_mfma_f32_16x16x32_bf16 v[80:83], v[172:175], v[28:31], v[80:83]
    v_mfma_f32_16x16x32_bf16 v[80:83], v[176:179], v[32:35], v[80:83]
    v_mfma_f32_16x16x32_bf16 v[80:83], v[180:183], v[36:39], v[80:83]
    v_mfma_f32_16x16x32_bf16 v[84:87], v[184:187], v[16:19], 0
    ds_read_b128 v[40:43], v13 offset:6144
    v_mfma_f32_16x16x32_bf16 v[84:87], v[188:191], v[20:23], v[84:87]
    ds_read_b128 v[44:47], v13 offset:7168
    v_mfma_f32_16x16x32_bf16 v[84:87], v[192:195], v[24:27], v[84:87]
    ds_read_b128 v[48:51], v13 offset:8192
    v_mfma_f32_16x16x32_bf16 v[84:87], v[196:199], v[28:31], v[84:87]
    ds_read_b128 v[52:55], v13 offset:9216
    v_mfma_f32_16x16x32_bf16 v[84:87], v[200:203], v[32:35], v[84:87]
    ds_read_b128 v[56:59], v13 offset:10240
    v_mfma_f32_16x16x32_bf16 v[84:87], v[204:207], v[36:39], v[84:87]
    ds_read_b128 v[60:63], v13 offset:11264
    v_mfma_f32_16x16x32_bf16 v[88:91], v[208:211], v[16:19], 0
    v_mfma_f32_16x16x32_bf16 v[88:91], v[212:215], v[20:23], v[88:91]
    v_mfma_f32_16x16x32_bf16 v[88:91], v[216:219], v[24:27], v[88:91]
    v_mfma_f32_16x16x32_bf16 v[88:91], v[220:223], v[28:31], v[88:91]
    v_mfma_f32_16x16x32_bf16 v[88:91], v[224:227], v[32:35], v[88:91]
    v_mfma_f32_16x16x32_bf16 v[88:91], v[228:231], v[36:39], v[88:91]
    v_mfma_f32_16x16x32_bf16 v[92:95], v[232:235], v[16:19], 0
    v_mfma_f32_16x16x32_bf16 v[92:95], v[236:239], v[20:23], v[92:95]
    v_mfma_f32_16x16x32_bf16 v[92:95], v[240:243], v[24:27], v[92:95]
    v_mfma_f32_16x16x32_bf16 v[92:95], v[244:247], v[28:31], v[92:95]
    v_mfma_f32_16x16x32_bf16 v[92:95], v[248:251], v[32:35], v[92:95]
    v_mfma_f32_16x16x32_bf16 v[92:95], v[252:255], v[36:39], v[92:95]
    s_waitcnt lgkmcnt(0)
    v_mfma_f32_16x16x32_bf16 v[96:99], a[192:195], v[40:43], 0
    v_mfma_f32_16x16x32_bf16 v[96:99], a[196:199], v[44:47], v[96:99]
    v_mfma_f32_16x16x32_bf16 v[96:99], a[200:203], v[48:51], v[96:99]
    v_cvt_pk_bf16_f32 v64, v64, v65
    v_mfma_f32_16x16x32_bf16 v[96:99], a[204:207], v[52:55], v[96:99]
    v_cvt_pk_bf16_f32 v65, v66, v67
    v_mfma_f32_16x16x32_bf16 v[96:99], a[208:211], v[56:59], v[96:99]
    v_cvt_pk_bf16_f32 v66, v68, v69
    v_mfma_f32_16x16x32_bf16 v[96:99], a[212:215], v[60:63], v[96:99]
    v_cvt_pk_bf16_f32 v67, v70, v71
    v_mfma_f32_16x16x32_bf16 v[100:103], a[216:219], v[40:43], 0
    buffer_store_dwordx4 v[64:67], v12, s[8:11], s25 offen offset:0 sc1
    v_mfma_f32_16x16x32_bf16 v[100:103], a[220:223], v[44:47], v[100:103]
    v_cvt_pk_bf16_f32 v72, v72, v73
    v_mfma_f32_16x16x32_bf16 v[100:103], a[224:227], v[48:51], v[100:103]
    v_cvt_pk_bf16_f32 v73, v74, v75
    v_mfma_f32_16x16x32_bf16 v[100:103], a[228:231], v[52:55], v[100:103]
    v_cvt_pk_bf16_f32 v74, v76, v77
    v_mfma_f32_16x16x32_bf16 v[100:103], a[232:235], v[56:59], v[100:103]
    v_cvt_pk_bf16_f32 v75, v78, v79
    v_mfma_f32_16x16x32_bf16 v[100:103], a[236:239], v[60:63], v[100:103]
    buffer_store_dwordx4 v[72:75], v12, s[8:11], s25 offen offset:128 sc1
    v_mfma_f32_16x16x32_bf16 v[104:107], a[240:243], v[40:43], 0
    v_cvt_pk_bf16_f32 v80, v80, v81
    v_mfma_f32_16x16x32_bf16 v[104:107], a[244:247], v[44:47], v[104:107]
    v_cvt_pk_bf16_f32 v81, v82, v83
    v_mfma_f32_16x16x32_bf16 v[104:107], a[248:251], v[48:51], v[104:107]
    v_cvt_pk_bf16_f32 v82, v84, v85
    v_mfma_f32_16x16x32_bf16 v[104:107], a[252:255], v[52:55], v[104:107]
    v_cvt_pk_bf16_f32 v83, v86, v87
    v_mfma_f32_16x16x32_bf16 v[104:107], v[128:131], v[56:59], v[104:107]
    buffer_store_dwordx4 v[80:83], v12, s[8:11], s25 offen offset:256 sc1
    v_mfma_f32_16x16x32_bf16 v[104:107], v[132:135], v[60:63], v[104:107]
    v_cvt_pk_bf16_f32 v88, v88, v89
    v_mfma_f32_16x16x32_bf16 v[108:111], v[136:139], v[40:43], 0
    v_cvt_pk_bf16_f32 v89, v90, v91
    v_mfma_f32_16x16x32_bf16 v[108:111], v[140:143], v[44:47], v[108:111]
    v_cvt_pk_bf16_f32 v90, v92, v93
    v_mfma_f32_16x16x32_bf16 v[108:111], v[144:147], v[48:51], v[108:111]
    v_cvt_pk_bf16_f32 v91, v94, v95
    v_mfma_f32_16x16x32_bf16 v[108:111], v[148:151], v[52:55], v[108:111]
    buffer_store_dwordx4 v[88:91], v12, s[8:11], s25 offen offset:384 sc1
    v_mfma_f32_16x16x32_bf16 v[108:111], v[152:155], v[56:59], v[108:111]
    s_add_u32 s25, s25, 133120
    v_mfma_f32_16x16x32_bf16 v[108:111], v[156:159], v[60:63], v[108:111]
    v_mfma_f32_16x16x32_bf16 v[112:115], v[160:163], v[40:43], 0
    v_mfma_f32_16x16x32_bf16 v[112:115], v[164:167], v[44:47], v[112:115]
    v_mfma_f32_16x16x32_bf16 v[112:115], v[168:171], v[48:51], v[112:115]
    v_mfma_f32_16x16x32_bf16 v[112:115], v[172:175], v[52:55], v[112:115]
    v_mfma_f32_16x16x32_bf16 v[112:115], v[176:179], v[56:59], v[112:115]
    v_mfma_f32_16x16x32_bf16 v[112:115], v[180:183], v[60:63], v[112:115]
    v_mfma_f32_16x16x32_bf16 v[116:119], v[184:187], v[40:43], 0
    ds_read_b128 v[16:19], v13 offset:12288
    v_mfma_f32_16x16x32_bf16 v[116:119], v[188:191], v[44:47], v[116:119]
    ds_read_b128 v[20:23], v13 offset:13312
    v_mfma_f32_16x16x32_bf16 v[116:119], v[192:195], v[48:51], v[116:119]
    ds_read_b128 v[24:27], v13 offset:14336
    v_mfma_f32_16x16x32_bf16 v[116:119], v[196:199], v[52:55], v[116:119]
    ds_read_b128 v[28:31], v13 offset:15360
    v_mfma_f32_16x16x32_bf16 v[116:119], v[200:203], v[56:59], v[116:119]
    ds_read_b128 v[32:35], v13 offset:16384
    v_mfma_f32_16x16x32_bf16 v[116:119], v[204:207], v[60:63], v[116:119]
    ds_read_b128 v[36:39], v13 offset:17408
    v_mfma_f32_16x16x32_bf16 v[120:123], v[208:211], v[40:43], 0
    v_mfma_f32_16x16x32_bf16 v[120:123], v[212:215], v[44:47], v[120:123]
    v_mfma_f32_16x16x32_bf16 v[120:123], v[216:219], v[48:51], v[120:123]
    v_mfma_f32_16x16x32_bf16 v[120:123], v[220:223], v[52:55], v[120:123]
    v_mfma_f32_16x16x32_bf16 v[120:123], v[224:227], v[56:59], v[120:123]
    v_mfma_f32_16x16x32_bf16 v[120:123], v[228:231], v[60:63], v[120:123]
    v_mfma_f32_16x16x32_bf16 v[124:127], v[232:235], v[40:43], 0
    v_mfma_f32_16x16x32_bf16 v[124:127], v[236:239], v[44:47], v[124:127]
    v_mfma_f32_16x16x32_bf16 v[124:127], v[240:243], v[48:51], v[124:127]
    v_mfma_f32_16x16x32_bf16 v[124:127], v[244:247], v[52:55], v[124:127]
    v_mfma_f32_16x16x32_bf16 v[124:127], v[248:251], v[56:59], v[124:127]
    v_mfma_f32_16x16x32_bf16 v[124:127], v[252:255], v[60:63], v[124:127]
    s_waitcnt lgkmcnt(0)
    v_mfma_f32_16x16x32_bf16 v[64:67], a[192:195], v[16:19], 0
    v_mfma_f32_16x16x32_bf16 v[64:67], a[196:199], v[20:23], v[64:67]
    v_mfma_f32_16x16x32_bf16 v[64:67], a[200:203], v[24:27], v[64:67]
    v_cvt_pk_bf16_f32 v96, v96, v97
    v_mfma_f32_16x16x32_bf16 v[64:67], a[204:207], v[28:31], v[64:67]
    v_cvt_pk_bf16_f32 v97, v98, v99
    v_mfma_f32_16x16x32_bf16 v[64:67], a[208:211], v[32:35], v[64:67]
    v_cvt_pk_bf16_f32 v98, v100, v101
    v_mfma_f32_16x16x32_bf16 v[64:67], a[212:215], v[36:39], v[64:67]
    v_cvt_pk_bf16_f32 v99, v102, v103
    v_mfma_f32_16x16x32_bf16 v[68:71], a[216:219], v[16:19], 0
    buffer_store_dwordx4 v[96:99], v12, s[8:11], s25 offen offset:0 sc1
    v_mfma_f32_16x16x32_bf16 v[68:71], a[220:223], v[20:23], v[68:71]
    v_cvt_pk_bf16_f32 v104, v104, v105
    v_mfma_f32_16x16x32_bf16 v[68:71], a[224:227], v[24:27], v[68:71]
    v_cvt_pk_bf16_f32 v105, v106, v107
    v_mfma_f32_16x16x32_bf16 v[68:71], a[228:231], v[28:31], v[68:71]
    v_cvt_pk_bf16_f32 v106, v108, v109
    v_mfma_f32_16x16x32_bf16 v[68:71], a[232:235], v[32:35], v[68:71]
    v_cvt_pk_bf16_f32 v107, v110, v111
    v_mfma_f32_16x16x32_bf16 v[68:71], a[236:239], v[36:39], v[68:71]
    buffer_store_dwordx4 v[104:107], v12, s[8:11], s25 offen offset:128 sc1
    v_mfma_f32_16x16x32_bf16 v[72:75], a[240:243], v[16:19], 0
    v_cvt_pk_bf16_f32 v112, v112, v113
    v_mfma_f32_16x16x32_bf16 v[72:75], a[244:247], v[20:23], v[72:75]
    v_cvt_pk_bf16_f32 v113, v114, v115
    v_mfma_f32_16x16x32_bf16 v[72:75], a[248:251], v[24:27], v[72:75]
    v_cvt_pk_bf16_f32 v114, v116, v117
    v_mfma_f32_16x16x32_bf16 v[72:75], a[252:255], v[28:31], v[72:75]
    v_cvt_pk_bf16_f32 v115, v118, v119
    v_mfma_f32_16x16x32_bf16 v[72:75], v[128:131], v[32:35], v[72:75]
    buffer_store_dwordx4 v[112:115], v12, s[8:11], s25 offen offset:256 sc1
    v_mfma_f32_16x16x32_bf16 v[72:75], v[132:135], v[36:39], v[72:75]
    v_cvt_pk_bf16_f32 v120, v120, v121
    v_mfma_f32_16x16x32_bf16 v[76:79], v[136:139], v[16:19], 0
    v_cvt_pk_bf16_f32 v121, v122, v123
    v_mfma_f32_16x16x32_bf16 v[76:79], v[140:143], v[20:23], v[76:79]
    v_cvt_pk_bf16_f32 v122, v124, v125
    v_mfma_f32_16x16x32_bf16 v[76:79], v[144:147], v[24:27], v[76:79]
    v_cvt_pk_bf16_f32 v123, v126, v127
    v_mfma_f32_16x16x32_bf16 v[76:79], v[148:151], v[28:31], v[76:79]
    buffer_store_dwordx4 v[120:123], v12, s[8:11], s25 offen offset:384 sc1
    v_mfma_f32_16x16x32_bf16 v[76:79], v[152:155], v[32:35], v[76:79]
    s_add_u32 s25, s25, 133120
    v_mfma_f32_16x16x32_bf16 v[76:79], v[156:159], v[36:39], v[76:79]
    v_mfma_f32_16x16x32_bf16 v[80:83], v[160:163], v[16:19], 0
    v_mfma_f32_16x16x32_bf16 v[80:83], v[164:167], v[20:23], v[80:83]
    v_mfma_f32_16x16x32_bf16 v[80:83], v[168:171], v[24:27], v[80:83]
    v_mfma_f32_16x16x32_bf16 v[80:83], v[172:175], v[28:31], v[80:83]
    v_mfma_f32_16x16x32_bf16 v[80:83], v[176:179], v[32:35], v[80:83]
    v_mfma_f32_16x16x32_bf16 v[80:83], v[180:183], v[36:39], v[80:83]
    v_mfma_f32_16x16x32_bf16 v[84:87], v[184:187], v[16:19], 0
    ds_read_b128 v[40:43], v13 offset:18432
    v_mfma_f32_16x16x32_bf16 v[84:87], v[188:191], v[20:23], v[84:87]
    ds_read_b128 v[44:47], v13 offset:19456
    v_mfma_f32_16x16x32_bf16 v[84:87], v[192:195], v[24:27], v[84:87]
    ds_read_b128 v[48:51], v13 offset:20480
    v_mfma_f32_16x16x32_bf16 v[84:87], v[196:199], v[28:31], v[84:87]
    ds_read_b128 v[52:55], v13 offset:21504
    v_mfma_f32_16x16x32_bf16 v[84:87], v[200:203], v[32:35], v[84:87]
    ds_read_b128 v[56:59], v13 offset:22528
    v_mfma_f32_16x16x32_bf16 v[84:87], v[204:207], v[36:39], v[84:87]
    ds_read_b128 v[60:63], v13 offset:23552
    v_mfma_f32_16x16x32_bf16 v[88:91], v[208:211], v[16:19], 0
    v_mfma_f32_16x16x32_bf16 v[88:91], v[212:215], v[20:23], v[88:91]
    v_mfma_f32_16x16x32_bf16 v[88:91], v[216:219], v[24:27], v[88:91]
    v_mfma_f32_16x16x32_bf16 v[88:91], v[220:223], v[28:31], v[88:91]
    v_mfma_f32_16x16x32_bf16 v[88:91], v[224:227], v[32:35], v[88:91]
    v_mfma_f32_16x16x32_bf16 v[88:91], v[228:231], v[36:39], v[88:91]
    v_mfma_f32_16x16x32_bf16 v[92:95], v[232:235], v[16:19], 0
    v_mfma_f32_16x16x32_bf16 v[92:95], v[236:239], v[20:23], v[92:95]
    v_mfma_f32_16x16x32_bf16 v[92:95], v[240:243], v[24:27], v[92:95]
    v_mfma_f32_16x16x32_bf16 v[92:95], v[244:247], v[28:31], v[92:95]
    v_mfma_f32_16x16x32_bf16 v[92:95], v[248:251], v[32:35], v[92:95]
    v_mfma_f32_16x16x32_bf16 v[92:95], v[252:255], v[36:39], v[92:95]
    s_waitcnt lgkmcnt(0)
    v_mfma_f32_16x16x32_bf16 v[96:99], a[192:195], v[40:43], 0
    v_mfma_f32_16x16x32_bf16 v[96:99], a[196:199], v[44:47], v[96:99]
    v_mfma_f32_16x16x32_bf16 v[96:99], a[200:203], v[48:51], v[96:99]
    v_cvt_pk_bf16_f32 v64, v64, v65
    v_mfma_f32_16x16x32_bf16 v[96:99], a[204:207], v[52:55], v[96:99]
    v_cvt_pk_bf16_f32 v65, v66, v67
    v_mfma_f32_16x16x32_bf16 v[96:99], a[208:211], v[56:59], v[96:99]
    v_cvt_pk_bf16_f32 v66, v68, v69
    v_mfma_f32_16x16x32_bf16 v[96:99], a[212:215], v[60:63], v[96:99]
    v_cvt_pk_bf16_f32 v67, v70, v71
    v_mfma_f32_16x16x32_bf16 v[100:103], a[216:219], v[40:43], 0
    buffer_store_dwordx4 v[64:67], v12, s[8:11], s25 offen offset:0 sc1
    v_mfma_f32_16x16x32_bf16 v[100:103], a[220:223], v[44:47], v[100:103]
    v_cvt_pk_bf16_f32 v72, v72, v73
    v_mfma_f32_16x16x32_bf16 v[100:103], a[224:227], v[48:51], v[100:103]
    v_cvt_pk_bf16_f32 v73, v74, v75
    v_mfma_f32_16x16x32_bf16 v[100:103], a[228:231], v[52:55], v[100:103]
    v_cvt_pk_bf16_f32 v74, v76, v77
    v_mfma_f32_16x16x32_bf16 v[100:103], a[232:235], v[56:59], v[100:103]
    v_cvt_pk_bf16_f32 v75, v78, v79
    v_mfma_f32_16x16x32_bf16 v[100:103], a[236:239], v[60:63], v[100:103]
    buffer_store_dwordx4 v[72:75], v12, s[8:11], s25 offen offset:128 sc1
    v_mfma_f32_16x16x32_bf16 v[104:107], a[240:243], v[40:43], 0
    v_cvt_pk_bf16_f32 v80, v80, v81
    v_mfma_f32_16x16x32_bf16 v[104:107], a[244:247], v[44:47], v[104:107]
    v_cvt_pk_bf16_f32 v81, v82, v83
    v_mfma_f32_16x16x32_bf16 v[104:107], a[248:251], v[48:51], v[104:107]
    v_cvt_pk_bf16_f32 v82, v84, v85
    v_mfma_f32_16x16x32_bf16 v[104:107], a[252:255], v[52:55], v[104:107]
    v_cvt_pk_bf16_f32 v83, v86, v87
    v_mfma_f32_16x16x32_bf16 v[104:107], v[128:131], v[56:59], v[104:107]
    buffer_store_dwordx4 v[80:83], v12, s[8:11], s25 offen offset:256 sc1
    v_mfma_f32_16x16x32_bf16 v[104:107], v[132:135], v[60:63], v[104:107]
    v_cvt_pk_bf16_f32 v88, v88, v89
    v_mfma_f32_16x16x32_bf16 v[108:111], v[136:139], v[40:43], 0
    v_cvt_pk_bf16_f32 v89, v90, v91
    v_mfma_f32_16x16x32_bf16 v[108:111], v[140:143], v[44:47], v[108:111]
    v_cvt_pk_bf16_f32 v90, v92, v93
    v_mfma_f32_16x16x32_bf16 v[108:111], v[144:147], v[48:51], v[108:111]
    v_cvt_pk_bf16_f32 v91, v94, v95
    v_mfma_f32_16x16x32_bf16 v[108:111], v[148:151], v[52:55], v[108:111]
    buffer_store_dwordx4 v[88:91], v12, s[8:11], s25 offen offset:384 sc1
    v_mfma_f32_16x16x32_bf16 v[108:111], v[152:155], v[56:59], v[108:111]
    s_add_u32 s25, s25, 133120
    v_mfma_f32_16x16x32_bf16 v[108:111], v[156:159], v[60:63], v[108:111]
    v_mfma_f32_16x16x32_bf16 v[112:115], v[160:163], v[40:43], 0
    v_mfma_f32_16x16x32_bf16 v[112:115], v[164:167], v[44:47], v[112:115]
    v_mfma_f32_16x16x32_bf16 v[112:115], v[168:171], v[48:51], v[112:115]
    v_mfma_f32_16x16x32_bf16 v[112:115], v[172:175], v[52:55], v[112:115]
    v_cvt_pk_bf16_f32 v96, v96, v97
    v_mfma_f32_16x16x32_bf16 v[112:115], v[176:179], v[56:59], v[112:115]
    v_cvt_pk_bf16_f32 v97, v98, v99
    v_mfma_f32_16x16x32_bf16 v[112:115], v[180:183], v[60:63], v[112:115]
    v_cvt_pk_bf16_f32 v98, v100, v101
    v_mfma_f32_16x16x32_bf16 v[116:119], v[184:187], v[40:43], 0
    v_cvt_pk_bf16_f32 v99, v102, v103
    v_mfma_f32_16x16x32_bf16 v[116:119], v[188:191], v[44:47], v[116:119]
    buffer_store_dwordx4 v[96:99], v12, s[8:11], s25 offen offset:0 sc1
    v_mfma_f32_16x16x32_bf16 v[116:119], v[192:195], v[48:51], v[116:119]
    v_cvt_pk_bf16_f32 v104, v104, v105
    v_mfma_f32_16x16x32_bf16 v[116:119], v[196:199], v[52:55], v[116:119]
    v_cvt_pk_bf16_f32 v105, v106, v107
    v_mfma_f32_16x16x32_bf16 v[116:119], v[200:203], v[56:59], v[116:119]
    v_cvt_pk_bf16_f32 v106, v108, v109
    v_mfma_f32_16x16x32_bf16 v[116:119], v[204:207], v[60:63], v[116:119]
    v_cvt_pk_bf16_f32 v107, v110, v111
    v_mfma_f32_16x16x32_bf16 v[120:123], v[208:211], v[40:43], 0
    buffer_store_dwordx4 v[104:107], v12, s[8:11], s25 offen offset:128 sc1
    v_mfma_f32_16x16x32_bf16 v[120:123], v[212:215], v[44:47], v[120:123]
    v_mfma_f32_16x16x32_bf16 v[120:123], v[216:219], v[48:51], v[120:123]
    v_mfma_f32_16x16x32_bf16 v[120:123], v[220:223], v[52:55], v[120:123]
    v_cvt_pk_bf16_f32 v112, v112, v113
    v_mfma_f32_16x16x32_bf16 v[120:123], v[224:227], v[56:59], v[120:123]
    v_cvt_pk_bf16_f32 v113, v114, v115
    v_mfma_f32_16x16x32_bf16 v[120:123], v[228:231], v[60:63], v[120:123]
    v_cvt_pk_bf16_f32 v114, v116, v117
    v_mfma_f32_16x16x32_bf16 v[124:127], v[232:235], v[40:43], 0
    v_cvt_pk_bf16_f32 v115, v118, v119
    v_mfma_f32_16x16x32_bf16 v[124:127], v[236:239], v[44:47], v[124:127]
    buffer_store_dwordx4 v[112:115], v12, s[8:11], s25 offen offset:256 sc1
    v_mfma_f32_16x16x32_bf16 v[124:127], v[240:243], v[48:51], v[124:127]
    v_mfma_f32_16x16x32_bf16 v[124:127], v[244:247], v[52:55], v[124:127]
    v_mfma_f32_16x16x32_bf16 v[124:127], v[248:251], v[56:59], v[124:127]
    v_mfma_f32_16x16x32_bf16 v[124:127], v[252:255], v[60:63], v[124:127]
    v_cvt_pk_bf16_f32 v120, v120, v121
    v_cvt_pk_bf16_f32 v121, v122, v123
    s_nop 5
    v_cvt_pk_bf16_f32 v122, v124, v125
    v_cvt_pk_bf16_f32 v123, v126, v127
    buffer_store_dwordx4 v[120:123], v12, s[8:11], s25 offen offset:384 sc1
    s_add_u32 s25, s25, 133120
    s_add_u32 s27, s27, s52
    s_lshr_b32 s25, s52, 6
    s_add_u32 s27, s27, s25
    s_add_u32 s34, s33, 1
    v_mov_b32 v4, s34
    v_lshrrev_b32 v13, 2, v1
    v_and_b32 v13, 127, v13
    s_waitcnt vmcnt(0)
    buffer_store_dword v4, v2, s[8:11], s57 offen sc1
    v_and_b32 v56, 1, v5
    v_lshlrev_b32 v56, 4, v56
    v_mov_b32 v57, 0x3f80
    v_lshlrev_b32 v56, v56, v57
    v_lshrrev_b32 v57, 1, v5
    v_lshlrev_b32 v58, 4, v5
    v_lshl_add_u32 v58, v6, 11, v58
    v_cmp_eq_u32 vcc, 0, v57
    s_nop 1
    v_cndmask_b32 v24, 0, v56, vcc
    v_cmp_eq_u32 vcc, 1, v57
    s_nop 1
    v_cndmask_b32 v25, 0, v56, vcc
    v_cmp_eq_u32 vcc, 2, v57
    s_nop 1
    v_cndmask_b32 v26, 0, v56, vcc
    v_cmp_eq_u32 vcc, 3, v57
    s_nop 1
    v_cndmask_b32 v27, 0, v56, vcc
    v_cmp_eq_u32 vcc, 4, v57
    s_nop 1
    v_cndmask_b32 v28, 0, v56, vcc
    v_cmp_eq_u32 vcc, 5, v57
    s_nop 1
    v_cndmask_b32 v29, 0, v56, vcc
    v_cmp_eq_u32 vcc, 6, v57
    s_nop 1
    v_cndmask_b32 v30, 0, v56, vcc
    v_cmp_eq_u32 vcc, 7, v57
    s_nop 1
    v_cndmask_b32 v31, 0, v56, vcc
L_pp_67:
    buffer_load_dword v4, v13, s[8:11], s56 offen sc1
    s_sub_u32 s30, s30, 1
    s_cbranch_scc1 M_done
    s_waitcnt vmcnt(0)
    v_cmp_gt_u32 vcc, s34, v4
    s_nop 0
    s_cbranch_vccnz L_pp_67
    buffer_load_dwordx4 v[64:67], v58, s[8:11], s27 offen offset:0 sc1
    buffer_load_dwordx4 v[68:71], v58, s[8:11], s27 offen offset:256 sc1
    buffer_load_dwordx4 v[72:75], v58, s[8:11], s27 offen offset:512 sc1
    buffer_load_dwordx4 v[76:79], v58, s[8:11], s27 offen offset:768 sc1
    s_add_u32 s27, s27, 8192
    buffer_load_dwordx4 v[80:83], v58, s[8:11], s27 offen offset:0 sc1
    buffer_load_dwordx4 v[84:87], v58, s[8:11], s27 offen offset:256 sc1
    buffer_load_dwordx4 v[88:91], v58, s[8:11], s27 offen offset:512 sc1
    buffer_load_dwordx4 v[92:95], v58, s[8:11], s27 offen offset:768 sc1
    s_add_u32 s27, s27, 4294960128
    buffer_load_dwordx4 v[96:99], v58, s[8:11], s27 offen offset:0 sc1
    buffer_load_dwordx4 v[100:103], v58, s[8:11], s27 offen offset:256 sc1
    buffer_load_dwordx4 v[104:107], v58, s[8:11], s27 offen offset:512 sc1
    buffer_load_dwordx4 v[108:111], v58, s[8:11], s27 offen offset:768 sc1
    s_add_u32 s27, s27, 8192
    buffer_load_dwordx4 v[112:115], v58, s[8:11], s27 offen offset:0 sc1
    buffer_load_dwordx4 v[116:119], v58, s[8:11], s27 offen offset:256 sc1
    buffer_load_dwordx4 v[120:123], v58, s[8:11], s27 offen offset:512 sc1
    buffer_load_dwordx4 v[124:127], v58, s[8:11], s27 offen offset:768 sc1
    s_add_u32 s27, s27, 8192
    buffer_load_dword v0, v7, s[8:11], s59 offen sc1
    v_and_b32 v12, 0x30, v1
    v_and_b32 v13, 0x40, v1
    v_lshl_add_u32 v12, v13, 4, v12
    v_lshrrev_b32 v13, 9, v1
    v_lshl_add_u32 v12, v13, 7, v12
    v_bfe_u32 v13, v1, 7, 1
    v_lshl_add_u32 v12, v13, 6, v12
    v_bfe_u32 v13, v1, 8, 1
    v_lshl_add_u32 v12, v13, 3, v12
    v_add_u32 v13, s58, v12
    ds_read2_b64 v[16:19], v13 offset1:32
    ds_read2_b64 v[20:23], v13 offset0:64 offset1:96
    s_waitcnt lgkmcnt(0)
    s_waitcnt vmcnt(16)
    v_mfma_f32_16x16x32_bf16 v[32:35], v[24:27], v[64:67], 0
    s_waitcnt vmcnt(15)
    v_mfma_f32_16x16x32_bf16 v[32:35], v[28:31], v[68:71], v[32:35]
    s_waitcnt vmcnt(14)
    v_mfma_f32_16x16x32_bf16 v[36:39], v[24:27], v[72:75], 0
    s_waitcnt vmcnt(13)
    v_mfma_f32_16x16x32_bf16 v[36:39], v[28:31], v[76:79], v[36:39]
    s_waitcnt vmcnt(12)
    v_mfma_f32_16x16x32_bf16 v[32:35], v[24:27], v[80:83], v[32:35]
    s_waitcnt vmcnt(11)
    v_mfma_f32_16x16x32_bf16 v[32:35], v[28:31], v[84:87], v[32:35]
    s_waitcnt vmcnt(10)
    v_mfma_f32_16x16x32_bf16 v[36:39], v[24:27], v[88:91], v[36:39]
    s_waitcnt vmcnt(9)
    v_mfma_f32_16x16x32_bf16 v[36:39], v[28:31], v[92:95], v[36:39]
    v_cvt_pk_bf16_f32 v64, v32, v33
    v_cvt_pk_bf16_f32 v65, v34, v35
    s_nop 5
    v_cvt_pk_bf16_f32 v66, v36, v37
    v_cvt_pk_bf16_f32 v67, v38, v39
    v_lshlrev_b32 v32, 16, v64
    v_and_b32 v33, 0xffff0000, v64
    v_lshlrev_b32 v34, 16, v65
    v_and_b32 v35, 0xffff0000, v65
    v_lshlrev_b32 v36, 16, v66
    v_and_b32 v37, 0xffff0000, v66
    v_lshlrev_b32 v38, 16, v67
    v_and_b32 v39, 0xffff0000, v67
    v_lshlrev_b32 v40, 16, v16
    v_and_b32 v41, 0xffff0000, v16
    v_lshlrev_b32 v42, 16, v17
    v_and_b32 v43, 0xffff0000, v17
    v_lshlrev_b32 v44, 16, v18
    v_and_b32 v45, 0xffff0000, v18
    v_lshlrev_b32 v46, 16, v19
    v_and_b32 v47, 0xffff0000, v19
    v_add_f32 v32, v32, v40
    v_add_f32 v33, v33, v41
    v_add_f32 v34, v34, v42
    v_add_f32 v35, v35, v43
    v_add_f32 v36, v36, v44
    v_add_f32 v37, v37, v45
    v_add_f32 v38, v38, v46
    v_add_f32 v39, v39, v47
    v_cvt_pk_bf16_f32 v16, v32, v33
    v_cvt_pk_bf16_f32 v17, v34, v35
    v_cvt_pk_bf16_f32 v18, v36, v37
    v_cvt_pk_bf16_f32 v19, v38, v39
    v_lshlrev_b32 v32, 16, v16
    v_and_b32 v33, 0xffff0000, v16
    v_lshlrev_b32 v34, 16, v17
    v_and_b32 v35, 0xffff0000, v17
    v_lshlrev_b32 v36, 16, v18
    v_and_b32 v37, 0xffff0000, v18
    v_lshlrev_b32 v38, 16, v19
    v_and_b32 v39, 0xffff0000, v19
    s_waitcnt vmcnt(8)
    v_mfma_f32_16x16x32_bf16 v[48:51], v[24:27], v[96:99], 0
    s_waitcnt vmcnt(7)
    v_mfma_f32_16x16x32_bf16 v[48:51], v[28:31], v[100:103], v[48:51]
    s_waitcnt vmcnt(6)
    v_mfma_f32_16x16x32_bf16 v[52:55], v[24:27], v[104:107], 0
    s_waitcnt vmcnt(5)
    v_mfma_f32_16x16x32_bf16 v[52:55], v[28:31], v[108:111], v[52:55]
    s_waitcnt vmcnt(4)
    v_mfma_f32_16x16x32_bf16 v[48:51], v[24:27], v[112:115], v[48:51]
    s_waitcnt vmcnt(3)
    v_mfma_f32_16x16x32_bf16 v[48:51], v[28:31], v[116:119], v[48:51]
    s_waitcnt vmcnt(2)
    v_mfma_f32_16x16x32_bf16 v[52:55], v[24:27], v[120:123], v[52:55]
    s_waitcnt vmcnt(1)
    v_mfma_f32_16x16x32_bf16 v[52:55], v[28:31], v[124:127], v[52:55]
    v_cvt_pk_bf16_f32 v96, v48, v49
    v_cvt_pk_bf16_f32 v97, v50, v51
    s_nop 5
    v_cvt_pk_bf16_f32 v98, v52, v53
    v_cvt_pk_bf16_f32 v99, v54, v55
    v_lshlrev_b32 v48, 16, v96
    v_and_b32 v49, 0xffff0000, v96
    v_lshlrev_b32 v50, 16, v97
    v_and_b32 v51, 0xffff0000, v97
    v_lshlrev_b32 v52, 16, v98
    v_and_b32 v53, 0xffff0000, v98
    v_lshlrev_b32 v54, 16, v99
    v_and_b32 v55, 0xffff0000, v99
    v_lshlrev_b32 v56, 16, v20
    v_and_b32 v57, 0xffff0000, v20
    v_lshlrev_b32 v58, 16, v21
    v_and_b32 v59, 0xffff0000, v21
    v_lshlrev_b32 v60, 16, v22
    v_and_b32 v61, 0xffff0000, v22
    v_lshlrev_b32 v62, 16, v23
    v_and_b32 v63, 0xffff0000, v23
    v_add_f32 v48, v48, v56
    v_add_f32 v49, v49, v57
    v_add_f32 v50, v50, v58
    v_add_f32 v51, v51, v59
    v_add_f32 v52, v52, v60
    v_add_f32 v53, v53, v61
    v_add_f32 v54, v54, v62
    v_add_f32 v55, v55, v63
    v_cvt_pk_bf16_f32 v20, v48, v49
    v_cvt_pk_bf16_f32 v21, v50, v51
    v_cvt_pk_bf16_f32 v22, v52, v53
    v_cvt_pk_bf16_f32 v23, v54, v55
    v_lshlrev_b32 v48, 16, v20
    v_and_b32 v49, 0xffff0000, v20
    v_lshlrev_b32 v50, 16, v21
    v_and_b32 v51, 0xffff0000, v21
    v_lshlrev_b32 v52, 16, v22
    v_and_b32 v53, 0xffff0000, v22
    v_lshlrev_b32 v54, 16, v23
    v_and_b32 v55, 0xffff0000, v23
    s_cmp_eq_u32 s23, 0
    s_cbranch_scc1 L_fx_68
    buffer_store_dwordx2 v[16:17], v12, s[16:19], s29 offen offset:0
    buffer_store_dwordx2 v[18:19], v12, s[16:19], s29 offen offset:256
    buffer_store_dwordx2 v[20:21], v12, s[16:19], s29 offen offset:512
    buffer_store_dwordx2 v[22:23], v12, s[16:19], s29 offen offset:768
    s_branch L_fy_69
L_fx_68:
    s_add_u32 s25, s29, 33554432
    buffer_store_dwordx2 v[16:17], v12, s[8:11], s25 offen offset:0 sc1
    buffer_store_dwordx2 v[18:19], v12, s[8:11], s25 offen offset:256 sc1
    buffer_store_dwordx2 v[20:21], v12, s[8:11], s25 offen offset:512 sc1
    buffer_store_dwordx2 v[22:23], v12, s[8:11], s25 offen offset:768 sc1
    s_add_u32 s25, s29, 23068672
    v_pk_add_f32 v[40:41], v[32:33], v[34:35]
    v_pk_add_f32 v[40:41], v[40:41], v[36:37]
    v_pk_add_f32 v[40:41], v[40:41], v[38:39]
    v_pk_add_f32 v[40:41], v[40:41], v[48:49]
    v_pk_add_f32 v[40:41], v[40:41], v[50:51]
    v_pk_add_f32 v[40:41], v[40:41], v[52:53]
    v_pk_add_f32 v[40:41], v[40:41], v[54:55]
    v_add_f32 v14, v40, v41
    s_nop 1
    v_add_f32_dpp v14, v14, v14 quad_perm:[1,0,3,2] row_mask:0xf bank_mask:0xf
    s_nop 1
    v_add_f32_dpp v14, v14, v14 quad_perm:[2,3,0,1] row_mask:0xf bank_mask:0xf
    s_nop 1
    v_add_f32_dpp v14, v14, v14 row_ror:8 row_mask:0xf bank_mask:0xf
    v_mov_b32 v42, v14
    s_nop 1
    v_permlane16_swap_b32 v14, v42
    v_add_f32 v14, v14, v42
    v_mov_b32 v42, v14
    s_nop 1
    v_permlane32_swap_b32 v14, v42
    v_add_f32 v14, v14, v42
    v_mul_f32 v14, 0xbb000000, v14
    v_pk_add_f32 v[32:33], v[32:33], v[14:15] op_sel_hi:[1,0]
    v_pk_add_f32 v[34:35], v[34:35], v[14:15] op_sel_hi:[1,0]
    v_pk_add_f32 v[36:37], v[36:37], v[14:15] op_sel_hi:[1,0]
    v_pk_add_f32 v[38:39], v[38:39], v[14:15] op_sel_hi:[1,0]
    v_pk_add_f32 v[48:49], v[48:49], v[14:15] op_sel_hi:[1,0]
    v_pk_add_f32 v[50:51], v[50:51], v[14:15] op_sel_hi:[1,0]
    v_pk_add_f32 v[52:53], v[52:53], v[14:15] op_sel_hi:[1,0]
    v_pk_add_f32 v[54:55], v[54:55], v[14:15] op_sel_hi:[1,0]
    v_pk_mul_f32 v[40:41], v[32:33], v[32:33]
    v_pk_fma_f32 v[40:41], v[34:35], v[34:35], v[40:41]
    v_pk_fma_f32 v[40:41], v[36:37], v[36:37], v[40:41]
    v_pk_fma_f32 v[40:41], v[38:39], v[38:39], v[40:41]
    v_pk_fma_f32 v[40:41], v[48:49], v[48:49], v[40:41]
    v_pk_fma_f32 v[40:41], v[50:51], v[50:51], v[40:41]
    v_pk_fma_f32 v[40:41], v[52:53], v[52:53], v[40:41]
    v_pk_fma_f32 v[40:41], v[54:55], v[54:55], v[40:41]
    v_add_f32 v15, v40, v41
    s_nop 1
    v_add_f32_dpp v15, v15, v15 quad_perm:[1,0,3,2] row_mask:0xf bank_mask:0xf
    s_nop 1
    v_add_f32_dpp v15, v15, v15 quad_perm:[2,3,0,1] row_mask:0xf bank_mask:0xf
    s_nop 1
    v_add_f32_dpp v15, v15, v15 row_ror:8 row_mask:0xf bank_mask:0xf
    v_mov_b32 v42, v15
    s_nop 1
    v_permlane16_swap_b32 v15, v42
    v_add_f32 v15, v15, v42
    v_mov_b32 v42, v15
    s_nop 1
    v_permlane32_swap_b32 v15, v42
    v_add_f32 v15, v15, v42
    v_mov_b32 v40, 0x3727c5ac
    v_fmac_f32 v40, 0x3b000000, v15
    v_rsq_f32 v14, v40
    s_nop 0
    v_pk_mul_f32 v[32:33], v[32:33], v[14:15] op_sel_hi:[1,0]
    v_pk_mul_f32 v[34:35], v[34:35], v[14:15] op_sel_hi:[1,0]
    v_pk_mul_f32 v[36:37], v[36:37], v[14:15] op_sel_hi:[1,0]
    v_pk_mul_f32 v[38:39], v[38:39], v[14:15] op_sel_hi:[1,0]
    v_pk_mul_f32 v[48:49], v[48:49], v[14:15] op_sel_hi:[1,0]
    v_pk_mul_f32 v[50:51], v[50:51], v[14:15] op_sel_hi:[1,0]
    v_pk_mul_f32 v[52:53], v[52:53], v[14:15] op_sel_hi:[1,0]
    v_pk_mul_f32 v[54:55], v[54:55], v[14:15] op_sel_hi:[1,0]
    v_cvt_pk_bf16_f32 v24, v32, v33
    v_cvt_pk_bf16_f32 v25, v34, v35
    v_cvt_pk_bf16_f32 v26, v36, v37
    v_cvt_pk_bf16_f32 v27, v38, v39
    v_cvt_pk_bf16_f32 v28, v48, v49
    v_cvt_pk_bf16_f32 v29, v50, v51
    v_cvt_pk_bf16_f32 v30, v52, v53
    v_cvt_pk_bf16_f32 v31, v54, v55
    buffer_store_dwordx2 v[24:25], v12, s[8:11], s25 offen offset:0 sc1
    buffer_store_dwordx2 v[26:27], v12, s[8:11], s25 offen offset:256 sc1
    buffer_store_dwordx2 v[28:29], v12, s[8:11], s25 offen offset:512 sc1
    buffer_store_dwordx2 v[30:31], v12, s[8:11], s25 offen offset:768 sc1
L_fy_69:
    s_cmp_lg_u32 s54, 0
    s_cbranch_scc1 L_fn_70
    s_waitcnt vmcnt(4)
    v_cmp_eq_u32 vcc, 0, v0
    s_nop 0
    s_cbranch_vccnz L_fn_70
    s_lshl_b32 s62, s55, 16
    s_lshl_b32 s63, s20, 14
    s_add_u32 s62, s62, s63
    s_add_u32 s62, s62, 29360128
    s_add_u32 m0, s63, 0
    v_xor_b32 v14, 0, v1
    buffer_load_dwordx4 v14, s[8:11], s62 offen offset:0 lds
    v_xor_b32 v15, 16, v1
    buffer_load_dwordx4 v15, s[8:11], s62 offen offset:1024 lds
    v_xor_b32 v14, 32, v1
    buffer_load_dwordx4 v14, s[8:11], s62 offen offset:2048 lds
    v_xor_b32 v15, 48, v1
    buffer_load_dwordx4 v15, s[8:11], s62 offen offset:3072 lds
    s_add_u32 s62, s62, 4096
    s_add_u32 m0, s63, 4096
    v_xor_b32 v14, 64, v1
    buffer_load_dwordx4 v14, s[8:11], s62 offen offset:0 lds
    v_xor_b32 v15, 80, v1
    buffer_load_dwordx4 v15, s[8:11], s62 offen offset:1024 lds
    v_xor_b32 v14, 96, v1
    buffer_load_dwordx4 v14, s[8:11], s62 offen offset:2048 lds
    v_xor_b32 v15, 112, v1
    buffer_load_dwordx4 v15, s[8:11], s62 offen offset:3072 lds
    s_add_u32 s62, s62, 4096
    s_add_u32 m0, s63, 8192
    v_xor_b32 v14, 128, v1
    buffer_load_dwordx4 v14, s[8:11], s62 offen offset:0 lds
    v_xor_b32 v15, 144, v1
    buffer_load_dwordx4 v15, s[8:11], s62 offen offset:1024 lds
    v_xor_b32 v14, 160, v1
    buffer_load_dwordx4 v14, s[8:11], s62 offen offset:2048 lds
    v_xor_b32 v15, 176, v1
    buffer_load_dwordx4 v15, s[8:11], s62 offen offset:3072 lds
    s_add_u32 s62, s62, 4096
    s_add_u32 m0, s63, 12288
    v_xor_b32 v14, 192, v1
    buffer_load_dwordx4 v14, s[8:11], s62 offen offset:0 lds
    v_xor_b32 v15, 208, v1
    buffer_load_dwordx4 v15, s[8:11], s62 offen offset:1024 lds
    v_xor_b32 v14, 224, v1
    buffer_load_dwordx4 v14, s[8:11], s62 offen offset:2048 lds
    v_xor_b32 v15, 240, v1
    buffer_load_dwordx4 v15, s[8:11], s62 offen offset:3072 lds
    s_mov_b32 s54, 1
    s_waitcnt vmcnt(16)
    s_branch L_fs_71
L_fn_70:
    s_waitcnt vmcnt(0)
L_fs_71:
    s_lshl_b32 s26, s24, 7
    s_lshr_b32 s35, s52, 12
    s_add_u32 s26, s26, s35
    s_add_u32 s26, s26, 35885824
    s_waitcnt vmcnt(63)
    buffer_store_dword v3, v2, s[8:11], s26 offen sc1
    s_cmp_ge_u32 s24, 60
    s_cbranch_scc1 M_done
    s_mov_b32 s24, s55
    s_lshr_b32 s23, s24, 5
    s_add_u32 s33, s33, 1
    s_branch F_loopG
F_loopL:
    s_cmp_lg_u32 s54, 0
    s_cbranch_scc1 L_fp_72
    s_lshl_b32 s26, s24, 8
    s_lshl_b32 s35, s20, 6
    s_add_u32 s26, s26, s35
    s_add_u32 s26, s26, 35869184
L_wf_73:
    buffer_load_dword v4, v7, s[8:11], s26 offen sc1
    s_waitcnt vmcnt(0)
    v_cmp_eq_u32 vcc, 0, v4
    s_nop 0
    s_cbranch_vccz L_wfd_74
    s_sleep 2
    s_sub_u32 s30, s30, 1
    s_cbranch_scc0 L_wf_73
    s_branch M_done
L_wfd_74:
    s_lshl_b32 s62, s24, 16
    s_lshl_b32 s63, s20, 14
    s_add_u32 s62, s62, s63
    s_add_u32 s62, s62, 29360128
    s_add_u32 m0, s63, 0
    v_xor_b32 v14, 0, v1
    buffer_load_dwordx4 v14, s[8:11], s62 offen offset:0 lds
    v_xor_b32 v15, 16, v1
    buffer_load_dwordx4 v15, s[8:11], s62 offen offset:1024 lds
    v_xor_b32 v14, 32, v1
    buffer_load_dwordx4 v14, s[8:11], s62 offen offset:2048 lds
    v_xor_b32 v15, 48, v1
    buffer_load_dwordx4 v15, s[8:11], s62 offen offset:3072 lds
    s_add_u32 s62, s62, 4096
    s_add_u32 m0, s63, 4096
    v_xor_b32 v14, 64, v1
    buffer_load_dwordx4 v14, s[8:11], s62 offen offset:0 lds
    v_xor_b32 v15, 80, v1
    buffer_load_dwordx4 v15, s[8:11], s62 offen offset:1024 lds
    v_xor_b32 v14, 96, v1
    buffer_load_dwordx4 v14, s[8:11], s62 offen offset:2048 lds
    v_xor_b32 v15, 112, v1
    buffer_load_dwordx4 v15, s[8:11], s62 offen offset:3072 lds
    s_add_u32 s62, s62, 4096
    s_add_u32 m0, s63, 8192
    v_xor_b32 v14, 128, v1
    buffer_load_dwordx4 v14, s[8:11], s62 offen offset:0 lds
    v_xor_b32 v15, 144, v1
    buffer_load_dwordx4 v15, s[8:11], s62 offen offset:1024 lds
    v_xor_b32 v14, 160, v1
    buffer_load_dwordx4 v14, s[8:11], s62 offen offset:2048 lds
    v_xor_b32 v15, 176, v1
    buffer_load_dwordx4 v15, s[8:11], s62 offen offset:3072 lds
    s_add_u32 s62, s62, 4096
    s_add_u32 m0, s63, 12288
    v_xor_b32 v14, 192, v1
    buffer_load_dwordx4 v14, s[8:11], s62 offen offset:0 lds
    v_xor_b32 v15, 208, v1
    buffer_load_dwordx4 v15, s[8:11], s62 offen offset:1024 lds
    v_xor_b32 v14, 224, v1
    buffer_load_dwordx4 v14, s[8:11], s62 offen offset:2048 lds
    v_xor_b32 v15, 240, v1
    buffer_load_dwordx4 v15, s[8:11], s62 offen offset:3072 lds
L_fp_72:
    s_waitcnt vmcnt(0)
    s_barrier
    s_lshl_b32 s28, s21, 3
    s_lshl_b32 s26, s20, 1
    s_add_u32 s28, s28, s26
    s_and_b32 s29, s24, 31
    s_lshl_b32 s29, s29, 6
    s_add_u32 s29, s29, s28
    s_lshl_b32 s29, s29, 10
    s_lshl_b32 s26, s23, 21
    s_add_u32 s26, s26, s29
    s_add_u32 s26, s26, 25165824
    s_lshl_b32 s58, s20, 11
    s_add_u32 s58, s58, 98304
    s_mov_b32 m0, s58
    s_nop 0
    buffer_load_dwordx4 v1, s[8:11], s26 offen sc1 lds
    buffer_load_dwordx4 v1, s[8:11], s26 offen offset:1024 sc1 lds
    s_mul_i32 s25, s20, 3
    s_add_u32 s25, s25, 0
    s_lshr_b32 s26, s25, 1
    s_lshl_b32 s26, s26, 10
    s_and_b32 s25, s25, 1
    s_lshl_b32 s25, s25, 3
    s_add_u32 s25, s25, s26
    s_add_u32 s25, s25, 65536
    v_add_u32 v96, s25, v1
    s_mul_i32 s25, s20, 3
    s_add_u32 s25, s25, 1
    s_lshr_b32 s26, s25, 1
    s_lshl_b32 s26, s26, 10
    s_and_b32 s25, s25, 1
    s_lshl_b32 s25, s25, 3
    s_add_u32 s25, s25, s26
    s_add_u32 s25, s25, 65536
    v_add_u32 v97, s25, v1
    s_mul_i32 s25, s20, 3
    s_add_u32 s25, s25, 2
    s_lshr_b32 s26, s25, 1
    s_lshl_b32 s26, s26, 10
    s_and_b32 s25, s25, 1
    s_lshl_b32 s25, s25, 3
    s_add_u32 s25, s25, s26
    s_add_u32 s25, s25, 65536
    v_add_u32 v98, s25, v1
    ds_read_b128 v[64:67], v8 offset:0
    ds_read_b128 v[68:71], v9 offset:0
    ds_read_b128 v[72:75], v10 offset:0
    ds_read_b128 v[76:79], v11 offset:0
    ds_read_b128 v[80:83], v8 offset:256
    ds_read_b128 v[84:87], v9 offset:256
    ds_read_b128 v[88:91], v10 offset:256
    s_waitcnt lgkmcnt(6)
    v_mfma_f32_16x16x32_bf16 v[16:19], a[0:3], v[64:67], 0
    v_mfma_f32_16x16x32_bf16 v[20:23], a[64:67], v[64:67], 0
    v_mfma_f32_16x16x32_bf16 v[24:27], a[128:131], v[64:67], 0
    ds_read_b128 v[92:95], v11 offset:256
    s_waitcnt lgkmcnt(6)
    v_mfma_f32_16x16x32_bf16 v[16:19], a[4:7], v[68:71], v[16:19]
    v_mfma_f32_16x16x32_bf16 v[20:23], a[68:71], v[68:71], v[20:23]
    v_mfma_f32_16x16x32_bf16 v[24:27], a[132:135], v[68:71], v[24:27]
    ds_read_b128 v[64:67], v8 offset:512
    s_waitcnt lgkmcnt(6)
    v_mfma_f32_16x16x32_bf16 v[16:19], a[8:11], v[72:75], v[16:19]
    v_mfma_f32_16x16x32_bf16 v[20:23], a[72:75], v[72:75], v[20:23]
    v_mfma_f32_16x16x32_bf16 v[24:27], a[136:139], v[72:75], v[24:27]
    ds_read_b128 v[68:71], v9 offset:512
    s_waitcnt lgkmcnt(6)
    v_mfma_f32_16x16x32_bf16 v[16:19], a[12:15], v[76:79], v[16:19]
    v_mfma_f32_16x16x32_bf16 v[20:23], a[76:79], v[76:79], v[20:23]
    v_mfma_f32_16x16x32_bf16 v[24:27], a[140:143], v[76:79], v[24:27]
    ds_read_b128 v[72:75], v10 offset:512
    s_waitcnt lgkmcnt(6)
    v_mfma_f32_16x16x32_bf16 v[16:19], a[16:19], v[80:83], v[16:19]
    v_mfma_f32_16x16x32_bf16 v[20:23], a[80:83], v[80:83], v[20:23]
    v_mfma_f32_16x16x32_bf16 v[24:27], a[144:147], v[80:83], v[24:27]
    ds_read_b128 v[76:79], v11 offset:512
    s_waitcnt lgkmcnt(6)
    v_mfma_f32_16x16x32_bf16 v[16:19], a[20:23], v[84:87], v[16:19]
    v_mfma_f32_16x16x32_bf16 v[20:23], a[84:87], v[84:87], v[20:23]
    v_mfma_f32_16x16x32_bf16 v[24:27], a[148:151], v[84:87], v[24:27]
    ds_read_b128 v[80:83], v8 offset:768
    s_waitcnt lgkmcnt(6)
    v_mfma_f32_16x16x32_bf16 v[16:19], a[24:27], v[88:91], v[16:19]
    v_mfma_f32_16x16x32_bf16 v[20:23], a[88:91], v[88:91], v[20:23]
    v_mfma_f32_16x16x32_bf16 v[24:27], a[152:155], v[88:91], v[24:27]
    ds_read_b128 v[84:87], v9 offset:768
    s_waitcnt lgkmcnt(6)
    v_mfma_f32_16x16x32_bf16 v[16:19], a[28:31], v[92:95], v[16:19]
    v_mfma_f32_16x16x32_bf16 v[20:23], a[92:95], v[92:95], v[20:23]
    v_mfma_f32_16x16x32_bf16 v[24:27], a[156:159], v[92:95], v[24:27]
    ds_read_b128 v[88:91], v10 offset:768
    s_waitcnt lgkmcnt(6)
    v_mfma_f32_16x16x32_bf16 v[16:19], a[32:35], v[64:67], v[16:19]
    v_mfma_f32_16x16x32_bf16 v[20:23], a[96:99], v[64:67], v[20:23]
    v_mfma_f32_16x16x32_bf16 v[24:27], a[160:163], v[64:67], v[24:27]
    ds_read_b128 v[92:95], v11 offset:768
    s_waitcnt lgkmcnt(6)
    v_mfma_f32_16x16x32_bf16 v[16:19], a[36:39], v[68:71], v[16:19]
    v_mfma_f32_16x16x32_bf16 v[20:23], a[100:103], v[68:71], v[20:23]
    v_mfma_f32_16x16x32_bf16 v[24:27], a[164:167], v[68:71], v[24:27]
    ds_read_b128 v[64:67], v8 offset:16384
    s_waitcnt lgkmcnt(6)
    v_mfma_f32_16x16x32_bf16 v[16:19], a[40:43], v[72:75], v[16:19]
    v_mfma_f32_16x16x32_bf16 v[20:23], a[104:107], v[72:75], v[20:23]
    v_mfma_f32_16x16x32_bf16 v[24:27], a[168:171], v[72:75], v[24:27]
    ds_read_b128 v[68:71], v9 offset:16384
    s_waitcnt lgkmcnt(6)
    v_mfma_f32_16x16x32_bf16 v[16:19], a[44:47], v[76:79], v[16:19]
    v_mfma_f32_16x16x32_bf16 v[20:23], a[108:111], v[76:79], v[20:23]
    v_mfma_f32_16x16x32_bf16 v[24:27], a[172:175], v[76:79], v[24:27]
    ds_read_b128 v[72:75], v10 offset:16384
    s_waitcnt lgkmcnt(6)
    v_mfma_f32_16x16x32_bf16 v[16:19], a[48:51], v[80:83], v[16:19]
    v_mfma_f32_16x16x32_bf16 v[20:23], a[112:115], v[80:83], v[20:23]
    v_mfma_f32_16x16x32_bf16 v[24:27], a[176:179], v[80:83], v[24:27]
    ds_read_b128 v[76:79], v11 offset:16384
    s_waitcnt lgkmcnt(6)
    v_mfma_f32_16x16x32_bf16 v[16:19], a[52:55], v[84:87], v[16:19]
    v_mfma_f32_16x16x32_bf16 v[20:23], a[116:119], v[84:87], v[20:23]
    v_mfma_f32_16x16x32_bf16 v[24:27], a[180:183], v[84:87], v[24:27]
    ds_read_b128 v[80:83], v8 offset:16640
    s_waitcnt lgkmcnt(6)
    v_mfma_f32_16x16x32_bf16 v[16:19], a[56:59], v[88:91], v[16:19]
    v_mfma_f32_16x16x32_bf16 v[20:23], a[120:123], v[88:91], v[20:23]
    v_mfma_f32_16x16x32_bf16 v[24:27], a[184:187], v[88:91], v[24:27]
    ds_read_b128 v[84:87], v9 offset:16640
    s_waitcnt lgkmcnt(6)
    v_mfma_f32_16x16x32_bf16 v[16:19], a[60:63], v[92:95], v[16:19]
    v_mfma_f32_16x16x32_bf16 v[20:23], a[124:127], v[92:95], v[20:23]
    v_mfma_f32_16x16x32_bf16 v[24:27], a[188:191], v[92:95], v[24:27]
    ds_read_b128 v[88:91], v10 offset:16640
    s_waitcnt lgkmcnt(6)
    v_mfma_f32_16x16x32_bf16 v[28:31], a[0:3], v[64:67], 0
    v_mfma_f32_16x16x32_bf16 v[32:35], a[64:67], v[64:67], 0
    v_mfma_f32_16x16x32_bf16 v[36:39], a[128:131], v[64:67], 0
    ds_read_b128 v[92:95], v11 offset:16640
    s_waitcnt lgkmcnt(6)
    v_mfma_f32_16x16x32_bf16 v[28:31], a[4:7], v[68:71], v[28:31]
    v_mul_f32 v100, s64, v16
    v_mul_f32 v101, s64, v17
    v_mfma_f32_16x16x32_bf16 v[32:35], a[68:71], v[68:71], v[32:35]
    v_mul_f32 v102, s64, v18
    v_mul_f32 v103, s64, v19
    v_mfma_f32_16x16x32_bf16 v[36:39], a[132:135], v[68:71], v[36:39]
    v_exp_f32 v100, v100
    ds_read_b128 v[64:67], v8 offset:16896
    s_waitcnt lgkmcnt(6)
    v_mfma_f32_16x16x32_bf16 v[28:31], a[8:11], v[72:75], v[28:31]
    v_exp_f32 v101, v101
    v_mfma_f32_16x16x32_bf16 v[32:35], a[72:75], v[72:75], v[32:35]
    v_exp_f32 v102, v102
    v_mfma_f32_16x16x32_bf16 v[36:39], a[136:139], v[72:75], v[36:39]
    v_exp_f32 v103, v103
    ds_read_b128 v[68:71], v9 offset:16896
    s_waitcnt lgkmcnt(6)
    v_mfma_f32_16x16x32_bf16 v[28:31], a[12:15], v[76:79], v[28:31]
    v_add_f32 v100, 1.0, v100
    v_add_f32 v101, 1.0, v101
    v_mfma_f32_16x16x32_bf16 v[32:35], a[76:79], v[76:79], v[32:35]
    v_add_f32 v102, 1.0, v102
    v_add_f32 v103, 1.0, v103
    v_mfma_f32_16x16x32_bf16 v[36:39], a[140:143], v[76:79], v[36:39]
    v_rcp_f32 v100, v100
    ds_read_b128 v[72:75], v10 offset:16896
    s_waitcnt lgkmcnt(6)
    v_mfma_f32_16x16x32_bf16 v[28:31], a[16:19], v[80:83], v[28:31]
    v_rcp_f32 v101, v101
    v_mfma_f32_16x16x32_bf16 v[32:35], a[80:83], v[80:83], v[32:35]
    v_rcp_f32 v102, v102
    v_mfma_f32_16x16x32_bf16 v[36:39], a[144:147], v[80:83], v[36:39]
    v_rcp_f32 v103, v103
    ds_read_b128 v[76:79], v11 offset:16896
    s_waitcnt lgkmcnt(6)
    v_mfma_f32_16x16x32_bf16 v[28:31], a[20:23], v[84:87], v[28:31]
    v_mul_f32 v16, v16, v100
    v_mul_f32 v17, v17, v101
    v_mfma_f32_16x16x32_bf16 v[32:35], a[84:87], v[84:87], v[32:35]
    v_mul_f32 v18, v18, v102
    v_mul_f32 v19, v19, v103
    v_mfma_f32_16x16x32_bf16 v[36:39], a[148:151], v[84:87], v[36:39]
    v_cvt_pk_bf16_f32 v16, v16, v17
    v_cvt_pk_bf16_f32 v17, v18, v19
    ds_read_b128 v[80:83], v8 offset:17152
    s_waitcnt lgkmcnt(6)
    v_mfma_f32_16x16x32_bf16 v[28:31], a[24:27], v[88:91], v[28:31]
    v_mul_f32 v104, s64, v20
    v_mul_f32 v105, s64, v21
    v_mfma_f32_16x16x32_bf16 v[32:35], a[88:91], v[88:91], v[32:35]
    v_mul_f32 v106, s64, v22
    v_mul_f32 v107, s64, v23
    v_mfma_f32_16x16x32_bf16 v[36:39], a[152:155], v[88:91], v[36:39]
    v_exp_f32 v104, v104
    ds_read_b128 v[84:87], v9 offset:17152
    s_waitcnt lgkmcnt(6)
    v_mfma_f32_16x16x32_bf16 v[28:31], a[28:31], v[92:95], v[28:31]
    v_exp_f32 v105, v105
    v_mfma_f32_16x16x32_bf16 v[32:35], a[92:95], v[92:95], v[32:35]
    v_exp_f32 v106, v106
    v_mfma_f32_16x16x32_bf16 v[36:39], a[156:159], v[92:95], v[36:39]
    v_exp_f32 v107, v107
    ds_read_b128 v[88:91], v10 offset:17152
    s_waitcnt lgkmcnt(6)
    v_mfma_f32_16x16x32_bf16 v[28:31], a[32:35], v[64:67], v[28:31]
    v_add_f32 v104, 1.0, v104
    v_add_f32 v105, 1.0, v105
    v_mfma_f32_16x16x32_bf16 v[32:35], a[96:99], v[64:67], v[32:35]
    v_add_f32 v106, 1.0, v106
    v_add_f32 v107, 1.0, v107
    v_mfma_f32_16x16x32_bf16 v[36:39], a[160:163], v[64:67], v[36:39]
    v_rcp_f32 v104, v104
    ds_read_b128 v[92:95], v11 offset:17152
    s_waitcnt lgkmcnt(6)
    v_mfma_f32_16x16x32_bf16 v[28:31], a[36:39], v[68:71], v[28:31]
    v_rcp_f32 v105, v105
    v_mfma_f32_16x16x32_bf16 v[32:35], a[100:103], v[68:71], v[32:35]
    v_rcp_f32 v106, v106
    v_mfma_f32_16x16x32_bf16 v[36:39], a[164:167], v[68:71], v[36:39]
    v_rcp_f32 v107, v107
    ds_read_b128 v[64:67], v8 offset:32768
    s_waitcnt lgkmcnt(6)
    v_mfma_f32_16x16x32_bf16 v[28:31], a[40:43], v[72:75], v[28:31]
    v_mul_f32 v20, v20, v104
    v_mul_f32 v21, v21, v105
    v_mfma_f32_16x16x32_bf16 v[32:35], a[104:107], v[72:75], v[32:35]
    v_mul_f32 v22, v22, v106
    v_mul_f32 v23, v23, v107
    v_mfma_f32_16x16x32_bf16 v[36:39], a[168:171], v[72:75], v[36:39]
    v_cvt_pk_bf16_f32 v20, v20, v21
    v_cvt_pk_bf16_f32 v21, v22, v23
    ds_read_b128 v[68:71], v9 offset:32768
    s_waitcnt lgkmcnt(6)
    v_mfma_f32_16x16x32_bf16 v[28:31], a[44:47], v[76:79], v[28:31]
    v_mul_f32 v108, s64, v24
    v_mul_f32 v109, s64, v25
    v_mfma_f32_16x16x32_bf16 v[32:35], a[108:111], v[76:79], v[32:35]
    v_mul_f32 v110, s64, v26
    v_mul_f32 v111, s64, v27
    v_mfma_f32_16x16x32_bf16 v[36:39], a[172:175], v[76:79], v[36:39]
    v_exp_f32 v108, v108
    ds_read_b128 v[72:75], v10 offset:32768
    s_waitcnt lgkmcnt(6)
    v_mfma_f32_16x16x32_bf16 v[28:31], a[48:51], v[80:83], v[28:31]
    v_exp_f32 v109, v109
    v_mfma_f32_16x16x32_bf16 v[32:35], a[112:115], v[80:83], v[32:35]
    v_exp_f32 v110, v110
    v_mfma_f32_16x16x32_bf16 v[36:39], a[176:179], v[80:83], v[36:39]
    v_exp_f32 v111, v111
    ds_read_b128 v[76:79], v11 offset:32768
    s_waitcnt lgkmcnt(6)
    v_mfma_f32_16x16x32_bf16 v[28:31], a[52:55], v[84:87], v[28:31]
    v_add_f32 v108, 1.0, v108
    v_add_f32 v109, 1.0, v109
    v_mfma_f32_16x16x32_bf16 v[32:35], a[116:119], v[84:87], v[32:35]
    v_add_f32 v110, 1.0, v110
    v_add_f32 v111, 1.0, v111
    v_mfma_f32_16x16x32_bf16 v[36:39], a[180:183], v[84:87], v[36:39]
    v_rcp_f32 v108, v108
    ds_read_b128 v[80:83], v8 offset:33024
    s_waitcnt lgkmcnt(6)
    v_mfma_f32_16x16x32_bf16 v[28:31], a[56:59], v[88:91], v[28:31]
    v_rcp_f32 v109, v109
    v_mfma_f32_16x16x32_bf16 v[32:35], a[120:123], v[88:91], v[32:35]
    v_rcp_f32 v110, v110
    v_mfma_f32_16x16x32_bf16 v[36:39], a[184:187], v[88:91], v[36:39]
    v_rcp_f32 v111, v111
    ds_read_b128 v[84:87], v9 offset:33024
    s_waitcnt lgkmcnt(6)
    v_mfma_f32_16x16x32_bf16 v[28:31], a[60:63], v[92:95], v[28:31]
    v_mul_f32 v24, v24, v108
    v_mul_f32 v25, v25, v109
    v_mfma_f32_16x16x32_bf16 v[32:35], a[124:127], v[92:95], v[32:35]
    v_mul_f32 v26, v26, v110
    v_mul_f32 v27, v27, v111
    v_mfma_f32_16x16x32_bf16 v[36:39], a[188:191], v[92:95], v[36:39]
    v_cvt_pk_bf16_f32 v24, v24, v25
    v_cvt_pk_bf16_f32 v25, v26, v27
    ds_read_b128 v[88:91], v10 offset:33024
    s_waitcnt lgkmcnt(6)
    v_mfma_f32_16x16x32_bf16 v[40:43], a[0:3], v[64:67], 0
    v_mfma_f32_16x16x32_bf16 v[44:47], a[64:67], v[64:67], 0
    v_mfma_f32_16x16x32_bf16 v[48:51], a[128:131], v[64:67], 0
    ds_read_b128 v[92:95], v11 offset:33024
    s_waitcnt lgkmcnt(6)
    v_mfma_f32_16x16x32_bf16 v[40:43], a[4:7], v[68:71], v[40:43]
    v_mul_f32 v100, s64, v28
    v_mul_f32 v101, s64, v29
    v_mfma_f32_16x16x32_bf16 v[44:47], a[68:71], v[68:71], v[44:47]
    v_mul_f32 v102, s64, v30
    v_mul_f32 v103, s64, v31
    v_mfma_f32_16x16x32_bf16 v[48:51], a[132:135], v[68:71], v[48:51]
    v_exp_f32 v100, v100
    ds_read_b128 v[64:67], v8 offset:33280
    s_waitcnt lgkmcnt(6)
    v_mfma_f32_16x16x32_bf16 v[40:43], a[8:11], v[72:75], v[40:43]
    v_exp_f32 v101, v101
    v_mfma_f32_16x16x32_bf16 v[44:47], a[72:75], v[72:75], v[44:47]
    v_exp_f32 v102, v102
    v_mfma_f32_16x16x32_bf16 v[48:51], a[136:139], v[72:75], v[48:51]
    v_exp_f32 v103, v103
    ds_read_b128 v[68:71], v9 offset:33280
    s_waitcnt lgkmcnt(6)
    v_mfma_f32_16x16x32_bf16 v[40:43], a[12:15], v[76:79], v[40:43]
    v_add_f32 v100, 1.0, v100
    v_add_f32 v101, 1.0, v101
    v_mfma_f32_16x16x32_bf16 v[44:47], a[76:79], v[76:79], v[44:47]
    v_add_f32 v102, 1.0, v102
    v_add_f32 v103, 1.0, v103
    v_mfma_f32_16x16x32_bf16 v[48:51], a[140:143], v[76:79], v[48:51]
    v_rcp_f32 v100, v100
    ds_read_b128 v[72:75], v10 offset:33280
    s_waitcnt lgkmcnt(6)
    v_mfma_f32_16x16x32_bf16 v[40:43], a[16:19], v[80:83], v[40:43]
    v_rcp_f32 v101, v101
    v_mfma_f32_16x16x32_bf16 v[44:47], a[80:83], v[80:83], v[44:47]
    v_rcp_f32 v102, v102
    v_mfma_f32_16x16x32_bf16 v[48:51], a[144:147], v[80:83], v[48:51]
    v_rcp_f32 v103, v103
    ds_read_b128 v[76:79], v11 offset:33280
    s_waitcnt lgkmcnt(6)
    v_mfma_f32_16x16x32_bf16 v[40:43], a[20:23], v[84:87], v[40:43]
    v_mul_f32 v28, v28, v100
    v_mul_f32 v29, v29, v101
    v_mfma_f32_16x16x32_bf16 v[44:47], a[84:87], v[84:87], v[44:47]
    v_mul_f32 v30, v30, v102
    v_mul_f32 v31, v31, v103
    v_mfma_f32_16x16x32_bf16 v[48:51], a[148:151], v[84:87], v[48:51]
    v_cvt_pk_bf16_f32 v28, v28, v29
    v_cvt_pk_bf16_f32 v29, v30, v31
    ds_read_b128 v[80:83], v8 offset:33536
    s_waitcnt lgkmcnt(6)
    v_mfma_f32_16x16x32_bf16 v[40:43], a[24:27], v[88:91], v[40:43]
    v_mul_f32 v104, s64, v32
    v_mul_f32 v105, s64, v33
    v_mfma_f32_16x16x32_bf16 v[44:47], a[88:91], v[88:91], v[44:47]
    v_mul_f32 v106, s64, v34
    v_mul_f32 v107, s64, v35
    v_mfma_f32_16x16x32_bf16 v[48:51], a[152:155], v[88:91], v[48:51]
    v_exp_f32 v104, v104
    ds_read_b128 v[84:87], v9 offset:33536
    s_waitcnt lgkmcnt(6)
    v_mfma_f32_16x16x32_bf16 v[40:43], a[28:31], v[92:95], v[40:43]
    v_exp_f32 v105, v105
    v_mfma_f32_16x16x32_bf16 v[44:47], a[92:95], v[92:95], v[44:47]
    v_exp_f32 v106, v106
    v_mfma_f32_16x16x32_bf16 v[48:51], a[156:159], v[92:95], v[48:51]
    v_exp_f32 v107, v107
    ds_read_b128 v[88:91], v10 offset:33536
    s_waitcnt lgkmcnt(6)
    v_mfma_f32_16x16x32_bf16 v[40:43], a[32:35], v[64:67], v[40:43]
    v_add_f32 v104, 1.0, v104
    v_add_f32 v105, 1.0, v105
    v_mfma_f32_16x16x32_bf16 v[44:47], a[96:99], v[64:67], v[44:47]
    v_add_f32 v106, 1.0, v106
    v_add_f32 v107, 1.0, v107
    v_mfma_f32_16x16x32_bf16 v[48:51], a[160:163], v[64:67], v[48:51]
    v_rcp_f32 v104, v104
    ds_read_b128 v[92:95], v11 offset:33536
    s_waitcnt lgkmcnt(6)
    v_mfma_f32_16x16x32_bf16 v[40:43], a[36:39], v[68:71], v[40:43]
    v_rcp_f32 v105, v105
    v_mfma_f32_16x16x32_bf16 v[44:47], a[100:103], v[68:71], v[44:47]
    v_rcp_f32 v106, v106
    v_mfma_f32_16x16x32_bf16 v[48:51], a[164:167], v[68:71], v[48:51]
    v_rcp_f32 v107, v107
    ds_read_b128 v[64:67], v8 offset:49152
    s_waitcnt lgkmcnt(6)
    v_mfma_f32_16x16x32_bf16 v[40:43], a[40:43], v[72:75], v[40:43]
    v_mul_f32 v32, v32, v104
    v_mul_f32 v33, v33, v105
    v_mfma_f32_16x16x32_bf16 v[44:47], a[104:107], v[72:75], v[44:47]
    v_mul_f32 v34, v34, v106
    v_mul_f32 v35, v35, v107
    v_mfma_f32_16x16x32_bf16 v[48:51], a[168:171], v[72:75], v[48:51]
    v_cvt_pk_bf16_f32 v32, v32, v33
    v_cvt_pk_bf16_f32 v33, v34, v35
    ds_read_b128 v[68:71], v9 offset:49152
    s_waitcnt lgkmcnt(6)
    v_mfma_f32_16x16x32_bf16 v[40:43], a[44:47], v[76:79], v[40:43]
    v_mul_f32 v108, s64, v36
    v_mul_f32 v109, s64, v37
    v_mfma_f32_16x16x32_bf16 v[44:47], a[108:111], v[76:79], v[44:47]
    v_mul_f32 v110, s64, v38
    v_mul_f32 v111, s64, v39
    v_mfma_f32_16x16x32_bf16 v[48:51], a[172:175], v[76:79], v[48:51]
    v_exp_f32 v108, v108
    ds_read_b128 v[72:75], v10 offset:49152
    s_waitcnt lgkmcnt(6)
    v_mfma_f32_16x16x32_bf16 v[40:43], a[48:51], v[80:83], v[40:43]
    v_exp_f32 v109, v109
    v_mfma_f32_16x16x32_bf16 v[44:47], a[112:115], v[80:83], v[44:47]
    v_exp_f32 v110, v110
    v_mfma_f32_16x16x32_bf16 v[48:51], a[176:179], v[80:83], v[48:51]
    v_exp_f32 v111, v111
    ds_read_b128 v[76:79], v11 offset:49152
    s_waitcnt lgkmcnt(6)
    v_mfma_f32_16x16x32_bf16 v[40:43], a[52:55], v[84:87], v[40:43]
    v_add_f32 v108, 1.0, v108
    v_add_f32 v109, 1.0, v109
    v_mfma_f32_16x16x32_bf16 v[44:47], a[116:119], v[84:87], v[44:47]
    v_add_f32 v110, 1.0, v110
    v_add_f32 v111, 1.0, v111
    v_mfma_f32_16x16x32_bf16 v[48:51], a[180:183], v[84:87], v[48:51]
    v_rcp_f32 v108, v108
    ds_read_b128 v[80:83], v8 offset:49408
    s_waitcnt lgkmcnt(6)
    v_mfma_f32_16x16x32_bf16 v[40:43], a[56:59], v[88:91], v[40:43]
    v_rcp_f32 v109, v109
    v_mfma_f32_16x16x32_bf16 v[44:47], a[120:123], v[88:91], v[44:47]
    v_rcp_f32 v110, v110
    v_mfma_f32_16x16x32_bf16 v[48:51], a[184:187], v[88:91], v[48:51]
    v_rcp_f32 v111, v111
    ds_read_b128 v[84:87], v9 offset:49408
    s_waitcnt lgkmcnt(6)
    v_mfma_f32_16x16x32_bf16 v[40:43], a[60:63], v[92:95], v[40:43]
    v_mul_f32 v36, v36, v108
    v_mul_f32 v37, v37, v109
    v_mfma_f32_16x16x32_bf16 v[44:47], a[124:127], v[92:95], v[44:47]
    v_mul_f32 v38, v38, v110
    v_mul_f32 v39, v39, v111
    v_mfma_f32_16x16x32_bf16 v[48:51], a[188:191], v[92:95], v[48:51]
    v_cvt_pk_bf16_f32 v36, v36, v37
    v_cvt_pk_bf16_f32 v37, v38, v39
    ds_read_b128 v[88:91], v10 offset:49408
    s_waitcnt lgkmcnt(6)
    v_mfma_f32_16x16x32_bf16 v[52:55], a[0:3], v[64:67], 0
    v_mfma_f32_16x16x32_bf16 v[56:59], a[64:67], v[64:67], 0
    v_mfma_f32_16x16x32_bf16 v[60:63], a[128:131], v[64:67], 0
    ds_read_b128 v[92:95], v11 offset:49408
    s_waitcnt lgkmcnt(6)
    v_mfma_f32_16x16x32_bf16 v[52:55], a[4:7], v[68:71], v[52:55]
    v_mul_f32 v100, s64, v40
    v_mul_f32 v101, s64, v41
    v_mfma_f32_16x16x32_bf16 v[56:59], a[68:71], v[68:71], v[56:59]
    v_mul_f32 v102, s64, v42
    v_mul_f32 v103, s64, v43
    v_mfma_f32_16x16x32_bf16 v[60:63], a[132:135], v[68:71], v[60:63]
    v_exp_f32 v100, v100
    ds_read_b128 v[64:67], v8 offset:49664
    s_waitcnt lgkmcnt(6)
    v_mfma_f32_16x16x32_bf16 v[52:55], a[8:11], v[72:75], v[52:55]
    v_exp_f32 v101, v101
    v_mfma_f32_16x16x32_bf16 v[56:59], a[72:75], v[72:75], v[56:59]
    v_exp_f32 v102, v102
    v_mfma_f32_16x16x32_bf16 v[60:63], a[136:139], v[72:75], v[60:63]
    v_exp_f32 v103, v103
    ds_read_b128 v[68:71], v9 offset:49664
    s_waitcnt lgkmcnt(6)
    v_mfma_f32_16x16x32_bf16 v[52:55], a[12:15], v[76:79], v[52:55]
    v_add_f32 v100, 1.0, v100
    v_add_f32 v101, 1.0, v101
    v_mfma_f32_16x16x32_bf16 v[56:59], a[76:79], v[76:79], v[56:59]
    v_add_f32 v102, 1.0, v102
    v_add_f32 v103, 1.0, v103
    v_mfma_f32_16x16x32_bf16 v[60:63], a[140:143], v[76:79], v[60:63]
    v_rcp_f32 v100, v100
    ds_read_b128 v[72:75], v10 offset:49664
    s_waitcnt lgkmcnt(6)
    v_mfma_f32_16x16x32_bf16 v[52:55], a[16:19], v[80:83], v[52:55]
    v_rcp_f32 v101, v101
    v_mfma_f32_16x16x32_bf16 v[56:59], a[80:83], v[80:83], v[56:59]
    v_rcp_f32 v102, v102
    v_mfma_f32_16x16x32_bf16 v[60:63], a[144:147], v[80:83], v[60:63]
    v_rcp_f32 v103, v103
    ds_read_b128 v[76:79], v11 offset:49664
    s_waitcnt lgkmcnt(6)
    v_mfma_f32_16x16x32_bf16 v[52:55], a[20:23], v[84:87], v[52:55]
    v_mul_f32 v40, v40, v100
    v_mul_f32 v41, v41, v101
    v_mfma_f32_16x16x32_bf16 v[56:59], a[84:87], v[84:87], v[56:59]
    v_mul_f32 v42, v42, v102
    v_mul_f32 v43, v43, v103
    v_mfma_f32_16x16x32_bf16 v[60:63], a[148:151], v[84:87], v[60:63]
    v_cvt_pk_bf16_f32 v40, v40, v41
    v_cvt_pk_bf16_f32 v41, v42, v43
    ds_read_b128 v[80:83], v8 offset:49920
    s_waitcnt lgkmcnt(6)
    v_mfma_f32_16x16x32_bf16 v[52:55], a[24:27], v[88:91], v[52:55]
    v_mul_f32 v104, s64, v44
    v_mul_f32 v105, s64, v45
    v_mfma_f32_16x16x32_bf16 v[56:59], a[88:91], v[88:91], v[56:59]
    v_mul_f32 v106, s64, v46
    v_mul_f32 v107, s64, v47
    v_mfma_f32_16x16x32_bf16 v[60:63], a[152:155], v[88:91], v[60:63]
    v_exp_f32 v104, v104
    ds_read_b128 v[84:87], v9 offset:49920
    s_waitcnt lgkmcnt(6)
    v_mfma_f32_16x16x32_bf16 v[52:55], a[28:31], v[92:95], v[52:55]
    v_exp_f32 v105, v105
    v_mfma_f32_16x16x32_bf16 v[56:59], a[92:95], v[92:95], v[56:59]
    v_exp_f32 v106, v106
    v_mfma_f32_16x16x32_bf16 v[60:63], a[156:159], v[92:95], v[60:63]
    v_exp_f32 v107, v107
    ds_read_b128 v[88:91], v10 offset:49920
    s_waitcnt lgkmcnt(6)
    v_mfma_f32_16x16x32_bf16 v[52:55], a[32:35], v[64:67], v[52:55]
    v_add_f32 v104, 1.0, v104
    v_add_f32 v105, 1.0, v105
    v_mfma_f32_16x16x32_bf16 v[56:59], a[96:99], v[64:67], v[56:59]
    v_add_f32 v106, 1.0, v106
    v_add_f32 v107, 1.0, v107
    v_mfma_f32_16x16x32_bf16 v[60:63], a[160:163], v[64:67], v[60:63]
    v_rcp_f32 v104, v104
    ds_read_b128 v[92:95], v11 offset:49920
    s_waitcnt lgkmcnt(6)
    v_mfma_f32_16x16x32_bf16 v[52:55], a[36:39], v[68:71], v[52:55]
    v_rcp_f32 v105, v105
    v_mfma_f32_16x16x32_bf16 v[56:59], a[100:103], v[68:71], v[56:59]
    v_rcp_f32 v106, v106
    v_mfma_f32_16x16x32_bf16 v[60:63], a[164:167], v[68:71], v[60:63]
    v_rcp_f32 v107, v107
    s_waitcnt lgkmcnt(5)
    v_mfma_f32_16x16x32_bf16 v[52:55], a[40:43], v[72:75], v[52:55]
    v_mul_f32 v44, v44, v104
    v_mul_f32 v45, v45, v105
    v_mfma_f32_16x16x32_bf16 v[56:59], a[104:107], v[72:75], v[56:59]
    v_mul_f32 v46, v46, v106
    v_mul_f32 v47, v47, v107
    v_mfma_f32_16x16x32_bf16 v[60:63], a[168:171], v[72:75], v[60:63]
    v_cvt_pk_bf16_f32 v44, v44, v45
    v_cvt_pk_bf16_f32 v45, v46, v47
    s_waitcnt lgkmcnt(4)
    v_mfma_f32_16x16x32_bf16 v[52:55], a[44:47], v[76:79], v[52:55]
    v_mul_f32 v108, s64, v48
    v_mul_f32 v109, s64, v49
    v_mfma_f32_16x16x32_bf16 v[56:59], a[108:111], v[76:79], v[56:59]
    v_mul_f32 v110, s64, v50
    v_mul_f32 v111, s64, v51
    v_mfma_f32_16x16x32_bf16 v[60:63], a[172:175], v[76:79], v[60:63]
    v_exp_f32 v108, v108
    s_waitcnt lgkmcnt(3)
    v_mfma_f32_16x16x32_bf16 v[52:55], a[48:51], v[80:83], v[52:55]
    v_exp_f32 v109, v109
    v_mfma_f32_16x16x32_bf16 v[56:59], a[112:115], v[80:83], v[56:59]
    v_exp_f32 v110, v110
    v_mfma_f32_16x16x32_bf16 v[60:63], a[176:179], v[80:83], v[60:63]
    v_exp_f32 v111, v111
    s_waitcnt lgkmcnt(2)
    v_mfma_f32_16x16x32_bf16 v[52:55], a[52:55], v[84:87], v[52:55]
    v_add_f32 v108, 1.0, v108
    v_add_f32 v109, 1.0, v109
    v_mfma_f32_16x16x32_bf16 v[56:59], a[116:119], v[84:87], v[56:59]
    v_add_f32 v110, 1.0, v110
    v_add_f32 v111, 1.0, v111
    v_mfma_f32_16x16x32_bf16 v[60:63], a[180:183], v[84:87], v[60:63]
    v_rcp_f32 v108, v108
    s_waitcnt lgkmcnt(1)
    v_mfma_f32_16x16x32_bf16 v[52:55], a[56:59], v[88:91], v[52:55]
    v_rcp_f32 v109, v109
    v_mfma_f32_16x16x32_bf16 v[56:59], a[120:123], v[88:91], v[56:59]
    v_rcp_f32 v110, v110
    v_mfma_f32_16x16x32_bf16 v[60:63], a[184:187], v[88:91], v[60:63]
    v_rcp_f32 v111, v111
    s_waitcnt lgkmcnt(0)
    v_mfma_f32_16x16x32_bf16 v[52:55], a[60:63], v[92:95], v[52:55]
    v_mul_f32 v48, v48, v108
    v_mul_f32 v49, v49, v109
    v_mfma_f32_16x16x32_bf16 v[56:59], a[124:127], v[92:95], v[56:59]
    v_mul_f32 v50, v50, v110
    v_mul_f32 v51, v51, v111
    v_mfma_f32_16x16x32_bf16 v[60:63], a[188:191], v[92:95], v[60:63]
    v_cvt_pk_bf16_f32 v48, v48, v49
    v_cvt_pk_bf16_f32 v49, v50, v51
    v_mul_f32 v100, s64, v52
    v_mul_f32 v101, s64, v53
    v_mul_f32 v102, s64, v54
    v_mul_f32 v103, s64, v55
    v_exp_f32 v100, v100
    v_exp_f32 v101, v101
    v_exp_f32 v102, v102
    v_exp_f32 v103, v103
    v_add_f32 v100, 1.0, v100
    v_add_f32 v101, 1.0, v101
    v_add_f32 v102, 1.0, v102
    v_add_f32 v103, 1.0, v103
    v_rcp_f32 v100, v100
    v_rcp_f32 v101, v101
    v_rcp_f32 v102, v102
    v_rcp_f32 v103, v103
    v_mul_f32 v52, v52, v100
    v_mul_f32 v53, v53, v101
    v_mul_f32 v54, v54, v102
    v_mul_f32 v55, v55, v103
    v_cvt_pk_bf16_f32 v52, v52, v53
    v_cvt_pk_bf16_f32 v53, v54, v55
    v_mul_f32 v104, s64, v56
    v_mul_f32 v105, s64, v57
    v_mul_f32 v106, s64, v58
    v_mul_f32 v107, s64, v59
    v_exp_f32 v104, v104
    v_exp_f32 v105, v105
    v_exp_f32 v106, v106
    v_exp_f32 v107, v107
    v_add_f32 v104, 1.0, v104
    v_add_f32 v105, 1.0, v105
    v_add_f32 v106, 1.0, v106
    v_add_f32 v107, 1.0, v107
    v_rcp_f32 v104, v104
    v_rcp_f32 v105, v105
    v_rcp_f32 v106, v106
    v_rcp_f32 v107, v107
    v_mul_f32 v56, v56, v104
    v_mul_f32 v57, v57, v105
    v_mul_f32 v58, v58, v106
    v_mul_f32 v59, v59, v107
    v_cvt_pk_bf16_f32 v56, v56, v57
    v_cvt_pk_bf16_f32 v57, v58, v59
    v_mul_f32 v108, s64, v60
    v_mul_f32 v109, s64, v61
    v_mul_f32 v110, s64, v62
    v_mul_f32 v111, s64, v63
    v_exp_f32 v108, v108
    v_exp_f32 v109, v109
    v_exp_f32 v110, v110
    v_exp_f32 v111, v111
    v_add_f32 v108, 1.0, v108
    v_add_f32 v109, 1.0, v109
    v_add_f32 v110, 1.0, v110
    v_add_f32 v111, 1.0, v111
    v_rcp_f32 v108, v108
    v_rcp_f32 v109, v109
    v_rcp_f32 v110, v110
    v_rcp_f32 v111, v111
    v_mul_f32 v60, v60, v108
    v_mul_f32 v61, v61, v109
    v_mul_f32 v62, v62, v110
    v_mul_f32 v63, v63, v111
    v_cvt_pk_bf16_f32 v60, v60, v61
    v_cvt_pk_bf16_f32 v61, v62, v63
    ds_write_b64 v96, v[16:17] offset:0
    ds_write_b64 v97, v[20:21] offset:0
    ds_write_b64 v98, v[24:25] offset:0
    ds_write_b64 v96, v[28:29] offset:6144
    ds_write_b64 v97, v[32:33] offset:6144
    ds_write_b64 v98, v[36:37] offset:6144
    ds_write_b64 v96, v[40:41] offset:12288
    ds_write_b64 v97, v[44:45] offset:12288
    ds_write_b64 v98, v[48:49] offset:12288
    ds_write_b64 v96, v[52:53] offset:18432
    ds_write_b64 v97, v[56:57] offset:18432
    ds_write_b64 v98, v[60:61] offset:18432
    s_cmp_lt_u32 s24, 32
    s_cselect_b32 s55, 24, -20
    s_sub_u32 s35, s24, 8
    s_cmp_lt_u32 s35, 44
    s_cselect_b32 s55, s55, 4
    s_add_u32 s55, s55, s24
    s_min_u32 s55, s55, 63
    s_lshl_b32 s59, s55, 8
    s_lshl_b32 s35, s20, 6
    s_add_u32 s59, s59, s35
    s_add_u32 s59, s59, 35869184
    s_mov_b32 s54, 0
    v_lshrrev_b32 v12, 1, v5
    v_mul_u32_u24 v12, 16640, v12
    v_and_b32 v13, 1, v5
    v_lshl_add_u32 v12, v13, 6, v12
    v_lshl_add_u32 v12, v6, 4, v12
    s_waitcnt lgkmcnt(0)
    s_barrier
    s_lshl_b32 s27, s22, 1
    s_and_b32 s25, s33, 1
    s_add_u32 s27, s27, s25
    s_lshl_b32 s27, s27, 20
    s_add_u32 s27, s27, 176160768
    s_lshl_b32 s25, s21, 11
    s_lshl_b32 s26, s20, 9
    s_add_u32 s25, s25, s26
    s_add_u32 s25, s25, s27
    v_add_u32 v13, 65536, v1
    ds_read_b128 v[16:19], v13 offset:0
    ds_read_b128 v[20:23], v13 offset:1024
    ds_read_b128 v[24:27], v13 offset:2048
    ds_read_b128 v[28:31], v13 offset:3072
    ds_read_b128 v[32:35], v13 offset:4096
    ds_read_b128 v[36:39], v13 offset:5120
    s_waitcnt lgkmcnt(5)
    v_mfma_f32_16x16x32_bf16 v[64:67], a[192:195], v[16:19], 0
    s_waitcnt lgkmcnt(4)
    v_mfma_f32_16x16x32_bf16 v[64:67], a[196:199], v[20:23], v[64:67]
    s_waitcnt lgkmcnt(3)
    v_mfma_f32_16x16x32_bf16 v[64:67], a[200:203], v[24:27], v[64:67]
    s_waitcnt lgkmcnt(2)
    v_mfma_f32_16x16x32_bf16 v[64:67], a[204:207], v[28:31], v[64:67]
    s_waitcnt lgkmcnt(1)
    v_mfma_f32_16x16x32_bf16 v[64:67], a[208:211], v[32:35], v[64:67]
    s_waitcnt lgkmcnt(0)
    v_mfma_f32_16x16x32_bf16 v[64:67], a[212:215], v[36:39], v[64:67]
    v_mfma_f32_16x16x32_bf16 v[68:71], a[216:219], v[16:19], 0
    v_mfma_f32_16x16x32_bf16 v[68:71], a[220:223], v[20:23], v[68:71]
    v_mfma_f32_16x16x32_bf16 v[68:71], a[224:227], v[24:27], v[68:71]
    v_mfma_f32_16x16x32_bf16 v[68:71], a[228:231], v[28:31], v[68:71]
    v_mfma_f32_16x16x32_bf16 v[68:71], a[232:235], v[32:35], v[68:71]
    v_mfma_f32_16x16x32_bf16 v[68:71], a[236:239], v[36:39], v[68:71]
    v_mfma_f32_16x16x32_bf16 v[72:75], a[240:243], v[16:19], 0
    v_mfma_f32_16x16x32_bf16 v[72:75], a[244:247], v[20:23], v[72:75]
    v_mfma_f32_16x16x32_bf16 v[72:75], a[248:251], v[24:27], v[72:75]
    v_mfma_f32_16x16x32_bf16 v[72:75], a[252:255], v[28:31], v[72:75]
    v_mfma_f32_16x16x32_bf16 v[72:75], v[128:131], v[32:35], v[72:75]
    v_mfma_f32_16x16x32_bf16 v[72:75], v[132:135], v[36:39], v[72:75]
    v_mfma_f32_16x16x32_bf16 v[76:79], v[136:139], v[16:19], 0
    v_mfma_f32_16x16x32_bf16 v[76:79], v[140:143], v[20:23], v[76:79]
    v_mfma_f32_16x16x32_bf16 v[76:79], v[144:147], v[24:27], v[76:79]
    v_mfma_f32_16x16x32_bf16 v[76:79], v[148:151], v[28:31], v[76:79]
    v_mfma_f32_16x16x32_bf16 v[76:79], v[152:155], v[32:35], v[76:79]
    v_mfma_f32_16x16x32_bf16 v[76:79], v[156:159], v[36:39], v[76:79]
    v_mfma_f32_16x16x32_bf16 v[80:83], v[160:163], v[16:19], 0
    v_mfma_f32_16x16x32_bf16 v[80:83], v[164:167], v[20:23], v[80:83]
    v_mfma_f32_16x16x32_bf16 v[80:83], v[168:171], v[24:27], v[80:83]
    v_mfma_f32_16x16x32_bf16 v[80:83], v[172:175], v[28:31], v[80:83]
    v_mfma_f32_16x16x32_bf16 v[80:83], v[176:179], v[32:35], v[80:83]
    v_mfma_f32_16x16x32_bf16 v[80:83], v[180:183], v[36:39], v[80:83]
    v_mfma_f32_16x16x32_bf16 v[84:87], v[184:187], v[16:19], 0
    ds_read_b128 v[40:43], v13 offset:6144
    v_mfma_f32_16x16x32_bf16 v[84:87], v[188:191], v[20:23], v[84:87]
    ds_read_b128 v[44:47], v13 offset:7168
    v_mfma_f32_16x16x32_bf16 v[84:87], v[192:195], v[24:27], v[84:87]
    ds_read_b128 v[48:51], v13 offset:8192
    v_mfma_f32_16x16x32_bf16 v[84:87], v[196:199], v[28:31], v[84:87]
    ds_read_b128 v[52:55], v13 offset:9216
    v_mfma_f32_16x16x32_bf16 v[84:87], v[200:203], v[32:35], v[84:87]
    ds_read_b128 v[56:59], v13 offset:10240
    v_mfma_f32_16x16x32_bf16 v[84:87], v[204:207], v[36:39], v[84:87]
    ds_read_b128 v[60:63], v13 offset:11264
    v_mfma_f32_16x16x32_bf16 v[88:91], v[208:211], v[16:19], 0
    v_mfma_f32_16x16x32_bf16 v[88:91], v[212:215], v[20:23], v[88:91]
    v_mfma_f32_16x16x32_bf16 v[88:91], v[216:219], v[24:27], v[88:91]
    v_mfma_f32_16x16x32_bf16 v[88:91], v[220:223], v[28:31], v[88:91]
    v_mfma_f32_16x16x32_bf16 v[88:91], v[224:227], v[32:35], v[88:91]
    v_mfma_f32_16x16x32_bf16 v[88:91], v[228:231], v[36:39], v[88:91]
    v_mfma_f32_16x16x32_bf16 v[92:95], v[232:235], v[16:19], 0
    v_mfma_f32_16x16x32_bf16 v[92:95], v[236:239], v[20:23], v[92:95]
    v_mfma_f32_16x16x32_bf16 v[92:95], v[240:243], v[24:27], v[92:95]
    v_mfma_f32_16x16x32_bf16 v[92:95], v[244:247], v[28:31], v[92:95]
    v_mfma_f32_16x16x32_bf16 v[92:95], v[248:251], v[32:35], v[92:95]
    v_mfma_f32_16x16x32_bf16 v[92:95], v[252:255], v[36:39], v[92:95]
    s_waitcnt lgkmcnt(0)
    v_mfma_f32_16x16x32_bf16 v[96:99], a[192:195], v[40:43], 0
    v_mfma_f32_16x16x32_bf16 v[96:99], a[196:199], v[44:47], v[96:99]
    v_mfma_f32_16x16x32_bf16 v[96:99], a[200:203], v[48:51], v[96:99]
    v_cvt_pk_bf16_f32 v64, v64, v65
    v_mfma_f32_16x16x32_bf16 v[96:99], a[204:207], v[52:55], v[96:99]
    v_cvt_pk_bf16_f32 v65, v66, v67
    v_mfma_f32_16x16x32_bf16 v[96:99], a[208:211], v[56:59], v[96:99]
    v_cvt_pk_bf16_f32 v66, v68, v69
    v_mfma_f32_16x16x32_bf16 v[96:99], a[212:215], v[60:63], v[96:99]
    v_cvt_pk_bf16_f32 v67, v70, v71
    v_mfma_f32_16x16x32_bf16 v[100:103], a[216:219], v[40:43], 0
    buffer_store_dwordx4 v[64:67], v12, s[8:11], s25 offen offset:0
    v_mfma_f32_16x16x32_bf16 v[100:103], a[220:223], v[44:47], v[100:103]
    v_cvt_pk_bf16_f32 v72, v72, v73
    v_mfma_f32_16x16x32_bf16 v[100:103], a[224:227], v[48:51], v[100:103]
    v_cvt_pk_bf16_f32 v73, v74, v75
    v_mfma_f32_16x16x32_bf16 v[100:103], a[228:231], v[52:55], v[100:103]
    v_cvt_pk_bf16_f32 v74, v76, v77
    v_mfma_f32_16x16x32_bf16 v[100:103], a[232:235], v[56:59], v[100:103]
    v_cvt_pk_bf16_f32 v75, v78, v79
    v_mfma_f32_16x16x32_bf16 v[100:103], a[236:239], v[60:63], v[100:103]
    buffer_store_dwordx4 v[72:75], v12, s[8:11], s25 offen offset:128
    v_mfma_f32_16x16x32_bf16 v[104:107], a[240:243], v[40:43], 0
    v_cvt_pk_bf16_f32 v80, v80, v81
    v_mfma_f32_16x16x32_bf16 v[104:107], a[244:247], v[44:47], v[104:107]
    v_cvt_pk_bf16_f32 v81, v82, v83
    v_mfma_f32_16x16x32_bf16 v[104:107], a[248:251], v[48:51], v[104:107]
    v_cvt_pk_bf16_f32 v82, v84, v85
    v_mfma_f32_16x16x32_bf16 v[104:107], a[252:255], v[52:55], v[104:107]
    v_cvt_pk_bf16_f32 v83, v86, v87
    v_mfma_f32_16x16x32_bf16 v[104:107], v[128:131], v[56:59], v[104:107]
    buffer_store_dwordx4 v[80:83], v12, s[8:11], s25 offen offset:256
    v_mfma_f32_16x16x32_bf16 v[104:107], v[132:135], v[60:63], v[104:107]
    v_cvt_pk_bf16_f32 v88, v88, v89
    v_mfma_f32_16x16x32_bf16 v[108:111], v[136:139], v[40:43], 0
    v_cvt_pk_bf16_f32 v89, v90, v91
    v_mfma_f32_16x16x32_bf16 v[108:111], v[140:143], v[44:47], v[108:111]
    v_cvt_pk_bf16_f32 v90, v92, v93
    v_mfma_f32_16x16x32_bf16 v[108:111], v[144:147], v[48:51], v[108:111]
    v_cvt_pk_bf16_f32 v91, v94, v95
    v_mfma_f32_16x16x32_bf16 v[108:111], v[148:151], v[52:55], v[108:111]
    buffer_store_dwordx4 v[88:91], v12, s[8:11], s25 offen offset:384
    v_mfma_f32_16x16x32_bf16 v[108:111], v[152:155], v[56:59], v[108:111]
    s_add_u32 s25, s25, 133120
    v_mfma_f32_16x16x32_bf16 v[108:111], v[156:159], v[60:63], v[108:111]
    v_mfma_f32_16x16x32_bf16 v[112:115], v[160:163], v[40:43], 0
    v_mfma_f32_16x16x32_bf16 v[112:115], v[164:167], v[44:47], v[112:115]
    v_mfma_f32_16x16x32_bf16 v[112:115], v[168:171], v[48:51], v[112:115]
    v_mfma_f32_16x16x32_bf16 v[112:115], v[172:175], v[52:55], v[112:115]
    v_mfma_f32_16x16x32_bf16 v[112:115], v[176:179], v[56:59], v[112:115]
    v_mfma_f32_16x16x32_bf16 v[112:115], v[180:183], v[60:63], v[112:115]
    v_mfma_f32_16x16x32_bf16 v[116:119], v[184:187], v[40:43], 0
    ds_read_b128 v[16:19], v13 offset:12288
    v_mfma_f32_16x16x32_bf16 v[116:119], v[188:191], v[44:47], v[116:119]
    ds_read_b128 v[20:23], v13 offset:13312
    v_mfma_f32_16x16x32_bf16 v[116:119], v[192:195], v[48:51], v[116:119]
    ds_read_b128 v[24:27], v13 offset:14336
    v_mfma_f32_16x16x32_bf16 v[116:119], v[196:199], v[52:55], v[116:119]
    ds_read_b128 v[28:31], v13 offset:15360
    v_mfma_f32_16x16x32_bf16 v[116:119], v[200:203], v[56:59], v[116:119]
    ds_read_b128 v[32:35], v13 offset:16384
    v_mfma_f32_16x16x32_bf16 v[116:119], v[204:207], v[60:63], v[116:119]
    ds_read_b128 v[36:39], v13 offset:17408
    v_mfma_f32_16x16x32_bf16 v[120:123], v[208:211], v[40:43], 0
    v_mfma_f32_16x16x32_bf16 v[120:123], v[212:215], v[44:47], v[120:123]
    v_mfma_f32_16x16x32_bf16 v[120:123], v[216:219], v[48:51], v[120:123]
    v_mfma_f32_16x16x32_bf16 v[120:123], v[220:223], v[52:55], v[120:123]
    v_mfma_f32_16x16x32_bf16 v[120:123], v[224:227], v[56:59], v[120:123]
    v_mfma_f32_16x16x32_bf16 v[120:123], v[228:231], v[60:63], v[120:123]
    v_mfma_f32_16x16x32_bf16 v[124:127], v[232:235], v[40:43], 0
    v_mfma_f32_16x16x32_bf16 v[124:127], v[236:239], v[44:47], v[124:127]
    v_mfma_f32_16x16x32_bf16 v[124:127], v[240:243], v[48:51], v[124:127]
    v_mfma_f32_16x16x32_bf16 v[124:127], v[244:247], v[52:55], v[124:127]
    v_mfma_f32_16x16x32_bf16 v[124:127], v[248:251], v[56:59], v[124:127]
    v_mfma_f32_16x16x32_bf16 v[124:127], v[252:255], v[60:63], v[124:127]
    s_waitcnt lgkmcnt(0)
    v_mfma_f32_16x16x32_bf16 v[64:67], a[192:195], v[16:19], 0
    v_mfma_f32_16x16x32_bf16 v[64:67], a[196:199], v[20:23], v[64:67]
    v_mfma_f32_16x16x32_bf16 v[64:67], a[200:203], v[24:27], v[64:67]
    v_cvt_pk_bf16_f32 v96, v96, v97
    v_mfma_f32_16x16x32_bf16 v[64:67], a[204:207], v[28:31], v[64:67]
    v_cvt_pk_bf16_f32 v97, v98, v99
    v_mfma_f32_16x16x32_bf16 v[64:67], a[208:211], v[32:35], v[64:67]
    v_cvt_pk_bf16_f32 v98, v100, v101
    v_mfma_f32_16x16x32_bf16 v[64:67], a[212:215], v[36:39], v[64:67]
    v_cvt_pk_bf16_f32 v99, v102, v103
    v_mfma_f32_16x16x32_bf16 v[68:71], a[216:219], v[16:19], 0
    buffer_store_dwordx4 v[96:99], v12, s[8:11], s25 offen offset:0
    v_mfma_f32_16x16x32_bf16 v[68:71], a[220:223], v[20:23], v[68:71]
    v_cvt_pk_bf16_f32 v104, v104, v105
    v_mfma_f32_16x16x32_bf16 v[68:71], a[224:227], v[24:27], v[68:71]
    v_cvt_pk_bf16_f32 v105, v106, v107
    v_mfma_f32_16x16x32_bf16 v[68:71], a[228:231], v[28:31], v[68:71]
    v_cvt_pk_bf16_f32 v106, v108, v109
    v_mfma_f32_16x16x32_bf16 v[68:71], a[232:235], v[32:35], v[68:71]
    v_cvt_pk_bf16_f32 v107, v110, v111
    v_mfma_f32_16x16x32_bf16 v[68:71], a[236:239], v[36:39], v[68:71]
    buffer_store_dwordx4 v[104:107], v12, s[8:11], s25 offen offset:128
    v_mfma_f32_16x16x32_bf16 v[72:75], a[240:243], v[16:19], 0
    v_cvt_pk_bf16_f32 v112, v112, v113
    v_mfma_f32_16x16x32_bf16 v[72:75], a[244:247], v[20:23], v[72:75]
    v_cvt_pk_bf16_f32 v113, v114, v115
    v_mfma_f32_16x16x32_bf16 v[72:75], a[248:251], v[24:27], v[72:75]
    v_cvt_pk_bf16_f32 v114, v116, v117
    v_mfma_f32_16x16x32_bf16 v[72:75], a[252:255], v[28:31], v[72:75]
    v_cvt_pk_bf16_f32 v115, v118, v119
    v_mfma_f32_16x16x32_bf16 v[72:75], v[128:131], v[32:35], v[72:75]
    buffer_store_dwordx4 v[112:115], v12, s[8:11], s25 offen offset:256
    v_mfma_f32_16x16x32_bf16 v[72:75], v[132:135], v[36:39], v[72:75]
    v_cvt_pk_bf16_f32 v120, v120, v121
    v_mfma_f32_16x16x32_bf16 v[76:79], v[136:139], v[16:19], 0
    v_cvt_pk_bf16_f32 v121, v122, v123
    v_mfma_f32_16x16x32_bf16 v[76:79], v[140:143], v[20:23], v[76:79]
    v_cvt_pk_bf16_f32 v122, v124, v125
    v_mfma_f32_16x16x32_bf16 v[76:79], v[144:147], v[24:27], v[76:79]
    v_cvt_pk_bf16_f32 v123, v126, v127
    v_mfma_f32_16x16x32_bf16 v[76:79], v[148:151], v[28:31], v[76:79]
    buffer_store_dwordx4 v[120:123], v12, s[8:11], s25 offen offset:384
    v_mfma_f32_16x16x32_bf16 v[76:79], v[152:155], v[32:35], v[76:79]
    s_add_u32 s25, s25, 133120
    v_mfma_f32_16x16x32_bf16 v[76:79], v[156:159], v[36:39], v[76:79]
    v_mfma_f32_16x16x32_bf16 v[80:83], v[160:163], v[16:19], 0
    v_mfma_f32_16x16x32_bf16 v[80:83], v[164:167], v[20:23], v[80:83]
    v_mfma_f32_16x16x32_bf16 v[80:83], v[168:171], v[24:27], v[80:83]
    v_mfma_f32_16x16x32_bf16 v[80:83], v[172:175], v[28:31], v[80:83]
    v_mfma_f32_16x16x32_bf16 v[80:83], v[176:179], v[32:35], v[80:83]
    v_mfma_f32_16x16x32_bf16 v[80:83], v[180:183], v[36:39], v[80:83]
    v_mfma_f32_16x16x32_bf16 v[84:87], v[184:187], v[16:19], 0
    ds_read_b128 v[40:43], v13 offset:18432
    v_mfma_f32_16x16x32_bf16 v[84:87], v[188:191], v[20:23], v[84:87]
    ds_read_b128 v[44:47], v13 offset:19456
    v_mfma_f32_16x16x32_bf16 v[84:87], v[192:195], v[24:27], v[84:87]
    ds_read_b128 v[48:51], v13 offset:20480
    v_mfma_f32_16x16x32_bf16 v[84:87], v[196:199], v[28:31], v[84:87]
    ds_read_b128 v[52:55], v13 offset:21504
    v_mfma_f32_16x16x32_bf16 v[84:87], v[200:203], v[32:35], v[84:87]
    ds_read_b128 v[56:59], v13 offset:22528
    v_mfma_f32_16x16x32_bf16 v[84:87], v[204:207], v[36:39], v[84:87]
    ds_read_b128 v[60:63], v13 offset:23552
    v_mfma_f32_16x16x32_bf16 v[88:91], v[208:211], v[16:19], 0
    v_mfma_f32_16x16x32_bf16 v[88:91], v[212:215], v[20:23], v[88:91]
    v_mfma_f32_16x16x32_bf16 v[88:91], v[216:219], v[24:27], v[88:91]
    v_mfma_f32_16x16x32_bf16 v[88:91], v[220:223], v[28:31], v[88:91]
    v_mfma_f32_16x16x32_bf16 v[88:91], v[224:227], v[32:35], v[88:91]
    v_mfma_f32_16x16x32_bf16 v[88:91], v[228:231], v[36:39], v[88:91]
    v_mfma_f32_16x16x32_bf16 v[92:95], v[232:235], v[16:19], 0
    v_mfma_f32_16x16x32_bf16 v[92:95], v[236:239], v[20:23], v[92:95]
    v_mfma_f32_16x16x32_bf16 v[92:95], v[240:243], v[24:27], v[92:95]
    v_mfma_f32_16x16x32_bf16 v[92:95], v[244:247], v[28:31], v[92:95]
    v_mfma_f32_16x16x32_bf16 v[92:95], v[248:251], v[32:35], v[92:95]
    v_mfma_f32_16x16x32_bf16 v[92:95], v[252:255], v[36:39], v[92:95]
    s_waitcnt lgkmcnt(0)
    v_mfma_f32_16x16x32_bf16 v[96:99], a[192:195], v[40:43], 0
    v_mfma_f32_16x16x32_bf16 v[96:99], a[196:199], v[44:47], v[96:99]
    v_mfma_f32_16x16x32_bf16 v[96:99], a[200:203], v[48:51], v[96:99]
    v_cvt_pk_bf16_f32 v64, v64, v65
    v_mfma_f32_16x16x32_bf16 v[96:99], a[204:207], v[52:55], v[96:99]
    v_cvt_pk_bf16_f32 v65, v66, v67
    v_mfma_f32_16x16x32_bf16 v[96:99], a[208:211], v[56:59], v[96:99]
    v_cvt_pk_bf16_f32 v66, v68, v69
    v_mfma_f32_16x16x32_bf16 v[96:99], a[212:215], v[60:63], v[96:99]
    v_cvt_pk_bf16_f32 v67, v70, v71
    v_mfma_f32_16x16x32_bf16 v[100:103], a[216:219], v[40:43], 0
    buffer_store_dwordx4 v[64:67], v12, s[8:11], s25 offen offset:0
    v_mfma_f32_16x16x32_bf16 v[100:103], a[220:223], v[44:47], v[100:103]
    v_cvt_pk_bf16_f32 v72, v72, v73
    v_mfma_f32_16x16x32_bf16 v[100:103], a[224:227], v[48:51], v[100:103]
    v_cvt_pk_bf16_f32 v73, v74, v75
    v_mfma_f32_16x16x32_bf16 v[100:103], a[228:231], v[52:55], v[100:103]
    v_cvt_pk_bf16_f32 v74, v76, v77
    v_mfma_f32_16x16x32_bf16 v[100:103], a[232:235], v[56:59], v[100:103]
    v_cvt_pk_bf16_f32 v75, v78, v79
    v_mfma_f32_16x16x32_bf16 v[100:103], a[236:239], v[60:63], v[100:103]
    buffer_store_dwordx4 v[72:75], v12, s[8:11], s25 offen offset:128
    v_mfma_f32_16x16x32_bf16 v[104:107], a[240:243], v[40:43], 0
    v_cvt_pk_bf16_f32 v80, v80, v81
    v_mfma_f32_16x16x32_bf16 v[104:107], a[244:247], v[44:47], v[104:107]
    v_cvt_pk_bf16_f32 v81, v82, v83
    v_mfma_f32_16x16x32_bf16 v[104:107], a[248:251], v[48:51], v[104:107]
    v_cvt_pk_bf16_f32 v82, v84, v85
    v_mfma_f32_16x16x32_bf16 v[104:107], a[252:255], v[52:55], v[104:107]
    v_cvt_pk_bf16_f32 v83, v86, v87
    v_mfma_f32_16x16x32_bf16 v[104:107], v[128:131], v[56:59], v[104:107]
    buffer_store_dwordx4 v[80:83], v12, s[8:11], s25 offen offset:256
    v_mfma_f32_16x16x32_bf16 v[104:107], v[132:135], v[60:63], v[104:107]
    v_cvt_pk_bf16_f32 v88, v88, v89
    v_mfma_f32_16x16x32_bf16 v[108:111], v[136:139], v[40:43], 0
    v_cvt_pk_bf16_f32 v89, v90, v91
    v_mfma_f32_16x16x32_bf16 v[108:111], v[140:143], v[44:47], v[108:111]
    v_cvt_pk_bf16_f32 v90, v92, v93
    v_mfma_f32_16x16x32_bf16 v[108:111], v[144:147], v[48:51], v[108:111]
    v_cvt_pk_bf16_f32 v91, v94, v95
    v_mfma_f32_16x16x32_bf16 v[108:111], v[148:151], v[52:55], v[108:111]
    buffer_store_dwordx4 v[88:91], v12, s[8:11], s25 offen offset:384
    v_mfma_f32_16x16x32_bf16 v[108:111], v[152:155], v[56:59], v[108:111]
    s_add_u32 s25, s25, 133120
    v_mfma_f32_16x16x32_bf16 v[108:111], v[156:159], v[60:63], v[108:111]
    v_mfma_f32_16x16x32_bf16 v[112:115], v[160:163], v[40:43], 0
    v_mfma_f32_16x16x32_bf16 v[112:115], v[164:167], v[44:47], v[112:115]
    v_mfma_f32_16x16x32_bf16 v[112:115], v[168:171], v[48:51], v[112:115]
    v_mfma_f32_16x16x32_bf16 v[112:115], v[172:175], v[52:55], v[112:115]
    v_cvt_pk_bf16_f32 v96, v96, v97
    v_mfma_f32_16x16x32_bf16 v[112:115], v[176:179], v[56:59], v[112:115]
    v_cvt_pk_bf16_f32 v97, v98, v99
    v_mfma_f32_16x16x32_bf16 v[112:115], v[180:183], v[60:63], v[112:115]
    v_cvt_pk_bf16_f32 v98, v100, v101
    v_mfma_f32_16x16x32_bf16 v[116:119], v[184:187], v[40:43], 0
    v_cvt_pk_bf16_f32 v99, v102, v103
    v_mfma_f32_16x16x32_bf16 v[116:119], v[188:191], v[44:47], v[116:119]
    buffer_store_dwordx4 v[96:99], v12, s[8:11], s25 offen offset:0
    v_mfma_f32_16x16x32_bf16 v[116:119], v[192:195], v[48:51], v[116:119]
    v_cvt_pk_bf16_f32 v104, v104, v105
    v_mfma_f32_16x16x32_bf16 v[116:119], v[196:199], v[52:55], v[116:119]
    v_cvt_pk_bf16_f32 v105, v106, v107
    v_mfma_f32_16x16x32_bf16 v[116:119], v[200:203], v[56:59], v[116:119]
    v_cvt_pk_bf16_f32 v106, v108, v109
    v_mfma_f32_16x16x32_bf16 v[116:119], v[204:207], v[60:63], v[116:119]
    v_cvt_pk_bf16_f32 v107, v110, v111
    v_mfma_f32_16x16x32_bf16 v[120:123], v[208:211], v[40:43], 0
    buffer_store_dwordx4 v[104:107], v12, s[8:11], s25 offen offset:128
    v_mfma_f32_16x16x32_bf16 v[120:123], v[212:215], v[44:47], v[120:123]
    v_mfma_f32_16x16x32_bf16 v[120:123], v[216:219], v[48:51], v[120:123]
    v_mfma_f32_16x16x32_bf16 v[120:123], v[220:223], v[52:55], v[120:123]
    v_cvt_pk_bf16_f32 v112, v112, v113
    v_mfma_f32_16x16x32_bf16 v[120:123], v[224:227], v[56:59], v[120:123]
    v_cvt_pk_bf16_f32 v113, v114, v115
    v_mfma_f32_16x16x32_bf16 v[120:123], v[228:231], v[60:63], v[120:123]
    v_cvt_pk_bf16_f32 v114, v116, v117
    v_mfma_f32_16x16x32_bf16 v[124:127], v[232:235], v[40:43], 0
    v_cvt_pk_bf16_f32 v115, v118, v119
    v_mfma_f32_16x16x32_bf16 v[124:127], v[236:239], v[44:47], v[124:127]
    buffer_store_dwordx4 v[112:115], v12, s[8:11], s25 offen offset:256
    v_mfma_f32_16x16x32_bf16 v[124:127], v[240:243], v[48:51], v[124:127]
    v_mfma_f32_16x16x32_bf16 v[124:127], v[244:247], v[52:55], v[124:127]
    v_mfma_f32_16x16x32_bf16 v[124:127], v[248:251], v[56:59], v[124:127]
    v_mfma_f32_16x16x32_bf16 v[124:127], v[252:255], v[60:63], v[124:127]
    v_cvt_pk_bf16_f32 v120, v120, v121
    v_cvt_pk_bf16_f32 v121, v122, v123
    s_nop 5
    v_cvt_pk_bf16_f32 v122, v124, v125
    v_cvt_pk_bf16_f32 v123, v126, v127
    buffer_store_dwordx4 v[120:123], v12, s[8:11], s25 offen offset:384
    s_add_u32 s25, s25, 133120
    s_add_u32 s27, s27, s52
    s_lshr_b32 s25, s52, 6
    s_add_u32 s27, s27, s25
    s_add_u32 s34, s33, 1
    v_mov_b32 v4, s34
    v_lshrrev_b32 v13, 2, v1
    v_and_b32 v13, 127, v13
    s_waitcnt vmcnt(0)
    buffer_store_dword v4, v2, s[8:11], s57 offen
    v_and_b32 v56, 1, v5
    v_lshlrev_b32 v56, 4, v56
    v_mov_b32 v57, 0x3f80
    v_lshlrev_b32 v56, v56, v57
    v_lshrrev_b32 v57, 1, v5
    v_lshlrev_b32 v58, 4, v5
    v_lshl_add_u32 v58, v6, 11, v58
    v_cmp_eq_u32 vcc, 0, v57
    s_nop 1
    v_cndmask_b32 v24, 0, v56, vcc
    v_cmp_eq_u32 vcc, 1, v57
    s_nop 1
    v_cndmask_b32 v25, 0, v56, vcc
    v_cmp_eq_u32 vcc, 2, v57
    s_nop 1
    v_cndmask_b32 v26, 0, v56, vcc
    v_cmp_eq_u32 vcc, 3, v57
    s_nop 1
    v_cndmask_b32 v27, 0, v56, vcc
    v_cmp_eq_u32 vcc, 4, v57
    s_nop 1
    v_cndmask_b32 v28, 0, v56, vcc
    v_cmp_eq_u32 vcc, 5, v57
    s_nop 1
    v_cndmask_b32 v29, 0, v56, vcc
    v_cmp_eq_u32 vcc, 6, v57
    s_nop 1
    v_cndmask_b32 v30, 0, v56, vcc
    v_cmp_eq_u32 vcc, 7, v57
    s_nop 1
    v_cndmask_b32 v31, 0, v56, vcc
L_pp_75:
    buffer_load_dword v4, v13, s[8:11], s56 offen sc1
    s_sub_u32 s30, s30, 1
    s_cbranch_scc1 M_done
    s_waitcnt vmcnt(0)
    v_cmp_gt_u32 vcc, s34, v4
    s_nop 0
    s_cbranch_vccnz L_pp_75
    buffer_load_dwordx4 v[64:67], v58, s[8:11], s27 offen offset:0 sc1
    buffer_load_dwordx4 v[68:71], v58, s[8:11], s27 offen offset:256 sc1
    buffer_load_dwordx4 v[72:75], v58, s[8:11], s27 offen offset:512 sc1
    buffer_load_dwordx4 v[76:79], v58, s[8:11], s27 offen offset:768 sc1
    s_add_u32 s27, s27, 8192
    buffer_load_dwordx4 v[80:83], v58, s[8:11], s27 offen offset:0 sc1
    buffer_load_dwordx4 v[84:87], v58, s[8:11], s27 offen offset:256 sc1
    buffer_load_dwordx4 v[88:91], v58, s[8:11], s27 offen offset:512 sc1
    buffer_load_dwordx4 v[92:95], v58, s[8:11], s27 offen offset:768 sc1
    s_add_u32 s27, s27, 4294960128
    buffer_load_dwordx4 v[96:99], v58, s[8:11], s27 offen offset:0 sc1
    buffer_load_dwordx4 v[100:103], v58, s[8:11], s27 offen offset:256 sc1
    buffer_load_dwordx4 v[104:107], v58, s[8:11], s27 offen offset:512 sc1
    buffer_load_dwordx4 v[108:111], v58, s[8:11], s27 offen offset:768 sc1
    s_add_u32 s27, s27, 8192
    buffer_load_dwordx4 v[112:115], v58, s[8:11], s27 offen offset:0 sc1
    buffer_load_dwordx4 v[116:119], v58, s[8:11], s27 offen offset:256 sc1
    buffer_load_dwordx4 v[120:123], v58, s[8:11], s27 offen offset:512 sc1
    buffer_load_dwordx4 v[124:127], v58, s[8:11], s27 offen offset:768 sc1
    s_add_u32 s27, s27, 8192
    buffer_load_dword v0, v7, s[8:11], s59 offen sc1
    v_and_b32 v12, 0x30, v1
    v_and_b32 v13, 0x40, v1
    v_lshl_add_u32 v12, v13, 4, v12
    v_lshrrev_b32 v13, 9, v1
    v_lshl_add_u32 v12, v13, 7, v12
    v_bfe_u32 v13, v1, 7, 1
    v_lshl_add_u32 v12, v13, 6, v12
    v_bfe_u32 v13, v1, 8, 1
    v_lshl_add_u32 v12, v13, 3, v12
    v_add_u32 v13, s58, v12
    ds_read2_b64 v[16:19], v13 offset1:32
    ds_read2_b64 v[20:23], v13 offset0:64 offset1:96
    s_waitcnt lgkmcnt(0)
    s_waitcnt vmcnt(16)
    v_mfma_f32_16x16x32_bf16 v[32:35], v[24:27], v[64:67], 0
    s_waitcnt vmcnt(15)
    v_mfma_f32_16x16x32_bf16 v[32:35], v[28:31], v[68:71], v[32:35]
    s_waitcnt vmcnt(14)
    v_mfma_f32_16x16x32_bf16 v[36:39], v[24:27], v[72:75], 0
    s_waitcnt vmcnt(13)
    v_mfma_f32_16x16x32_bf16 v[36:39], v[28:31], v[76:79], v[36:39]
    s_waitcnt vmcnt(12)
    v_mfma_f32_16x16x32_bf16 v[32:35], v[24:27], v[80:83], v[32:35]
    s_waitcnt vmcnt(11)
    v_mfma_f32_16x16x32_bf16 v[32:35], v[28:31], v[84:87], v[32:35]
    s_waitcnt vmcnt(10)
    v_mfma_f32_16x16x32_bf16 v[36:39], v[24:27], v[88:91], v[36:39]
    s_waitcnt vmcnt(9)
    v_mfma_f32_16x16x32_bf16 v[36:39], v[28:31], v[92:95], v[36:39]
    v_cvt_pk_bf16_f32 v64, v32, v33
    v_cvt_pk_bf16_f32 v65, v34, v35
    s_nop 5
    v_cvt_pk_bf16_f32 v66, v36, v37
    v_cvt_pk_bf16_f32 v67, v38, v39
    v_lshlrev_b32 v32, 16, v64
    v_and_b32 v33, 0xffff0000, v64
    v_lshlrev_b32 v34, 16, v65
    v_and_b32 v35, 0xffff0000, v65
    v_lshlrev_b32 v36, 16, v66
    v_and_b32 v37, 0xffff0000, v66
    v_lshlrev_b32 v38, 16, v67
    v_and_b32 v39, 0xffff0000, v67
    v_lshlrev_b32 v40, 16, v16
    v_and_b32 v41, 0xffff0000, v16
    v_lshlrev_b32 v42, 16, v17
    v_and_b32 v43, 0xffff0000, v17
    v_lshlrev_b32 v44, 16, v18
    v_and_b32 v45, 0xffff0000, v18
    v_lshlrev_b32 v46, 16, v19
    v_and_b32 v47, 0xffff0000, v19
    v_add_f32 v32, v32, v40
    v_add_f32 v33, v33, v41
    v_add_f32 v34, v34, v42
    v_add_f32 v35, v35, v43
    v_add_f32 v36, v36, v44
    v_add_f32 v37, v37, v45
    v_add_f32 v38, v38, v46
    v_add_f32 v39, v39, v47
    v_cvt_pk_bf16_f32 v16, v32, v33
    v_cvt_pk_bf16_f32 v17, v34, v35
    v_cvt_pk_bf16_f32 v18, v36, v37
    v_cvt_pk_bf16_f32 v19, v38, v39
    v_lshlrev_b32 v32, 16, v16
    v_and_b32 v33, 0xffff0000, v16
    v_lshlrev_b32 v34, 16, v17
    v_and_b32 v35, 0xffff0000, v17
    v_lshlrev_b32 v36, 16, v18
    v_and_b32 v37, 0xffff0000, v18
    v_lshlrev_b32 v38, 16, v19
    v_and_b32 v39, 0xffff0000, v19
    s_waitcnt vmcnt(8)
    v_mfma_f32_16x16x32_bf16 v[48:51], v[24:27], v[96:99], 0
    s_waitcnt vmcnt(7)
    v_mfma_f32_16x16x32_bf16 v[48:51], v[28:31], v[100:103], v[48:51]
    s_waitcnt vmcnt(6)
    v_mfma_f32_16x16x32_bf16 v[52:55], v[24:27], v[104:107], 0
    s_waitcnt vmcnt(5)
    v_mfma_f32_16x16x32_bf16 v[52:55], v[28:31], v[108:111], v[52:55]
    s_waitcnt vmcnt(4)
    v_mfma_f32_16x16x32_bf16 v[48:51], v[24:27], v[112:115], v[48:51]
    s_waitcnt vmcnt(3)
    v_mfma_f32_16x16x32_bf16 v[48:51], v[28:31], v[116:119], v[48:51]
    s_waitcnt vmcnt(2)
    v_mfma_f32_16x16x32_bf16 v[52:55], v[24:27], v[120:123], v[52:55]
    s_waitcnt vmcnt(1)
    v_mfma_f32_16x16x32_bf16 v[52:55], v[28:31], v[124:127], v[52:55]
    v_cvt_pk_bf16_f32 v96, v48, v49
    v_cvt_pk_bf16_f32 v97, v50, v51
    s_nop 5
    v_cvt_pk_bf16_f32 v98, v52, v53
    v_cvt_pk_bf16_f32 v99, v54, v55
    v_lshlrev_b32 v48, 16, v96
    v_and_b32 v49, 0xffff0000, v96
    v_lshlrev_b32 v50, 16, v97
    v_and_b32 v51, 0xffff0000, v97
    v_lshlrev_b32 v52, 16, v98
    v_and_b32 v53, 0xffff0000, v98
    v_lshlrev_b32 v54, 16, v99
    v_and_b32 v55, 0xffff0000, v99
    v_lshlrev_b32 v56, 16, v20
    v_and_b32 v57, 0xffff0000, v20
    v_lshlrev_b32 v58, 16, v21
    v_and_b32 v59, 0xffff0000, v21
    v_lshlrev_b32 v60, 16, v22
    v_and_b32 v61, 0xffff0000, v22
    v_lshlrev_b32 v62, 16, v23
    v_and_b32 v63, 0xffff0000, v23
    v_add_f32 v48, v48, v56
    v_add_f32 v49, v49, v57
    v_add_f32 v50, v50, v58
    v_add_f32 v51, v51, v59
    v_add_f32 v52, v52, v60
    v_add_f32 v53, v53, v61
    v_add_f32 v54, v54, v62
    v_add_f32 v55, v55, v63
    v_cvt_pk_bf16_f32 v20, v48, v49
    v_cvt_pk_bf16_f32 v21, v50, v51
    v_cvt_pk_bf16_f32 v22, v52, v53
    v_cvt_pk_bf16_f32 v23, v54, v55
    v_lshlrev_b32 v48, 16, v20
    v_and_b32 v49, 0xffff0000, v20
    v_lshlrev_b32 v50, 16, v21
    v_and_b32 v51, 0xffff0000, v21
    v_lshlrev_b32 v52, 16, v22
    v_and_b32 v53, 0xffff0000, v22
    v_lshlrev_b32 v54, 16, v23
    v_and_b32 v55, 0xffff0000, v23
    s_cmp_eq_u32 s23, 0
    s_cbranch_scc1 L_fx_76
    buffer_store_dwordx2 v[16:17], v12, s[16:19], s29 offen offset:0
    buffer_store_dwordx2 v[18:19], v12, s[16:19], s29 offen offset:256
    buffer_store_dwordx2 v[20:21], v12, s[16:19], s29 offen offset:512
    buffer_store_dwordx2 v[22:23], v12, s[16:19], s29 offen offset:768
    s_branch L_fy_77
L_fx_76:
    s_add_u32 s25, s29, 33554432
    buffer_store_dwordx2 v[16:17], v12, s[8:11], s25 offen offset:0 sc1
    buffer_store_dwordx2 v[18:19], v12, s[8:11], s25 offen offset:256 sc1
    buffer_store_dwordx2 v[20:21], v12, s[8:11], s25 offen offset:512 sc1
    buffer_store_dwordx2 v[22:23], v12, s[8:11], s25 offen offset:768 sc1
    s_add_u32 s25, s29, 23068672
    v_pk_add_f32 v[40:41], v[32:33], v[34:35]
    v_pk_add_f32 v[40:41], v[40:41], v[36:37]
    v_pk_add_f32 v[40:41], v[40:41], v[38:39]
    v_pk_add_f32 v[40:41], v[40:41], v[48:49]
    v_pk_add_f32 v[40:41], v[40:41], v[50:51]
    v_pk_add_f32 v[40:41], v[40:41], v[52:53]
    v_pk_add_f32 v[40:41], v[40:41], v[54:55]
    v_add_f32 v14, v40, v41
    s_nop 1
    v_add_f32_dpp v14, v14, v14 quad_perm:[1,0,3,2] row_mask:0xf bank_mask:0xf
    s_nop 1
    v_add_f32_dpp v14, v14, v14 quad_perm:[2,3,0,1] row_mask:0xf bank_mask:0xf
    s_nop 1
    v_add_f32_dpp v14, v14, v14 row_ror:8 row_mask:0xf bank_mask:0xf
    v_mov_b32 v42, v14
    s_nop 1
    v_permlane16_swap_b32 v14, v42
    v_add_f32 v14, v14, v42
    v_mov_b32 v42, v14
    s_nop 1
    v_permlane32_swap_b32 v14, v42
    v_add_f32 v14, v14, v42
    v_mul_f32 v14, 0xbb000000, v14
    v_pk_add_f32 v[32:33], v[32:33], v[14:15] op_sel_hi:[1,0]
    v_pk_add_f32 v[34:35], v[34:35], v[14:15] op_sel_hi:[1,0]
    v_pk_add_f32 v[36:37], v[36:37], v[14:15] op_sel_hi:[1,0]
    v_pk_add_f32 v[38:39], v[38:39], v[14:15] op_sel_hi:[1,0]
    v_pk_add_f32 v[48:49], v[48:49], v[14:15] op_sel_hi:[1,0]
    v_pk_add_f32 v[50:51], v[50:51], v[14:15] op_sel_hi:[1,0]
    v_pk_add_f32 v[52:53], v[52:53], v[14:15] op_sel_hi:[1,0]
    v_pk_add_f32 v[54:55], v[54:55], v[14:15] op_sel_hi:[1,0]
    v_pk_mul_f32 v[40:41], v[32:33], v[32:33]
    v_pk_fma_f32 v[40:41], v[34:35], v[34:35], v[40:41]
    v_pk_fma_f32 v[40:41], v[36:37], v[36:37], v[40:41]
    v_pk_fma_f32 v[40:41], v[38:39], v[38:39], v[40:41]
    v_pk_fma_f32 v[40:41], v[48:49], v[48:49], v[40:41]
    v_pk_fma_f32 v[40:41], v[50:51], v[50:51], v[40:41]
    v_pk_fma_f32 v[40:41], v[52:53], v[52:53], v[40:41]
    v_pk_fma_f32 v[40:41], v[54:55], v[54:55], v[40:41]
    v_add_f32 v15, v40, v41
    s_nop 1
    v_add_f32_dpp v15, v15, v15 quad_perm:[1,0,3,2] row_mask:0xf bank_mask:0xf
    s_nop 1
    v_add_f32_dpp v15, v15, v15 quad_perm:[2,3,0,1] row_mask:0xf bank_mask:0xf
    s_nop 1
    v_add_f32_dpp v15, v15, v15 row_ror:8 row_mask:0xf bank_mask:0xf
    v_mov_b32 v42, v15
    s_nop 1
    v_permlane16_swap_b32 v15, v42
    v_add_f32 v15, v15, v42
    v_mov_b32 v42, v15
    s_nop 1
    v_permlane32_swap_b32 v15, v42
    v_add_f32 v15, v15, v42
    v_mov_b32 v40, 0x3727c5ac
    v_fmac_f32 v40, 0x3b000000, v15
    v_rsq_f32 v14, v40
    s_nop 0
    v_pk_mul_f32 v[32:33], v[32:33], v[14:15] op_sel_hi:[1,0]
    v_pk_mul_f32 v[34:35], v[34:35], v[14:15] op_sel_hi:[1,0]
    v_pk_mul_f32 v[36:37], v[36:37], v[14:15] op_sel_hi:[1,0]
    v_pk_mul_f32 v[38:39], v[38:39], v[14:15] op_sel_hi:[1,0]
    v_pk_mul_f32 v[48:49], v[48:49], v[14:15] op_sel_hi:[1,0]
    v_pk_mul_f32 v[50:51], v[50:51], v[14:15] op_sel_hi:[1,0]
    v_pk_mul_f32 v[52:53], v[52:53], v[14:15] op_sel_hi:[1,0]
    v_pk_mul_f32 v[54:55], v[54:55], v[14:15] op_sel_hi:[1,0]
    v_cvt_pk_bf16_f32 v24, v32, v33
    v_cvt_pk_bf16_f32 v25, v34, v35
    v_cvt_pk_bf16_f32 v26, v36, v37
    v_cvt_pk_bf16_f32 v27, v38, v39
    v_cvt_pk_bf16_f32 v28, v48, v49
    v_cvt_pk_bf16_f32 v29, v50, v51
    v_cvt_pk_bf16_f32 v30, v52, v53
    v_cvt_pk_bf16_f32 v31, v54, v55
    buffer_store_dwordx2 v[24:25], v12, s[8:11], s25 offen offset:0 sc1
    buffer_store_dwordx2 v[26:27], v12, s[8:11], s25 offen offset:256 sc1
    buffer_store_dwordx2 v[28:29], v12, s[8:11], s25 offen offset:512 sc1
    buffer_store_dwordx2 v[30:31], v12, s[8:11], s25 offen offset:768 sc1
L_fy_77:
    s_cmp_lg_u32 s54, 0
    s_cbranch_scc1 L_fn_78
    s_waitcnt vmcnt(4)
    v_cmp_eq_u32 vcc, 0, v0
    s_nop 0
    s_cbranch_vccnz L_fn_78
    s_lshl_b32 s62, s55, 16
    s_lshl_b32 s63, s20, 14
    s_add_u32 s62, s62, s63
    s_add_u32 s62, s62, 29360128
    s_add_u32 m0, s63, 0
    v_xor_b32 v14, 0, v1
    buffer_load_dwordx4 v14, s[8:11], s62 offen offset:0 lds
    v_xor_b32 v15, 16, v1
    buffer_load_dwordx4 v15, s[8:11], s62 offen offset:1024 lds
    v_xor_b32 v14, 32, v1
    buffer_load_dwordx4 v14, s[8:11], s62 offen offset:2048 lds
    v_xor_b32 v15, 48, v1
    buffer_load_dwordx4 v15, s[8:11], s62 offen offset:3072 lds
    s_add_u32 s62, s62, 4096
    s_add_u32 m0, s63, 4096
    v_xor_b32 v14, 64, v1
    buffer_load_dwordx4 v14, s[8:11], s62 offen offset:0 lds
    v_xor_b32 v15, 80, v1
    buffer_load_dwordx4 v15, s[8:11], s62 offen offset:1024 lds
    v_xor_b32 v14, 96, v1
    buffer_load_dwordx4 v14, s[8:11], s62 offen offset:2048 lds
    v_xor_b32 v15, 112, v1
    buffer_load_dwordx4 v15, s[8:11], s62 offen offset:3072 lds
    s_add_u32 s62, s62, 4096
    s_add_u32 m0, s63, 8192
    v_xor_b32 v14, 128, v1
    buffer_load_dwordx4 v14, s[8:11], s62 offen offset:0 lds
    v_xor_b32 v15, 144, v1
    buffer_load_dwordx4 v15, s[8:11], s62 offen offset:1024 lds
    v_xor_b32 v14, 160, v1
    buffer_load_dwordx4 v14, s[8:11], s62 offen offset:2048 lds
    v_xor_b32 v15, 176, v1
    buffer_load_dwordx4 v15, s[8:11], s62 offen offset:3072 lds
    s_add_u32 s62, s62, 4096
    s_add_u32 m0, s63, 12288
    v_xor_b32 v14, 192, v1
    buffer_load_dwordx4 v14, s[8:11], s62 offen offset:0 lds
    v_xor_b32 v15, 208, v1
    buffer_load_dwordx4 v15, s[8:11], s62 offen offset:1024 lds
    v_xor_b32 v14, 224, v1
    buffer_load_dwordx4 v14, s[8:11], s62 offen offset:2048 lds
    v_xor_b32 v15, 240, v1
    buffer_load_dwordx4 v15, s[8:11], s62 offen offset:3072 lds
    s_mov_b32 s54, 1
    s_waitcnt vmcnt(16)
    s_branch L_fs_79
L_fn_78:
    s_waitcnt vmcnt(0)
L_fs_79:
    s_lshl_b32 s26, s24, 7
    s_lshr_b32 s35, s52, 12
    s_add_u32 s26, s26, s35
    s_add_u32 s26, s26, 35885824
    s_waitcnt vmcnt(63)
    buffer_store_dword v3, v2, s[8:11], s26 offen sc1
    s_cmp_ge_u32 s24, 60
    s_cbranch_scc1 M_done
    s_mov_b32 s24, s55
    s_lshr_b32 s23, s24, 5
    s_add_u32 s33, s33, 1
    s_branch F_loopL
M_done:
M_exit:
    s_waitcnt vmcnt(0)
    s_endpgm
.section .rodata,"a"
.p2align 6
.amdhsa_kernel interleave_layers__memory_aug_recurrent_mem_tr__dense_activation_silu__prompt_kernel
  .amdhsa_next_free_vgpr 512
  .amdhsa_next_free_sgpr 100
  .amdhsa_accum_offset 256
  .amdhsa_group_segment_fixed_size 0
  .amdhsa_kernarg_size 104
  .amdhsa_user_sgpr_count 2
  .amdhsa_user_sgpr_kernarg_segment_ptr 1
  .amdhsa_system_sgpr_workgroup_id_x 1
.end_amdhsa_kernel
```
